```python
import torch

def _softmax(x, axis=-1):
    return torch.softmax(x, dim=axis)
def _gelu(x):
    return torch.nn.functional.gelu(x, approximate="tanh")
def _silu(x):
    return torch.nn.functional.silu(x)
def _sigmoid(x):
    return torch.sigmoid(x)
def _layernorm(x, axis=-1, eps=1e-5):
    m = x.mean(dim=axis, keepdim=True)
    v = x.var(dim=axis, keepdim=True, unbiased=False)
    return (x - m) / torch.sqrt(v + eps)
def _scatter_add(tgt, idx, src, axis=0):
    return tgt.clone().index_add_(axis, idx, src)
def _segment_sum(src, seg, n):
    out = torch.zeros((n,) + src.shape[1:], dtype=src.dtype)
    return out.index_add_(0, seg, src)
def _pad(x, pw):
    flat = tuple(v for pair in reversed(pw) for v in pair)
    return torch.nn.functional.pad(x, flat)

kernel_name = 'parallel_sum__compressed_kv_cla__glu_gated_swiglu__prompt'

def setup_inputs():

    _w = (lambda a: (lambda t: t.to(torch.bfloat16) if t.is_floating_point() else t)(torch.as_tensor(a)))
    def _A_setup():
        B, H, Sq, Sk, D, M = 1, 32, 2048, 2048, 128, 512
        Dc = 4 * D
        return {
            "x": _w((lambda *s: torch.randn(*s, dtype=torch.bfloat16) * 0.05)(B, Sq, M)),
            "c_kv": _w((lambda *s: torch.randn(*s, dtype=torch.bfloat16) * 0.4)(B, Sk, Dc)),
            "w_q": _w((lambda *s: torch.randn(*s, dtype=torch.bfloat16) * 1.6)(M, H, D) * (M ** -0.5)),
            "w_uk": _w((lambda *s: torch.randn(*s, dtype=torch.bfloat16) * 1.6)(Dc, H, D) * (Dc ** -0.5)),
            "w_uv": _w((lambda *s: torch.randn(*s, dtype=torch.bfloat16) * 0.4)(Dc, H, D) * (Dc ** -0.5)),
            "w_o": _w((lambda *s: torch.randn(*s, dtype=torch.bfloat16) * 0.4)(H, D, M) * ((H * D) ** -0.5)),
        }
    _A_in = _A_setup()

    def _B_setup():
        B, S, D, F = 1, 2048, 512, 1376
        return {
            "x": _w((lambda *s: torch.randn(*s, dtype=torch.bfloat16) * 0.05)(B, S, D)),
            "w1": _w((lambda *s: torch.randn(*s, dtype=torch.bfloat16) * 0.2)(D, F) * (2.0 / D) ** 0.5),
            "w3": _w((lambda *s: torch.randn(*s, dtype=torch.bfloat16) * 0.2)(D, F) * (2.0 / D) ** 0.5),
            "w2": _w((lambda *s: torch.randn(*s, dtype=torch.bfloat16) * 0.2)(F, D) * (2.0 / F) ** 0.5),
        }
    _B_in = _B_setup()

    return {
        "A_x": _A_in["x"],
        "A_c_kv": _A_in["c_kv"],
        "A_w_q": _A_in["w_q"],
        "A_w_uk": _A_in["w_uk"],
        "A_w_uv": _A_in["w_uv"],
        "A_w_o": _A_in["w_o"],
        "B_x": _B_in["x"],
        "B_w1": _B_in["w1"],
        "B_w3": _B_in["w3"],
        "B_w2": _B_in["w2"],
    }

def reference(A_x, A_c_kv, A_w_q, A_w_uk, A_w_uv, A_w_o, B_x, B_w1, B_w3, B_w2):
    def _A_ref(x, c_kv, w_q, w_uk, w_uv, w_o):
        B, Sq, M = x.shape[0], x.shape[1], x.shape[2]
        Sk = c_kv.shape[1]
        H, D = w_q.shape[1], w_q.shape[2]
        q = torch.einsum("bqm,mhd->bhqd", x, w_q)
        k = torch.einsum("bkc,chd->bhkd", c_kv, w_uk)
        v = torch.einsum("bkc,chd->bhkd", c_kv, w_uv)
        scores = torch.einsum("bhqd,bhkd->bhqk", q, k) * (D ** -0.5)
        off = Sk - Sq
        qi = torch.arange(Sq)[:, None]
        kj = torch.arange(Sk)[None, :]
        cmask = kj <= (qi + off)
        scores = torch.where(cmask[None, None], scores, -1e9)
        p = _softmax(scores, axis=-1)
        ctx = torch.einsum("bhqk,bhkd->bhqd", p, v)
        return torch.einsum("bhqd,hdm->bqm", ctx, w_o)

    def _B_ref(x, w1, w3, w2):
        gate = torch.einsum("bsd,df->bsf", x, w1)
        up = torch.einsum("bsd,df->bsf", x, w3)
        h = _silu(gate) * up
        out = torch.einsum("bsf,fd->bsd", h, w2)
        return out

    x = A_x
    xn = _layernorm(x, axis=-1)
    return x + _A_ref(xn, A_c_kv, A_w_q, A_w_uk, A_w_uv, A_w_o) + _B_ref(xn, B_w1, B_w3, B_w2)
```

```asm
; @launch grid=(256,1,1) block=(256,1,1) lds=163840
.amdgcn_target "amdgcn-amd-amdhsa--gfx950"
.text
.globl parallel_sum__compressed_kv_cla__glu_gated_swiglu__prompt_kernel
.p2align 8
.type parallel_sum__compressed_kv_cla__glu_gated_swiglu__prompt_kernel,@function
parallel_sum__compressed_kv_cla__glu_gated_swiglu__prompt_kernel:
  s_cmp_ge_u32 s2, 256
  s_cbranch_scc1 L_end_kv_kernel
  s_load_dwordx4 s[4:7], s[0:1], 0
  s_load_dwordx4 s[8:11], s[0:1], 24
  s_load_dwordx2 s[12:13], s[0:1], 96
  s_load_dwordx2 s[100:101], s[0:1], 88
  v_and_b32 v224, 63, v0
  v_lshrrev_b32 v225, 6, v0
  v_lshlrev_b32 v252, 4, v224
  v_readfirstlane_b32 s46, v225
  s_and_b32 s44, s2, 7
  s_lshr_b32 s53, s2, 3
  s_and_b32 s53, s53, 3
  s_lshl_b32 s53, s53, 3
  s_add_u32 s44, s44, s53
  s_lshr_b32 s45, s2, 5
  s_lshl_b32 s54, s45, 8
  s_lshl_b32 s55, s46, 6
  s_add_u32 s54, s54, s55
  s_lshl_b32 s54, s54, 10
  v_lshrrev_b32 v226, 3, v224
  v_lshlrev_b32 v226, 10, v226
  v_add_u32 v226, s54, v226
  v_lshrrev_b32 v227, 4, v224
  v_and_b32 v228, 7, v224
  v_add_u32 v229, 0, v227
  v_xor_b32 v229, v229, v228
  v_lshlrev_b32 v229, 4, v229
  v_add_u32 v229, v229, v226
  v_add_u32 v236, 0, v229
  v_add_u32 v238, 14336, v229
  v_add_u32 v240, 32768, v229
  v_add_u32 v242, 47104, v229
  v_add_u32 v229, 4, v227
  v_xor_b32 v229, v229, v228
  v_lshlrev_b32 v229, 4, v229
  v_add_u32 v229, v229, v226
  v_add_u32 v237, 7168, v229
  v_add_u32 v239, 21504, v229
  v_add_u32 v241, 39936, v229
  v_add_u32 v243, 54272, v229
  s_lshl_b32 s54, s44, 8
  s_lshl_b32 s55, s46, 6
  s_add_u32 s54, s54, s55
  v_lshrrev_b32 v227, 5, v224
  v_lshlrev_b32 v227, 1, v227
  v_and_b32 v226, 3, v224
  v_xor_b32 v226, v226, v227
  v_lshlrev_b32 v226, 4, v226
  v_lshrrev_b32 v227, 2, v224
  v_lshlrev_b32 v227, 13, v227
  v_add_u32 v226, v226, v227
  v_add_u32 v244, s54, v226
  v_add_u32 v245, 130048, v244
  v_add_u32 v246, 260096, v244
  v_add_u32 v247, 390144, v244
  s_mul_i32 s56, s46, 24576
  s_waitcnt lgkmcnt(0)
  s_mov_b32 s16, s6
  s_mov_b32 s17, s7
  s_mov_b32 s18, 0x200000
  s_mov_b32 s19, 0x20000
  s_mov_b32 s20, s8
  s_mov_b32 s21, s9
  s_mov_b32 s22, 0x400000
  s_mov_b32 s23, 0x20000
  s_lshl_b32 s53, s2, 3
  s_lshl_b32 s54, s46, 1
  s_add_u32 s61, s53, s54
  s_mov_b32 s40, s4
  s_mov_b32 s41, s5
  s_mov_b32 s42, 0x200000
  s_mov_b32 s43, 0x20000
  s_lshl_b32 s54, s61, 10
  buffer_load_dwordx4 v[128:131], v252, s[40:43], s54 offen
  buffer_load_dwordx4 v[132:135], v252, s[40:43], s54 offen offset:1024
  s_mov_b32 s47, 0
  s_add_u32 m0, s56, 0
  s_nop 0
  buffer_load_dwordx4 v236, s[16:19], s47 offen offset:0 lds
  buffer_load_dwordx4 v237, s[16:19], s47 offen offset:1024 lds
  buffer_load_dwordx4 v238, s[16:19], s47 offen offset:2048 lds
  buffer_load_dwordx4 v239, s[16:19], s47 offen offset:3072 lds
  s_add_u32 m0, s56, 4096
  s_nop 0
  buffer_load_dwordx4 v240, s[16:19], s47 offen offset:0 lds
  buffer_load_dwordx4 v241, s[16:19], s47 offen offset:1024 lds
  buffer_load_dwordx4 v242, s[16:19], s47 offen offset:2048 lds
  buffer_load_dwordx4 v243, s[16:19], s47 offen offset:3072 lds
  s_mov_b32 s48, 0
  s_lshl_b32 s53, s46, 12
  s_add_u32 m0, s53, 98304
  s_nop 0
  buffer_load_dwordx4 v244, s[20:23], s48 offen offset:0 lds
  buffer_load_dwordx4 v245, s[20:23], s48 offen offset:1024 lds
  buffer_load_dwordx4 v246, s[20:23], s48 offen offset:2048 lds
  buffer_load_dwordx4 v247, s[20:23], s48 offen offset:3072 lds
  s_mov_b32 s24, s10
  s_mov_b32 s25, s11
  s_mov_b32 s26, 0x400000
  s_mov_b32 s27, 0x20000
  s_lshl_b32 s53, s2, 13
  s_lshl_b32 s54, s46, 11
  s_add_u32 s53, s53, s54
  buffer_load_dwordx4 v[188:191], v252, s[16:19], s53 offen offset:0
  buffer_load_dwordx4 v[188:191], v252, s[16:19], s53 offen offset:1024
  s_lshl_b32 s53, s2, 14
  s_lshl_b32 s54, s46, 12
  s_add_u32 s53, s53, s54
  buffer_load_dwordx4 v[188:191], v252, s[20:23], s53 offen offset:0
  buffer_load_dwordx4 v[188:191], v252, s[20:23], s53 offen offset:1024
  buffer_load_dwordx4 v[188:191], v252, s[20:23], s53 offen offset:2048
  buffer_load_dwordx4 v[188:191], v252, s[20:23], s53 offen offset:3072
  s_getpc_b64 s[58:59]
  v_lshlrev_b32 v253, 3, v252
  s_mul_i32 s60, s46, 16384
  v_add_u32 v253, s60, v253
  global_load_dword v188, v253, s[58:59]
  v_add_u32 v253, 8192, v253
  global_load_dword v188, v253, s[58:59]
  s_add_u32 s28, s12, 0x200000
  s_addc_u32 s29, s13, 0
  s_mov_b32 s30, 0x1000000
  s_mov_b32 s31, 0x20000
  s_add_u32 s32, s12, 0x1200000
  s_addc_u32 s33, s13, 0
  s_mov_b32 s34, 0x1000000
  s_mov_b32 s35, 0x20000
  s_add_u32 s36, s12, 0x0
  s_addc_u32 s37, s13, 0
  s_mov_b32 s38, 0x200000
  s_mov_b32 s39, 0x20000
  s_mov_b32 s24, s10
  s_mov_b32 s25, s11
  s_mov_b32 s26, 0x400000
  s_mov_b32 s27, 0x20000
  s_lshl_b32 s53, s45, 2
  s_add_u32 s53, s53, s46
  s_lshl_b32 s53, s53, 14
  s_lshl_b32 s54, s44, 19
  s_add_u32 s49, s53, s54
  s_add_u32 s50, s49, 4096
  s_add_u32 s51, s49, 8192
  s_add_u32 s52, s49, 12288
  s_mov_b32 s57, 0x3e0293ee
  s_and_b32 s60, s46, 1
  s_lshl_b32 s60, s60, 12
  v_and_b32 v226, 15, v224
  v_lshrrev_b32 v227, 1, v226
  v_lshrrev_b32 v228, 4, v224
  v_xor_b32 v227, v227, v228
  v_lshlrev_b32 v227, 4, v227
  v_lshlrev_b32 v226, 7, v226
  v_add3_u32 v248, v226, v227, s56
  v_xor_b32 v249, 64, v248
  v_and_b32 v226, 15, v224
  v_lshrrev_b32 v226, 2, v226
  v_lshlrev_b32 v227, 3, v228
  v_add_u32 v226, v226, v227
  v_lshlrev_b32 v226, 6, v226
  v_and_b32 v227, 1, v228
  v_lshlrev_b32 v227, 5, v227
  v_add_u32 v226, v226, v227
  v_and_b32 v227, 3, v224
  v_lshlrev_b32 v227, 3, v227
  v_add_u32 v226, v226, v227
  v_add_u32 v250, 98304, v226
  v_xor_b32 v251, 32, v250
  s_waitcnt vmcnt(21)
  v_lshlrev_b32 v136, 16, v128
  v_and_b32 v137, 0xffff0000, v128
  v_lshlrev_b32 v138, 16, v129
  v_and_b32 v139, 0xffff0000, v129
  v_lshlrev_b32 v140, 16, v130
  v_and_b32 v141, 0xffff0000, v130
  v_lshlrev_b32 v142, 16, v131
  v_and_b32 v143, 0xffff0000, v131
  s_waitcnt vmcnt(20)
  v_lshlrev_b32 v144, 16, v132
  v_and_b32 v145, 0xffff0000, v132
  v_lshlrev_b32 v146, 16, v133
  v_and_b32 v147, 0xffff0000, v133
  v_lshlrev_b32 v148, 16, v134
  v_and_b32 v149, 0xffff0000, v134
  v_lshlrev_b32 v150, 16, v135
  v_and_b32 v151, 0xffff0000, v135
  v_add_f32 v152, v136, v137
  v_add_f32 v152, v152, v138
  v_add_f32 v152, v152, v139
  v_add_f32 v152, v152, v140
  v_add_f32 v152, v152, v141
  v_add_f32 v152, v152, v142
  v_add_f32 v152, v152, v143
  v_add_f32 v154, v144, v145
  v_add_f32 v154, v154, v146
  v_add_f32 v154, v154, v147
  v_add_f32 v154, v154, v148
  v_add_f32 v154, v154, v149
  v_add_f32 v154, v154, v150
  v_add_f32 v154, v154, v151
  v_add_f32_dpp v152, v152, v152 row_ror:8 row_mask:0xf bank_mask:0xf
  s_nop 0
  v_add_f32_dpp v154, v154, v154 row_ror:8 row_mask:0xf bank_mask:0xf
  v_add_f32_dpp v152, v152, v152 row_ror:4 row_mask:0xf bank_mask:0xf
  s_nop 0
  v_add_f32_dpp v154, v154, v154 row_ror:4 row_mask:0xf bank_mask:0xf
  v_add_f32_dpp v152, v152, v152 row_ror:2 row_mask:0xf bank_mask:0xf
  s_nop 0
  v_add_f32_dpp v154, v154, v154 row_ror:2 row_mask:0xf bank_mask:0xf
  v_add_f32_dpp v152, v152, v152 row_ror:1 row_mask:0xf bank_mask:0xf
  s_nop 0
  v_add_f32_dpp v154, v154, v154 row_ror:1 row_mask:0xf bank_mask:0xf
  v_mov_b32 v153, v152
  v_mov_b32 v155, v154
  s_nop 0
  v_permlane16_swap_b32 v152, v153
  v_permlane16_swap_b32 v154, v155
  v_add_f32 v152, v152, v153
  v_add_f32 v154, v154, v155
  v_mov_b32 v153, v152
  v_mov_b32 v155, v154
  s_nop 0
  v_permlane32_swap_b32 v152, v153
  v_permlane32_swap_b32 v154, v155
  v_add_f32 v152, v152, v153
  v_add_f32 v154, v154, v155
  v_mul_f32 v156, 0x3b000000, v152
  v_mul_f32 v157, 0x3b000000, v154
  v_sub_f32 v160, v136, v156
  v_sub_f32 v161, v137, v156
  v_sub_f32 v162, v138, v156
  v_sub_f32 v163, v139, v156
  v_sub_f32 v164, v140, v156
  v_sub_f32 v165, v141, v156
  v_sub_f32 v166, v142, v156
  v_sub_f32 v167, v143, v156
  v_sub_f32 v168, v144, v157
  v_sub_f32 v169, v145, v157
  v_sub_f32 v170, v146, v157
  v_sub_f32 v171, v147, v157
  v_sub_f32 v172, v148, v157
  v_sub_f32 v173, v149, v157
  v_sub_f32 v174, v150, v157
  v_sub_f32 v175, v151, v157
  v_mul_f32 v152, v160, v160
  v_fmac_f32 v152, v161, v161
  v_fmac_f32 v152, v162, v162
  v_fmac_f32 v152, v163, v163
  v_fmac_f32 v152, v164, v164
  v_fmac_f32 v152, v165, v165
  v_fmac_f32 v152, v166, v166
  v_fmac_f32 v152, v167, v167
  v_mul_f32 v154, v168, v168
  v_fmac_f32 v154, v169, v169
  v_fmac_f32 v154, v170, v170
  v_fmac_f32 v154, v171, v171
  v_fmac_f32 v154, v172, v172
  v_fmac_f32 v154, v173, v173
  v_fmac_f32 v154, v174, v174
  v_fmac_f32 v154, v175, v175
  v_add_f32_dpp v152, v152, v152 row_ror:8 row_mask:0xf bank_mask:0xf
  s_nop 0
  v_add_f32_dpp v154, v154, v154 row_ror:8 row_mask:0xf bank_mask:0xf
  v_add_f32_dpp v152, v152, v152 row_ror:4 row_mask:0xf bank_mask:0xf
  s_nop 0
  v_add_f32_dpp v154, v154, v154 row_ror:4 row_mask:0xf bank_mask:0xf
  v_add_f32_dpp v152, v152, v152 row_ror:2 row_mask:0xf bank_mask:0xf
  s_nop 0
  v_add_f32_dpp v154, v154, v154 row_ror:2 row_mask:0xf bank_mask:0xf
  v_add_f32_dpp v152, v152, v152 row_ror:1 row_mask:0xf bank_mask:0xf
  s_nop 0
  v_add_f32_dpp v154, v154, v154 row_ror:1 row_mask:0xf bank_mask:0xf
  v_mov_b32 v153, v152
  v_mov_b32 v155, v154
  s_nop 0
  v_permlane16_swap_b32 v152, v153
  v_permlane16_swap_b32 v154, v155
  v_add_f32 v152, v152, v153
  v_add_f32 v154, v154, v155
  v_mov_b32 v153, v152
  v_mov_b32 v155, v154
  s_nop 0
  v_permlane32_swap_b32 v152, v153
  v_permlane32_swap_b32 v154, v155
  v_add_f32 v152, v152, v153
  v_add_f32 v154, v154, v155
  v_mul_f32 v152, 0x3b000000, v152
  v_cvt_pk_bf16_f32 v152, v152, v156
  v_mul_f32 v154, 0x3b000000, v154
  v_cvt_pk_bf16_f32 v154, v154, v157
  v_and_b32 v156, 0xffff0000, v152
  v_lshlrev_b32 v152, 16, v152
  v_add_f32 v152, 0x3727c5ac, v152
  v_cvt_pk_bf16_f32 v152, v152, v152
  v_lshlrev_b32 v152, 16, v152
  v_sqrt_f32 v152, v152
  v_and_b32 v157, 0xffff0000, v154
  v_lshlrev_b32 v154, 16, v154
  v_add_f32 v154, 0x3727c5ac, v154
  v_cvt_pk_bf16_f32 v154, v154, v154
  v_lshlrev_b32 v154, 16, v154
  v_sqrt_f32 v154, v154
  v_cvt_pk_bf16_f32 v152, v152, v152
  v_lshlrev_b32 v152, 16, v152
  v_rcp_f32 v152, v152
  v_cvt_pk_bf16_f32 v154, v154, v154
  v_lshlrev_b32 v154, 16, v154
  v_rcp_f32 v154, v154
  v_sub_f32 v160, v136, v156
  v_sub_f32 v161, v137, v156
  v_sub_f32 v162, v138, v156
  v_sub_f32 v163, v139, v156
  v_sub_f32 v164, v140, v156
  v_sub_f32 v165, v141, v156
  v_sub_f32 v166, v142, v156
  v_sub_f32 v167, v143, v156
  v_cvt_pk_bf16_f32 v136, v160, v161
  v_cvt_pk_bf16_f32 v137, v162, v163
  v_cvt_pk_bf16_f32 v138, v164, v165
  v_cvt_pk_bf16_f32 v139, v166, v167
  v_lshlrev_b32 v160, 16, v136
  v_and_b32 v161, 0xffff0000, v136
  v_lshlrev_b32 v162, 16, v137
  v_and_b32 v163, 0xffff0000, v137
  v_lshlrev_b32 v164, 16, v138
  v_and_b32 v165, 0xffff0000, v138
  v_lshlrev_b32 v166, 16, v139
  v_and_b32 v167, 0xffff0000, v139
  v_mul_f32 v160, v160, v152
  v_mul_f32 v161, v161, v152
  v_mul_f32 v162, v162, v152
  v_mul_f32 v163, v163, v152
  v_mul_f32 v164, v164, v152
  v_mul_f32 v165, v165, v152
  v_mul_f32 v166, v166, v152
  v_mul_f32 v167, v167, v152
  v_cvt_pk_bf16_f32 v176, v160, v161
  v_cvt_pk_bf16_f32 v177, v162, v163
  v_cvt_pk_bf16_f32 v178, v164, v165
  v_cvt_pk_bf16_f32 v179, v166, v167
  v_sub_f32 v168, v144, v157
  v_sub_f32 v169, v145, v157
  v_sub_f32 v170, v146, v157
  v_sub_f32 v171, v147, v157
  v_sub_f32 v172, v148, v157
  v_sub_f32 v173, v149, v157
  v_sub_f32 v174, v150, v157
  v_sub_f32 v175, v151, v157
  v_cvt_pk_bf16_f32 v144, v168, v169
  v_cvt_pk_bf16_f32 v145, v170, v171
  v_cvt_pk_bf16_f32 v146, v172, v173
  v_cvt_pk_bf16_f32 v147, v174, v175
  v_lshlrev_b32 v168, 16, v144
  v_and_b32 v169, 0xffff0000, v144
  v_lshlrev_b32 v170, 16, v145
  v_and_b32 v171, 0xffff0000, v145
  v_lshlrev_b32 v172, 16, v146
  v_and_b32 v173, 0xffff0000, v146
  v_lshlrev_b32 v174, 16, v147
  v_and_b32 v175, 0xffff0000, v147
  v_mul_f32 v168, v168, v154
  v_mul_f32 v169, v169, v154
  v_mul_f32 v170, v170, v154
  v_mul_f32 v171, v171, v154
  v_mul_f32 v172, v172, v154
  v_mul_f32 v173, v173, v154
  v_mul_f32 v174, v174, v154
  v_mul_f32 v175, v175, v154
  v_cvt_pk_bf16_f32 v180, v168, v169
  v_cvt_pk_bf16_f32 v181, v170, v171
  v_cvt_pk_bf16_f32 v182, v172, v173
  v_cvt_pk_bf16_f32 v183, v174, v175
  s_lshl_b32 s54, s46, 11
  s_add_u32 s54, s54, 16384
  v_add_u32 v184, s54, v252
  ds_write_b128 v184, v[176:179]
  ds_write_b128 v184, v[180:183] offset:1024
  s_waitcnt lgkmcnt(0)
  s_barrier
  v_lshrrev_b32 v184, 7, v252
  v_and_b32 v185, 0x70, v252
  v_lshlrev_b32 v186, 6, v185
  v_lshlrev_b32 v187, 4, v184
  v_add_u32 v186, v186, v187
  s_lshl_b32 s54, s46, 8
  s_add_u32 s54, s54, 16384
  v_add_u32 v186, s54, v186
  ds_read_b128 v[176:179], v186
  ds_read_b128 v[180:183], v186 offset:128
  v_lshrrev_b32 v187, 2, v184
  v_lshlrev_b32 v187, 10, v187
  v_and_b32 v184, 3, v184
  v_lshlrev_b32 v184, 8, v184
  v_add3_u32 v184, v184, v187, v185
  s_lshl_b32 s54, s2, 3
  s_lshr_b32 s55, s54, 4
  s_lshl_b32 s55, s55, 12
  s_and_b32 s54, s54, 8
  s_lshl_b32 s54, s54, 4
  s_add_u32 s55, s55, s54
  s_lshl_b32 s54, s46, 19
  s_add_u32 s61, s55, s54
  s_waitcnt lgkmcnt(1)
  buffer_store_dwordx4 v[176:179], v184, s[36:39], s61 offen sc1
  s_waitcnt lgkmcnt(0)
  buffer_store_dwordx4 v[180:183], v184, s[36:39], s61 offen offset:2048 sc1
  s_waitcnt lgkmcnt(0)
  s_barrier
  s_add_u32 s40, s12, 0x4000000
  s_addc_u32 s41, s13, 0
  s_mov_b32 s42, 0x2800
  s_mov_b32 s43, 0x20000
  v_mov_b32 v128, 0
  v_mov_b32 v129, 0
  v_mov_b32 v130, 0
  v_mov_b32 v131, 0
  s_lshl_b32 s53, s2, 7
  v_and_b32 v132, 0x70, v252
  buffer_store_dwordx4 v[128:131], v132, s[40:43], s53 offen sc1
  s_mov_b32 s47, 128
  s_add_u32 m0, s56, 8192
  s_nop 0
  buffer_load_dwordx4 v236, s[16:19], s47 offen offset:0 lds
  buffer_load_dwordx4 v237, s[16:19], s47 offen offset:1024 lds
  buffer_load_dwordx4 v238, s[16:19], s47 offen offset:2048 lds
  buffer_load_dwordx4 v239, s[16:19], s47 offen offset:3072 lds
  s_add_u32 m0, s56, 12288
  s_nop 0
  buffer_load_dwordx4 v240, s[16:19], s47 offen offset:0 lds
  buffer_load_dwordx4 v241, s[16:19], s47 offen offset:1024 lds
  buffer_load_dwordx4 v242, s[16:19], s47 offen offset:2048 lds
  buffer_load_dwordx4 v243, s[16:19], s47 offen offset:3072 lds
  s_mov_b32 s48, 524288
  s_lshl_b32 s53, s46, 12
  s_add_u32 m0, s53, 114688
  s_nop 0
  buffer_load_dwordx4 v244, s[20:23], s48 offen offset:0 lds
  buffer_load_dwordx4 v245, s[20:23], s48 offen offset:1024 lds
  buffer_load_dwordx4 v246, s[20:23], s48 offen offset:2048 lds
  buffer_load_dwordx4 v247, s[20:23], s48 offen offset:3072 lds
  s_mov_b32 s42, s46
L_main_kv_kernel:
  s_waitcnt vmcnt(27)
  ds_read_b128 a[0:3], v248 offset:0
  ds_read_b128 a[64:67], v248 offset:2048
  ds_read_b128 a[128:131], v248 offset:4096
  ds_read_b128 a[192:195], v248 offset:6144
  ds_read_b128 a[4:7], v249 offset:0
  ds_read_b128 a[68:71], v249 offset:2048
  ds_read_b128 a[132:135], v249 offset:4096
  ds_read_b128 a[196:199], v249 offset:6144
  s_waitcnt vmcnt(23)
  s_barrier
  ds_read_b64_tr_b16 v[192:193], v250 offset:0
  ds_read_b64_tr_b16 v[194:195], v250 offset:256
  ds_read_b64_tr_b16 v[196:197], v250 offset:2048
  ds_read_b64_tr_b16 v[198:199], v250 offset:2304
  ds_read_b64_tr_b16 v[200:201], v251 offset:0
  ds_read_b64_tr_b16 v[202:203], v251 offset:256
  ds_read_b64_tr_b16 v[204:205], v251 offset:2048
  ds_read_b64_tr_b16 v[206:207], v251 offset:2304
  s_waitcnt lgkmcnt(4)
  v_mfma_f32_16x16x32_bf16 v[0:3], v[192:195], a[0:3], 0
  ds_read_b64_tr_b16 v[208:209], v250 offset:4096
  v_mfma_f32_16x16x32_bf16 v[0:3], v[196:199], a[4:7], v[0:3]
  s_waitcnt vmcnt(4)
  s_mov_b32 s47, 256
  s_add_u32 m0, s56, 16384
  s_nop 0
  buffer_load_dwordx4 v236, s[16:19], s47 offen offset:0 lds
  v_mfma_f32_16x16x32_bf16 v[4:7], v[192:195], a[64:67], 0
  ds_read_b64_tr_b16 v[210:211], v250 offset:4352
  v_mfma_f32_16x16x32_bf16 v[4:7], v[196:199], a[68:71], v[4:7]
  ds_read_b128 a[8:11], v248 offset:8192
  buffer_load_dwordx4 v237, s[16:19], s47 offen offset:1024 lds
  v_mfma_f32_16x16x32_bf16 v[8:11], v[192:195], a[128:131], 0
  ds_read_b64_tr_b16 v[212:213], v250 offset:6144
  v_mfma_f32_16x16x32_bf16 v[8:11], v[196:199], a[132:135], v[8:11]
  ds_read_b128 a[72:75], v248 offset:10240
  v_mfma_f32_16x16x32_bf16 v[12:15], v[192:195], a[192:195], 0
  ds_read_b64_tr_b16 v[214:215], v250 offset:6400
  buffer_load_dwordx4 v238, s[16:19], s47 offen offset:2048 lds
  v_mfma_f32_16x16x32_bf16 v[12:15], v[196:199], a[196:199], v[12:15]
  s_waitcnt lgkmcnt(6)
  ds_read_b128 a[136:139], v248 offset:12288
  v_mfma_f32_16x16x32_bf16 v[16:19], v[200:203], a[0:3], 0
  ds_read_b64_tr_b16 v[216:217], v251 offset:4096
  v_mfma_f32_16x16x32_bf16 v[16:19], v[204:207], a[4:7], v[16:19]
  ds_read_b128 a[200:203], v248 offset:14336
  buffer_load_dwordx4 v239, s[16:19], s47 offen offset:3072 lds
  v_mfma_f32_16x16x32_bf16 v[20:23], v[200:203], a[64:67], 0
  ds_read_b64_tr_b16 v[218:219], v251 offset:4352
  v_mfma_f32_16x16x32_bf16 v[20:23], v[204:207], a[68:71], v[20:23]
  s_add_u32 m0, s56, 20480
  ds_read_b128 a[12:15], v249 offset:8192
  v_mfma_f32_16x16x32_bf16 v[24:27], v[200:203], a[128:131], 0
  ds_read_b64_tr_b16 v[220:221], v251 offset:6144
  buffer_load_dwordx4 v240, s[16:19], s47 offen offset:0 lds
  v_mfma_f32_16x16x32_bf16 v[24:27], v[204:207], a[132:135], v[24:27]
  ds_read_b128 a[76:79], v249 offset:10240
  v_mfma_f32_16x16x32_bf16 v[28:31], v[200:203], a[192:195], 0
  ds_read_b64_tr_b16 v[222:223], v251 offset:6400
  v_mfma_f32_16x16x32_bf16 v[28:31], v[204:207], a[196:199], v[28:31]
  s_waitcnt lgkmcnt(8)
  ds_read_b128 a[140:143], v249 offset:12288
  buffer_load_dwordx4 v241, s[16:19], s47 offen offset:1024 lds
  v_mfma_f32_16x16x32_bf16 v[32:35], v[208:211], a[0:3], 0
  ds_read_b64_tr_b16 v[192:193], v250 offset:8192
  v_mfma_f32_16x16x32_bf16 v[32:35], v[212:215], a[4:7], v[32:35]
  ds_read_b128 a[204:207], v249 offset:14336
  v_mfma_f32_16x16x32_bf16 v[36:39], v[208:211], a[64:67], 0
  ds_read_b64_tr_b16 v[194:195], v250 offset:8448
  buffer_load_dwordx4 v242, s[16:19], s47 offen offset:2048 lds
  v_mfma_f32_16x16x32_bf16 v[36:39], v[212:215], a[68:71], v[36:39]
  v_mfma_f32_16x16x32_bf16 v[40:43], v[208:211], a[128:131], 0
  ds_read_b64_tr_b16 v[196:197], v250 offset:10240
  v_mfma_f32_16x16x32_bf16 v[40:43], v[212:215], a[132:135], v[40:43]
  s_mov_b32 s48, 1048576
  buffer_load_dwordx4 v243, s[16:19], s47 offen offset:3072 lds
  v_mfma_f32_16x16x32_bf16 v[44:47], v[208:211], a[192:195], 0
  s_lshl_b32 s53, s46, 12
  ds_read_b64_tr_b16 v[198:199], v250 offset:10496
  v_mfma_f32_16x16x32_bf16 v[44:47], v[212:215], a[196:199], v[44:47]
  s_add_u32 m0, s53, 131072
  s_waitcnt lgkmcnt(6)
  v_mfma_f32_16x16x32_bf16 v[48:51], v[216:219], a[0:3], 0
  ds_read_b64_tr_b16 v[200:201], v251 offset:8192
  buffer_load_dwordx4 v244, s[20:23], s48 offen offset:0 lds
  v_mfma_f32_16x16x32_bf16 v[48:51], v[220:223], a[4:7], v[48:51]
  v_mfma_f32_16x16x32_bf16 v[52:55], v[216:219], a[64:67], 0
  ds_read_b64_tr_b16 v[202:203], v251 offset:8448
  v_mfma_f32_16x16x32_bf16 v[52:55], v[220:223], a[68:71], v[52:55]
  buffer_load_dwordx4 v245, s[20:23], s48 offen offset:1024 lds
  v_mfma_f32_16x16x32_bf16 v[56:59], v[216:219], a[128:131], 0
  ds_read_b64_tr_b16 v[204:205], v251 offset:10240
  v_mfma_f32_16x16x32_bf16 v[56:59], v[220:223], a[132:135], v[56:59]
  v_mfma_f32_16x16x32_bf16 v[60:63], v[216:219], a[192:195], 0
  ds_read_b64_tr_b16 v[206:207], v251 offset:10496
  buffer_load_dwordx4 v246, s[20:23], s48 offen offset:2048 lds
  v_mfma_f32_16x16x32_bf16 v[60:63], v[220:223], a[196:199], v[60:63]
  s_waitcnt lgkmcnt(4)
  v_mfma_f32_16x16x32_bf16 v[64:67], v[192:195], a[0:3], 0
  ds_read_b64_tr_b16 v[208:209], v250 offset:12288
  v_mfma_f32_16x16x32_bf16 v[64:67], v[196:199], a[4:7], v[64:67]
  buffer_load_dwordx4 v247, s[20:23], s48 offen offset:3072 lds
  v_mfma_f32_16x16x32_bf16 v[68:71], v[192:195], a[64:67], 0
  s_mov_b32 s47, 384
  ds_read_b64_tr_b16 v[210:211], v250 offset:12544
  v_mfma_f32_16x16x32_bf16 v[68:71], v[196:199], a[68:71], v[68:71]
  s_add_u32 m0, s56, 0
  v_mfma_f32_16x16x32_bf16 v[72:75], v[192:195], a[128:131], 0
  ds_read_b64_tr_b16 v[212:213], v250 offset:14336
  buffer_load_dwordx4 v236, s[16:19], s47 offen offset:0 lds
  v_mfma_f32_16x16x32_bf16 v[72:75], v[196:199], a[132:135], v[72:75]
  v_mfma_f32_16x16x32_bf16 v[76:79], v[192:195], a[192:195], 0
  ds_read_b64_tr_b16 v[214:215], v250 offset:14592
  v_mfma_f32_16x16x32_bf16 v[76:79], v[196:199], a[196:199], v[76:79]
  s_waitcnt lgkmcnt(4)
  buffer_load_dwordx4 v237, s[16:19], s47 offen offset:1024 lds
  v_mfma_f32_16x16x32_bf16 v[80:83], v[200:203], a[0:3], 0
  ds_read_b64_tr_b16 v[216:217], v251 offset:12288
  v_mfma_f32_16x16x32_bf16 v[80:83], v[204:207], a[4:7], v[80:83]
  v_mfma_f32_16x16x32_bf16 v[84:87], v[200:203], a[64:67], 0
  ds_read_b64_tr_b16 v[218:219], v251 offset:12544
  buffer_load_dwordx4 v238, s[16:19], s47 offen offset:2048 lds
  v_mfma_f32_16x16x32_bf16 v[84:87], v[204:207], a[68:71], v[84:87]
  v_mfma_f32_16x16x32_bf16 v[88:91], v[200:203], a[128:131], 0
  ds_read_b64_tr_b16 v[220:221], v251 offset:14336
  v_mfma_f32_16x16x32_bf16 v[88:91], v[204:207], a[132:135], v[88:91]
  buffer_load_dwordx4 v239, s[16:19], s47 offen offset:3072 lds
  v_mfma_f32_16x16x32_bf16 v[92:95], v[200:203], a[192:195], 0
  ds_read_b64_tr_b16 v[222:223], v251 offset:14592
  v_mfma_f32_16x16x32_bf16 v[92:95], v[204:207], a[196:199], v[92:95]
  s_waitcnt vmcnt(16)
  s_barrier
  s_add_u32 m0, s56, 4096
  s_waitcnt lgkmcnt(4)
  v_mfma_f32_16x16x32_bf16 v[96:99], v[208:211], a[0:3], 0
  ds_read_b64_tr_b16 v[192:193], v250 offset:16384
  buffer_load_dwordx4 v240, s[16:19], s47 offen offset:0 lds
  v_mfma_f32_16x16x32_bf16 v[96:99], v[212:215], a[4:7], v[96:99]
  v_mfma_f32_16x16x32_bf16 v[100:103], v[208:211], a[64:67], 0
  ds_read_b64_tr_b16 v[194:195], v250 offset:16640
  v_mfma_f32_16x16x32_bf16 v[100:103], v[212:215], a[68:71], v[100:103]
  buffer_load_dwordx4 v241, s[16:19], s47 offen offset:1024 lds
  v_mfma_f32_16x16x32_bf16 v[104:107], v[208:211], a[128:131], 0
  ds_read_b64_tr_b16 v[196:197], v250 offset:18432
  v_mfma_f32_16x16x32_bf16 v[104:107], v[212:215], a[132:135], v[104:107]
  v_mfma_f32_16x16x32_bf16 v[108:111], v[208:211], a[192:195], 0
  ds_read_b64_tr_b16 v[198:199], v250 offset:18688
  buffer_load_dwordx4 v242, s[16:19], s47 offen offset:2048 lds
  v_mfma_f32_16x16x32_bf16 v[108:111], v[212:215], a[196:199], v[108:111]
  s_waitcnt lgkmcnt(4)
  v_mfma_f32_16x16x32_bf16 v[112:115], v[216:219], a[0:3], 0
  ds_read_b64_tr_b16 v[200:201], v251 offset:16384
  v_mfma_f32_16x16x32_bf16 v[112:115], v[220:223], a[4:7], v[112:115]
  buffer_load_dwordx4 v243, s[16:19], s47 offen offset:3072 lds
  v_mfma_f32_16x16x32_bf16 v[116:119], v[216:219], a[64:67], 0
  ds_read_b64_tr_b16 v[202:203], v251 offset:16640
  v_mfma_f32_16x16x32_bf16 v[116:119], v[220:223], a[68:71], v[116:119]
  v_mfma_f32_16x16x32_bf16 v[120:123], v[216:219], a[128:131], 0
  ds_read_b64_tr_b16 v[204:205], v251 offset:18432
  v_mfma_f32_16x16x32_bf16 v[120:123], v[220:223], a[132:135], v[120:123]
  v_mfma_f32_16x16x32_bf16 v[124:127], v[216:219], a[192:195], 0
  ds_read_b64_tr_b16 v[206:207], v251 offset:18688
  v_mfma_f32_16x16x32_bf16 v[124:127], v[220:223], a[196:199], v[124:127]
  s_waitcnt lgkmcnt(4)
  v_mfma_f32_16x16x32_bf16 v[0:3], v[192:195], a[8:11], v[0:3]
  ds_read_b64_tr_b16 v[208:209], v250 offset:20480
  v_mfma_f32_16x16x32_bf16 v[0:3], v[196:199], a[12:15], v[0:3]
  s_waitcnt vmcnt(12)
  s_mov_b32 s48, 1572864
  s_lshl_b32 s53, s46, 12
  s_add_u32 m0, s53, 147456
  s_nop 0
  buffer_load_dwordx4 v244, s[20:23], s48 offen offset:0 lds
  v_mfma_f32_16x16x32_bf16 v[4:7], v[192:195], a[72:75], v[4:7]
  ds_read_b64_tr_b16 v[210:211], v250 offset:20736
  v_mfma_f32_16x16x32_bf16 v[4:7], v[196:199], a[76:79], v[4:7]
  ds_read_b128 a[16:19], v248 offset:16384
  v_mfma_f32_16x16x32_bf16 v[8:11], v[192:195], a[136:139], v[8:11]
  ds_read_b64_tr_b16 v[212:213], v250 offset:22528
  v_mfma_f32_16x16x32_bf16 v[8:11], v[196:199], a[140:143], v[8:11]
  ds_read_b128 a[80:83], v248 offset:18432
  buffer_load_dwordx4 v245, s[20:23], s48 offen offset:1024 lds
  v_mfma_f32_16x16x32_bf16 v[12:15], v[192:195], a[200:203], v[12:15]
  ds_read_b64_tr_b16 v[214:215], v250 offset:22784
  v_mfma_f32_16x16x32_bf16 v[12:15], v[196:199], a[204:207], v[12:15]
  s_waitcnt lgkmcnt(6)
  ds_read_b128 a[144:147], v248 offset:20480
  v_mfma_f32_16x16x32_bf16 v[16:19], v[200:203], a[8:11], v[16:19]
  ds_read_b64_tr_b16 v[216:217], v251 offset:20480
  v_mfma_f32_16x16x32_bf16 v[16:19], v[204:207], a[12:15], v[16:19]
  ds_read_b128 a[208:211], v248 offset:22528
  v_mfma_f32_16x16x32_bf16 v[20:23], v[200:203], a[72:75], v[20:23]
  ds_read_b64_tr_b16 v[218:219], v251 offset:20736
  buffer_load_dwordx4 v246, s[20:23], s48 offen offset:2048 lds
  v_mfma_f32_16x16x32_bf16 v[20:23], v[204:207], a[76:79], v[20:23]
  ds_read_b128 a[20:23], v249 offset:16384
  v_mfma_f32_16x16x32_bf16 v[24:27], v[200:203], a[136:139], v[24:27]
  ds_read_b64_tr_b16 v[220:221], v251 offset:22528
  v_mfma_f32_16x16x32_bf16 v[24:27], v[204:207], a[140:143], v[24:27]
  ds_read_b128 a[84:87], v249 offset:18432
  v_mfma_f32_16x16x32_bf16 v[28:31], v[200:203], a[200:203], v[28:31]
  ds_read_b64_tr_b16 v[222:223], v251 offset:22784
  v_mfma_f32_16x16x32_bf16 v[28:31], v[204:207], a[204:207], v[28:31]
  s_waitcnt lgkmcnt(8)
  ds_read_b128 a[148:151], v249 offset:20480
  buffer_load_dwordx4 v247, s[20:23], s48 offen offset:3072 lds
  v_mfma_f32_16x16x32_bf16 v[32:35], v[208:211], a[8:11], v[32:35]
  ds_read_b64_tr_b16 v[192:193], v250 offset:24576
  v_mfma_f32_16x16x32_bf16 v[32:35], v[212:215], a[12:15], v[32:35]
  ds_read_b128 a[212:215], v249 offset:22528
  v_mfma_f32_16x16x32_bf16 v[36:39], v[208:211], a[72:75], v[36:39]
  s_mov_b32 s47, 512
  ds_read_b64_tr_b16 v[194:195], v250 offset:24832
  v_mfma_f32_16x16x32_bf16 v[36:39], v[212:215], a[76:79], v[36:39]
  s_add_u32 m0, s56, 8192
  v_mfma_f32_16x16x32_bf16 v[40:43], v[208:211], a[136:139], v[40:43]
  ds_read_b64_tr_b16 v[196:197], v250 offset:26624
  buffer_load_dwordx4 v236, s[16:19], s47 offen offset:0 lds
  v_mfma_f32_16x16x32_bf16 v[40:43], v[212:215], a[140:143], v[40:43]
  v_mfma_f32_16x16x32_bf16 v[44:47], v[208:211], a[200:203], v[44:47]
  ds_read_b64_tr_b16 v[198:199], v250 offset:26880
  v_mfma_f32_16x16x32_bf16 v[44:47], v[212:215], a[204:207], v[44:47]
  s_waitcnt lgkmcnt(6)
  v_mfma_f32_16x16x32_bf16 v[48:51], v[216:219], a[8:11], v[48:51]
  ds_read_b64_tr_b16 v[200:201], v251 offset:24576
  v_mfma_f32_16x16x32_bf16 v[48:51], v[220:223], a[12:15], v[48:51]
  buffer_load_dwordx4 v237, s[16:19], s47 offen offset:1024 lds
  v_mfma_f32_16x16x32_bf16 v[52:55], v[216:219], a[72:75], v[52:55]
  ds_read_b64_tr_b16 v[202:203], v251 offset:24832
  v_mfma_f32_16x16x32_bf16 v[52:55], v[220:223], a[76:79], v[52:55]
  v_mfma_f32_16x16x32_bf16 v[56:59], v[216:219], a[136:139], v[56:59]
  ds_read_b64_tr_b16 v[204:205], v251 offset:26624
  v_mfma_f32_16x16x32_bf16 v[56:59], v[220:223], a[140:143], v[56:59]
  v_mfma_f32_16x16x32_bf16 v[60:63], v[216:219], a[200:203], v[60:63]
  ds_read_b64_tr_b16 v[206:207], v251 offset:26880
  buffer_load_dwordx4 v238, s[16:19], s47 offen offset:2048 lds
  v_mfma_f32_16x16x32_bf16 v[60:63], v[220:223], a[204:207], v[60:63]
  s_waitcnt lgkmcnt(4)
  v_mfma_f32_16x16x32_bf16 v[64:67], v[192:195], a[8:11], v[64:67]
  ds_read_b64_tr_b16 v[208:209], v250 offset:28672
  v_mfma_f32_16x16x32_bf16 v[64:67], v[196:199], a[12:15], v[64:67]
  v_mfma_f32_16x16x32_bf16 v[68:71], v[192:195], a[72:75], v[68:71]
  ds_read_b64_tr_b16 v[210:211], v250 offset:28928
  v_mfma_f32_16x16x32_bf16 v[68:71], v[196:199], a[76:79], v[68:71]
  buffer_load_dwordx4 v239, s[16:19], s47 offen offset:3072 lds
  v_mfma_f32_16x16x32_bf16 v[72:75], v[192:195], a[136:139], v[72:75]
  ds_read_b64_tr_b16 v[212:213], v250 offset:30720
  v_mfma_f32_16x16x32_bf16 v[72:75], v[196:199], a[140:143], v[72:75]
  v_mfma_f32_16x16x32_bf16 v[76:79], v[192:195], a[200:203], v[76:79]
  ds_read_b64_tr_b16 v[214:215], v250 offset:30976
  v_mfma_f32_16x16x32_bf16 v[76:79], v[196:199], a[204:207], v[76:79]
  s_add_u32 m0, s56, 12288
  s_waitcnt lgkmcnt(4)
  v_mfma_f32_16x16x32_bf16 v[80:83], v[200:203], a[8:11], v[80:83]
  ds_read_b64_tr_b16 v[216:217], v251 offset:28672
  buffer_load_dwordx4 v240, s[16:19], s47 offen offset:0 lds
  v_mfma_f32_16x16x32_bf16 v[80:83], v[204:207], a[12:15], v[80:83]
  v_mfma_f32_16x16x32_bf16 v[84:87], v[200:203], a[72:75], v[84:87]
  ds_read_b64_tr_b16 v[218:219], v251 offset:28928
  v_mfma_f32_16x16x32_bf16 v[84:87], v[204:207], a[76:79], v[84:87]
  v_mfma_f32_16x16x32_bf16 v[88:91], v[200:203], a[136:139], v[88:91]
  ds_read_b64_tr_b16 v[220:221], v251 offset:30720
  v_mfma_f32_16x16x32_bf16 v[88:91], v[204:207], a[140:143], v[88:91]
  buffer_load_dwordx4 v241, s[16:19], s47 offen offset:1024 lds
  v_mfma_f32_16x16x32_bf16 v[92:95], v[200:203], a[200:203], v[92:95]
  ds_read_b64_tr_b16 v[222:223], v251 offset:30976
  v_mfma_f32_16x16x32_bf16 v[92:95], v[204:207], a[204:207], v[92:95]
  s_waitcnt vmcnt(18)
  s_barrier
  s_waitcnt lgkmcnt(4)
  v_mfma_f32_16x16x32_bf16 v[96:99], v[208:211], a[8:11], v[96:99]
  ds_read_b64_tr_b16 v[192:193], v250 offset:32768
  v_mfma_f32_16x16x32_bf16 v[96:99], v[212:215], a[12:15], v[96:99]
  v_mfma_f32_16x16x32_bf16 v[100:103], v[208:211], a[72:75], v[100:103]
  ds_read_b64_tr_b16 v[194:195], v250 offset:33024
  buffer_load_dwordx4 v242, s[16:19], s47 offen offset:2048 lds
  v_mfma_f32_16x16x32_bf16 v[100:103], v[212:215], a[76:79], v[100:103]
  v_mfma_f32_16x16x32_bf16 v[104:107], v[208:211], a[136:139], v[104:107]
  ds_read_b64_tr_b16 v[196:197], v250 offset:34816
  v_mfma_f32_16x16x32_bf16 v[104:107], v[212:215], a[140:143], v[104:107]
  v_mfma_f32_16x16x32_bf16 v[108:111], v[208:211], a[200:203], v[108:111]
  ds_read_b64_tr_b16 v[198:199], v250 offset:35072
  v_mfma_f32_16x16x32_bf16 v[108:111], v[212:215], a[204:207], v[108:111]
  s_waitcnt lgkmcnt(4)
  buffer_load_dwordx4 v243, s[16:19], s47 offen offset:3072 lds
  v_mfma_f32_16x16x32_bf16 v[112:115], v[216:219], a[8:11], v[112:115]
  ds_read_b64_tr_b16 v[200:201], v251 offset:32768
  v_mfma_f32_16x16x32_bf16 v[112:115], v[220:223], a[12:15], v[112:115]
  v_mfma_f32_16x16x32_bf16 v[116:119], v[216:219], a[72:75], v[116:119]
  ds_read_b64_tr_b16 v[202:203], v251 offset:33024
  v_mfma_f32_16x16x32_bf16 v[116:119], v[220:223], a[76:79], v[116:119]
  v_mfma_f32_16x16x32_bf16 v[120:123], v[216:219], a[136:139], v[120:123]
  ds_read_b64_tr_b16 v[204:205], v251 offset:34816
  v_mfma_f32_16x16x32_bf16 v[120:123], v[220:223], a[140:143], v[120:123]
  v_mfma_f32_16x16x32_bf16 v[124:127], v[216:219], a[200:203], v[124:127]
  ds_read_b64_tr_b16 v[206:207], v251 offset:35072
  v_mfma_f32_16x16x32_bf16 v[124:127], v[220:223], a[204:207], v[124:127]
  s_waitcnt lgkmcnt(4)
  v_mfma_f32_16x16x32_bf16 v[0:3], v[192:195], a[16:19], v[0:3]
  ds_read_b64_tr_b16 v[208:209], v250 offset:36864
  v_mfma_f32_16x16x32_bf16 v[0:3], v[196:199], a[20:23], v[0:3]
  s_waitcnt vmcnt(12)
  s_mov_b32 s48, 2097152
  s_lshl_b32 s53, s46, 12
  s_add_u32 m0, s53, 98304
  s_nop 0
  buffer_load_dwordx4 v244, s[20:23], s48 offen offset:0 lds
  v_mfma_f32_16x16x32_bf16 v[4:7], v[192:195], a[80:83], v[4:7]
  ds_read_b64_tr_b16 v[210:211], v250 offset:37120
  v_mfma_f32_16x16x32_bf16 v[4:7], v[196:199], a[84:87], v[4:7]
  ds_read_b128 a[24:27], v248 offset:0
  v_mfma_f32_16x16x32_bf16 v[8:11], v[192:195], a[144:147], v[8:11]
  ds_read_b64_tr_b16 v[212:213], v250 offset:38912
  v_mfma_f32_16x16x32_bf16 v[8:11], v[196:199], a[148:151], v[8:11]
  ds_read_b128 a[88:91], v248 offset:2048
  buffer_load_dwordx4 v245, s[20:23], s48 offen offset:1024 lds
  v_mfma_f32_16x16x32_bf16 v[12:15], v[192:195], a[208:211], v[12:15]
  ds_read_b64_tr_b16 v[214:215], v250 offset:39168
  v_mfma_f32_16x16x32_bf16 v[12:15], v[196:199], a[212:215], v[12:15]
  s_waitcnt lgkmcnt(6)
  ds_read_b128 a[152:155], v248 offset:4096
  v_mfma_f32_16x16x32_bf16 v[16:19], v[200:203], a[16:19], v[16:19]
  ds_read_b64_tr_b16 v[216:217], v251 offset:36864
  v_mfma_f32_16x16x32_bf16 v[16:19], v[204:207], a[20:23], v[16:19]
  ds_read_b128 a[216:219], v248 offset:6144
  v_mfma_f32_16x16x32_bf16 v[20:23], v[200:203], a[80:83], v[20:23]
  ds_read_b64_tr_b16 v[218:219], v251 offset:37120
  buffer_load_dwordx4 v246, s[20:23], s48 offen offset:2048 lds
  v_mfma_f32_16x16x32_bf16 v[20:23], v[204:207], a[84:87], v[20:23]
  ds_read_b128 a[28:31], v249 offset:0
  v_mfma_f32_16x16x32_bf16 v[24:27], v[200:203], a[144:147], v[24:27]
  ds_read_b64_tr_b16 v[220:221], v251 offset:38912
  v_mfma_f32_16x16x32_bf16 v[24:27], v[204:207], a[148:151], v[24:27]
  ds_read_b128 a[92:95], v249 offset:2048
  v_mfma_f32_16x16x32_bf16 v[28:31], v[200:203], a[208:211], v[28:31]
  ds_read_b64_tr_b16 v[222:223], v251 offset:39168
  v_mfma_f32_16x16x32_bf16 v[28:31], v[204:207], a[212:215], v[28:31]
  s_waitcnt lgkmcnt(8)
  ds_read_b128 a[156:159], v249 offset:4096
  buffer_load_dwordx4 v247, s[20:23], s48 offen offset:3072 lds
  v_mfma_f32_16x16x32_bf16 v[32:35], v[208:211], a[16:19], v[32:35]
  ds_read_b64_tr_b16 v[192:193], v250 offset:40960
  v_mfma_f32_16x16x32_bf16 v[32:35], v[212:215], a[20:23], v[32:35]
  ds_read_b128 a[220:223], v249 offset:6144
  v_mfma_f32_16x16x32_bf16 v[36:39], v[208:211], a[80:83], v[36:39]
  s_mov_b32 s47, 640
  ds_read_b64_tr_b16 v[194:195], v250 offset:41216
  v_mfma_f32_16x16x32_bf16 v[36:39], v[212:215], a[84:87], v[36:39]
  s_add_u32 m0, s56, 16384
  v_mfma_f32_16x16x32_bf16 v[40:43], v[208:211], a[144:147], v[40:43]
  ds_read_b64_tr_b16 v[196:197], v250 offset:43008
  buffer_load_dwordx4 v236, s[16:19], s47 offen offset:0 lds
  v_mfma_f32_16x16x32_bf16 v[40:43], v[212:215], a[148:151], v[40:43]
  v_mfma_f32_16x16x32_bf16 v[44:47], v[208:211], a[208:211], v[44:47]
  ds_read_b64_tr_b16 v[198:199], v250 offset:43264
  v_mfma_f32_16x16x32_bf16 v[44:47], v[212:215], a[212:215], v[44:47]
  s_waitcnt lgkmcnt(6)
  v_mfma_f32_16x16x32_bf16 v[48:51], v[216:219], a[16:19], v[48:51]
  ds_read_b64_tr_b16 v[200:201], v251 offset:40960
  v_mfma_f32_16x16x32_bf16 v[48:51], v[220:223], a[20:23], v[48:51]
  buffer_load_dwordx4 v237, s[16:19], s47 offen offset:1024 lds
  v_mfma_f32_16x16x32_bf16 v[52:55], v[216:219], a[80:83], v[52:55]
  ds_read_b64_tr_b16 v[202:203], v251 offset:41216
  v_mfma_f32_16x16x32_bf16 v[52:55], v[220:223], a[84:87], v[52:55]
  v_mfma_f32_16x16x32_bf16 v[56:59], v[216:219], a[144:147], v[56:59]
  ds_read_b64_tr_b16 v[204:205], v251 offset:43008
  v_mfma_f32_16x16x32_bf16 v[56:59], v[220:223], a[148:151], v[56:59]
  v_mfma_f32_16x16x32_bf16 v[60:63], v[216:219], a[208:211], v[60:63]
  ds_read_b64_tr_b16 v[206:207], v251 offset:43264
  buffer_load_dwordx4 v238, s[16:19], s47 offen offset:2048 lds
  v_mfma_f32_16x16x32_bf16 v[60:63], v[220:223], a[212:215], v[60:63]
  s_waitcnt lgkmcnt(4)
  v_mfma_f32_16x16x32_bf16 v[64:67], v[192:195], a[16:19], v[64:67]
  ds_read_b64_tr_b16 v[208:209], v250 offset:45056
  v_mfma_f32_16x16x32_bf16 v[64:67], v[196:199], a[20:23], v[64:67]
  v_mfma_f32_16x16x32_bf16 v[68:71], v[192:195], a[80:83], v[68:71]
  ds_read_b64_tr_b16 v[210:211], v250 offset:45312
  v_mfma_f32_16x16x32_bf16 v[68:71], v[196:199], a[84:87], v[68:71]
  buffer_load_dwordx4 v239, s[16:19], s47 offen offset:3072 lds
  v_mfma_f32_16x16x32_bf16 v[72:75], v[192:195], a[144:147], v[72:75]
  ds_read_b64_tr_b16 v[212:213], v250 offset:47104
  v_mfma_f32_16x16x32_bf16 v[72:75], v[196:199], a[148:151], v[72:75]
  v_mfma_f32_16x16x32_bf16 v[76:79], v[192:195], a[208:211], v[76:79]
  ds_read_b64_tr_b16 v[214:215], v250 offset:47360
  v_mfma_f32_16x16x32_bf16 v[76:79], v[196:199], a[212:215], v[76:79]
  s_add_u32 m0, s56, 20480
  s_waitcnt lgkmcnt(4)
  v_mfma_f32_16x16x32_bf16 v[80:83], v[200:203], a[16:19], v[80:83]
  ds_read_b64_tr_b16 v[216:217], v251 offset:45056
  buffer_load_dwordx4 v240, s[16:19], s47 offen offset:0 lds
  v_mfma_f32_16x16x32_bf16 v[80:83], v[204:207], a[20:23], v[80:83]
  v_mfma_f32_16x16x32_bf16 v[84:87], v[200:203], a[80:83], v[84:87]
  ds_read_b64_tr_b16 v[218:219], v251 offset:45312
  v_mfma_f32_16x16x32_bf16 v[84:87], v[204:207], a[84:87], v[84:87]
  v_mfma_f32_16x16x32_bf16 v[88:91], v[200:203], a[144:147], v[88:91]
  ds_read_b64_tr_b16 v[220:221], v251 offset:47104
  v_mfma_f32_16x16x32_bf16 v[88:91], v[204:207], a[148:151], v[88:91]
  buffer_load_dwordx4 v241, s[16:19], s47 offen offset:1024 lds
  v_mfma_f32_16x16x32_bf16 v[92:95], v[200:203], a[208:211], v[92:95]
  ds_read_b64_tr_b16 v[222:223], v251 offset:47360
  v_mfma_f32_16x16x32_bf16 v[92:95], v[204:207], a[212:215], v[92:95]
  s_waitcnt vmcnt(18)
  s_barrier
  s_waitcnt lgkmcnt(4)
  v_mfma_f32_16x16x32_bf16 v[96:99], v[208:211], a[16:19], v[96:99]
  ds_read_b64_tr_b16 v[192:193], v250 offset:49152
  v_mfma_f32_16x16x32_bf16 v[96:99], v[212:215], a[20:23], v[96:99]
  v_mfma_f32_16x16x32_bf16 v[100:103], v[208:211], a[80:83], v[100:103]
  ds_read_b64_tr_b16 v[194:195], v250 offset:49408
  buffer_load_dwordx4 v242, s[16:19], s47 offen offset:2048 lds
  v_mfma_f32_16x16x32_bf16 v[100:103], v[212:215], a[84:87], v[100:103]
  v_mfma_f32_16x16x32_bf16 v[104:107], v[208:211], a[144:147], v[104:107]
  ds_read_b64_tr_b16 v[196:197], v250 offset:51200
  v_mfma_f32_16x16x32_bf16 v[104:107], v[212:215], a[148:151], v[104:107]
  v_mfma_f32_16x16x32_bf16 v[108:111], v[208:211], a[208:211], v[108:111]
  ds_read_b64_tr_b16 v[198:199], v250 offset:51456
  v_mfma_f32_16x16x32_bf16 v[108:111], v[212:215], a[212:215], v[108:111]
  s_waitcnt lgkmcnt(4)
  buffer_load_dwordx4 v243, s[16:19], s47 offen offset:3072 lds
  v_mfma_f32_16x16x32_bf16 v[112:115], v[216:219], a[16:19], v[112:115]
  ds_read_b64_tr_b16 v[200:201], v251 offset:49152
  v_mfma_f32_16x16x32_bf16 v[112:115], v[220:223], a[20:23], v[112:115]
  v_mfma_f32_16x16x32_bf16 v[116:119], v[216:219], a[80:83], v[116:119]
  ds_read_b64_tr_b16 v[202:203], v251 offset:49408
  v_mfma_f32_16x16x32_bf16 v[116:119], v[220:223], a[84:87], v[116:119]
  v_mfma_f32_16x16x32_bf16 v[120:123], v[216:219], a[144:147], v[120:123]
  ds_read_b64_tr_b16 v[204:205], v251 offset:51200
  v_mfma_f32_16x16x32_bf16 v[120:123], v[220:223], a[148:151], v[120:123]
  v_mfma_f32_16x16x32_bf16 v[124:127], v[216:219], a[208:211], v[124:127]
  ds_read_b64_tr_b16 v[206:207], v251 offset:51456
  v_mfma_f32_16x16x32_bf16 v[124:127], v[220:223], a[212:215], v[124:127]
  s_waitcnt lgkmcnt(4)
  v_mfma_f32_16x16x32_bf16 v[0:3], v[192:195], a[24:27], v[0:3]
  ds_read_b64_tr_b16 v[208:209], v250 offset:53248
  v_mfma_f32_16x16x32_bf16 v[0:3], v[196:199], a[28:31], v[0:3]
  s_waitcnt vmcnt(12)
  s_mov_b32 s48, 2621440
  s_lshl_b32 s53, s46, 12
  s_add_u32 m0, s53, 114688
  s_nop 0
  buffer_load_dwordx4 v244, s[20:23], s48 offen offset:0 lds
  v_mfma_f32_16x16x32_bf16 v[4:7], v[192:195], a[88:91], v[4:7]
  ds_read_b64_tr_b16 v[210:211], v250 offset:53504
  v_mfma_f32_16x16x32_bf16 v[4:7], v[196:199], a[92:95], v[4:7]
  ds_read_b128 a[32:35], v248 offset:8192
  v_mfma_f32_16x16x32_bf16 v[8:11], v[192:195], a[152:155], v[8:11]
  ds_read_b64_tr_b16 v[212:213], v250 offset:55296
  v_mfma_f32_16x16x32_bf16 v[8:11], v[196:199], a[156:159], v[8:11]
  ds_read_b128 a[96:99], v248 offset:10240
  buffer_load_dwordx4 v245, s[20:23], s48 offen offset:1024 lds
  v_mfma_f32_16x16x32_bf16 v[12:15], v[192:195], a[216:219], v[12:15]
  ds_read_b64_tr_b16 v[214:215], v250 offset:55552
  v_mfma_f32_16x16x32_bf16 v[12:15], v[196:199], a[220:223], v[12:15]
  s_waitcnt lgkmcnt(6)
  ds_read_b128 a[160:163], v248 offset:12288
  v_mfma_f32_16x16x32_bf16 v[16:19], v[200:203], a[24:27], v[16:19]
  ds_read_b64_tr_b16 v[216:217], v251 offset:53248
  v_mfma_f32_16x16x32_bf16 v[16:19], v[204:207], a[28:31], v[16:19]
  ds_read_b128 a[224:227], v248 offset:14336
  v_mfma_f32_16x16x32_bf16 v[20:23], v[200:203], a[88:91], v[20:23]
  ds_read_b64_tr_b16 v[218:219], v251 offset:53504
  buffer_load_dwordx4 v246, s[20:23], s48 offen offset:2048 lds
  v_mfma_f32_16x16x32_bf16 v[20:23], v[204:207], a[92:95], v[20:23]
  ds_read_b128 a[36:39], v249 offset:8192
  v_mfma_f32_16x16x32_bf16 v[24:27], v[200:203], a[152:155], v[24:27]
  ds_read_b64_tr_b16 v[220:221], v251 offset:55296
  v_mfma_f32_16x16x32_bf16 v[24:27], v[204:207], a[156:159], v[24:27]
  ds_read_b128 a[100:103], v249 offset:10240
  v_mfma_f32_16x16x32_bf16 v[28:31], v[200:203], a[216:219], v[28:31]
  ds_read_b64_tr_b16 v[222:223], v251 offset:55552
  v_mfma_f32_16x16x32_bf16 v[28:31], v[204:207], a[220:223], v[28:31]
  s_waitcnt lgkmcnt(8)
  ds_read_b128 a[164:167], v249 offset:12288
  buffer_load_dwordx4 v247, s[20:23], s48 offen offset:3072 lds
  v_mfma_f32_16x16x32_bf16 v[32:35], v[208:211], a[24:27], v[32:35]
  ds_read_b64_tr_b16 v[192:193], v250 offset:57344
  v_mfma_f32_16x16x32_bf16 v[32:35], v[212:215], a[28:31], v[32:35]
  ds_read_b128 a[228:231], v249 offset:14336
  v_mfma_f32_16x16x32_bf16 v[36:39], v[208:211], a[88:91], v[36:39]
  s_mov_b32 s47, 768
  ds_read_b64_tr_b16 v[194:195], v250 offset:57600
  v_mfma_f32_16x16x32_bf16 v[36:39], v[212:215], a[92:95], v[36:39]
  s_add_u32 m0, s56, 0
  v_mfma_f32_16x16x32_bf16 v[40:43], v[208:211], a[152:155], v[40:43]
  ds_read_b64_tr_b16 v[196:197], v250 offset:59392
  buffer_load_dwordx4 v236, s[16:19], s47 offen offset:0 lds
  v_mfma_f32_16x16x32_bf16 v[40:43], v[212:215], a[156:159], v[40:43]
  v_mfma_f32_16x16x32_bf16 v[44:47], v[208:211], a[216:219], v[44:47]
  ds_read_b64_tr_b16 v[198:199], v250 offset:59648
  v_mfma_f32_16x16x32_bf16 v[44:47], v[212:215], a[220:223], v[44:47]
  s_waitcnt lgkmcnt(6)
  v_mfma_f32_16x16x32_bf16 v[48:51], v[216:219], a[24:27], v[48:51]
  ds_read_b64_tr_b16 v[200:201], v251 offset:57344
  v_mfma_f32_16x16x32_bf16 v[48:51], v[220:223], a[28:31], v[48:51]
  buffer_load_dwordx4 v237, s[16:19], s47 offen offset:1024 lds
  v_mfma_f32_16x16x32_bf16 v[52:55], v[216:219], a[88:91], v[52:55]
  ds_read_b64_tr_b16 v[202:203], v251 offset:57600
  v_mfma_f32_16x16x32_bf16 v[52:55], v[220:223], a[92:95], v[52:55]
  v_mfma_f32_16x16x32_bf16 v[56:59], v[216:219], a[152:155], v[56:59]
  ds_read_b64_tr_b16 v[204:205], v251 offset:59392
  v_mfma_f32_16x16x32_bf16 v[56:59], v[220:223], a[156:159], v[56:59]
  v_mfma_f32_16x16x32_bf16 v[60:63], v[216:219], a[216:219], v[60:63]
  ds_read_b64_tr_b16 v[206:207], v251 offset:59648
  buffer_load_dwordx4 v238, s[16:19], s47 offen offset:2048 lds
  v_mfma_f32_16x16x32_bf16 v[60:63], v[220:223], a[220:223], v[60:63]
  s_waitcnt lgkmcnt(4)
  v_mfma_f32_16x16x32_bf16 v[64:67], v[192:195], a[24:27], v[64:67]
  ds_read_b64_tr_b16 v[208:209], v250 offset:61440
  v_mfma_f32_16x16x32_bf16 v[64:67], v[196:199], a[28:31], v[64:67]
  v_mfma_f32_16x16x32_bf16 v[68:71], v[192:195], a[88:91], v[68:71]
  ds_read_b64_tr_b16 v[210:211], v250 offset:61696
  v_mfma_f32_16x16x32_bf16 v[68:71], v[196:199], a[92:95], v[68:71]
  buffer_load_dwordx4 v239, s[16:19], s47 offen offset:3072 lds
  v_mfma_f32_16x16x32_bf16 v[72:75], v[192:195], a[152:155], v[72:75]
  ds_read_b64_tr_b16 v[212:213], v250 offset:63488
  v_mfma_f32_16x16x32_bf16 v[72:75], v[196:199], a[156:159], v[72:75]
  v_mfma_f32_16x16x32_bf16 v[76:79], v[192:195], a[216:219], v[76:79]
  ds_read_b64_tr_b16 v[214:215], v250 offset:63744
  v_mfma_f32_16x16x32_bf16 v[76:79], v[196:199], a[220:223], v[76:79]
  s_add_u32 m0, s56, 4096
  s_waitcnt lgkmcnt(4)
  v_mfma_f32_16x16x32_bf16 v[80:83], v[200:203], a[24:27], v[80:83]
  ds_read_b64_tr_b16 v[216:217], v251 offset:61440
  buffer_load_dwordx4 v240, s[16:19], s47 offen offset:0 lds
  v_mfma_f32_16x16x32_bf16 v[80:83], v[204:207], a[28:31], v[80:83]
  v_mfma_f32_16x16x32_bf16 v[84:87], v[200:203], a[88:91], v[84:87]
  ds_read_b64_tr_b16 v[218:219], v251 offset:61696
  v_mfma_f32_16x16x32_bf16 v[84:87], v[204:207], a[92:95], v[84:87]
  v_mfma_f32_16x16x32_bf16 v[88:91], v[200:203], a[152:155], v[88:91]
  ds_read_b64_tr_b16 v[220:221], v251 offset:63488
  v_mfma_f32_16x16x32_bf16 v[88:91], v[204:207], a[156:159], v[88:91]
  buffer_load_dwordx4 v241, s[16:19], s47 offen offset:1024 lds
  v_mfma_f32_16x16x32_bf16 v[92:95], v[200:203], a[216:219], v[92:95]
  ds_read_b64_tr_b16 v[222:223], v251 offset:63744
  v_mfma_f32_16x16x32_bf16 v[92:95], v[204:207], a[220:223], v[92:95]
  s_waitcnt vmcnt(18)
  s_barrier
  s_waitcnt lgkmcnt(4)
  v_mfma_f32_16x16x32_bf16 v[96:99], v[208:211], a[24:27], v[96:99]
  ds_read_b64_tr_b16 v[192:193], v250 offset:0
  v_mfma_f32_16x16x32_bf16 v[96:99], v[212:215], a[28:31], v[96:99]
  v_mfma_f32_16x16x32_bf16 v[100:103], v[208:211], a[88:91], v[100:103]
  ds_read_b64_tr_b16 v[194:195], v250 offset:256
  buffer_load_dwordx4 v242, s[16:19], s47 offen offset:2048 lds
  v_mfma_f32_16x16x32_bf16 v[100:103], v[212:215], a[92:95], v[100:103]
  v_mfma_f32_16x16x32_bf16 v[104:107], v[208:211], a[152:155], v[104:107]
  ds_read_b64_tr_b16 v[196:197], v250 offset:2048
  v_mfma_f32_16x16x32_bf16 v[104:107], v[212:215], a[156:159], v[104:107]
  v_mfma_f32_16x16x32_bf16 v[108:111], v[208:211], a[216:219], v[108:111]
  ds_read_b64_tr_b16 v[198:199], v250 offset:2304
  v_mfma_f32_16x16x32_bf16 v[108:111], v[212:215], a[220:223], v[108:111]
  s_waitcnt lgkmcnt(4)
  buffer_load_dwordx4 v243, s[16:19], s47 offen offset:3072 lds
  v_mfma_f32_16x16x32_bf16 v[112:115], v[216:219], a[24:27], v[112:115]
  ds_read_b64_tr_b16 v[200:201], v251 offset:0
  v_mfma_f32_16x16x32_bf16 v[112:115], v[220:223], a[28:31], v[112:115]
  v_mfma_f32_16x16x32_bf16 v[116:119], v[216:219], a[88:91], v[116:119]
  ds_read_b64_tr_b16 v[202:203], v251 offset:256
  v_mfma_f32_16x16x32_bf16 v[116:119], v[220:223], a[92:95], v[116:119]
  v_mfma_f32_16x16x32_bf16 v[120:123], v[216:219], a[152:155], v[120:123]
  ds_read_b64_tr_b16 v[204:205], v251 offset:2048
  v_mfma_f32_16x16x32_bf16 v[120:123], v[220:223], a[156:159], v[120:123]
  v_mfma_f32_16x16x32_bf16 v[124:127], v[216:219], a[216:219], v[124:127]
  ds_read_b64_tr_b16 v[206:207], v251 offset:2304
  v_mfma_f32_16x16x32_bf16 v[124:127], v[220:223], a[220:223], v[124:127]
  s_waitcnt lgkmcnt(4)
  v_mfma_f32_16x16x32_bf16 v[0:3], v[192:195], a[32:35], v[0:3]
  ds_read_b64_tr_b16 v[208:209], v250 offset:4096
  v_mfma_f32_16x16x32_bf16 v[0:3], v[196:199], a[36:39], v[0:3]
  s_waitcnt vmcnt(12)
  s_mov_b32 s48, 3145728
  s_lshl_b32 s53, s46, 12
  s_add_u32 m0, s53, 131072
  s_nop 0
  buffer_load_dwordx4 v244, s[20:23], s48 offen offset:0 lds
  v_mfma_f32_16x16x32_bf16 v[4:7], v[192:195], a[96:99], v[4:7]
  ds_read_b64_tr_b16 v[210:211], v250 offset:4352
  v_mfma_f32_16x16x32_bf16 v[4:7], v[196:199], a[100:103], v[4:7]
  ds_read_b128 a[40:43], v248 offset:16384
  v_mfma_f32_16x16x32_bf16 v[8:11], v[192:195], a[160:163], v[8:11]
  ds_read_b64_tr_b16 v[212:213], v250 offset:6144
  v_mfma_f32_16x16x32_bf16 v[8:11], v[196:199], a[164:167], v[8:11]
  ds_read_b128 a[104:107], v248 offset:18432
  buffer_load_dwordx4 v245, s[20:23], s48 offen offset:1024 lds
  v_mfma_f32_16x16x32_bf16 v[12:15], v[192:195], a[224:227], v[12:15]
  ds_read_b64_tr_b16 v[214:215], v250 offset:6400
  v_mfma_f32_16x16x32_bf16 v[12:15], v[196:199], a[228:231], v[12:15]
  s_waitcnt lgkmcnt(6)
  ds_read_b128 a[168:171], v248 offset:20480
  v_mfma_f32_16x16x32_bf16 v[16:19], v[200:203], a[32:35], v[16:19]
  ds_read_b64_tr_b16 v[216:217], v251 offset:4096
  v_mfma_f32_16x16x32_bf16 v[16:19], v[204:207], a[36:39], v[16:19]
  ds_read_b128 a[232:235], v248 offset:22528
  v_mfma_f32_16x16x32_bf16 v[20:23], v[200:203], a[96:99], v[20:23]
  ds_read_b64_tr_b16 v[218:219], v251 offset:4352
  buffer_load_dwordx4 v246, s[20:23], s48 offen offset:2048 lds
  v_mfma_f32_16x16x32_bf16 v[20:23], v[204:207], a[100:103], v[20:23]
  ds_read_b128 a[44:47], v249 offset:16384
  v_mfma_f32_16x16x32_bf16 v[24:27], v[200:203], a[160:163], v[24:27]
  ds_read_b64_tr_b16 v[220:221], v251 offset:6144
  v_mfma_f32_16x16x32_bf16 v[24:27], v[204:207], a[164:167], v[24:27]
  ds_read_b128 a[108:111], v249 offset:18432
  v_mfma_f32_16x16x32_bf16 v[28:31], v[200:203], a[224:227], v[28:31]
  ds_read_b64_tr_b16 v[222:223], v251 offset:6400
  v_mfma_f32_16x16x32_bf16 v[28:31], v[204:207], a[228:231], v[28:31]
  s_waitcnt lgkmcnt(8)
  ds_read_b128 a[172:175], v249 offset:20480
  buffer_load_dwordx4 v247, s[20:23], s48 offen offset:3072 lds
  v_mfma_f32_16x16x32_bf16 v[32:35], v[208:211], a[32:35], v[32:35]
  ds_read_b64_tr_b16 v[192:193], v250 offset:8192
  v_mfma_f32_16x16x32_bf16 v[32:35], v[212:215], a[36:39], v[32:35]
  ds_read_b128 a[236:239], v249 offset:22528
  v_mfma_f32_16x16x32_bf16 v[36:39], v[208:211], a[96:99], v[36:39]
  s_mov_b32 s47, 896
  ds_read_b64_tr_b16 v[194:195], v250 offset:8448
  v_mfma_f32_16x16x32_bf16 v[36:39], v[212:215], a[100:103], v[36:39]
  s_add_u32 m0, s56, 8192
  v_mfma_f32_16x16x32_bf16 v[40:43], v[208:211], a[160:163], v[40:43]
  ds_read_b64_tr_b16 v[196:197], v250 offset:10240
  buffer_load_dwordx4 v236, s[16:19], s47 offen offset:0 lds
  v_mfma_f32_16x16x32_bf16 v[40:43], v[212:215], a[164:167], v[40:43]
  v_mfma_f32_16x16x32_bf16 v[44:47], v[208:211], a[224:227], v[44:47]
  ds_read_b64_tr_b16 v[198:199], v250 offset:10496
  v_mfma_f32_16x16x32_bf16 v[44:47], v[212:215], a[228:231], v[44:47]
  s_waitcnt lgkmcnt(6)
  v_mfma_f32_16x16x32_bf16 v[48:51], v[216:219], a[32:35], v[48:51]
  ds_read_b64_tr_b16 v[200:201], v251 offset:8192
  v_mfma_f32_16x16x32_bf16 v[48:51], v[220:223], a[36:39], v[48:51]
  buffer_load_dwordx4 v237, s[16:19], s47 offen offset:1024 lds
  v_mfma_f32_16x16x32_bf16 v[52:55], v[216:219], a[96:99], v[52:55]
  ds_read_b64_tr_b16 v[202:203], v251 offset:8448
  v_mfma_f32_16x16x32_bf16 v[52:55], v[220:223], a[100:103], v[52:55]
  v_mfma_f32_16x16x32_bf16 v[56:59], v[216:219], a[160:163], v[56:59]
  ds_read_b64_tr_b16 v[204:205], v251 offset:10240
  v_mfma_f32_16x16x32_bf16 v[56:59], v[220:223], a[164:167], v[56:59]
  v_mfma_f32_16x16x32_bf16 v[60:63], v[216:219], a[224:227], v[60:63]
  ds_read_b64_tr_b16 v[206:207], v251 offset:10496
  buffer_load_dwordx4 v238, s[16:19], s47 offen offset:2048 lds
  v_mfma_f32_16x16x32_bf16 v[60:63], v[220:223], a[228:231], v[60:63]
  s_waitcnt lgkmcnt(4)
  v_mfma_f32_16x16x32_bf16 v[64:67], v[192:195], a[32:35], v[64:67]
  ds_read_b64_tr_b16 v[208:209], v250 offset:12288
  v_mfma_f32_16x16x32_bf16 v[64:67], v[196:199], a[36:39], v[64:67]
  v_mfma_f32_16x16x32_bf16 v[68:71], v[192:195], a[96:99], v[68:71]
  ds_read_b64_tr_b16 v[210:211], v250 offset:12544
  v_mfma_f32_16x16x32_bf16 v[68:71], v[196:199], a[100:103], v[68:71]
  buffer_load_dwordx4 v239, s[16:19], s47 offen offset:3072 lds
  v_mfma_f32_16x16x32_bf16 v[72:75], v[192:195], a[160:163], v[72:75]
  ds_read_b64_tr_b16 v[212:213], v250 offset:14336
  v_mfma_f32_16x16x32_bf16 v[72:75], v[196:199], a[164:167], v[72:75]
  v_mfma_f32_16x16x32_bf16 v[76:79], v[192:195], a[224:227], v[76:79]
  ds_read_b64_tr_b16 v[214:215], v250 offset:14592
  v_mfma_f32_16x16x32_bf16 v[76:79], v[196:199], a[228:231], v[76:79]
  s_add_u32 m0, s56, 12288
  s_waitcnt lgkmcnt(4)
  v_mfma_f32_16x16x32_bf16 v[80:83], v[200:203], a[32:35], v[80:83]
  ds_read_b64_tr_b16 v[216:217], v251 offset:12288
  buffer_load_dwordx4 v240, s[16:19], s47 offen offset:0 lds
  v_mfma_f32_16x16x32_bf16 v[80:83], v[204:207], a[36:39], v[80:83]
  v_mfma_f32_16x16x32_bf16 v[84:87], v[200:203], a[96:99], v[84:87]
  ds_read_b64_tr_b16 v[218:219], v251 offset:12544
  v_mfma_f32_16x16x32_bf16 v[84:87], v[204:207], a[100:103], v[84:87]
  v_mfma_f32_16x16x32_bf16 v[88:91], v[200:203], a[160:163], v[88:91]
  ds_read_b64_tr_b16 v[220:221], v251 offset:14336
  v_mfma_f32_16x16x32_bf16 v[88:91], v[204:207], a[164:167], v[88:91]
  buffer_load_dwordx4 v241, s[16:19], s47 offen offset:1024 lds
  v_mfma_f32_16x16x32_bf16 v[92:95], v[200:203], a[224:227], v[92:95]
  ds_read_b64_tr_b16 v[222:223], v251 offset:14592
  v_mfma_f32_16x16x32_bf16 v[92:95], v[204:207], a[228:231], v[92:95]
  s_waitcnt vmcnt(18)
  s_barrier
  s_waitcnt lgkmcnt(4)
  v_mfma_f32_16x16x32_bf16 v[96:99], v[208:211], a[32:35], v[96:99]
  ds_read_b64_tr_b16 v[192:193], v250 offset:16384
  v_mfma_f32_16x16x32_bf16 v[96:99], v[212:215], a[36:39], v[96:99]
  v_mfma_f32_16x16x32_bf16 v[100:103], v[208:211], a[96:99], v[100:103]
  ds_read_b64_tr_b16 v[194:195], v250 offset:16640
  buffer_load_dwordx4 v242, s[16:19], s47 offen offset:2048 lds
  v_mfma_f32_16x16x32_bf16 v[100:103], v[212:215], a[100:103], v[100:103]
  v_mfma_f32_16x16x32_bf16 v[104:107], v[208:211], a[160:163], v[104:107]
  ds_read_b64_tr_b16 v[196:197], v250 offset:18432
  v_mfma_f32_16x16x32_bf16 v[104:107], v[212:215], a[164:167], v[104:107]
  v_mfma_f32_16x16x32_bf16 v[108:111], v[208:211], a[224:227], v[108:111]
  ds_read_b64_tr_b16 v[198:199], v250 offset:18688
  v_mfma_f32_16x16x32_bf16 v[108:111], v[212:215], a[228:231], v[108:111]
  s_waitcnt lgkmcnt(4)
  buffer_load_dwordx4 v243, s[16:19], s47 offen offset:3072 lds
  v_mfma_f32_16x16x32_bf16 v[112:115], v[216:219], a[32:35], v[112:115]
  ds_read_b64_tr_b16 v[200:201], v251 offset:16384
  v_mfma_f32_16x16x32_bf16 v[112:115], v[220:223], a[36:39], v[112:115]
  v_mfma_f32_16x16x32_bf16 v[116:119], v[216:219], a[96:99], v[116:119]
  ds_read_b64_tr_b16 v[202:203], v251 offset:16640
  v_mfma_f32_16x16x32_bf16 v[116:119], v[220:223], a[100:103], v[116:119]
  v_mfma_f32_16x16x32_bf16 v[120:123], v[216:219], a[160:163], v[120:123]
  ds_read_b64_tr_b16 v[204:205], v251 offset:18432
  v_mfma_f32_16x16x32_bf16 v[120:123], v[220:223], a[164:167], v[120:123]
  v_mfma_f32_16x16x32_bf16 v[124:127], v[216:219], a[224:227], v[124:127]
  ds_read_b64_tr_b16 v[206:207], v251 offset:18688
  v_mfma_f32_16x16x32_bf16 v[124:127], v[220:223], a[228:231], v[124:127]
  s_waitcnt lgkmcnt(4)
  v_mfma_f32_16x16x32_bf16 v[0:3], v[192:195], a[40:43], v[0:3]
  ds_read_b64_tr_b16 v[208:209], v250 offset:20480
  v_mfma_f32_16x16x32_bf16 v[0:3], v[196:199], a[44:47], v[0:3]
  s_waitcnt vmcnt(12)
  s_mov_b32 s48, 3670016
  s_lshl_b32 s53, s46, 12
  s_add_u32 m0, s53, 147456
  s_nop 0
  buffer_load_dwordx4 v244, s[20:23], s48 offen offset:0 lds
  v_mfma_f32_16x16x32_bf16 v[4:7], v[192:195], a[104:107], v[4:7]
  ds_read_b64_tr_b16 v[210:211], v250 offset:20736
  v_mfma_f32_16x16x32_bf16 v[4:7], v[196:199], a[108:111], v[4:7]
  ds_read_b128 a[48:51], v248 offset:0
  v_mfma_f32_16x16x32_bf16 v[8:11], v[192:195], a[168:171], v[8:11]
  ds_read_b64_tr_b16 v[212:213], v250 offset:22528
  v_mfma_f32_16x16x32_bf16 v[8:11], v[196:199], a[172:175], v[8:11]
  ds_read_b128 a[112:115], v248 offset:2048
  v_mfma_f32_16x16x32_bf16 v[12:15], v[192:195], a[232:235], v[12:15]
  ds_read_b64_tr_b16 v[214:215], v250 offset:22784
  v_mfma_f32_16x16x32_bf16 v[12:15], v[196:199], a[236:239], v[12:15]
  s_waitcnt lgkmcnt(6)
  ds_read_b128 a[176:179], v248 offset:4096
  v_mfma_f32_16x16x32_bf16 v[16:19], v[200:203], a[40:43], v[16:19]
  ds_read_b64_tr_b16 v[216:217], v251 offset:20480
  v_mfma_f32_16x16x32_bf16 v[16:19], v[204:207], a[44:47], v[16:19]
  ds_read_b128 a[240:243], v248 offset:6144
  v_mfma_f32_16x16x32_bf16 v[20:23], v[200:203], a[104:107], v[20:23]
  ds_read_b64_tr_b16 v[218:219], v251 offset:20736
  v_mfma_f32_16x16x32_bf16 v[20:23], v[204:207], a[108:111], v[20:23]
  ds_read_b128 a[52:55], v249 offset:0
  v_mfma_f32_16x16x32_bf16 v[24:27], v[200:203], a[168:171], v[24:27]
  ds_read_b64_tr_b16 v[220:221], v251 offset:22528
  v_mfma_f32_16x16x32_bf16 v[24:27], v[204:207], a[172:175], v[24:27]
  ds_read_b128 a[116:119], v249 offset:2048
  v_mfma_f32_16x16x32_bf16 v[28:31], v[200:203], a[232:235], v[28:31]
  ds_read_b64_tr_b16 v[222:223], v251 offset:22784
  v_mfma_f32_16x16x32_bf16 v[28:31], v[204:207], a[236:239], v[28:31]
  s_waitcnt lgkmcnt(8)
  ds_read_b128 a[180:183], v249 offset:4096
  buffer_load_dwordx4 v245, s[20:23], s48 offen offset:1024 lds
  v_mfma_f32_16x16x32_bf16 v[32:35], v[208:211], a[40:43], v[32:35]
  ds_read_b64_tr_b16 v[192:193], v250 offset:24576
  v_mfma_f32_16x16x32_bf16 v[32:35], v[212:215], a[44:47], v[32:35]
  ds_read_b128 a[244:247], v249 offset:6144
  v_mfma_f32_16x16x32_bf16 v[36:39], v[208:211], a[104:107], v[36:39]
  ds_read_b64_tr_b16 v[194:195], v250 offset:24832
  v_mfma_f32_16x16x32_bf16 v[36:39], v[212:215], a[108:111], v[36:39]
  v_mfma_f32_16x16x32_bf16 v[40:43], v[208:211], a[168:171], v[40:43]
  ds_read_b64_tr_b16 v[196:197], v250 offset:26624
  v_mfma_f32_16x16x32_bf16 v[40:43], v[212:215], a[172:175], v[40:43]
  v_mfma_f32_16x16x32_bf16 v[44:47], v[208:211], a[232:235], v[44:47]
  ds_read_b64_tr_b16 v[198:199], v250 offset:26880
  v_mfma_f32_16x16x32_bf16 v[44:47], v[212:215], a[236:239], v[44:47]
  s_waitcnt lgkmcnt(6)
  v_mfma_f32_16x16x32_bf16 v[48:51], v[216:219], a[40:43], v[48:51]
  ds_read_b64_tr_b16 v[200:201], v251 offset:24576
  v_mfma_f32_16x16x32_bf16 v[48:51], v[220:223], a[44:47], v[48:51]
  v_mfma_f32_16x16x32_bf16 v[52:55], v[216:219], a[104:107], v[52:55]
  ds_read_b64_tr_b16 v[202:203], v251 offset:24832
  v_mfma_f32_16x16x32_bf16 v[52:55], v[220:223], a[108:111], v[52:55]
  v_mfma_f32_16x16x32_bf16 v[56:59], v[216:219], a[168:171], v[56:59]
  ds_read_b64_tr_b16 v[204:205], v251 offset:26624
  v_mfma_f32_16x16x32_bf16 v[56:59], v[220:223], a[172:175], v[56:59]
  v_mfma_f32_16x16x32_bf16 v[60:63], v[216:219], a[232:235], v[60:63]
  ds_read_b64_tr_b16 v[206:207], v251 offset:26880
  buffer_load_dwordx4 v246, s[20:23], s48 offen offset:2048 lds
  v_mfma_f32_16x16x32_bf16 v[60:63], v[220:223], a[236:239], v[60:63]
  s_waitcnt lgkmcnt(4)
  v_mfma_f32_16x16x32_bf16 v[64:67], v[192:195], a[40:43], v[64:67]
  ds_read_b64_tr_b16 v[208:209], v250 offset:28672
  v_mfma_f32_16x16x32_bf16 v[64:67], v[196:199], a[44:47], v[64:67]
  v_mfma_f32_16x16x32_bf16 v[68:71], v[192:195], a[104:107], v[68:71]
  ds_read_b64_tr_b16 v[210:211], v250 offset:28928
  v_mfma_f32_16x16x32_bf16 v[68:71], v[196:199], a[108:111], v[68:71]
  v_mfma_f32_16x16x32_bf16 v[72:75], v[192:195], a[168:171], v[72:75]
  ds_read_b64_tr_b16 v[212:213], v250 offset:30720
  v_mfma_f32_16x16x32_bf16 v[72:75], v[196:199], a[172:175], v[72:75]
  v_mfma_f32_16x16x32_bf16 v[76:79], v[192:195], a[232:235], v[76:79]
  ds_read_b64_tr_b16 v[214:215], v250 offset:30976
  v_mfma_f32_16x16x32_bf16 v[76:79], v[196:199], a[236:239], v[76:79]
  s_waitcnt lgkmcnt(4)
  v_mfma_f32_16x16x32_bf16 v[80:83], v[200:203], a[40:43], v[80:83]
  ds_read_b64_tr_b16 v[216:217], v251 offset:28672
  v_lshrrev_b32 v224, 4, v252
  v_mfma_f32_16x16x32_bf16 v[80:83], v[204:207], a[44:47], v[80:83]
  s_and_b32 s53, s46, 1
  v_mfma_f32_16x16x32_bf16 v[84:87], v[200:203], a[104:107], v[84:87]
  s_lshl_b32 s53, s53, 19
  ds_read_b64_tr_b16 v[218:219], v251 offset:28928
  v_mfma_f32_16x16x32_bf16 v[84:87], v[204:207], a[108:111], v[84:87]
  s_lshl_b32 s54, s44, 8
  v_mfma_f32_16x16x32_bf16 v[88:91], v[200:203], a[168:171], v[88:91]
  s_add_u32 s53, s53, s54
  ds_read_b64_tr_b16 v[220:221], v251 offset:30720
  v_mfma_f32_16x16x32_bf16 v[88:91], v[204:207], a[172:175], v[88:91]
  s_lshr_b32 s54, s46, 1
  buffer_load_dwordx4 v247, s[20:23], s48 offen offset:3072 lds
  v_mfma_f32_16x16x32_bf16 v[92:95], v[200:203], a[232:235], v[92:95]
  s_lshl_b32 s54, s54, 6
  ds_read_b64_tr_b16 v[222:223], v251 offset:30976
  v_mfma_f32_16x16x32_bf16 v[92:95], v[204:207], a[236:239], v[92:95]
  s_waitcnt vmcnt(12)
  s_barrier
  s_add_u32 s53, s53, s54
  s_waitcnt lgkmcnt(4)
  v_mfma_f32_16x16x32_bf16 v[96:99], v[208:211], a[40:43], v[96:99]
  ds_read_b64_tr_b16 v[192:193], v250 offset:32768
  v_lshrrev_b32 v227, 5, v224
  v_mfma_f32_16x16x32_bf16 v[96:99], v[212:215], a[44:47], v[96:99]
  v_lshlrev_b32 v227, 1, v227
  v_mfma_f32_16x16x32_bf16 v[100:103], v[208:211], a[104:107], v[100:103]
  ds_read_b64_tr_b16 v[194:195], v250 offset:33024
  v_mfma_f32_16x16x32_bf16 v[100:103], v[212:215], a[108:111], v[100:103]
  v_and_b32 v226, 3, v224
  v_mfma_f32_16x16x32_bf16 v[104:107], v[208:211], a[168:171], v[104:107]
  s_lshl_b32 s62, s2, 14
  ds_read_b64_tr_b16 v[196:197], v250 offset:34816
  s_lshl_b32 s63, s46, 12
  s_add_u32 s62, s62, s63
  buffer_load_dwordx4 v[188:191], v252, s[24:27], s62 offen offset:0
  v_mfma_f32_16x16x32_bf16 v[104:107], v[212:215], a[172:175], v[104:107]
  v_xor_b32 v226, v226, v227
  v_lshlrev_b32 v226, 4, v226
  v_mfma_f32_16x16x32_bf16 v[108:111], v[208:211], a[232:235], v[108:111]
  ds_read_b64_tr_b16 v[198:199], v250 offset:35072
  v_lshrrev_b32 v227, 2, v224
  v_mfma_f32_16x16x32_bf16 v[108:111], v[212:215], a[236:239], v[108:111]
  s_waitcnt lgkmcnt(4)
  v_lshlrev_b32 v227, 13, v227
  v_mfma_f32_16x16x32_bf16 v[112:115], v[216:219], a[40:43], v[112:115]
  ds_read_b64_tr_b16 v[200:201], v251 offset:32768
  buffer_load_dwordx4 v[188:191], v252, s[24:27], s62 offen offset:1024
  v_mfma_f32_16x16x32_bf16 v[112:115], v[220:223], a[44:47], v[112:115]
  v_add_u32 v226, v226, v227
  v_add_u32 v244, s53, v226
  v_mfma_f32_16x16x32_bf16 v[116:119], v[216:219], a[104:107], v[116:119]
  ds_read_b64_tr_b16 v[202:203], v251 offset:33024
  v_add_u32 v245, 130048, v244
  v_mfma_f32_16x16x32_bf16 v[116:119], v[220:223], a[108:111], v[116:119]
  v_add_u32 v246, 260096, v244
  v_mfma_f32_16x16x32_bf16 v[120:123], v[216:219], a[168:171], v[120:123]
  ds_read_b64_tr_b16 v[204:205], v251 offset:34816
  buffer_load_dwordx4 v[188:191], v252, s[24:27], s62 offen offset:2048
  v_mfma_f32_16x16x32_bf16 v[120:123], v[220:223], a[172:175], v[120:123]
  v_add_u32 v247, 390144, v244
  v_mfma_f32_16x16x32_bf16 v[124:127], v[216:219], a[232:235], v[124:127]
  ds_read_b64_tr_b16 v[206:207], v251 offset:35072
  v_mfma_f32_16x16x32_bf16 v[124:127], v[220:223], a[236:239], v[124:127]
  s_waitcnt lgkmcnt(4)
  v_mfma_f32_16x16x32_bf16 v[0:3], v[192:195], a[48:51], v[0:3]
  ds_read_b64_tr_b16 v[208:209], v250 offset:36864
  buffer_load_dwordx4 v[188:191], v252, s[24:27], s62 offen offset:3072
  v_mfma_f32_16x16x32_bf16 v[0:3], v[196:199], a[52:55], v[0:3]
  s_waitcnt vmcnt(8)
  v_mfma_f32_16x16x32_bf16 v[4:7], v[192:195], a[112:115], v[4:7]
  s_mov_b32 s48, 0
  ds_read_b64_tr_b16 v[210:211], v250 offset:37120
  s_mov_b32 s53, 16384
  s_cmp_ge_u32 s46, 2
  s_cmov_b32 s53, 40960
  s_add_u32 m0, s53, s60
  s_nop 0
  buffer_load_dwordx4 v244, s[24:27], s48 offen offset:0 lds
  v_mfma_f32_16x16x32_bf16 v[4:7], v[196:199], a[116:119], v[4:7]
  ds_read_b128 a[56:59], v248 offset:8192
  v_mfma_f32_16x16x32_bf16 v[8:11], v[192:195], a[176:179], v[8:11]
  ds_read_b64_tr_b16 v[212:213], v250 offset:38912
  v_mfma_f32_16x16x32_bf16 v[8:11], v[196:199], a[180:183], v[8:11]
  ds_read_b128 a[120:123], v248 offset:10240
  v_mfma_f32_16x16x32_bf16 v[12:15], v[192:195], a[240:243], v[12:15]
  ds_read_b64_tr_b16 v[214:215], v250 offset:39168
  v_mfma_f32_16x16x32_bf16 v[12:15], v[196:199], a[244:247], v[12:15]
  s_waitcnt lgkmcnt(6)
  ds_read_b128 a[184:187], v248 offset:12288
  v_mfma_f32_16x16x32_bf16 v[16:19], v[200:203], a[48:51], v[16:19]
  ds_read_b64_tr_b16 v[216:217], v251 offset:36864
  buffer_load_dwordx4 v245, s[24:27], s48 offen offset:1024 lds
  v_mfma_f32_16x16x32_bf16 v[16:19], v[204:207], a[52:55], v[16:19]
  ds_read_b128 a[248:251], v248 offset:14336
  v_mfma_f32_16x16x32_bf16 v[20:23], v[200:203], a[112:115], v[20:23]
  ds_read_b64_tr_b16 v[218:219], v251 offset:37120
  v_mfma_f32_16x16x32_bf16 v[20:23], v[204:207], a[116:119], v[20:23]
  ds_read_b128 a[60:63], v249 offset:8192
  v_mfma_f32_16x16x32_bf16 v[24:27], v[200:203], a[176:179], v[24:27]
  ds_read_b64_tr_b16 v[220:221], v251 offset:38912
  v_mfma_f32_16x16x32_bf16 v[24:27], v[204:207], a[180:183], v[24:27]
  ds_read_b128 a[124:127], v249 offset:10240
  v_mfma_f32_16x16x32_bf16 v[28:31], v[200:203], a[240:243], v[28:31]
  ds_read_b64_tr_b16 v[222:223], v251 offset:39168
  buffer_load_dwordx4 v246, s[24:27], s48 offen offset:2048 lds
  v_mfma_f32_16x16x32_bf16 v[28:31], v[204:207], a[244:247], v[28:31]
  s_waitcnt lgkmcnt(8)
  ds_read_b128 a[188:191], v249 offset:12288
  v_mfma_f32_16x16x32_bf16 v[32:35], v[208:211], a[48:51], v[32:35]
  ds_read_b64_tr_b16 v[192:193], v250 offset:40960
  v_mfma_f32_16x16x32_bf16 v[32:35], v[212:215], a[52:55], v[32:35]
  ds_read_b128 a[252:255], v249 offset:14336
  v_mfma_f32_16x16x32_bf16 v[36:39], v[208:211], a[112:115], v[36:39]
  ds_read_b64_tr_b16 v[194:195], v250 offset:41216
  v_mfma_f32_16x16x32_bf16 v[36:39], v[212:215], a[116:119], v[36:39]
  v_mfma_f32_16x16x32_bf16 v[40:43], v[208:211], a[176:179], v[40:43]
  ds_read_b64_tr_b16 v[196:197], v250 offset:43008
  buffer_load_dwordx4 v247, s[24:27], s48 offen offset:3072 lds
  v_mfma_f32_16x16x32_bf16 v[40:43], v[212:215], a[180:183], v[40:43]
  v_mfma_f32_16x16x32_bf16 v[44:47], v[208:211], a[240:243], v[44:47]
  s_mov_b32 s48, 1048576
  ds_read_b64_tr_b16 v[198:199], v250 offset:43264
  v_mfma_f32_16x16x32_bf16 v[44:47], v[212:215], a[244:247], v[44:47]
  s_mov_b32 s53, 65536
  s_waitcnt lgkmcnt(6)
  v_mfma_f32_16x16x32_bf16 v[48:51], v[216:219], a[48:51], v[48:51]
  s_cmp_ge_u32 s46, 2
  s_cmov_b32 s53, 90112
  ds_read_b64_tr_b16 v[200:201], v251 offset:40960
  v_mfma_f32_16x16x32_bf16 v[48:51], v[220:223], a[52:55], v[48:51]
  s_add_u32 m0, s53, s60
  v_mfma_f32_16x16x32_bf16 v[52:55], v[216:219], a[112:115], v[52:55]
  ds_read_b64_tr_b16 v[202:203], v251 offset:41216
  buffer_load_dwordx4 v244, s[24:27], s48 offen offset:0 lds
  v_mfma_f32_16x16x32_bf16 v[52:55], v[220:223], a[116:119], v[52:55]
  v_mfma_f32_16x16x32_bf16 v[56:59], v[216:219], a[176:179], v[56:59]
  ds_read_b64_tr_b16 v[204:205], v251 offset:43008
  v_mfma_f32_16x16x32_bf16 v[56:59], v[220:223], a[180:183], v[56:59]
  v_mfma_f32_16x16x32_bf16 v[60:63], v[216:219], a[240:243], v[60:63]
  ds_read_b64_tr_b16 v[206:207], v251 offset:43264
  v_mfma_f32_16x16x32_bf16 v[60:63], v[220:223], a[244:247], v[60:63]
  s_waitcnt lgkmcnt(4)
  v_mfma_f32_16x16x32_bf16 v[64:67], v[192:195], a[48:51], v[64:67]
  ds_read_b64_tr_b16 v[208:209], v250 offset:45056
  buffer_load_dwordx4 v245, s[24:27], s48 offen offset:1024 lds
  v_mfma_f32_16x16x32_bf16 v[64:67], v[196:199], a[52:55], v[64:67]
  v_mfma_f32_16x16x32_bf16 v[68:71], v[192:195], a[112:115], v[68:71]
  ds_read_b64_tr_b16 v[210:211], v250 offset:45312
  v_mfma_f32_16x16x32_bf16 v[68:71], v[196:199], a[116:119], v[68:71]
  v_mfma_f32_16x16x32_bf16 v[72:75], v[192:195], a[176:179], v[72:75]
  ds_read_b64_tr_b16 v[212:213], v250 offset:47104
  v_mfma_f32_16x16x32_bf16 v[72:75], v[196:199], a[180:183], v[72:75]
  v_mfma_f32_16x16x32_bf16 v[76:79], v[192:195], a[240:243], v[76:79]
  ds_read_b64_tr_b16 v[214:215], v250 offset:47360
  buffer_load_dwordx4 v246, s[24:27], s48 offen offset:2048 lds
  v_mfma_f32_16x16x32_bf16 v[76:79], v[196:199], a[244:247], v[76:79]
  s_waitcnt lgkmcnt(4)
  v_mfma_f32_16x16x32_bf16 v[80:83], v[200:203], a[48:51], v[80:83]
  ds_read_b64_tr_b16 v[216:217], v251 offset:45056
  v_mfma_f32_16x16x32_bf16 v[80:83], v[204:207], a[52:55], v[80:83]
  v_mfma_f32_16x16x32_bf16 v[84:87], v[200:203], a[112:115], v[84:87]
  ds_read_b64_tr_b16 v[218:219], v251 offset:45312
  v_mfma_f32_16x16x32_bf16 v[84:87], v[204:207], a[116:119], v[84:87]
  v_mfma_f32_16x16x32_bf16 v[88:91], v[200:203], a[176:179], v[88:91]
  ds_read_b64_tr_b16 v[220:221], v251 offset:47104
  buffer_load_dwordx4 v247, s[24:27], s48 offen offset:3072 lds
  v_mfma_f32_16x16x32_bf16 v[88:91], v[204:207], a[180:183], v[88:91]
  v_mfma_f32_16x16x32_bf16 v[92:95], v[200:203], a[240:243], v[92:95]
  ds_read_b64_tr_b16 v[222:223], v251 offset:47360
  v_mfma_f32_16x16x32_bf16 v[92:95], v[204:207], a[244:247], v[92:95]
  s_waitcnt vmcnt(12)
  s_barrier
  s_waitcnt lgkmcnt(4)
  v_mfma_f32_16x16x32_bf16 v[96:99], v[208:211], a[48:51], v[96:99]
  ds_read_b64_tr_b16 v[192:193], v250 offset:49152
  v_mfma_f32_16x16x32_bf16 v[96:99], v[212:215], a[52:55], v[96:99]
  v_mfma_f32_16x16x32_bf16 v[100:103], v[208:211], a[112:115], v[100:103]
  ds_read_b64_tr_b16 v[194:195], v250 offset:49408
  v_mfma_f32_16x16x32_bf16 v[100:103], v[212:215], a[116:119], v[100:103]
  v_mfma_f32_16x16x32_bf16 v[104:107], v[208:211], a[176:179], v[104:107]
  ds_read_b64_tr_b16 v[196:197], v250 offset:51200
  v_mfma_f32_16x16x32_bf16 v[104:107], v[212:215], a[180:183], v[104:107]
  v_mfma_f32_16x16x32_bf16 v[108:111], v[208:211], a[240:243], v[108:111]
  ds_read_b64_tr_b16 v[198:199], v250 offset:51456
  v_mfma_f32_16x16x32_bf16 v[108:111], v[212:215], a[244:247], v[108:111]
  s_waitcnt lgkmcnt(4)
  v_mfma_f32_16x16x32_bf16 v[112:115], v[216:219], a[48:51], v[112:115]
  ds_read_b64_tr_b16 v[200:201], v251 offset:49152
  v_mfma_f32_16x16x32_bf16 v[112:115], v[220:223], a[52:55], v[112:115]
  v_mfma_f32_16x16x32_bf16 v[116:119], v[216:219], a[112:115], v[116:119]
  ds_read_b64_tr_b16 v[202:203], v251 offset:49408
  v_mfma_f32_16x16x32_bf16 v[116:119], v[220:223], a[116:119], v[116:119]
  v_mfma_f32_16x16x32_bf16 v[120:123], v[216:219], a[176:179], v[120:123]
  ds_read_b64_tr_b16 v[204:205], v251 offset:51200
  v_mfma_f32_16x16x32_bf16 v[120:123], v[220:223], a[180:183], v[120:123]
  v_mfma_f32_16x16x32_bf16 v[124:127], v[216:219], a[240:243], v[124:127]
  ds_read_b64_tr_b16 v[206:207], v251 offset:51456
  v_mfma_f32_16x16x32_bf16 v[124:127], v[220:223], a[244:247], v[124:127]
  s_waitcnt lgkmcnt(4)
  v_mfma_f32_16x16x32_bf16 v[0:3], v[192:195], a[56:59], v[0:3]
  ds_read_b64_tr_b16 v[208:209], v250 offset:53248
  v_mfma_f32_16x16x32_bf16 v[0:3], v[196:199], a[60:63], v[0:3]
  v_mfma_f32_16x16x32_bf16 v[4:7], v[192:195], a[120:123], v[4:7]
  ds_read_b64_tr_b16 v[210:211], v250 offset:53504
  v_mfma_f32_16x16x32_bf16 v[4:7], v[196:199], a[124:127], v[4:7]
  v_mfma_f32_16x16x32_bf16 v[8:11], v[192:195], a[184:187], v[8:11]
  ds_read_b64_tr_b16 v[212:213], v250 offset:55296
  v_mfma_f32_16x16x32_bf16 v[8:11], v[196:199], a[188:191], v[8:11]
  v_mfma_f32_16x16x32_bf16 v[12:15], v[192:195], a[248:251], v[12:15]
  ds_read_b64_tr_b16 v[214:215], v250 offset:55552
  v_mfma_f32_16x16x32_bf16 v[12:15], v[196:199], a[252:255], v[12:15]
  s_waitcnt lgkmcnt(4)
  v_mfma_f32_16x16x32_bf16 v[16:19], v[200:203], a[56:59], v[16:19]
  ds_read_b64_tr_b16 v[216:217], v251 offset:53248
  v_mfma_f32_16x16x32_bf16 v[16:19], v[204:207], a[60:63], v[16:19]
  v_mfma_f32_16x16x32_bf16 v[20:23], v[200:203], a[120:123], v[20:23]
  ds_read_b64_tr_b16 v[218:219], v251 offset:53504
  v_mfma_f32_16x16x32_bf16 v[20:23], v[204:207], a[124:127], v[20:23]
  v_mfma_f32_16x16x32_bf16 v[24:27], v[200:203], a[184:187], v[24:27]
  ds_read_b64_tr_b16 v[220:221], v251 offset:55296
  v_mfma_f32_16x16x32_bf16 v[24:27], v[204:207], a[188:191], v[24:27]
  v_mfma_f32_16x16x32_bf16 v[28:31], v[200:203], a[248:251], v[28:31]
  ds_read_b64_tr_b16 v[222:223], v251 offset:55552
  v_mfma_f32_16x16x32_bf16 v[28:31], v[204:207], a[252:255], v[28:31]
  s_waitcnt lgkmcnt(4)
  v_mfma_f32_16x16x32_bf16 v[32:35], v[208:211], a[56:59], v[32:35]
  ds_read_b64_tr_b16 v[192:193], v250 offset:57344
  v_mfma_f32_16x16x32_bf16 v[32:35], v[212:215], a[60:63], v[32:35]
  v_mfma_f32_16x16x32_bf16 v[36:39], v[208:211], a[120:123], v[36:39]
  ds_read_b64_tr_b16 v[194:195], v250 offset:57600
  v_mfma_f32_16x16x32_bf16 v[36:39], v[212:215], a[124:127], v[36:39]
  v_mfma_f32_16x16x32_bf16 v[40:43], v[208:211], a[184:187], v[40:43]
  ds_read_b64_tr_b16 v[196:197], v250 offset:59392
  v_mfma_f32_16x16x32_bf16 v[40:43], v[212:215], a[188:191], v[40:43]
  v_mfma_f32_16x16x32_bf16 v[44:47], v[208:211], a[248:251], v[44:47]
  ds_read_b64_tr_b16 v[198:199], v250 offset:59648
  v_mfma_f32_16x16x32_bf16 v[44:47], v[212:215], a[252:255], v[44:47]
  s_waitcnt lgkmcnt(4)
  v_mfma_f32_16x16x32_bf16 v[48:51], v[216:219], a[56:59], v[48:51]
  ds_read_b64_tr_b16 v[200:201], v251 offset:57344
  v_mfma_f32_16x16x32_bf16 v[48:51], v[220:223], a[60:63], v[48:51]
  v_mfma_f32_16x16x32_bf16 v[52:55], v[216:219], a[120:123], v[52:55]
  ds_read_b64_tr_b16 v[202:203], v251 offset:57600
  v_mfma_f32_16x16x32_bf16 v[52:55], v[220:223], a[124:127], v[52:55]
  v_mfma_f32_16x16x32_bf16 v[56:59], v[216:219], a[184:187], v[56:59]
  ds_read_b64_tr_b16 v[204:205], v251 offset:59392
  v_mfma_f32_16x16x32_bf16 v[56:59], v[220:223], a[188:191], v[56:59]
  v_mfma_f32_16x16x32_bf16 v[60:63], v[216:219], a[248:251], v[60:63]
  ds_read_b64_tr_b16 v[206:207], v251 offset:59648
  v_mfma_f32_16x16x32_bf16 v[60:63], v[220:223], a[252:255], v[60:63]
  s_waitcnt lgkmcnt(4)
  v_mfma_f32_16x16x32_bf16 v[64:67], v[192:195], a[56:59], v[64:67]
  ds_read_b64_tr_b16 v[208:209], v250 offset:61440
  v_mfma_f32_16x16x32_bf16 v[64:67], v[196:199], a[60:63], v[64:67]
  v_mfma_f32_16x16x32_bf16 v[68:71], v[192:195], a[120:123], v[68:71]
  ds_read_b64_tr_b16 v[210:211], v250 offset:61696
  v_mfma_f32_16x16x32_bf16 v[68:71], v[196:199], a[124:127], v[68:71]
  v_mfma_f32_16x16x32_bf16 v[72:75], v[192:195], a[184:187], v[72:75]
  ds_read_b64_tr_b16 v[212:213], v250 offset:63488
  v_mfma_f32_16x16x32_bf16 v[72:75], v[196:199], a[188:191], v[72:75]
  v_mfma_f32_16x16x32_bf16 v[76:79], v[192:195], a[248:251], v[76:79]
  ds_read_b64_tr_b16 v[214:215], v250 offset:63744
  v_mfma_f32_16x16x32_bf16 v[76:79], v[196:199], a[252:255], v[76:79]
  s_waitcnt lgkmcnt(4)
  v_mfma_f32_16x16x32_bf16 v[80:83], v[200:203], a[56:59], v[80:83]
  ds_read_b64_tr_b16 v[216:217], v251 offset:61440
  v_mfma_f32_16x16x32_bf16 v[80:83], v[204:207], a[60:63], v[80:83]
  v_mfma_f32_16x16x32_bf16 v[84:87], v[200:203], a[120:123], v[84:87]
  ds_read_b64_tr_b16 v[218:219], v251 offset:61696
  v_mfma_f32_16x16x32_bf16 v[84:87], v[204:207], a[124:127], v[84:87]
  v_mfma_f32_16x16x32_bf16 v[88:91], v[200:203], a[184:187], v[88:91]
  ds_read_b64_tr_b16 v[220:221], v251 offset:63488
  v_mfma_f32_16x16x32_bf16 v[88:91], v[204:207], a[188:191], v[88:91]
  v_mfma_f32_16x16x32_bf16 v[92:95], v[200:203], a[248:251], v[92:95]
  ds_read_b64_tr_b16 v[222:223], v251 offset:63744
  v_mfma_f32_16x16x32_bf16 v[92:95], v[204:207], a[252:255], v[92:95]
  v_add_u32 v250, 0xfffec000, v250
  v_add_u32 v251, 0xfffec000, v251
  s_waitcnt vmcnt(0)
  s_barrier
  s_waitcnt lgkmcnt(4)
  v_mfma_f32_16x16x32_bf16 v[96:99], v[208:211], a[56:59], v[96:99]
  ds_read_b64_tr_b16 v[192:193], v250 offset:0
  v_mfma_f32_16x16x32_bf16 v[96:99], v[212:215], a[60:63], v[96:99]
  ds_read_b64_tr_b16 v[194:195], v250 offset:256
  s_cmp_lg_u32 s46, 0
  s_cbranch_scc1 L_sig_ln
  s_and_b32 s62, s2, 31
  s_lshl_b32 s62, s62, 2
  v_mov_b32 v254, s62
  v_mov_b32 v255, 1
  s_mov_b64 exec, 1
  global_atomic_add v254, v255, s[100:101] sc1
  s_mov_b64 exec, -1
L_sig_ln:
  v_mfma_f32_16x16x32_bf16 v[100:103], v[208:211], a[120:123], v[100:103]
  ds_read_b64_tr_b16 v[196:197], v250 offset:2048
  v_mfma_f32_16x16x32_bf16 v[100:103], v[212:215], a[124:127], v[100:103]
  ds_read_b64_tr_b16 v[198:199], v250 offset:2304
  v_mfma_f32_16x16x32_bf16 v[104:107], v[208:211], a[184:187], v[104:107]
  s_mov_b32 s48, 2097152
  ds_read_b64_tr_b16 v[200:201], v250 offset:4096
  s_mov_b32 s53, 0
  s_cmp_ge_u32 s46, 2
  s_cmov_b32 s53, 24576
  s_add_u32 m0, s53, s60
  s_nop 0
  buffer_load_dwordx4 v244, s[24:27], s48 offen offset:0 lds
  v_mfma_f32_16x16x32_bf16 v[104:107], v[212:215], a[188:191], v[104:107]
  ds_read_b64_tr_b16 v[202:203], v250 offset:4352
  v_mfma_f32_16x16x32_bf16 v[108:111], v[208:211], a[248:251], v[108:111]
  ds_read_b64_tr_b16 v[204:205], v250 offset:6144
  v_mfma_f32_16x16x32_bf16 v[108:111], v[212:215], a[252:255], v[108:111]
  s_waitcnt lgkmcnt(7)
  ds_read_b64_tr_b16 v[206:207], v250 offset:6400
  v_mfma_f32_16x16x32_bf16 v[112:115], v[216:219], a[56:59], v[112:115]
  v_mfma_f32_16x16x32_bf16 v[112:115], v[220:223], a[60:63], v[112:115]
  v_mfma_f32_16x16x32_bf16 v[116:119], v[216:219], a[120:123], v[116:119]
  v_mfma_f32_16x16x32_bf16 v[116:119], v[220:223], a[124:127], v[116:119]
  buffer_load_dwordx4 v245, s[24:27], s48 offen offset:1024 lds
  v_mfma_f32_16x16x32_bf16 v[120:123], v[216:219], a[184:187], v[120:123]
  v_mfma_f32_16x16x32_bf16 v[120:123], v[220:223], a[188:191], v[120:123]
  v_mfma_f32_16x16x32_bf16 v[124:127], v[216:219], a[248:251], v[124:127]
  v_mfma_f32_16x16x32_bf16 v[124:127], v[220:223], a[252:255], v[124:127]
  s_waitcnt lgkmcnt(0)
  v_mfma_f32_16x16x32_bf16 v[128:131], a[0:3], v[192:195], 0
  ds_read_b64_tr_b16 v[208:209], v251 offset:0
  v_mfma_f32_16x16x32_bf16 v[128:131], a[4:7], v[196:199], v[128:131]
  ds_read_b64_tr_b16 v[210:211], v251 offset:256
  v_mfma_f32_16x16x32_bf16 v[128:131], a[8:11], v[200:203], v[128:131]
  ds_read_b64_tr_b16 v[212:213], v251 offset:2048
  v_mfma_f32_16x16x32_bf16 v[128:131], a[12:15], v[204:207], v[128:131]
  ds_read_b64_tr_b16 v[214:215], v251 offset:2304
  buffer_load_dwordx4 v246, s[24:27], s48 offen offset:2048 lds
  v_mfma_f32_16x16x32_bf16 v[132:135], a[64:67], v[192:195], 0
  ds_read_b64_tr_b16 v[216:217], v251 offset:4096
  v_mul_f32 v0, s57, v0
  v_mfma_f32_16x16x32_bf16 v[132:135], a[68:71], v[196:199], v[132:135]
  ds_read_b64_tr_b16 v[218:219], v251 offset:4352
  v_mul_f32 v1, s57, v1
  v_mfma_f32_16x16x32_bf16 v[132:135], a[72:75], v[200:203], v[132:135]
  ds_read_b64_tr_b16 v[220:221], v251 offset:6144
  v_mul_f32 v2, s57, v2
  v_mfma_f32_16x16x32_bf16 v[132:135], a[76:79], v[204:207], v[132:135]
  ds_read_b64_tr_b16 v[222:223], v251 offset:6400
  v_mul_f32 v3, s57, v3
  v_mfma_f32_16x16x32_bf16 v[136:139], a[128:131], v[192:195], 0
  v_mul_f32 v16, s57, v16
  v_mfma_f32_16x16x32_bf16 v[136:139], a[132:135], v[196:199], v[136:139]
  v_mul_f32 v17, s57, v17
  v_mfma_f32_16x16x32_bf16 v[136:139], a[136:139], v[200:203], v[136:139]
  buffer_load_dwordx4 v247, s[24:27], s48 offen offset:3072 lds
  v_mfma_f32_16x16x32_bf16 v[136:139], a[140:143], v[204:207], v[136:139]
  v_mul_f32 v18, s57, v18
  v_mfma_f32_16x16x32_bf16 v[140:143], a[192:195], v[192:195], 0
  v_mul_f32 v19, s57, v19
  v_mfma_f32_16x16x32_bf16 v[140:143], a[196:199], v[196:199], v[140:143]
  v_cvt_pk_bf16_f32 v0, v0, v1
  v_mfma_f32_16x16x32_bf16 v[140:143], a[200:203], v[200:203], v[140:143]
  s_mov_b32 s48, 3145728
  v_cvt_pk_bf16_f32 v1, v2, v3
  v_mfma_f32_16x16x32_bf16 v[140:143], a[204:207], v[204:207], v[140:143]
  s_mov_b32 s53, 49152
  v_cvt_pk_bf16_f32 v2, v16, v17
  s_waitcnt lgkmcnt(0)
  v_mfma_f32_16x16x32_bf16 v[144:147], a[0:3], v[208:211], 0
  s_cmp_ge_u32 s46, 2
  s_cmov_b32 s53, 73728
  ds_read_b64_tr_b16 v[192:193], v250 offset:24576
  v_mfma_f32_16x16x32_bf16 v[144:147], a[4:7], v[212:215], v[144:147]
  s_add_u32 m0, s53, s60
  ds_read_b64_tr_b16 v[194:195], v250 offset:24832
  v_cvt_pk_bf16_f32 v3, v18, v19
  v_mfma_f32_16x16x32_bf16 v[144:147], a[8:11], v[216:219], v[144:147]
  ds_read_b64_tr_b16 v[196:197], v250 offset:26624
  buffer_load_dwordx4 v244, s[24:27], s48 offen offset:0 lds
  v_mfma_f32_16x16x32_bf16 v[144:147], a[12:15], v[220:223], v[144:147]
  ds_read_b64_tr_b16 v[198:199], v250 offset:26880
  v_mul_f32 v4, s57, v4
  v_mfma_f32_16x16x32_bf16 v[148:151], a[64:67], v[208:211], 0
  ds_read_b64_tr_b16 v[200:201], v250 offset:28672
  v_mul_f32 v5, s57, v5
  v_mfma_f32_16x16x32_bf16 v[148:151], a[68:71], v[212:215], v[148:151]
  ds_read_b64_tr_b16 v[202:203], v250 offset:28928
  v_mul_f32 v6, s57, v6
  v_mfma_f32_16x16x32_bf16 v[148:151], a[72:75], v[216:219], v[148:151]
  ds_read_b64_tr_b16 v[204:205], v250 offset:30720
  v_mul_f32 v7, s57, v7
  v_mfma_f32_16x16x32_bf16 v[148:151], a[76:79], v[220:223], v[148:151]
  ds_read_b64_tr_b16 v[206:207], v250 offset:30976
  v_mul_f32 v20, s57, v20
  v_mfma_f32_16x16x32_bf16 v[152:155], a[128:131], v[208:211], 0
  v_mul_f32 v21, s57, v21
  v_mfma_f32_16x16x32_bf16 v[152:155], a[132:135], v[212:215], v[152:155]
  buffer_load_dwordx4 v245, s[24:27], s48 offen offset:1024 lds
  v_mfma_f32_16x16x32_bf16 v[152:155], a[136:139], v[216:219], v[152:155]
  v_mul_f32 v22, s57, v22
  v_mul_f32 v23, s57, v23
  v_mfma_f32_16x16x32_bf16 v[152:155], a[140:143], v[220:223], v[152:155]
  v_cvt_pk_bf16_f32 v4, v4, v5
  v_mfma_f32_16x16x32_bf16 v[156:159], a[192:195], v[208:211], 0
  v_cvt_pk_bf16_f32 v5, v6, v7
  v_mfma_f32_16x16x32_bf16 v[156:159], a[196:199], v[212:215], v[156:159]
  v_cvt_pk_bf16_f32 v6, v20, v21
  v_mfma_f32_16x16x32_bf16 v[156:159], a[200:203], v[216:219], v[156:159]
  v_cvt_pk_bf16_f32 v7, v22, v23
  v_mfma_f32_16x16x32_bf16 v[156:159], a[204:207], v[220:223], v[156:159]
  s_waitcnt lgkmcnt(0)
  v_mfma_f32_16x16x32_bf16 v[160:163], a[0:3], v[192:195], 0
  ds_read_b64_tr_b16 v[208:209], v251 offset:24576
  v_mul_f32 v8, s57, v8
  v_mfma_f32_16x16x32_bf16 v[160:163], a[4:7], v[196:199], v[160:163]
  ds_read_b64_tr_b16 v[210:211], v251 offset:24832
  buffer_load_dwordx4 v246, s[24:27], s48 offen offset:2048 lds
  v_mfma_f32_16x16x32_bf16 v[160:163], a[8:11], v[200:203], v[160:163]
  ds_read_b64_tr_b16 v[212:213], v251 offset:26624
  v_mul_f32 v9, s57, v9
  v_mfma_f32_16x16x32_bf16 v[160:163], a[12:15], v[204:207], v[160:163]
  ds_read_b64_tr_b16 v[214:215], v251 offset:26880
  v_mul_f32 v10, s57, v10
  v_mfma_f32_16x16x32_bf16 v[164:167], a[64:67], v[192:195], 0
  ds_read_b64_tr_b16 v[216:217], v251 offset:28672
  v_mul_f32 v11, s57, v11
  v_mfma_f32_16x16x32_bf16 v[164:167], a[68:71], v[196:199], v[164:167]
  ds_read_b64_tr_b16 v[218:219], v251 offset:28928
  v_mul_f32 v24, s57, v24
  v_mfma_f32_16x16x32_bf16 v[164:167], a[72:75], v[200:203], v[164:167]
  ds_read_b64_tr_b16 v[220:221], v251 offset:30720
  v_mul_f32 v25, s57, v25
  v_mfma_f32_16x16x32_bf16 v[164:167], a[76:79], v[204:207], v[164:167]
  ds_read_b64_tr_b16 v[222:223], v251 offset:30976
  v_mul_f32 v26, s57, v26
  v_mfma_f32_16x16x32_bf16 v[168:171], a[128:131], v[192:195], 0
  buffer_load_dwordx4 v247, s[24:27], s48 offen offset:3072 lds
  v_mfma_f32_16x16x32_bf16 v[168:171], a[132:135], v[196:199], v[168:171]
  v_mul_f32 v27, s57, v27
  v_cvt_pk_bf16_f32 v8, v8, v9
  v_mfma_f32_16x16x32_bf16 v[168:171], a[136:139], v[200:203], v[168:171]
  v_cvt_pk_bf16_f32 v9, v10, v11
  v_mfma_f32_16x16x32_bf16 v[168:171], a[140:143], v[204:207], v[168:171]
  v_cvt_pk_bf16_f32 v10, v24, v25
  v_mfma_f32_16x16x32_bf16 v[172:175], a[192:195], v[192:195], 0
  v_cvt_pk_bf16_f32 v11, v26, v27
  v_mfma_f32_16x16x32_bf16 v[172:175], a[196:199], v[196:199], v[172:175]
  v_mfma_f32_16x16x32_bf16 v[172:175], a[200:203], v[200:203], v[172:175]
  v_mul_f32 v12, s57, v12
  v_mfma_f32_16x16x32_bf16 v[172:175], a[204:207], v[204:207], v[172:175]
  s_waitcnt lgkmcnt(0)
  v_add_u32 v250, 0xc000, v250
  v_add_u32 v251, 0xc000, v251
  v_mfma_f32_16x16x32_bf16 v[176:179], a[0:3], v[208:211], 0
  ds_read_b64_tr_b16 v[192:193], v250 offset:0
  v_mul_f32 v13, s57, v13
  buffer_store_dwordx4 v[0:3], v252, s[28:31], s49 offen offset:0 sc1
  v_mfma_f32_16x16x32_bf16 v[176:179], a[4:7], v[212:215], v[176:179]
  ds_read_b64_tr_b16 v[194:195], v250 offset:256
  v_mul_f32 v14, s57, v14
  v_mfma_f32_16x16x32_bf16 v[176:179], a[8:11], v[216:219], v[176:179]
  s_mov_b32 s48, 128
  ds_read_b64_tr_b16 v[196:197], v250 offset:2048
  s_mov_b32 s53, 8192
  s_cmp_ge_u32 s46, 2
  s_cmov_b32 s53, 32768
  s_add_u32 m0, s53, s60
  s_nop 0
  buffer_load_dwordx4 v244, s[24:27], s48 offen offset:0 lds
  v_mfma_f32_16x16x32_bf16 v[176:179], a[12:15], v[220:223], v[176:179]
  ds_read_b64_tr_b16 v[198:199], v250 offset:2304
  v_mul_f32 v15, s57, v15
  v_mfma_f32_16x16x32_bf16 v[180:183], a[64:67], v[208:211], 0
  ds_read_b64_tr_b16 v[200:201], v250 offset:4096
  v_mul_f32 v28, s57, v28
  v_mfma_f32_16x16x32_bf16 v[180:183], a[68:71], v[212:215], v[180:183]
  ds_read_b64_tr_b16 v[202:203], v250 offset:4352
  v_mul_f32 v29, s57, v29
  v_mfma_f32_16x16x32_bf16 v[180:183], a[72:75], v[216:219], v[180:183]
  ds_read_b64_tr_b16 v[204:205], v250 offset:6144
  v_mul_f32 v30, s57, v30
  v_mfma_f32_16x16x32_bf16 v[180:183], a[76:79], v[220:223], v[180:183]
  ds_read_b64_tr_b16 v[206:207], v250 offset:6400
  v_mul_f32 v31, s57, v31
  v_mfma_f32_16x16x32_bf16 v[184:187], a[128:131], v[208:211], 0
  v_cvt_pk_bf16_f32 v12, v12, v13
  v_cvt_pk_bf16_f32 v13, v14, v15
  v_mfma_f32_16x16x32_bf16 v[184:187], a[132:135], v[212:215], v[184:187]
  v_cvt_pk_bf16_f32 v14, v28, v29
  v_mfma_f32_16x16x32_bf16 v[184:187], a[136:139], v[216:219], v[184:187]
  buffer_load_dwordx4 v245, s[24:27], s48 offen offset:1024 lds
  v_mfma_f32_16x16x32_bf16 v[184:187], a[140:143], v[220:223], v[184:187]
  v_cvt_pk_bf16_f32 v15, v30, v31
  v_mfma_f32_16x16x32_bf16 v[188:191], a[192:195], v[208:211], 0
  v_mul_f32 v32, s57, v32
  v_mfma_f32_16x16x32_bf16 v[188:191], a[196:199], v[212:215], v[188:191]
  v_mul_f32 v33, s57, v33
  v_mfma_f32_16x16x32_bf16 v[188:191], a[200:203], v[216:219], v[188:191]
  v_mul_f32 v34, s57, v34
  v_mfma_f32_16x16x32_bf16 v[188:191], a[204:207], v[220:223], v[188:191]
  s_waitcnt lgkmcnt(0)
  v_mul_f32 v35, s57, v35
  v_mfma_f32_16x16x32_bf16 v[128:131], a[16:19], v[192:195], v[128:131]
  ds_read_b64_tr_b16 v[208:209], v251 offset:0
  v_mul_f32 v48, s57, v48
  v_mfma_f32_16x16x32_bf16 v[128:131], a[20:23], v[196:199], v[128:131]
  ds_read_b64_tr_b16 v[210:211], v251 offset:256
  v_mul_f32 v49, s57, v49
  v_mfma_f32_16x16x32_bf16 v[128:131], a[24:27], v[200:203], v[128:131]
  ds_read_b64_tr_b16 v[212:213], v251 offset:2048
  v_mfma_f32_16x16x32_bf16 v[128:131], a[28:31], v[204:207], v[128:131]
  ds_read_b64_tr_b16 v[214:215], v251 offset:2304
  buffer_load_dwordx4 v246, s[24:27], s48 offen offset:2048 lds
  v_mfma_f32_16x16x32_bf16 v[132:135], a[80:83], v[192:195], v[132:135]
  ds_read_b64_tr_b16 v[216:217], v251 offset:4096
  v_mul_f32 v50, s57, v50
  v_mfma_f32_16x16x32_bf16 v[132:135], a[84:87], v[196:199], v[132:135]
  ds_read_b64_tr_b16 v[218:219], v251 offset:4352
  v_mul_f32 v51, s57, v51
  v_mfma_f32_16x16x32_bf16 v[132:135], a[88:91], v[200:203], v[132:135]
  ds_read_b64_tr_b16 v[220:221], v251 offset:6144
  v_cvt_pk_bf16_f32 v32, v32, v33
  v_mfma_f32_16x16x32_bf16 v[132:135], a[92:95], v[204:207], v[132:135]
  ds_read_b64_tr_b16 v[222:223], v251 offset:6400
  v_cvt_pk_bf16_f32 v33, v34, v35
  v_mfma_f32_16x16x32_bf16 v[136:139], a[144:147], v[192:195], v[136:139]
  v_cvt_pk_bf16_f32 v34, v48, v49
  v_cvt_pk_bf16_f32 v35, v50, v51
  v_mfma_f32_16x16x32_bf16 v[136:139], a[148:151], v[196:199], v[136:139]
  buffer_store_dwordx4 v[4:7], v252, s[28:31], s50 offen offset:0 sc1
  v_mfma_f32_16x16x32_bf16 v[136:139], a[152:155], v[200:203], v[136:139]
  v_mul_f32 v36, s57, v36
  v_mfma_f32_16x16x32_bf16 v[136:139], a[156:159], v[204:207], v[136:139]
  buffer_load_dwordx4 v247, s[24:27], s48 offen offset:3072 lds
  v_mfma_f32_16x16x32_bf16 v[140:143], a[208:211], v[192:195], v[140:143]
  v_mul_f32 v37, s57, v37
  v_mul_f32 v38, s57, v38
  v_mfma_f32_16x16x32_bf16 v[140:143], a[212:215], v[196:199], v[140:143]
  v_mul_f32 v39, s57, v39
  v_mfma_f32_16x16x32_bf16 v[140:143], a[216:219], v[200:203], v[140:143]
  v_mul_f32 v52, s57, v52
  v_mfma_f32_16x16x32_bf16 v[140:143], a[220:223], v[204:207], v[140:143]
  s_waitcnt lgkmcnt(0)
  v_mul_f32 v53, s57, v53
  v_mfma_f32_16x16x32_bf16 v[144:147], a[16:19], v[208:211], v[144:147]
  s_mov_b32 s48, 1048704
  ds_read_b64_tr_b16 v[192:193], v250 offset:24576
  v_mfma_f32_16x16x32_bf16 v[144:147], a[20:23], v[212:215], v[144:147]
  s_mov_b32 s53, 57344
  ds_read_b64_tr_b16 v[194:195], v250 offset:24832
  v_mul_f32 v54, s57, v54
  v_mfma_f32_16x16x32_bf16 v[144:147], a[24:27], v[216:219], v[144:147]
  s_cmp_ge_u32 s46, 2
  s_cmov_b32 s53, 81920
  ds_read_b64_tr_b16 v[196:197], v250 offset:26624
  v_mfma_f32_16x16x32_bf16 v[144:147], a[28:31], v[220:223], v[144:147]
  s_add_u32 m0, s53, s60
  ds_read_b64_tr_b16 v[198:199], v250 offset:26880
  v_mul_f32 v55, s57, v55
  v_mfma_f32_16x16x32_bf16 v[148:151], a[80:83], v[208:211], v[148:151]
  ds_read_b64_tr_b16 v[200:201], v250 offset:28672
  buffer_load_dwordx4 v244, s[24:27], s48 offen offset:0 lds
  v_mfma_f32_16x16x32_bf16 v[148:151], a[84:87], v[212:215], v[148:151]
  ds_read_b64_tr_b16 v[202:203], v250 offset:28928
  v_cvt_pk_bf16_f32 v36, v36, v37
  v_mfma_f32_16x16x32_bf16 v[148:151], a[88:91], v[216:219], v[148:151]
  ds_read_b64_tr_b16 v[204:205], v250 offset:30720
  v_cvt_pk_bf16_f32 v37, v38, v39
  v_mfma_f32_16x16x32_bf16 v[148:151], a[92:95], v[220:223], v[148:151]
  ds_read_b64_tr_b16 v[206:207], v250 offset:30976
  v_cvt_pk_bf16_f32 v38, v52, v53
  v_mfma_f32_16x16x32_bf16 v[152:155], a[144:147], v[208:211], v[152:155]
  v_cvt_pk_bf16_f32 v39, v54, v55
  v_mul_f32 v40, s57, v40
  v_mfma_f32_16x16x32_bf16 v[152:155], a[148:151], v[212:215], v[152:155]
  v_mul_f32 v41, s57, v41
  v_mfma_f32_16x16x32_bf16 v[152:155], a[152:155], v[216:219], v[152:155]
  v_mul_f32 v42, s57, v42
  v_mfma_f32_16x16x32_bf16 v[152:155], a[156:159], v[220:223], v[152:155]
  v_mul_f32 v43, s57, v43
  v_mfma_f32_16x16x32_bf16 v[156:159], a[208:211], v[208:211], v[156:159]
  buffer_load_dwordx4 v245, s[24:27], s48 offen offset:1024 lds
  v_mfma_f32_16x16x32_bf16 v[156:159], a[212:215], v[212:215], v[156:159]
  v_mul_f32 v56, s57, v56
  v_mul_f32 v57, s57, v57
  v_mfma_f32_16x16x32_bf16 v[156:159], a[216:219], v[216:219], v[156:159]
  v_mfma_f32_16x16x32_bf16 v[156:159], a[220:223], v[220:223], v[156:159]
  s_waitcnt lgkmcnt(0)
  v_mul_f32 v58, s57, v58
  v_mfma_f32_16x16x32_bf16 v[160:163], a[16:19], v[192:195], v[160:163]
  ds_read_b64_tr_b16 v[208:209], v251 offset:24576
  v_mul_f32 v59, s57, v59
  v_mfma_f32_16x16x32_bf16 v[160:163], a[20:23], v[196:199], v[160:163]
  ds_read_b64_tr_b16 v[210:211], v251 offset:24832
  v_cvt_pk_bf16_f32 v40, v40, v41
  v_mfma_f32_16x16x32_bf16 v[160:163], a[24:27], v[200:203], v[160:163]
  ds_read_b64_tr_b16 v[212:213], v251 offset:26624
  v_cvt_pk_bf16_f32 v41, v42, v43
  buffer_store_dwordx4 v[8:11], v252, s[28:31], s51 offen offset:0 sc1
  v_mfma_f32_16x16x32_bf16 v[160:163], a[28:31], v[204:207], v[160:163]
  ds_read_b64_tr_b16 v[214:215], v251 offset:26880
  v_cvt_pk_bf16_f32 v42, v56, v57
  v_mfma_f32_16x16x32_bf16 v[164:167], a[80:83], v[192:195], v[164:167]
  ds_read_b64_tr_b16 v[216:217], v251 offset:28672
  v_cvt_pk_bf16_f32 v43, v58, v59
  v_mfma_f32_16x16x32_bf16 v[164:167], a[84:87], v[196:199], v[164:167]
  ds_read_b64_tr_b16 v[218:219], v251 offset:28928
  buffer_load_dwordx4 v246, s[24:27], s48 offen offset:2048 lds
  v_mfma_f32_16x16x32_bf16 v[164:167], a[88:91], v[200:203], v[164:167]
  ds_read_b64_tr_b16 v[220:221], v251 offset:30720
  v_mul_f32 v44, s57, v44
  v_mfma_f32_16x16x32_bf16 v[164:167], a[92:95], v[204:207], v[164:167]
  ds_read_b64_tr_b16 v[222:223], v251 offset:30976
  v_mul_f32 v45, s57, v45
  v_mfma_f32_16x16x32_bf16 v[168:171], a[144:147], v[192:195], v[168:171]
  v_mul_f32 v46, s57, v46
  v_mfma_f32_16x16x32_bf16 v[168:171], a[148:151], v[196:199], v[168:171]
  v_mul_f32 v47, s57, v47
  v_mfma_f32_16x16x32_bf16 v[168:171], a[152:155], v[200:203], v[168:171]
  v_mul_f32 v60, s57, v60
  v_mfma_f32_16x16x32_bf16 v[168:171], a[156:159], v[204:207], v[168:171]
  v_mul_f32 v61, s57, v61
  v_mfma_f32_16x16x32_bf16 v[172:175], a[208:211], v[192:195], v[172:175]
  v_mfma_f32_16x16x32_bf16 v[172:175], a[212:215], v[196:199], v[172:175]
  buffer_load_dwordx4 v247, s[24:27], s48 offen offset:3072 lds
  v_mfma_f32_16x16x32_bf16 v[172:175], a[216:219], v[200:203], v[172:175]
  v_mul_f32 v62, s57, v62
  v_mul_f32 v63, s57, v63
  v_mfma_f32_16x16x32_bf16 v[172:175], a[220:223], v[204:207], v[172:175]
  v_add_u32 v250, 0xffff0000, v250
  v_add_u32 v251, 0xffff0000, v251
  s_waitcnt vmcnt(11)
  s_barrier
  s_waitcnt lgkmcnt(0)
  v_mfma_f32_16x16x32_bf16 v[176:179], a[16:19], v[208:211], v[176:179]
  ds_read_b64_tr_b16 v[192:193], v250 offset:0
  v_cvt_pk_bf16_f32 v44, v44, v45
  v_mfma_f32_16x16x32_bf16 v[176:179], a[20:23], v[212:215], v[176:179]
  ds_read_b64_tr_b16 v[194:195], v250 offset:256
  v_cvt_pk_bf16_f32 v45, v46, v47
  v_mfma_f32_16x16x32_bf16 v[176:179], a[24:27], v[216:219], v[176:179]
  ds_read_b64_tr_b16 v[196:197], v250 offset:2048
  v_cvt_pk_bf16_f32 v46, v60, v61
  v_mfma_f32_16x16x32_bf16 v[176:179], a[28:31], v[220:223], v[176:179]
  ds_read_b64_tr_b16 v[198:199], v250 offset:2304
  v_cvt_pk_bf16_f32 v47, v62, v63
  v_mfma_f32_16x16x32_bf16 v[180:183], a[80:83], v[208:211], v[180:183]
  ds_read_b64_tr_b16 v[200:201], v250 offset:4096
  v_mul_f32 v64, s57, v64
  v_mfma_f32_16x16x32_bf16 v[180:183], a[84:87], v[212:215], v[180:183]
  ds_read_b64_tr_b16 v[202:203], v250 offset:4352
  v_mul_f32 v65, s57, v65
  v_mfma_f32_16x16x32_bf16 v[180:183], a[88:91], v[216:219], v[180:183]
  ds_read_b64_tr_b16 v[204:205], v250 offset:6144
  v_mul_f32 v66, s57, v66
  v_mfma_f32_16x16x32_bf16 v[180:183], a[92:95], v[220:223], v[180:183]
  ds_read_b64_tr_b16 v[206:207], v250 offset:6400
  v_mul_f32 v67, s57, v67
  v_mfma_f32_16x16x32_bf16 v[184:187], a[144:147], v[208:211], v[184:187]
  v_mul_f32 v80, s57, v80
  v_mfma_f32_16x16x32_bf16 v[184:187], a[148:151], v[212:215], v[184:187]
  v_mul_f32 v81, s57, v81
  v_mfma_f32_16x16x32_bf16 v[184:187], a[152:155], v[216:219], v[184:187]
  s_mov_b32 s48, 2097280
  s_mov_b32 s53, 98304
  s_cmp_ge_u32 s46, 2
  s_cmov_b32 s53, 106496
  s_add_u32 m0, s53, s60
  s_nop 0
  buffer_load_dwordx4 v244, s[24:27], s48 offen offset:0 lds
  v_mfma_f32_16x16x32_bf16 v[184:187], a[156:159], v[220:223], v[184:187]
  v_lshrrev_b32 v253, 2, v252
  v_mul_f32 v82, s57, v82
  buffer_store_dwordx4 v[12:15], v252, s[28:31], s52 offen offset:0 sc1
  v_mfma_f32_16x16x32_bf16 v[188:191], a[208:211], v[208:211], v[188:191]
  v_and_b32 v253, 0x7c, v253
  v_mul_f32 v83, s57, v83
  v_mfma_f32_16x16x32_bf16 v[188:191], a[212:215], v[212:215], v[188:191]
  v_cvt_pk_bf16_f32 v64, v64, v65
  v_mfma_f32_16x16x32_bf16 v[188:191], a[216:219], v[216:219], v[188:191]
  v_cvt_pk_bf16_f32 v65, v66, v67
  v_mfma_f32_16x16x32_bf16 v[188:191], a[220:223], v[220:223], v[188:191]
  s_waitcnt lgkmcnt(0)
  v_cvt_pk_bf16_f32 v66, v80, v81
  v_mfma_f32_16x16x32_bf16 v[128:131], a[32:35], v[192:195], v[128:131]
  ds_read_b64_tr_b16 v[208:209], v251 offset:0
  global_load_dword v254, v253, s[100:101] sc1
  v_mfma_f32_16x16x32_bf16 v[128:131], a[36:39], v[196:199], v[128:131]
  ds_read_b64_tr_b16 v[210:211], v251 offset:256
  v_cvt_pk_bf16_f32 v67, v82, v83
  v_mfma_f32_16x16x32_bf16 v[128:131], a[40:43], v[200:203], v[128:131]
  ds_read_b64_tr_b16 v[212:213], v251 offset:2048
  buffer_load_dwordx4 v245, s[24:27], s48 offen offset:1024 lds
  v_mfma_f32_16x16x32_bf16 v[128:131], a[44:47], v[204:207], v[128:131]
  ds_read_b64_tr_b16 v[214:215], v251 offset:2304
  v_mul_f32 v68, s57, v68
  v_mfma_f32_16x16x32_bf16 v[132:135], a[96:99], v[192:195], v[132:135]
  ds_read_b64_tr_b16 v[216:217], v251 offset:4096
  v_mul_f32 v69, s57, v69
  v_mfma_f32_16x16x32_bf16 v[132:135], a[100:103], v[196:199], v[132:135]
  ds_read_b64_tr_b16 v[218:219], v251 offset:4352
  v_mul_f32 v70, s57, v70
  v_mfma_f32_16x16x32_bf16 v[132:135], a[104:107], v[200:203], v[132:135]
  ds_read_b64_tr_b16 v[220:221], v251 offset:6144
  v_mul_f32 v71, s57, v71
  v_mfma_f32_16x16x32_bf16 v[132:135], a[108:111], v[204:207], v[132:135]
  ds_read_b64_tr_b16 v[222:223], v251 offset:6400
  v_mul_f32 v84, s57, v84
  v_mfma_f32_16x16x32_bf16 v[136:139], a[160:163], v[192:195], v[136:139]
  v_mul_f32 v85, s57, v85
  v_mfma_f32_16x16x32_bf16 v[136:139], a[164:167], v[196:199], v[136:139]
  v_mul_f32 v86, s57, v86
  v_mfma_f32_16x16x32_bf16 v[136:139], a[168:171], v[200:203], v[136:139]
  buffer_load_dwordx4 v246, s[24:27], s48 offen offset:2048 lds
  v_mfma_f32_16x16x32_bf16 v[136:139], a[172:175], v[204:207], v[136:139]
  v_mul_f32 v87, s57, v87
  v_cvt_pk_bf16_f32 v68, v68, v69
  v_mfma_f32_16x16x32_bf16 v[140:143], a[224:227], v[192:195], v[140:143]
  v_cvt_pk_bf16_f32 v69, v70, v71
  v_mfma_f32_16x16x32_bf16 v[140:143], a[228:231], v[196:199], v[140:143]
  v_cvt_pk_bf16_f32 v70, v84, v85
  v_mfma_f32_16x16x32_bf16 v[140:143], a[232:235], v[200:203], v[140:143]
  v_cvt_pk_bf16_f32 v71, v86, v87
  v_mfma_f32_16x16x32_bf16 v[140:143], a[236:239], v[204:207], v[140:143]
  s_waitcnt lgkmcnt(0)
  v_mfma_f32_16x16x32_bf16 v[144:147], a[32:35], v[208:211], v[144:147]
  ds_read_b64_tr_b16 v[192:193], v250 offset:24576
  v_mul_f32 v72, s57, v72
  v_mfma_f32_16x16x32_bf16 v[144:147], a[36:39], v[212:215], v[144:147]
  ds_read_b64_tr_b16 v[194:195], v250 offset:24832
  v_mul_f32 v73, s57, v73
  v_mfma_f32_16x16x32_bf16 v[144:147], a[40:43], v[216:219], v[144:147]
  ds_read_b64_tr_b16 v[196:197], v250 offset:26624
  buffer_load_dwordx4 v247, s[24:27], s48 offen offset:3072 lds
  v_mfma_f32_16x16x32_bf16 v[144:147], a[44:47], v[220:223], v[144:147]
  ds_read_b64_tr_b16 v[198:199], v250 offset:26880
  v_mul_f32 v74, s57, v74
  v_mfma_f32_16x16x32_bf16 v[148:151], a[96:99], v[208:211], v[148:151]
  ds_read_b64_tr_b16 v[200:201], v250 offset:28672
  v_mul_f32 v75, s57, v75
  buffer_store_dwordx4 v[32:35], v252, s[28:31], s49 offen offset:1024 sc1
  v_mfma_f32_16x16x32_bf16 v[148:151], a[100:103], v[212:215], v[148:151]
  ds_read_b64_tr_b16 v[202:203], v250 offset:28928
  v_mul_f32 v88, s57, v88
  v_mfma_f32_16x16x32_bf16 v[148:151], a[104:107], v[216:219], v[148:151]
  ds_read_b64_tr_b16 v[204:205], v250 offset:30720
  v_mul_f32 v89, s57, v89
  v_mfma_f32_16x16x32_bf16 v[148:151], a[108:111], v[220:223], v[148:151]
  s_mov_b32 s48, 3145856
  ds_read_b64_tr_b16 v[206:207], v250 offset:30976
  v_mul_f32 v90, s57, v90
  v_mfma_f32_16x16x32_bf16 v[152:155], a[160:163], v[208:211], v[152:155]
  s_mov_b32 s53, 114688
  v_mul_f32 v91, s57, v91
  v_mfma_f32_16x16x32_bf16 v[152:155], a[164:167], v[212:215], v[152:155]
  s_cmp_ge_u32 s46, 2
  s_cmov_b32 s53, 122880
  v_cvt_pk_bf16_f32 v72, v72, v73
  v_mfma_f32_16x16x32_bf16 v[152:155], a[168:171], v[216:219], v[152:155]
  s_add_u32 m0, s53, s60
  v_cvt_pk_bf16_f32 v73, v74, v75
  v_mfma_f32_16x16x32_bf16 v[152:155], a[172:175], v[220:223], v[152:155]
  buffer_load_dwordx4 v244, s[24:27], s48 offen offset:0 lds
  v_mfma_f32_16x16x32_bf16 v[156:159], a[224:227], v[208:211], v[156:159]
  v_cvt_pk_bf16_f32 v74, v88, v89
  v_cvt_pk_bf16_f32 v75, v90, v91
  v_mfma_f32_16x16x32_bf16 v[156:159], a[228:231], v[212:215], v[156:159]
  v_mfma_f32_16x16x32_bf16 v[156:159], a[232:235], v[216:219], v[156:159]
  v_mul_f32 v76, s57, v76
  v_mfma_f32_16x16x32_bf16 v[156:159], a[236:239], v[220:223], v[156:159]
  s_waitcnt lgkmcnt(0)
  v_mul_f32 v77, s57, v77
  v_mfma_f32_16x16x32_bf16 v[160:163], a[32:35], v[192:195], v[160:163]
  ds_read_b64_tr_b16 v[208:209], v251 offset:24576
  v_mul_f32 v78, s57, v78
  v_mfma_f32_16x16x32_bf16 v[160:163], a[36:39], v[196:199], v[160:163]
  ds_read_b64_tr_b16 v[210:211], v251 offset:24832
  v_mul_f32 v79, s57, v79
  v_mfma_f32_16x16x32_bf16 v[160:163], a[40:43], v[200:203], v[160:163]
  ds_read_b64_tr_b16 v[212:213], v251 offset:26624
  v_mul_f32 v92, s57, v92
  v_mfma_f32_16x16x32_bf16 v[160:163], a[44:47], v[204:207], v[160:163]
  ds_read_b64_tr_b16 v[214:215], v251 offset:26880
  buffer_load_dwordx4 v245, s[24:27], s48 offen offset:1024 lds
  v_mfma_f32_16x16x32_bf16 v[164:167], a[96:99], v[192:195], v[164:167]
  ds_read_b64_tr_b16 v[216:217], v251 offset:28672
  v_mul_f32 v93, s57, v93
  v_mfma_f32_16x16x32_bf16 v[164:167], a[100:103], v[196:199], v[164:167]
  ds_read_b64_tr_b16 v[218:219], v251 offset:28928
  v_mul_f32 v94, s57, v94
  v_mfma_f32_16x16x32_bf16 v[164:167], a[104:107], v[200:203], v[164:167]
  ds_read_b64_tr_b16 v[220:221], v251 offset:30720
  v_mul_f32 v95, s57, v95
  v_mfma_f32_16x16x32_bf16 v[164:167], a[108:111], v[204:207], v[164:167]
  ds_read_b64_tr_b16 v[222:223], v251 offset:30976
  v_cvt_pk_bf16_f32 v76, v76, v77
  v_mfma_f32_16x16x32_bf16 v[168:171], a[160:163], v[192:195], v[168:171]
  v_cvt_pk_bf16_f32 v77, v78, v79
  v_mfma_f32_16x16x32_bf16 v[168:171], a[164:167], v[196:199], v[168:171]
  v_cvt_pk_bf16_f32 v78, v92, v93
  v_mfma_f32_16x16x32_bf16 v[168:171], a[168:171], v[200:203], v[168:171]
  v_cvt_pk_bf16_f32 v79, v94, v95
  v_mfma_f32_16x16x32_bf16 v[168:171], a[172:175], v[204:207], v[168:171]
  buffer_load_dwordx4 v246, s[24:27], s48 offen offset:2048 lds
  v_mfma_f32_16x16x32_bf16 v[172:175], a[224:227], v[192:195], v[172:175]
  v_mul_f32 v96, s57, v96
  v_mfma_f32_16x16x32_bf16 v[172:175], a[228:231], v[196:199], v[172:175]
  v_mul_f32 v97, s57, v97
  buffer_store_dwordx4 v[36:39], v252, s[28:31], s50 offen offset:1024 sc1
  v_mfma_f32_16x16x32_bf16 v[172:175], a[232:235], v[200:203], v[172:175]
  v_mul_f32 v98, s57, v98
  v_mfma_f32_16x16x32_bf16 v[172:175], a[236:239], v[204:207], v[172:175]
  s_waitcnt lgkmcnt(0)
  v_add_u32 v250, 0xc000, v250
  v_add_u32 v251, 0xc000, v251
  v_mfma_f32_16x16x32_bf16 v[176:179], a[32:35], v[208:211], v[176:179]
  ds_read_b64_tr_b16 v[192:193], v250 offset:0
  v_mul_f32 v99, s57, v99
  v_mfma_f32_16x16x32_bf16 v[176:179], a[36:39], v[212:215], v[176:179]
  ds_read_b64_tr_b16 v[194:195], v250 offset:256
  v_mul_f32 v112, s57, v112
  v_mfma_f32_16x16x32_bf16 v[176:179], a[40:43], v[216:219], v[176:179]
  ds_read_b64_tr_b16 v[196:197], v250 offset:2048
  s_load_dwordx2 s[6:7], s[0:1], 16
  s_load_dwordx4 s[8:11], s[0:1], 56
  v_mfma_f32_16x16x32_bf16 v[176:179], a[44:47], v[220:223], v[176:179]
  ds_read_b64_tr_b16 v[198:199], v250 offset:2304
  buffer_load_dwordx4 v247, s[24:27], s48 offen offset:3072 lds
  v_mfma_f32_16x16x32_bf16 v[180:183], a[96:99], v[208:211], v[180:183]
  ds_read_b64_tr_b16 v[200:201], v250 offset:4096
  v_mul_f32 v113, s57, v113
  v_mfma_f32_16x16x32_bf16 v[180:183], a[100:103], v[212:215], v[180:183]
  ds_read_b64_tr_b16 v[202:203], v250 offset:4352
  v_mul_f32 v114, s57, v114
  v_mfma_f32_16x16x32_bf16 v[180:183], a[104:107], v[216:219], v[180:183]
  ds_read_b64_tr_b16 v[204:205], v250 offset:6144
  v_mul_f32 v115, s57, v115
  v_mfma_f32_16x16x32_bf16 v[180:183], a[108:111], v[220:223], v[180:183]
  ds_read_b64_tr_b16 v[206:207], v250 offset:6400
  v_cvt_pk_bf16_f32 v96, v96, v97
  v_mfma_f32_16x16x32_bf16 v[184:187], a[160:163], v[208:211], v[184:187]
  v_cvt_pk_bf16_f32 v97, v98, v99
  v_cvt_pk_bf16_f32 v98, v112, v113
  v_mfma_f32_16x16x32_bf16 v[184:187], a[164:167], v[212:215], v[184:187]
  v_cvt_pk_bf16_f32 v99, v114, v115
  v_mfma_f32_16x16x32_bf16 v[184:187], a[168:171], v[216:219], v[184:187]
  v_mul_f32 v100, s57, v100
  v_mfma_f32_16x16x32_bf16 v[184:187], a[172:175], v[220:223], v[184:187]
  v_mul_f32 v101, s57, v101
  v_mfma_f32_16x16x32_bf16 v[188:191], a[224:227], v[208:211], v[188:191]
  v_mul_f32 v102, s57, v102
  v_mfma_f32_16x16x32_bf16 v[188:191], a[228:231], v[212:215], v[188:191]
  v_mul_f32 v103, s57, v103
  v_mfma_f32_16x16x32_bf16 v[188:191], a[232:235], v[216:219], v[188:191]
  s_waitcnt lgkmcnt(0)
  v_mul_f32 v116, s57, v116
  v_mfma_f32_16x16x32_bf16 v[188:191], a[236:239], v[220:223], v[188:191]
  s_lshl_b32 s62, s2, 14
  v_mul_f32 v117, s57, v117
  s_lshl_b32 s63, s42, 12
  s_add_u32 s62, s62, s63
  s_mov_b32 s64, s6
  s_mov_b32 s65, s7
  s_mov_b32 s66, 0x400000
  s_mov_b32 s67, 0x20000
  buffer_load_dwordx4 v[224:227], v252, s[64:67], s62 offen offset:0
  v_mfma_f32_16x16x32_bf16 v[128:131], a[48:51], v[192:195], v[128:131]
  ds_read_b64_tr_b16 v[208:209], v251 offset:0
  v_mfma_f32_16x16x32_bf16 v[128:131], a[52:55], v[196:199], v[128:131]
  ds_read_b64_tr_b16 v[210:211], v251 offset:256
  v_mul_f32 v118, s57, v118
  v_mfma_f32_16x16x32_bf16 v[128:131], a[56:59], v[200:203], v[128:131]
  ds_read_b64_tr_b16 v[212:213], v251 offset:2048
  v_mul_f32 v119, s57, v119
  v_mfma_f32_16x16x32_bf16 v[128:131], a[60:63], v[204:207], v[128:131]
  ds_read_b64_tr_b16 v[214:215], v251 offset:2304
  v_cvt_pk_bf16_f32 v100, v100, v101
  buffer_load_dwordx4 v[224:227], v252, s[64:67], s62 offen offset:1024
  v_mfma_f32_16x16x32_bf16 v[132:135], a[112:115], v[192:195], v[132:135]
  ds_read_b64_tr_b16 v[216:217], v251 offset:4096
  v_cvt_pk_bf16_f32 v101, v102, v103
  v_mfma_f32_16x16x32_bf16 v[132:135], a[116:119], v[196:199], v[132:135]
  ds_read_b64_tr_b16 v[218:219], v251 offset:4352
  v_cvt_pk_bf16_f32 v102, v116, v117
  v_mfma_f32_16x16x32_bf16 v[132:135], a[120:123], v[200:203], v[132:135]
  ds_read_b64_tr_b16 v[220:221], v251 offset:6144
  v_cvt_pk_bf16_f32 v103, v118, v119
  buffer_store_dwordx4 v[40:43], v252, s[28:31], s51 offen offset:1024 sc1
  v_mfma_f32_16x16x32_bf16 v[132:135], a[124:127], v[204:207], v[132:135]
  ds_read_b64_tr_b16 v[222:223], v251 offset:6400
  buffer_load_dwordx4 v[224:227], v252, s[64:67], s62 offen offset:2048
  v_mfma_f32_16x16x32_bf16 v[136:139], a[176:179], v[192:195], v[136:139]
  v_mul_f32 v104, s57, v104
  v_mfma_f32_16x16x32_bf16 v[136:139], a[180:183], v[196:199], v[136:139]
  v_mul_f32 v105, s57, v105
  v_mfma_f32_16x16x32_bf16 v[136:139], a[184:187], v[200:203], v[136:139]
  v_mul_f32 v106, s57, v106
  v_mfma_f32_16x16x32_bf16 v[136:139], a[188:191], v[204:207], v[136:139]
  v_mul_f32 v107, s57, v107
  buffer_load_dwordx4 v[224:227], v252, s[64:67], s62 offen offset:3072
  s_mul_i32 s62, s2, 5504
  s_mul_i32 s63, s42, 1376
  s_add_u32 s62, s62, s63
  s_and_b32 s62, s62, 0xffffff80
  v_mfma_f32_16x16x32_bf16 v[140:143], a[240:243], v[192:195], v[140:143]
  s_mov_b32 s64, s8
  v_mul_f32 v120, s57, v120
  v_mfma_f32_16x16x32_bf16 v[140:143], a[244:247], v[196:199], v[140:143]
  s_mov_b32 s65, s9
  v_mul_f32 v121, s57, v121
  v_mfma_f32_16x16x32_bf16 v[140:143], a[248:251], v[200:203], v[140:143]
  s_mov_b32 s66, 1409024
  v_mfma_f32_16x16x32_bf16 v[140:143], a[252:255], v[204:207], v[140:143]
  s_waitcnt lgkmcnt(0)
  v_mul_f32 v122, s57, v122
  buffer_load_dwordx4 v[224:227], v252, s[64:67], s62 offen offset:0
  v_mfma_f32_16x16x32_bf16 v[144:147], a[48:51], v[208:211], v[144:147]
  ds_read_b64_tr_b16 v[192:193], v250 offset:24576
  v_mul_f32 v123, s57, v123
  v_mfma_f32_16x16x32_bf16 v[144:147], a[52:55], v[212:215], v[144:147]
  ds_read_b64_tr_b16 v[194:195], v250 offset:24832
  v_cvt_pk_bf16_f32 v104, v104, v105
  v_mfma_f32_16x16x32_bf16 v[144:147], a[56:59], v[216:219], v[144:147]
  ds_read_b64_tr_b16 v[196:197], v250 offset:26624
  v_cvt_pk_bf16_f32 v105, v106, v107
  v_mfma_f32_16x16x32_bf16 v[144:147], a[60:63], v[220:223], v[144:147]
  ds_read_b64_tr_b16 v[198:199], v250 offset:26880
  v_cvt_pk_bf16_f32 v106, v120, v121
  buffer_load_dwordx4 v[224:227], v252, s[64:67], s62 offen offset:1024
  v_mfma_f32_16x16x32_bf16 v[148:151], a[112:115], v[208:211], v[148:151]
  s_mov_b32 s64, s10
  ds_read_b64_tr_b16 v[200:201], v250 offset:28672
  v_cvt_pk_bf16_f32 v107, v122, v123
  v_mfma_f32_16x16x32_bf16 v[148:151], a[116:119], v[212:215], v[148:151]
  s_mov_b32 s65, s11
  ds_read_b64_tr_b16 v[202:203], v250 offset:28928
  v_mfma_f32_16x16x32_bf16 v[148:151], a[120:123], v[216:219], v[148:151]
  s_mov_b32 s66, 1409024
  ds_read_b64_tr_b16 v[204:205], v250 offset:30720
  v_mul_f32 v108, s57, v108
  v_mfma_f32_16x16x32_bf16 v[148:151], a[124:127], v[220:223], v[148:151]
  ds_read_b64_tr_b16 v[206:207], v250 offset:30976
  v_mul_f32 v109, s57, v109
  buffer_load_dwordx4 v[224:227], v252, s[64:67], s62 offen offset:0
  v_mfma_f32_16x16x32_bf16 v[152:155], a[176:179], v[208:211], v[152:155]
  v_mul_f32 v110, s57, v110
  v_mfma_f32_16x16x32_bf16 v[152:155], a[180:183], v[212:215], v[152:155]
  v_mul_f32 v111, s57, v111
  v_mfma_f32_16x16x32_bf16 v[152:155], a[184:187], v[216:219], v[152:155]
  v_mul_f32 v124, s57, v124
  v_mfma_f32_16x16x32_bf16 v[152:155], a[188:191], v[220:223], v[152:155]
  v_mul_f32 v125, s57, v125
  buffer_load_dwordx4 v[224:227], v252, s[64:67], s62 offen offset:1024
  v_mfma_f32_16x16x32_bf16 v[156:159], a[240:243], v[208:211], v[156:159]
  v_mfma_f32_16x16x32_bf16 v[156:159], a[244:247], v[212:215], v[156:159]
  v_mul_f32 v126, s57, v126
  v_mfma_f32_16x16x32_bf16 v[156:159], a[248:251], v[216:219], v[156:159]
  v_mul_f32 v127, s57, v127
  v_mfma_f32_16x16x32_bf16 v[156:159], a[252:255], v[220:223], v[156:159]
  s_waitcnt lgkmcnt(0)
  v_cvt_pk_bf16_f32 v108, v108, v109
  buffer_store_dwordx4 v[44:47], v252, s[28:31], s52 offen offset:1024 sc1
  v_mfma_f32_16x16x32_bf16 v[160:163], a[48:51], v[192:195], v[160:163]
  ds_read_b64_tr_b16 v[208:209], v251 offset:24576
  v_cvt_pk_bf16_f32 v109, v110, v111
  v_mfma_f32_16x16x32_bf16 v[160:163], a[52:55], v[196:199], v[160:163]
  ds_read_b64_tr_b16 v[210:211], v251 offset:24832
  v_cvt_pk_bf16_f32 v110, v124, v125
  v_mfma_f32_16x16x32_bf16 v[160:163], a[56:59], v[200:203], v[160:163]
  s_mov_b32 s42, s46
  ds_read_b64_tr_b16 v[212:213], v251 offset:26624
  v_cvt_pk_bf16_f32 v111, v126, v127
  v_mfma_f32_16x16x32_bf16 v[160:163], a[60:63], v[204:207], v[160:163]
  s_mov_b32 s4, s12
  ds_read_b64_tr_b16 v[214:215], v251 offset:26880
  v_mfma_f32_16x16x32_bf16 v[164:167], a[112:115], v[192:195], v[164:167]
  ds_read_b64_tr_b16 v[216:217], v251 offset:28672
  v_mfma_f32_16x16x32_bf16 v[164:167], a[116:119], v[196:199], v[164:167]
  s_mov_b32 s5, s13
  ds_read_b64_tr_b16 v[218:219], v251 offset:28928
  v_mfma_f32_16x16x32_bf16 v[164:167], a[120:123], v[200:203], v[164:167]
  ds_read_b64_tr_b16 v[220:221], v251 offset:30720
  v_lshrrev_b32 v243, 4, v252
  v_mfma_f32_16x16x32_bf16 v[164:167], a[124:127], v[204:207], v[164:167]
  ds_read_b64_tr_b16 v[222:223], v251 offset:30976
  v_mfma_f32_16x16x32_bf16 v[168:171], a[176:179], v[192:195], v[168:171]
  s_and_b32 s40, s2, 7
  v_mfma_f32_16x16x32_bf16 v[168:171], a[180:183], v[196:199], v[168:171]
  s_lshr_b32 s46, s2, 3
  v_mfma_f32_16x16x32_bf16 v[168:171], a[184:187], v[200:203], v[168:171]
  v_mfma_f32_16x16x32_bf16 v[168:171], a[188:191], v[204:207], v[168:171]
  s_and_b32 s46, s46, 3
  v_mfma_f32_16x16x32_bf16 v[172:175], a[240:243], v[192:195], v[172:175]
  v_mfma_f32_16x16x32_bf16 v[172:175], a[244:247], v[196:199], v[172:175]
  s_lshl_b32 s46, s46, 3
  v_mfma_f32_16x16x32_bf16 v[172:175], a[248:251], v[200:203], v[172:175]
  s_add_u32 s40, s40, s46
  v_mfma_f32_16x16x32_bf16 v[172:175], a[252:255], v[204:207], v[172:175]
  v_add_u32 v250, 0xffff6000, v250
  v_add_u32 v251, 0xffff6000, v251
  s_waitcnt vmcnt(22)
  s_barrier
  s_waitcnt lgkmcnt(0)
  v_mfma_f32_16x16x32_bf16 v[176:179], a[48:51], v[208:211], v[176:179]
  s_lshr_b32 s41, s2, 5
  ds_read_b64_tr_b16 v[192:193], v250 offset:0
  v_mfma_f32_16x16x32_bf16 v[176:179], a[52:55], v[212:215], v[176:179]
  ds_read_b64_tr_b16 v[194:195], v250 offset:256
  v_lshrrev_b32 v237, 5, v243
  v_mfma_f32_16x16x32_bf16 v[176:179], a[56:59], v[216:219], v[176:179]
  ds_read_b64_tr_b16 v[196:197], v250 offset:2048
  v_mfma_f32_16x16x32_bf16 v[176:179], a[60:63], v[220:223], v[176:179]
  ds_read_b64_tr_b16 v[198:199], v250 offset:2304
  v_lshlrev_b32 v237, 1, v237
  v_mfma_f32_16x16x32_bf16 v[180:183], a[112:115], v[208:211], v[180:183]
  ds_read_b64_tr_b16 v[200:201], v250 offset:4096
  v_mfma_f32_16x16x32_bf16 v[180:183], a[116:119], v[212:215], v[180:183]
  ds_read_b64_tr_b16 v[202:203], v250 offset:4352
  v_and_b32 v236, 3, v243
  v_mfma_f32_16x16x32_bf16 v[180:183], a[120:123], v[216:219], v[180:183]
  ds_read_b64_tr_b16 v[204:205], v250 offset:6144
  v_xor_b32 v236, v236, v237
  v_mfma_f32_16x16x32_bf16 v[180:183], a[124:127], v[220:223], v[180:183]
  ds_read_b64_tr_b16 v[206:207], v250 offset:6400
  v_mfma_f32_16x16x32_bf16 v[184:187], a[176:179], v[208:211], v[184:187]
  buffer_store_dwordx4 v[64:67], v252, s[28:31], s49 offen offset:2048 sc1
  v_mfma_f32_16x16x32_bf16 v[184:187], a[180:183], v[212:215], v[184:187]
  v_lshlrev_b32 v236, 4, v236
  v_lshrrev_b32 v237, 2, v243
  v_mfma_f32_16x16x32_bf16 v[184:187], a[184:187], v[216:219], v[184:187]
  v_mfma_f32_16x16x32_bf16 v[184:187], a[188:191], v[220:223], v[184:187]
  v_lshlrev_b32 v237, 13, v237
  v_mfma_f32_16x16x32_bf16 v[188:191], a[240:243], v[208:211], v[188:191]
  v_add_u32 v236, v236, v237
  v_mfma_f32_16x16x32_bf16 v[188:191], a[244:247], v[212:215], v[188:191]
  v_mfma_f32_16x16x32_bf16 v[188:191], a[248:251], v[216:219], v[188:191]
  s_lshl_b32 s46, s40, 8
  v_mfma_f32_16x16x32_bf16 v[188:191], a[252:255], v[220:223], v[188:191]
  s_waitcnt lgkmcnt(0)
  v_mfma_f32_16x16x32_bf16 v[16:19], a[0:3], v[192:195], 0
  s_lshl_b32 s47, s42, 6
  ds_read_b64_tr_b16 v[208:209], v251 offset:0
  v_mfma_f32_16x16x32_bf16 v[16:19], a[4:7], v[196:199], v[16:19]
  s_add_u32 s46, s46, s47
  ds_read_b64_tr_b16 v[210:211], v251 offset:256
  v_mfma_f32_16x16x32_bf16 v[16:19], a[8:11], v[200:203], v[16:19]
  ds_read_b64_tr_b16 v[212:213], v251 offset:2048
  v_mfma_f32_16x16x32_bf16 v[16:19], a[12:15], v[204:207], v[16:19]
  ds_read_b64_tr_b16 v[214:215], v251 offset:2304
  v_add_u32 v244, s46, v236
  v_mfma_f32_16x16x32_bf16 v[20:23], a[64:67], v[192:195], 0
  ds_read_b64_tr_b16 v[216:217], v251 offset:4096
  v_cvt_pk_bf16_f32 v128, v128, v129
  v_mfma_f32_16x16x32_bf16 v[20:23], a[68:71], v[196:199], v[20:23]
  ds_read_b64_tr_b16 v[218:219], v251 offset:4352
  v_add_u32 v245, 130048, v244
  v_mfma_f32_16x16x32_bf16 v[20:23], a[72:75], v[200:203], v[20:23]
  ds_read_b64_tr_b16 v[220:221], v251 offset:6144
  v_add_u32 v246, 260096, v244
  v_mfma_f32_16x16x32_bf16 v[20:23], a[76:79], v[204:207], v[20:23]
  ds_read_b64_tr_b16 v[222:223], v251 offset:6400
  v_mfma_f32_16x16x32_bf16 v[24:27], a[128:131], v[192:195], 0
  v_cvt_pk_bf16_f32 v129, v130, v131
  v_add_u32 v247, 390144, v244
  v_mfma_f32_16x16x32_bf16 v[24:27], a[132:135], v[196:199], v[24:27]
  s_lshl_b32 s46, s41, 3
  v_mfma_f32_16x16x32_bf16 v[24:27], a[136:139], v[200:203], v[24:27]
  v_mfma_f32_16x16x32_bf16 v[24:27], a[140:143], v[204:207], v[24:27]
  s_lshl_b32 s47, s42, 1
  v_mfma_f32_16x16x32_bf16 v[28:31], a[192:195], v[192:195], 0
  s_add_u32 s46, s46, s47
  v_cvt_pk_bf16_f32 v130, v132, v133
  v_mfma_f32_16x16x32_bf16 v[28:31], a[196:199], v[196:199], v[28:31]
  v_mfma_f32_16x16x32_bf16 v[28:31], a[200:203], v[200:203], v[28:31]
  s_lshl_b32 s58, s46, 12
  v_mfma_f32_16x16x32_bf16 v[28:31], a[204:207], v[204:207], v[28:31]
  s_sub_u32 s46, 15, s41
  s_waitcnt lgkmcnt(0)
  v_mfma_f32_16x16x32_bf16 v[48:51], a[0:3], v[208:211], 0
  ds_read_b64_tr_b16 v[192:193], v250 offset:24576
  v_cvt_pk_bf16_f32 v131, v134, v135
  v_mfma_f32_16x16x32_bf16 v[48:51], a[4:7], v[212:215], v[48:51]
  ds_read_b64_tr_b16 v[194:195], v250 offset:24832
  buffer_store_dwordx4 v[68:71], v252, s[28:31], s50 offen offset:2048 sc1
  v_mfma_f32_16x16x32_bf16 v[48:51], a[8:11], v[216:219], v[48:51]
  s_lshl_b32 s46, s46, 3
  ds_read_b64_tr_b16 v[196:197], v250 offset:26624
  v_mfma_f32_16x16x32_bf16 v[48:51], a[12:15], v[220:223], v[48:51]
  s_add_u32 s46, s46, s47
  ds_read_b64_tr_b16 v[198:199], v250 offset:26880
  v_mfma_f32_16x16x32_bf16 v[52:55], a[64:67], v[208:211], 0
  s_lshl_b32 s59, s46, 12
  ds_read_b64_tr_b16 v[200:201], v250 offset:28672
  v_cvt_pk_bf16_f32 v136, v136, v137
  v_mfma_f32_16x16x32_bf16 v[52:55], a[68:71], v[212:215], v[52:55]
  ds_read_b64_tr_b16 v[202:203], v250 offset:28928
  v_mfma_f32_16x16x32_bf16 v[52:55], a[72:75], v[216:219], v[52:55]
  s_add_u32 s12, s4, 0x0
  s_addc_u32 s13, s5, 0
  ds_read_b64_tr_b16 v[204:205], v250 offset:30720
  v_mfma_f32_16x16x32_bf16 v[52:55], a[76:79], v[220:223], v[52:55]
  s_mov_b32 s14, 0x200000
  ds_read_b64_tr_b16 v[206:207], v250 offset:30976
  v_mfma_f32_16x16x32_bf16 v[56:59], a[128:131], v[208:211], 0
  v_cvt_pk_bf16_f32 v137, v138, v139
  v_mfma_f32_16x16x32_bf16 v[56:59], a[132:135], v[212:215], v[56:59]
  s_mov_b32 s15, 0x20000
  v_mfma_f32_16x16x32_bf16 v[56:59], a[136:139], v[216:219], v[56:59]
  v_mfma_f32_16x16x32_bf16 v[56:59], a[140:143], v[220:223], v[56:59]
  s_mov_b32 s16, s6
  v_mfma_f32_16x16x32_bf16 v[60:63], a[192:195], v[208:211], 0
  s_mov_b32 s17, s7
  v_cvt_pk_bf16_f32 v138, v140, v141
  v_mfma_f32_16x16x32_bf16 v[60:63], a[196:199], v[212:215], v[60:63]
  v_mfma_f32_16x16x32_bf16 v[60:63], a[200:203], v[216:219], v[60:63]
  s_mov_b32 s18, 0x400000
  v_mfma_f32_16x16x32_bf16 v[60:63], a[204:207], v[220:223], v[60:63]
  s_mov_b32 s19, 0x20000
  s_waitcnt lgkmcnt(0)
  v_mfma_f32_16x16x32_bf16 v[80:83], a[0:3], v[192:195], 0
  ds_read_b64_tr_b16 v[208:209], v251 offset:24576
  v_cvt_pk_bf16_f32 v139, v142, v143
  v_mfma_f32_16x16x32_bf16 v[80:83], a[4:7], v[196:199], v[80:83]
  ds_read_b64_tr_b16 v[210:211], v251 offset:24832
  v_lshrrev_b32 v238, 4, v243
  v_mfma_f32_16x16x32_bf16 v[80:83], a[8:11], v[200:203], v[80:83]
  ds_read_b64_tr_b16 v[212:213], v251 offset:26624
  v_and_b32 v236, 15, v243
  v_mfma_f32_16x16x32_bf16 v[80:83], a[12:15], v[204:207], v[80:83]
  ds_read_b64_tr_b16 v[214:215], v251 offset:26880
  v_mfma_f32_16x16x32_bf16 v[84:87], a[64:67], v[192:195], 0
  ds_read_b64_tr_b16 v[216:217], v251 offset:28672
  v_cvt_pk_bf16_f32 v144, v144, v145
  v_mfma_f32_16x16x32_bf16 v[84:87], a[68:71], v[196:199], v[84:87]
  ds_read_b64_tr_b16 v[218:219], v251 offset:28928
  v_lshrrev_b32 v236, 2, v236
  v_mfma_f32_16x16x32_bf16 v[84:87], a[72:75], v[200:203], v[84:87]
  ds_read_b64_tr_b16 v[220:221], v251 offset:30720
  v_lshlrev_b32 v237, 3, v238
  v_mfma_f32_16x16x32_bf16 v[84:87], a[76:79], v[204:207], v[84:87]
  ds_read_b64_tr_b16 v[222:223], v251 offset:30976
  v_add_u32 v237, v236, v237
  v_mfma_f32_16x16x32_bf16 v[88:91], a[128:131], v[192:195], 0
  v_cvt_pk_bf16_f32 v145, v146, v147
  v_mfma_f32_16x16x32_bf16 v[88:91], a[132:135], v[196:199], v[88:91]
  v_lshlrev_b32 v239, 6, v237
  v_mfma_f32_16x16x32_bf16 v[88:91], a[136:139], v[200:203], v[88:91]
  buffer_store_dwordx4 v[72:75], v252, s[28:31], s51 offen offset:2048 sc1
  v_mfma_f32_16x16x32_bf16 v[88:91], a[140:143], v[204:207], v[88:91]
  v_and_b32 v240, 1, v238
  v_mfma_f32_16x16x32_bf16 v[92:95], a[192:195], v[192:195], 0
  v_cvt_pk_bf16_f32 v146, v148, v149
  v_lshlrev_b32 v241, 5, v240
  v_mfma_f32_16x16x32_bf16 v[92:95], a[196:199], v[196:199], v[92:95]
  v_mfma_f32_16x16x32_bf16 v[92:95], a[200:203], v[200:203], v[92:95]
  v_add_u32 v239, v239, v241
  v_mfma_f32_16x16x32_bf16 v[92:95], a[204:207], v[204:207], v[92:95]
  s_waitcnt lgkmcnt(0)
  v_add_u32 v250, 0xc000, v250
  v_add_u32 v251, 0xc000, v251
  v_mfma_f32_16x16x32_bf16 v[112:115], a[0:3], v[208:211], 0
  ds_read_b64_tr_b16 v[192:193], v250 offset:0
  v_cvt_pk_bf16_f32 v147, v150, v151
  v_mfma_f32_16x16x32_bf16 v[112:115], a[4:7], v[212:215], v[112:115]
  ds_read_b64_tr_b16 v[194:195], v250 offset:256
  v_and_b32 v241, 3, v243
  v_mfma_f32_16x16x32_bf16 v[112:115], a[8:11], v[216:219], v[112:115]
  ds_read_b64_tr_b16 v[196:197], v250 offset:2048
  v_lshlrev_b32 v241, 3, v241
  v_mfma_f32_16x16x32_bf16 v[112:115], a[12:15], v[220:223], v[112:115]
  ds_read_b64_tr_b16 v[198:199], v250 offset:2304
  v_add_u32 v248, v239, v241
  v_mfma_f32_16x16x32_bf16 v[116:119], a[64:67], v[208:211], 0
  ds_read_b64_tr_b16 v[200:201], v250 offset:4096
  v_cvt_pk_bf16_f32 v152, v152, v153
  v_mfma_f32_16x16x32_bf16 v[116:119], a[68:71], v[212:215], v[116:119]
  ds_read_b64_tr_b16 v[202:203], v250 offset:4352
  v_xor_b32 v249, 32, v248
  v_mfma_f32_16x16x32_bf16 v[116:119], a[72:75], v[216:219], v[116:119]
  ds_read_b64_tr_b16 v[204:205], v250 offset:6144
  v_mfma_f32_16x16x32_bf16 v[116:119], a[76:79], v[220:223], v[116:119]
  ds_read_b64_tr_b16 v[206:207], v250 offset:6400
  v_mfma_f32_16x16x32_bf16 v[120:123], a[128:131], v[208:211], 0
  v_cvt_pk_bf16_f32 v153, v154, v155
  v_mfma_f32_16x16x32_bf16 v[120:123], a[132:135], v[212:215], v[120:123]
  v_mfma_f32_16x16x32_bf16 v[120:123], a[136:139], v[216:219], v[120:123]
  s_waitcnt vmcnt(22)
  v_cmp_gt_u32 vcc, 8, v254
  s_nop 4
  s_cbranch_vccnz L_spin_ln
L_back_ln:
  v_mfma_f32_16x16x32_bf16 v[120:123], a[140:143], v[220:223], v[120:123]
  v_mfma_f32_16x16x32_bf16 v[124:127], a[192:195], v[208:211], 0
  v_cvt_pk_bf16_f32 v154, v156, v157
  v_mfma_f32_16x16x32_bf16 v[124:127], a[196:199], v[212:215], v[124:127]
  v_mfma_f32_16x16x32_bf16 v[124:127], a[200:203], v[216:219], v[124:127]
  v_mfma_f32_16x16x32_bf16 v[124:127], a[204:207], v[220:223], v[124:127]
  s_waitcnt lgkmcnt(0)
  v_mfma_f32_16x16x32_bf16 v[16:19], a[16:19], v[192:195], v[16:19]
  ds_read_b64_tr_b16 v[208:209], v251 offset:0
  v_cvt_pk_bf16_f32 v155, v158, v159
  v_mfma_f32_16x16x32_bf16 v[16:19], a[20:23], v[196:199], v[16:19]
  ds_read_b64_tr_b16 v[210:211], v251 offset:256
  v_mfma_f32_16x16x32_bf16 v[16:19], a[24:27], v[200:203], v[16:19]
  s_add_u32 s48, s58, 0
  ds_read_b64_tr_b16 v[212:213], v251 offset:2048
  buffer_load_dwordx4 a[0:3], v252, s[12:15], s48 offen offset:0 sc1
  v_mfma_f32_16x16x32_bf16 v[16:19], a[28:31], v[204:207], v[16:19]
  ds_read_b64_tr_b16 v[214:215], v251 offset:2304
  buffer_store_dwordx4 v[76:79], v252, s[28:31], s52 offen offset:2048 sc1
  v_mfma_f32_16x16x32_bf16 v[20:23], a[80:83], v[192:195], v[20:23]
  ds_read_b64_tr_b16 v[216:217], v251 offset:4096
  v_cvt_pk_bf16_f32 v160, v160, v161
  v_mfma_f32_16x16x32_bf16 v[20:23], a[84:87], v[196:199], v[20:23]
  ds_read_b64_tr_b16 v[218:219], v251 offset:4352
  buffer_load_dwordx4 a[4:7], v252, s[12:15], s48 offen offset:1024 sc1
  v_mfma_f32_16x16x32_bf16 v[20:23], a[88:91], v[200:203], v[20:23]
  ds_read_b64_tr_b16 v[220:221], v251 offset:6144
  v_mfma_f32_16x16x32_bf16 v[20:23], a[92:95], v[204:207], v[20:23]
  ds_read_b64_tr_b16 v[222:223], v251 offset:6400
  v_mfma_f32_16x16x32_bf16 v[24:27], a[144:147], v[192:195], v[24:27]
  v_cvt_pk_bf16_f32 v161, v162, v163
  v_mfma_f32_16x16x32_bf16 v[24:27], a[148:151], v[196:199], v[24:27]
  buffer_load_dwordx4 a[8:11], v252, s[12:15], s48 offen offset:2048 sc1
  v_mfma_f32_16x16x32_bf16 v[24:27], a[152:155], v[200:203], v[24:27]
  v_mfma_f32_16x16x32_bf16 v[24:27], a[156:159], v[204:207], v[24:27]
  v_mfma_f32_16x16x32_bf16 v[28:31], a[208:211], v[192:195], v[28:31]
  v_cvt_pk_bf16_f32 v162, v164, v165
  buffer_load_dwordx4 a[12:15], v252, s[12:15], s48 offen offset:3072 sc1
  v_mfma_f32_16x16x32_bf16 v[28:31], a[212:215], v[196:199], v[28:31]
  v_mfma_f32_16x16x32_bf16 v[28:31], a[216:219], v[200:203], v[28:31]
  v_mfma_f32_16x16x32_bf16 v[28:31], a[220:223], v[204:207], v[28:31]
  s_add_u32 s48, s58, 4096
  s_waitcnt lgkmcnt(0)
  v_mfma_f32_16x16x32_bf16 v[48:51], a[16:19], v[208:211], v[48:51]
  ds_read_b64_tr_b16 v[192:193], v250 offset:24576
  v_cvt_pk_bf16_f32 v163, v166, v167
  buffer_load_dwordx4 a[64:67], v252, s[12:15], s48 offen offset:0 sc1
  v_mfma_f32_16x16x32_bf16 v[48:51], a[20:23], v[212:215], v[48:51]
  ds_read_b64_tr_b16 v[194:195], v250 offset:24832
  v_mfma_f32_16x16x32_bf16 v[48:51], a[24:27], v[216:219], v[48:51]
  ds_read_b64_tr_b16 v[196:197], v250 offset:26624
  v_mfma_f32_16x16x32_bf16 v[48:51], a[28:31], v[220:223], v[48:51]
  ds_read_b64_tr_b16 v[198:199], v250 offset:26880
  v_mfma_f32_16x16x32_bf16 v[52:55], a[80:83], v[208:211], v[52:55]
  ds_read_b64_tr_b16 v[200:201], v250 offset:28672
  v_cvt_pk_bf16_f32 v168, v168, v169
  buffer_load_dwordx4 a[68:71], v252, s[12:15], s48 offen offset:1024 sc1
  v_mfma_f32_16x16x32_bf16 v[52:55], a[84:87], v[212:215], v[52:55]
  ds_read_b64_tr_b16 v[202:203], v250 offset:28928
  v_mfma_f32_16x16x32_bf16 v[52:55], a[88:91], v[216:219], v[52:55]
  ds_read_b64_tr_b16 v[204:205], v250 offset:30720
  v_mfma_f32_16x16x32_bf16 v[52:55], a[92:95], v[220:223], v[52:55]
  ds_read_b64_tr_b16 v[206:207], v250 offset:30976
  buffer_load_dwordx4 a[72:75], v252, s[12:15], s48 offen offset:2048 sc1
  v_mfma_f32_16x16x32_bf16 v[56:59], a[144:147], v[208:211], v[56:59]
  v_cvt_pk_bf16_f32 v169, v170, v171
  v_mfma_f32_16x16x32_bf16 v[56:59], a[148:151], v[212:215], v[56:59]
  v_mfma_f32_16x16x32_bf16 v[56:59], a[152:155], v[216:219], v[56:59]
  v_mfma_f32_16x16x32_bf16 v[56:59], a[156:159], v[220:223], v[56:59]
  buffer_load_dwordx4 a[76:79], v252, s[12:15], s48 offen offset:3072 sc1
  v_mfma_f32_16x16x32_bf16 v[60:63], a[208:211], v[208:211], v[60:63]
  buffer_store_dwordx4 v[96:99], v252, s[28:31], s49 offen offset:3072 sc1
  v_mfma_f32_16x16x32_bf16 v[60:63], a[212:215], v[212:215], v[60:63]
  v_cvt_pk_bf16_f32 v170, v172, v173
  v_mfma_f32_16x16x32_bf16 v[60:63], a[216:219], v[216:219], v[60:63]
  s_add_u32 s48, s59, 0
  v_mfma_f32_16x16x32_bf16 v[60:63], a[220:223], v[220:223], v[60:63]
  s_waitcnt lgkmcnt(0)
  buffer_load_dwordx4 a[128:131], v252, s[12:15], s48 offen offset:0 sc1
  v_mfma_f32_16x16x32_bf16 v[80:83], a[16:19], v[192:195], v[80:83]
  ds_read_b64_tr_b16 v[208:209], v251 offset:24576
  v_cvt_pk_bf16_f32 v171, v174, v175
  v_mfma_f32_16x16x32_bf16 v[80:83], a[20:23], v[196:199], v[80:83]
  ds_read_b64_tr_b16 v[210:211], v251 offset:24832
  v_mfma_f32_16x16x32_bf16 v[80:83], a[24:27], v[200:203], v[80:83]
  ds_read_b64_tr_b16 v[212:213], v251 offset:26624
  buffer_load_dwordx4 a[132:135], v252, s[12:15], s48 offen offset:1024 sc1
  v_mfma_f32_16x16x32_bf16 v[80:83], a[28:31], v[204:207], v[80:83]
  ds_read_b64_tr_b16 v[214:215], v251 offset:26880
  v_mfma_f32_16x16x32_bf16 v[84:87], a[80:83], v[192:195], v[84:87]
  ds_read_b64_tr_b16 v[216:217], v251 offset:28672
  v_cvt_pk_bf16_f32 v176, v176, v177
  v_mfma_f32_16x16x32_bf16 v[84:87], a[84:87], v[196:199], v[84:87]
  ds_read_b64_tr_b16 v[218:219], v251 offset:28928
  v_mfma_f32_16x16x32_bf16 v[84:87], a[88:91], v[200:203], v[84:87]
  ds_read_b64_tr_b16 v[220:221], v251 offset:30720
  buffer_load_dwordx4 a[136:139], v252, s[12:15], s48 offen offset:2048 sc1
  v_mfma_f32_16x16x32_bf16 v[84:87], a[92:95], v[204:207], v[84:87]
  ds_read_b64_tr_b16 v[222:223], v251 offset:30976
  v_mfma_f32_16x16x32_bf16 v[88:91], a[144:147], v[192:195], v[88:91]
  v_cvt_pk_bf16_f32 v177, v178, v179
  v_mfma_f32_16x16x32_bf16 v[88:91], a[148:151], v[196:199], v[88:91]
  buffer_load_dwordx4 a[140:143], v252, s[12:15], s48 offen offset:3072 sc1
  v_mfma_f32_16x16x32_bf16 v[88:91], a[152:155], v[200:203], v[88:91]
  v_mfma_f32_16x16x32_bf16 v[88:91], a[156:159], v[204:207], v[88:91]
  v_mfma_f32_16x16x32_bf16 v[92:95], a[208:211], v[192:195], v[92:95]
  s_add_u32 s48, s59, 4096
  v_cvt_pk_bf16_f32 v178, v180, v181
  v_mfma_f32_16x16x32_bf16 v[92:95], a[212:215], v[196:199], v[92:95]
  buffer_load_dwordx4 a[192:195], v252, s[12:15], s48 offen offset:0 sc1
  v_mfma_f32_16x16x32_bf16 v[92:95], a[216:219], v[200:203], v[92:95]
  v_mfma_f32_16x16x32_bf16 v[92:95], a[220:223], v[204:207], v[92:95]
  v_add_u32 v250, 0xa000, v250
  v_add_u32 v251, 0xa000, v251
  s_waitcnt vmcnt(28)
  s_barrier
  s_waitcnt lgkmcnt(0)
  v_mfma_f32_16x16x32_bf16 v[112:115], a[16:19], v[208:211], v[112:115]
  ds_read_b64_tr_b16 v[192:193], v250 offset:0
  v_cvt_pk_bf16_f32 v179, v182, v183
  v_mfma_f32_16x16x32_bf16 v[112:115], a[20:23], v[212:215], v[112:115]
  ds_read_b64_tr_b16 v[194:195], v250 offset:256
  buffer_load_dwordx4 a[196:199], v252, s[12:15], s48 offen offset:1024 sc1
  v_mfma_f32_16x16x32_bf16 v[112:115], a[24:27], v[216:219], v[112:115]
  ds_read_b64_tr_b16 v[196:197], v250 offset:2048
  v_mfma_f32_16x16x32_bf16 v[112:115], a[28:31], v[220:223], v[112:115]
  ds_read_b64_tr_b16 v[198:199], v250 offset:2304
  v_mfma_f32_16x16x32_bf16 v[116:119], a[80:83], v[208:211], v[116:119]
  ds_read_b64_tr_b16 v[200:201], v250 offset:4096
  v_cvt_pk_bf16_f32 v184, v184, v185
  buffer_load_dwordx4 a[200:203], v252, s[12:15], s48 offen offset:2048 sc1
  v_mfma_f32_16x16x32_bf16 v[116:119], a[84:87], v[212:215], v[116:119]
  ds_read_b64_tr_b16 v[202:203], v250 offset:4352
  buffer_store_dwordx4 v[100:103], v252, s[28:31], s50 offen offset:3072 sc1
  v_mfma_f32_16x16x32_bf16 v[116:119], a[88:91], v[216:219], v[116:119]
  ds_read_b64_tr_b16 v[204:205], v250 offset:6144
  v_mfma_f32_16x16x32_bf16 v[116:119], a[92:95], v[220:223], v[116:119]
  ds_read_b64_tr_b16 v[206:207], v250 offset:6400
  v_mfma_f32_16x16x32_bf16 v[120:123], a[144:147], v[208:211], v[120:123]
  v_cvt_pk_bf16_f32 v185, v186, v187
  buffer_load_dwordx4 a[204:207], v252, s[12:15], s48 offen offset:3072 sc1
  v_mfma_f32_16x16x32_bf16 v[120:123], a[148:151], v[212:215], v[120:123]
  v_mfma_f32_16x16x32_bf16 v[120:123], a[152:155], v[216:219], v[120:123]
  v_mfma_f32_16x16x32_bf16 v[120:123], a[156:159], v[220:223], v[120:123]
  v_mfma_f32_16x16x32_bf16 v[124:127], a[208:211], v[208:211], v[124:127]
  v_cvt_pk_bf16_f32 v186, v188, v189
  v_mfma_f32_16x16x32_bf16 v[124:127], a[212:215], v[212:215], v[124:127]
  v_mfma_f32_16x16x32_bf16 v[124:127], a[216:219], v[216:219], v[124:127]
  v_mfma_f32_16x16x32_bf16 v[124:127], a[220:223], v[220:223], v[124:127]
  s_waitcnt lgkmcnt(0)
  v_mfma_f32_16x16x32_bf16 v[16:19], a[32:35], v[192:195], v[16:19]
  s_mov_b32 s46, 0
  ds_read_b64_tr_b16 v[208:209], v251 offset:0
  v_cvt_pk_bf16_f32 v187, v190, v191
  s_lshl_b32 s47, s42, 13
  s_add_u32 m0, s47, 0
  s_nop 0
  buffer_load_dwordx4 v244, s[16:19], s46 offen offset:0 lds
  v_mfma_f32_16x16x32_bf16 v[16:19], a[36:39], v[196:199], v[16:19]
  ds_read_b64_tr_b16 v[210:211], v251 offset:256
  v_mfma_f32_16x16x32_bf16 v[16:19], a[40:43], v[200:203], v[16:19]
  ds_read_b64_tr_b16 v[212:213], v251 offset:2048
  v_mfma_f32_16x16x32_bf16 v[16:19], a[44:47], v[204:207], v[16:19]
  ds_read_b64_tr_b16 v[214:215], v251 offset:2304
  buffer_load_dwordx4 v245, s[16:19], s46 offen offset:1024 lds
  v_mfma_f32_16x16x32_bf16 v[20:23], a[96:99], v[192:195], v[20:23]
  ds_read_b64_tr_b16 v[216:217], v251 offset:4096
  v_mfma_f32_16x16x32_bf16 v[20:23], a[100:103], v[196:199], v[20:23]
  ds_read_b64_tr_b16 v[218:219], v251 offset:4352
  v_mfma_f32_16x16x32_bf16 v[20:23], a[104:107], v[200:203], v[20:23]
  ds_read_b64_tr_b16 v[220:221], v251 offset:6144
  v_mfma_f32_16x16x32_bf16 v[20:23], a[108:111], v[204:207], v[20:23]
  ds_read_b64_tr_b16 v[222:223], v251 offset:6400
  buffer_load_dwordx4 v246, s[16:19], s46 offen offset:2048 lds
  v_mfma_f32_16x16x32_bf16 v[24:27], a[160:163], v[192:195], v[24:27]
  v_mfma_f32_16x16x32_bf16 v[24:27], a[164:167], v[196:199], v[24:27]
  v_mfma_f32_16x16x32_bf16 v[24:27], a[168:171], v[200:203], v[24:27]
  v_mfma_f32_16x16x32_bf16 v[24:27], a[172:175], v[204:207], v[24:27]
  buffer_load_dwordx4 v247, s[16:19], s46 offen offset:3072 lds
  v_mfma_f32_16x16x32_bf16 v[28:31], a[224:227], v[192:195], v[28:31]
  s_mov_b32 s46, 524288
  v_mfma_f32_16x16x32_bf16 v[28:31], a[228:231], v[196:199], v[28:31]
  s_lshl_b32 s47, s42, 13
  v_mfma_f32_16x16x32_bf16 v[28:31], a[232:235], v[200:203], v[28:31]
  s_add_u32 m0, s47, 4096
  buffer_store_dwordx4 v[104:107], v252, s[28:31], s51 offen offset:3072 sc1
  v_mfma_f32_16x16x32_bf16 v[28:31], a[236:239], v[204:207], v[28:31]
  s_waitcnt lgkmcnt(0)
  buffer_load_dwordx4 v244, s[16:19], s46 offen offset:0 lds
  v_mfma_f32_16x16x32_bf16 v[48:51], a[32:35], v[208:211], v[48:51]
  ds_read_b64_tr_b16 v[192:193], v250 offset:8192
  v_mfma_f32_16x16x32_bf16 v[48:51], a[36:39], v[212:215], v[48:51]
  ds_read_b64_tr_b16 v[194:195], v250 offset:8448
  v_mfma_f32_16x16x32_bf16 v[48:51], a[40:43], v[216:219], v[48:51]
  ds_read_b64_tr_b16 v[196:197], v250 offset:10240
  buffer_load_dwordx4 v245, s[16:19], s46 offen offset:1024 lds
  v_mfma_f32_16x16x32_bf16 v[48:51], a[44:47], v[220:223], v[48:51]
  ds_read_b64_tr_b16 v[198:199], v250 offset:10496
  v_mfma_f32_16x16x32_bf16 v[52:55], a[96:99], v[208:211], v[52:55]
  ds_read_b64_tr_b16 v[200:201], v250 offset:12288
  v_mfma_f32_16x16x32_bf16 v[52:55], a[100:103], v[212:215], v[52:55]
  ds_read_b64_tr_b16 v[202:203], v250 offset:12544
  v_mfma_f32_16x16x32_bf16 v[52:55], a[104:107], v[216:219], v[52:55]
  ds_read_b64_tr_b16 v[204:205], v250 offset:14336
  buffer_load_dwordx4 v246, s[16:19], s46 offen offset:2048 lds
  v_mfma_f32_16x16x32_bf16 v[52:55], a[108:111], v[220:223], v[52:55]
  ds_read_b64_tr_b16 v[206:207], v250 offset:14592
  v_mfma_f32_16x16x32_bf16 v[56:59], a[160:163], v[208:211], v[56:59]
  v_mfma_f32_16x16x32_bf16 v[56:59], a[164:167], v[212:215], v[56:59]
  v_mfma_f32_16x16x32_bf16 v[56:59], a[168:171], v[216:219], v[56:59]
  buffer_load_dwordx4 v247, s[16:19], s46 offen offset:3072 lds
  v_mfma_f32_16x16x32_bf16 v[56:59], a[172:175], v[220:223], v[56:59]
  v_mfma_f32_16x16x32_bf16 v[60:63], a[224:227], v[208:211], v[60:63]
  v_mfma_f32_16x16x32_bf16 v[60:63], a[228:231], v[212:215], v[60:63]
  v_mfma_f32_16x16x32_bf16 v[60:63], a[232:235], v[216:219], v[60:63]
  v_mfma_f32_16x16x32_bf16 v[60:63], a[236:239], v[220:223], v[60:63]
  s_waitcnt lgkmcnt(0)
  v_mfma_f32_16x16x32_bf16 v[80:83], a[32:35], v[192:195], v[80:83]
  ds_read_b64_tr_b16 v[208:209], v251 offset:8192
  v_mfma_f32_16x16x32_bf16 v[80:83], a[36:39], v[196:199], v[80:83]
  ds_read_b64_tr_b16 v[210:211], v251 offset:8448
  v_mfma_f32_16x16x32_bf16 v[80:83], a[40:43], v[200:203], v[80:83]
  s_add_u32 s48, s58, 524288
  ds_read_b64_tr_b16 v[212:213], v251 offset:10240
  buffer_load_dwordx4 a[16:19], v252, s[12:15], s48 offen offset:0 sc1
  v_mfma_f32_16x16x32_bf16 v[80:83], a[44:47], v[204:207], v[80:83]
  ds_read_b64_tr_b16 v[214:215], v251 offset:10496
  v_mfma_f32_16x16x32_bf16 v[84:87], a[96:99], v[192:195], v[84:87]
  ds_read_b64_tr_b16 v[216:217], v251 offset:12288
  v_mfma_f32_16x16x32_bf16 v[84:87], a[100:103], v[196:199], v[84:87]
  ds_read_b64_tr_b16 v[218:219], v251 offset:12544
  buffer_load_dwordx4 a[20:23], v252, s[12:15], s48 offen offset:1024 sc1
  v_mfma_f32_16x16x32_bf16 v[84:87], a[104:107], v[200:203], v[84:87]
  ds_read_b64_tr_b16 v[220:221], v251 offset:14336
  v_mfma_f32_16x16x32_bf16 v[84:87], a[108:111], v[204:207], v[84:87]
  ds_read_b64_tr_b16 v[222:223], v251 offset:14592
  buffer_store_dwordx4 v[108:111], v252, s[28:31], s52 offen offset:3072 sc1
  v_mfma_f32_16x16x32_bf16 v[88:91], a[160:163], v[192:195], v[88:91]
  buffer_load_dwordx4 a[24:27], v252, s[12:15], s48 offen offset:2048 sc1
  v_mfma_f32_16x16x32_bf16 v[88:91], a[164:167], v[196:199], v[88:91]
  v_mfma_f32_16x16x32_bf16 v[88:91], a[168:171], v[200:203], v[88:91]
  v_mfma_f32_16x16x32_bf16 v[88:91], a[172:175], v[204:207], v[88:91]
  buffer_load_dwordx4 a[28:31], v252, s[12:15], s48 offen offset:3072 sc1
  v_mfma_f32_16x16x32_bf16 v[92:95], a[224:227], v[192:195], v[92:95]
  v_mfma_f32_16x16x32_bf16 v[92:95], a[228:231], v[196:199], v[92:95]
  v_mfma_f32_16x16x32_bf16 v[92:95], a[232:235], v[200:203], v[92:95]
  s_add_u32 s48, s58, 528384
  v_mfma_f32_16x16x32_bf16 v[92:95], a[236:239], v[204:207], v[92:95]
  s_waitcnt lgkmcnt(0)
  v_add_u32 v250, 0x4000, v250
  v_add_u32 v251, 0x4000, v251
  buffer_load_dwordx4 a[80:83], v252, s[12:15], s48 offen offset:0 sc1
  v_mfma_f32_16x16x32_bf16 v[112:115], a[32:35], v[208:211], v[112:115]
  ds_read_b64_tr_b16 v[192:193], v250 offset:0
  v_mfma_f32_16x16x32_bf16 v[112:115], a[36:39], v[212:215], v[112:115]
  ds_read_b64_tr_b16 v[194:195], v250 offset:256
  v_mfma_f32_16x16x32_bf16 v[112:115], a[40:43], v[216:219], v[112:115]
  ds_read_b64_tr_b16 v[196:197], v250 offset:2048
  buffer_load_dwordx4 a[84:87], v252, s[12:15], s48 offen offset:1024 sc1
  v_mfma_f32_16x16x32_bf16 v[112:115], a[44:47], v[220:223], v[112:115]
  ds_read_b64_tr_b16 v[198:199], v250 offset:2304
  v_mfma_f32_16x16x32_bf16 v[116:119], a[96:99], v[208:211], v[116:119]
  ds_read_b64_tr_b16 v[200:201], v250 offset:4096
  v_mfma_f32_16x16x32_bf16 v[116:119], a[100:103], v[212:215], v[116:119]
  ds_read_b64_tr_b16 v[202:203], v250 offset:4352
  buffer_load_dwordx4 a[88:91], v252, s[12:15], s48 offen offset:2048 sc1
  v_mfma_f32_16x16x32_bf16 v[116:119], a[104:107], v[216:219], v[116:119]
  ds_read_b64_tr_b16 v[204:205], v250 offset:6144
  v_mfma_f32_16x16x32_bf16 v[116:119], a[108:111], v[220:223], v[116:119]
  ds_read_b64_tr_b16 v[206:207], v250 offset:6400
  v_mfma_f32_16x16x32_bf16 v[120:123], a[160:163], v[208:211], v[120:123]
  buffer_load_dwordx4 a[92:95], v252, s[12:15], s48 offen offset:3072 sc1
  v_mfma_f32_16x16x32_bf16 v[120:123], a[164:167], v[212:215], v[120:123]
  v_mfma_f32_16x16x32_bf16 v[120:123], a[168:171], v[216:219], v[120:123]
  v_mfma_f32_16x16x32_bf16 v[120:123], a[172:175], v[220:223], v[120:123]
  s_add_u32 s48, s59, 524288
  v_mfma_f32_16x16x32_bf16 v[124:127], a[224:227], v[208:211], v[124:127]
  buffer_load_dwordx4 a[144:147], v252, s[12:15], s48 offen offset:0 sc1
  v_mfma_f32_16x16x32_bf16 v[124:127], a[228:231], v[212:215], v[124:127]
  v_mfma_f32_16x16x32_bf16 v[124:127], a[232:235], v[216:219], v[124:127]
  v_mfma_f32_16x16x32_bf16 v[124:127], a[236:239], v[220:223], v[124:127]
  s_waitcnt lgkmcnt(0)
  buffer_load_dwordx4 a[148:151], v252, s[12:15], s48 offen offset:1024 sc1
  v_mfma_f32_16x16x32_bf16 v[16:19], a[48:51], v[192:195], v[16:19]
  ds_read_b64_tr_b16 v[208:209], v251 offset:0
  v_mfma_f32_16x16x32_bf16 v[16:19], a[52:55], v[196:199], v[16:19]
  ds_read_b64_tr_b16 v[210:211], v251 offset:256
  v_mfma_f32_16x16x32_bf16 v[16:19], a[56:59], v[200:203], v[16:19]
  ds_read_b64_tr_b16 v[212:213], v251 offset:2048
  buffer_load_dwordx4 a[152:155], v252, s[12:15], s48 offen offset:2048 sc1
  v_mfma_f32_16x16x32_bf16 v[16:19], a[60:63], v[204:207], v[16:19]
  ds_read_b64_tr_b16 v[214:215], v251 offset:2304
  v_mfma_f32_16x16x32_bf16 v[20:23], a[112:115], v[192:195], v[20:23]
  ds_read_b64_tr_b16 v[216:217], v251 offset:4096
  v_mfma_f32_16x16x32_bf16 v[20:23], a[116:119], v[196:199], v[20:23]
  ds_read_b64_tr_b16 v[218:219], v251 offset:4352
  buffer_load_dwordx4 a[156:159], v252, s[12:15], s48 offen offset:3072 sc1
  v_mfma_f32_16x16x32_bf16 v[20:23], a[120:123], v[200:203], v[20:23]
  ds_read_b64_tr_b16 v[220:221], v251 offset:6144
  v_mfma_f32_16x16x32_bf16 v[20:23], a[124:127], v[204:207], v[20:23]
  ds_read_b64_tr_b16 v[222:223], v251 offset:6400
  v_mfma_f32_16x16x32_bf16 v[24:27], a[176:179], v[192:195], v[24:27]
  s_add_u32 s48, s59, 528384
  v_mfma_f32_16x16x32_bf16 v[24:27], a[180:183], v[196:199], v[24:27]
  buffer_load_dwordx4 a[208:211], v252, s[12:15], s48 offen offset:0 sc1
  v_mfma_f32_16x16x32_bf16 v[24:27], a[184:187], v[200:203], v[24:27]
  v_mfma_f32_16x16x32_bf16 v[24:27], a[188:191], v[204:207], v[24:27]
  v_mfma_f32_16x16x32_bf16 v[28:31], a[240:243], v[192:195], v[28:31]
  buffer_load_dwordx4 a[212:215], v252, s[12:15], s48 offen offset:1024 sc1
  v_mfma_f32_16x16x32_bf16 v[28:31], a[244:247], v[196:199], v[28:31]
  v_mfma_f32_16x16x32_bf16 v[28:31], a[248:251], v[200:203], v[28:31]
  v_mfma_f32_16x16x32_bf16 v[28:31], a[252:255], v[204:207], v[28:31]
  s_waitcnt lgkmcnt(0)
  buffer_load_dwordx4 a[216:219], v252, s[12:15], s48 offen offset:2048 sc1
  v_mfma_f32_16x16x32_bf16 v[48:51], a[48:51], v[208:211], v[48:51]
  ds_read_b64_tr_b16 v[192:193], v250 offset:8192
  v_mfma_f32_16x16x32_bf16 v[48:51], a[52:55], v[212:215], v[48:51]
  ds_read_b64_tr_b16 v[194:195], v250 offset:8448
  v_mfma_f32_16x16x32_bf16 v[48:51], a[56:59], v[216:219], v[48:51]
  ds_read_b64_tr_b16 v[196:197], v250 offset:10240
  buffer_load_dwordx4 a[220:223], v252, s[12:15], s48 offen offset:3072 sc1
  v_mfma_f32_16x16x32_bf16 v[48:51], a[60:63], v[220:223], v[48:51]
  ds_read_b64_tr_b16 v[198:199], v250 offset:10496
  v_mfma_f32_16x16x32_bf16 v[52:55], a[112:115], v[208:211], v[52:55]
  ds_read_b64_tr_b16 v[200:201], v250 offset:12288
  v_cvt_pk_bf16_f32 v132, v16, v17
  v_mfma_f32_16x16x32_bf16 v[52:55], a[116:119], v[212:215], v[52:55]
  ds_read_b64_tr_b16 v[202:203], v250 offset:12544
  v_cvt_pk_bf16_f32 v133, v18, v19
  v_mfma_f32_16x16x32_bf16 v[52:55], a[120:123], v[216:219], v[52:55]
  ds_read_b64_tr_b16 v[204:205], v250 offset:14336
  v_cvt_pk_bf16_f32 v134, v20, v21
  v_mfma_f32_16x16x32_bf16 v[52:55], a[124:127], v[220:223], v[52:55]
  ds_read_b64_tr_b16 v[206:207], v250 offset:14592
  v_cvt_pk_bf16_f32 v135, v22, v23
  v_mfma_f32_16x16x32_bf16 v[56:59], a[176:179], v[208:211], v[56:59]
  v_mfma_f32_16x16x32_bf16 v[56:59], a[180:183], v[212:215], v[56:59]
  v_cvt_pk_bf16_f32 v140, v24, v25
  v_mfma_f32_16x16x32_bf16 v[56:59], a[184:187], v[216:219], v[56:59]
  s_mov_b32 s46, 1048576
  v_cvt_pk_bf16_f32 v141, v26, v27
  s_lshl_b32 s47, s42, 13
  s_add_u32 m0, s47, 32768
  s_nop 0
  buffer_load_dwordx4 v244, s[16:19], s46 offen offset:0 lds
  v_mfma_f32_16x16x32_bf16 v[56:59], a[188:191], v[220:223], v[56:59]
  v_cvt_pk_bf16_f32 v142, v28, v29
  v_mfma_f32_16x16x32_bf16 v[60:63], a[240:243], v[208:211], v[60:63]
  v_cvt_pk_bf16_f32 v143, v30, v31
  v_mfma_f32_16x16x32_bf16 v[60:63], a[244:247], v[212:215], v[60:63]
  buffer_load_dwordx4 v245, s[16:19], s46 offen offset:1024 lds
  v_mfma_f32_16x16x32_bf16 v[60:63], a[248:251], v[216:219], v[60:63]
  buffer_store_dwordx4 v[128:131], v252, s[32:35], s49 offen offset:0 sc1
  v_mfma_f32_16x16x32_bf16 v[60:63], a[252:255], v[220:223], v[60:63]
  s_waitcnt lgkmcnt(0)
  v_mfma_f32_16x16x32_bf16 v[80:83], a[48:51], v[192:195], v[80:83]
  ds_read_b64_tr_b16 v[208:209], v251 offset:8192
  v_mfma_f32_16x16x32_bf16 v[80:83], a[52:55], v[196:199], v[80:83]
  ds_read_b64_tr_b16 v[210:211], v251 offset:8448
  buffer_load_dwordx4 v246, s[16:19], s46 offen offset:2048 lds
  v_mfma_f32_16x16x32_bf16 v[80:83], a[56:59], v[200:203], v[80:83]
  ds_read_b64_tr_b16 v[212:213], v251 offset:10240
  v_mfma_f32_16x16x32_bf16 v[80:83], a[60:63], v[204:207], v[80:83]
  ds_read_b64_tr_b16 v[214:215], v251 offset:10496
  v_mfma_f32_16x16x32_bf16 v[84:87], a[112:115], v[192:195], v[84:87]
  ds_read_b64_tr_b16 v[216:217], v251 offset:12288
  v_cvt_pk_bf16_f32 v148, v48, v49
  v_mfma_f32_16x16x32_bf16 v[84:87], a[116:119], v[196:199], v[84:87]
  ds_read_b64_tr_b16 v[218:219], v251 offset:12544
  v_cvt_pk_bf16_f32 v149, v50, v51
  buffer_load_dwordx4 v247, s[16:19], s46 offen offset:3072 lds
  v_mfma_f32_16x16x32_bf16 v[84:87], a[120:123], v[200:203], v[84:87]
  s_mov_b32 s46, 1572864
  ds_read_b64_tr_b16 v[220:221], v251 offset:14336
  v_cvt_pk_bf16_f32 v150, v52, v53
  v_mfma_f32_16x16x32_bf16 v[84:87], a[124:127], v[204:207], v[84:87]
  s_lshl_b32 s47, s42, 13
  ds_read_b64_tr_b16 v[222:223], v251 offset:14592
  v_cvt_pk_bf16_f32 v151, v54, v55
  v_mfma_f32_16x16x32_bf16 v[88:91], a[176:179], v[192:195], v[88:91]
  s_add_u32 m0, s47, 36864
  v_mfma_f32_16x16x32_bf16 v[88:91], a[180:183], v[196:199], v[88:91]
  v_cvt_pk_bf16_f32 v156, v56, v57
  buffer_load_dwordx4 v244, s[16:19], s46 offen offset:0 lds
  v_mfma_f32_16x16x32_bf16 v[88:91], a[184:187], v[200:203], v[88:91]
  v_cvt_pk_bf16_f32 v157, v58, v59
  v_mfma_f32_16x16x32_bf16 v[88:91], a[188:191], v[204:207], v[88:91]
  v_cvt_pk_bf16_f32 v158, v60, v61
  v_mfma_f32_16x16x32_bf16 v[92:95], a[240:243], v[192:195], v[92:95]
  v_cvt_pk_bf16_f32 v159, v62, v63
  buffer_load_dwordx4 v245, s[16:19], s46 offen offset:1024 lds
  v_mfma_f32_16x16x32_bf16 v[92:95], a[244:247], v[196:199], v[92:95]
  v_mfma_f32_16x16x32_bf16 v[92:95], a[248:251], v[200:203], v[92:95]
  v_mfma_f32_16x16x32_bf16 v[92:95], a[252:255], v[204:207], v[92:95]
  s_waitcnt vmcnt(24)
  s_barrier
  s_waitcnt lgkmcnt(0)
  v_mfma_f32_16x16x32_bf16 v[112:115], a[48:51], v[208:211], v[112:115]
  ds_read_b64_tr_b16 v[192:193], v248 offset:0
  buffer_load_dwordx4 v246, s[16:19], s46 offen offset:2048 lds
  v_mfma_f32_16x16x32_bf16 v[112:115], a[52:55], v[212:215], v[112:115]
  ds_read_b64_tr_b16 v[194:195], v248 offset:256
  v_mfma_f32_16x16x32_bf16 v[112:115], a[56:59], v[216:219], v[112:115]
  ds_read_b64_tr_b16 v[196:197], v248 offset:2048
  v_mfma_f32_16x16x32_bf16 v[112:115], a[60:63], v[220:223], v[112:115]
  ds_read_b64_tr_b16 v[198:199], v248 offset:2304
  v_mfma_f32_16x16x32_bf16 v[116:119], a[112:115], v[208:211], v[116:119]
  v_cvt_pk_bf16_f32 v164, v80, v81
  ds_read_b64_tr_b16 v[200:201], v248 offset:4096
  buffer_load_dwordx4 v247, s[16:19], s46 offen offset:3072 lds
  v_mfma_f32_16x16x32_bf16 v[116:119], a[116:119], v[212:215], v[116:119]
  v_cvt_pk_bf16_f32 v165, v82, v83
  ds_read_b64_tr_b16 v[202:203], v248 offset:4352
  v_mfma_f32_16x16x32_bf16 v[116:119], a[120:123], v[216:219], v[116:119]
  v_cvt_pk_bf16_f32 v166, v84, v85
  ds_read_b64_tr_b16 v[204:205], v248 offset:6144
  v_mfma_f32_16x16x32_bf16 v[116:119], a[124:127], v[220:223], v[116:119]
  v_cvt_pk_bf16_f32 v167, v86, v87
  ds_read_b64_tr_b16 v[206:207], v248 offset:6400
  v_mfma_f32_16x16x32_bf16 v[120:123], a[176:179], v[208:211], v[120:123]
  v_mfma_f32_16x16x32_bf16 v[120:123], a[180:183], v[212:215], v[120:123]
  v_cvt_pk_bf16_f32 v172, v88, v89
  buffer_store_dwordx4 v[136:139], v252, s[32:35], s49 offen offset:1024 sc1
  v_mfma_f32_16x16x32_bf16 v[120:123], a[184:187], v[216:219], v[120:123]
  v_cvt_pk_bf16_f32 v173, v90, v91
  v_mfma_f32_16x16x32_bf16 v[120:123], a[188:191], v[220:223], v[120:123]
  v_cvt_pk_bf16_f32 v174, v92, v93
  v_mfma_f32_16x16x32_bf16 v[124:127], a[240:243], v[208:211], v[124:127]
  v_cvt_pk_bf16_f32 v175, v94, v95
  v_mfma_f32_16x16x32_bf16 v[124:127], a[244:247], v[212:215], v[124:127]
  v_mfma_f32_16x16x32_bf16 v[124:127], a[248:251], v[216:219], v[124:127]
  v_mfma_f32_16x16x32_bf16 v[124:127], a[252:255], v[220:223], v[124:127]
  s_waitcnt lgkmcnt(0)
  v_mfma_f32_16x16x32_bf16 v[0:3], v[192:195], a[0:3], 0
  s_add_u32 s48, s58, 1048576
  ds_read_b64_tr_b16 v[208:209], v249 offset:0
  buffer_load_dwordx4 a[32:35], v252, s[12:15], s48 offen offset:0 sc1
  v_mfma_f32_16x16x32_bf16 v[0:3], v[196:199], a[4:7], v[0:3]
  ds_read_b64_tr_b16 v[210:211], v249 offset:256
  v_mfma_f32_16x16x32_bf16 v[0:3], v[200:203], a[8:11], v[0:3]
  ds_read_b64_tr_b16 v[212:213], v249 offset:2048
  v_mfma_f32_16x16x32_bf16 v[0:3], v[204:207], a[12:15], v[0:3]
  ds_read_b64_tr_b16 v[214:215], v249 offset:2304
  buffer_load_dwordx4 a[36:39], v252, s[12:15], s48 offen offset:1024 sc1
  v_mfma_f32_16x16x32_bf16 v[4:7], v[192:195], a[64:67], 0
  v_cvt_pk_bf16_f32 v180, v112, v113
  ds_read_b64_tr_b16 v[216:217], v249 offset:4096
  v_mfma_f32_16x16x32_bf16 v[4:7], v[196:199], a[68:71], v[4:7]
  v_cvt_pk_bf16_f32 v181, v114, v115
  ds_read_b64_tr_b16 v[218:219], v249 offset:4352
  v_mfma_f32_16x16x32_bf16 v[4:7], v[200:203], a[72:75], v[4:7]
  v_cvt_pk_bf16_f32 v182, v116, v117
  ds_read_b64_tr_b16 v[220:221], v249 offset:6144
  v_mfma_f32_16x16x32_bf16 v[4:7], v[204:207], a[76:79], v[4:7]
  v_cvt_pk_bf16_f32 v183, v118, v119
  ds_read_b64_tr_b16 v[222:223], v249 offset:6400
  buffer_load_dwordx4 a[40:43], v252, s[12:15], s48 offen offset:2048 sc1
  v_mfma_f32_16x16x32_bf16 v[8:11], v[192:195], a[128:131], 0
  v_mfma_f32_16x16x32_bf16 v[8:11], v[196:199], a[132:135], v[8:11]
  v_cvt_pk_bf16_f32 v188, v120, v121
  v_mfma_f32_16x16x32_bf16 v[8:11], v[200:203], a[136:139], v[8:11]
  v_cvt_pk_bf16_f32 v189, v122, v123
  buffer_load_dwordx4 a[44:47], v252, s[12:15], s48 offen offset:3072 sc1
  v_mfma_f32_16x16x32_bf16 v[8:11], v[204:207], a[140:143], v[8:11]
  v_cvt_pk_bf16_f32 v190, v124, v125
  v_mfma_f32_16x16x32_bf16 v[12:15], v[192:195], a[192:195], 0
  v_cvt_pk_bf16_f32 v191, v126, v127
  v_mfma_f32_16x16x32_bf16 v[12:15], v[196:199], a[196:199], v[12:15]
  s_add_u32 s48, s58, 1052672
  v_mfma_f32_16x16x32_bf16 v[12:15], v[200:203], a[200:203], v[12:15]
  buffer_load_dwordx4 a[96:99], v252, s[12:15], s48 offen offset:0 sc1
  v_mfma_f32_16x16x32_bf16 v[12:15], v[204:207], a[204:207], v[12:15]
  s_waitcnt lgkmcnt(0)
  v_mfma_f32_16x16x32_bf16 v[16:19], v[208:211], a[0:3], 0
  ds_read_b64_tr_b16 v[192:193], v248 offset:8192
  v_mfma_f32_16x16x32_bf16 v[16:19], v[212:215], a[4:7], v[16:19]
  ds_read_b64_tr_b16 v[194:195], v248 offset:8448
  buffer_load_dwordx4 a[100:103], v252, s[12:15], s48 offen offset:1024 sc1
  v_mfma_f32_16x16x32_bf16 v[16:19], v[216:219], a[8:11], v[16:19]
  ds_read_b64_tr_b16 v[196:197], v248 offset:10240
  v_mfma_f32_16x16x32_bf16 v[16:19], v[220:223], a[12:15], v[16:19]
  ds_read_b64_tr_b16 v[198:199], v248 offset:10496
  v_mfma_f32_16x16x32_bf16 v[20:23], v[208:211], a[64:67], 0
  buffer_store_dwordx4 v[144:147], v252, s[32:35], s49 offen offset:2048 sc1
  ds_read_b64_tr_b16 v[200:201], v248 offset:12288
  v_mfma_f32_16x16x32_bf16 v[20:23], v[212:215], a[68:71], v[20:23]
  ds_read_b64_tr_b16 v[202:203], v248 offset:12544
  buffer_load_dwordx4 a[104:107], v252, s[12:15], s48 offen offset:2048 sc1
  v_mfma_f32_16x16x32_bf16 v[20:23], v[216:219], a[72:75], v[20:23]
  s_getpc_b64 s[76:77]
  ds_read_b64_tr_b16 v[204:205], v248 offset:14336
  v_lshlrev_b32 v233, 3, v252
  v_mfma_f32_16x16x32_bf16 v[20:23], v[220:223], a[76:79], v[20:23]
  s_mul_i32 s78, s42, 16384
  ds_read_b64_tr_b16 v[206:207], v248 offset:14592
  v_mfma_f32_16x16x32_bf16 v[24:27], v[208:211], a[128:131], 0
  buffer_load_dwordx4 a[108:111], v252, s[12:15], s48 offen offset:3072 sc1
  v_mfma_f32_16x16x32_bf16 v[24:27], v[212:215], a[132:135], v[24:27]
  v_add_u32 v233, s78, v233
  v_mfma_f32_16x16x32_bf16 v[24:27], v[216:219], a[136:139], v[24:27]
  v_mfma_f32_16x16x32_bf16 v[24:27], v[220:223], a[140:143], v[24:27]
  s_add_u32 s48, s59, 1048576
  global_load_dword v240, v233, s[76:77]
  v_mfma_f32_16x16x32_bf16 v[28:31], v[208:211], a[192:195], 0
  buffer_load_dwordx4 a[160:163], v252, s[12:15], s48 offen offset:0 sc1
  v_mfma_f32_16x16x32_bf16 v[28:31], v[212:215], a[196:199], v[28:31]
  v_add_u32 v233, 8192, v233
  v_mfma_f32_16x16x32_bf16 v[28:31], v[216:219], a[200:203], v[28:31]
  v_mfma_f32_16x16x32_bf16 v[28:31], v[220:223], a[204:207], v[28:31]
  s_waitcnt lgkmcnt(0)
  buffer_load_dwordx4 a[164:167], v252, s[12:15], s48 offen offset:1024 sc1
  v_mfma_f32_16x16x32_bf16 v[32:35], v[192:195], a[0:3], 0
  ds_read_b64_tr_b16 v[208:209], v249 offset:8192
  v_mfma_f32_16x16x32_bf16 v[32:35], v[196:199], a[4:7], v[32:35]
  ds_read_b64_tr_b16 v[210:211], v249 offset:8448
  v_mfma_f32_16x16x32_bf16 v[32:35], v[200:203], a[8:11], v[32:35]
  ds_read_b64_tr_b16 v[212:213], v249 offset:10240
  v_mfma_f32_16x16x32_bf16 v[32:35], v[204:207], a[12:15], v[32:35]
  ds_read_b64_tr_b16 v[214:215], v249 offset:10496
  buffer_load_dwordx4 a[168:171], v252, s[12:15], s48 offen offset:2048 sc1
  v_mfma_f32_16x16x32_bf16 v[36:39], v[192:195], a[64:67], 0
  ds_read_b64_tr_b16 v[216:217], v249 offset:12288
  v_mfma_f32_16x16x32_bf16 v[36:39], v[196:199], a[68:71], v[36:39]
  ds_read_b64_tr_b16 v[218:219], v249 offset:12544
  v_mfma_f32_16x16x32_bf16 v[36:39], v[200:203], a[72:75], v[36:39]
  ds_read_b64_tr_b16 v[220:221], v249 offset:14336
  buffer_load_dwordx4 a[172:175], v252, s[12:15], s48 offen offset:3072 sc1
  v_mfma_f32_16x16x32_bf16 v[36:39], v[204:207], a[76:79], v[36:39]
  ds_read_b64_tr_b16 v[222:223], v249 offset:14592
  v_mfma_f32_16x16x32_bf16 v[40:43], v[192:195], a[128:131], 0
  global_load_dword v240, v233, s[76:77]
  v_mfma_f32_16x16x32_bf16 v[40:43], v[196:199], a[132:135], v[40:43]
  s_add_u32 s48, s59, 1052672
  v_lshrrev_b32 v232, 4, v252
  s_mov_b32 s20, s8
  v_mfma_f32_16x16x32_bf16 v[40:43], v[200:203], a[136:139], v[40:43]
  s_mov_b32 s21, s9
  buffer_load_dwordx4 a[224:227], v252, s[12:15], s48 offen offset:0 sc1
  v_mfma_f32_16x16x32_bf16 v[40:43], v[204:207], a[140:143], v[40:43]
  s_mov_b32 s22, 0x158000
  s_mov_b32 s23, 0x20000
  s_mov_b32 s24, s10
  v_mfma_f32_16x16x32_bf16 v[44:47], v[192:195], a[192:195], 0
  v_mfma_f32_16x16x32_bf16 v[44:47], v[196:199], a[196:199], v[44:47]
  s_mov_b32 s25, s11
  buffer_load_dwordx4 a[228:231], v252, s[12:15], s48 offen offset:1024 sc1
  v_mfma_f32_16x16x32_bf16 v[44:47], v[200:203], a[200:203], v[44:47]
  v_mfma_f32_16x16x32_bf16 v[44:47], v[204:207], a[204:207], v[44:47]
  s_mov_b32 s26, 0x158000
  buffer_store_dwordx4 v[152:155], v252, s[32:35], s49 offen offset:3072 sc1
  s_waitcnt lgkmcnt(0)
  v_mfma_f32_16x16x32_bf16 v[48:51], v[208:211], a[0:3], 0
  ds_read_b64_tr_b16 v[192:193], v248 offset:16384
  v_mfma_f32_16x16x32_bf16 v[48:51], v[212:215], a[4:7], v[48:51]
  ds_read_b64_tr_b16 v[194:195], v248 offset:16640
  buffer_load_dwordx4 a[232:235], v252, s[12:15], s48 offen offset:2048 sc1
  v_mfma_f32_16x16x32_bf16 v[48:51], v[216:219], a[8:11], v[48:51]
  s_mov_b32 s27, 0x20000
  ds_read_b64_tr_b16 v[196:197], v248 offset:18432
  v_mfma_f32_16x16x32_bf16 v[48:51], v[220:223], a[12:15], v[48:51]
  s_lshl_b32 s43, s41, 1
  ds_read_b64_tr_b16 v[198:199], v248 offset:18688
  v_mfma_f32_16x16x32_bf16 v[52:55], v[208:211], a[64:67], 0
  ds_read_b64_tr_b16 v[200:201], v248 offset:20480
  buffer_load_dwordx4 a[236:239], v252, s[12:15], s48 offen offset:3072 sc1
  v_mfma_f32_16x16x32_bf16 v[52:55], v[212:215], a[68:71], v[52:55]
  s_sub_u32 s44, 32, s43
  ds_read_b64_tr_b16 v[202:203], v248 offset:20736
  v_mfma_f32_16x16x32_bf16 v[52:55], v[216:219], a[72:75], v[52:55]
  ds_read_b64_tr_b16 v[204:205], v248 offset:22528
  v_mfma_f32_16x16x32_bf16 v[52:55], v[220:223], a[76:79], v[52:55]
  s_add_u32 s43, s43, 2
  ds_read_b64_tr_b16 v[206:207], v248 offset:22784
  v_mfma_f32_16x16x32_bf16 v[56:59], v[208:211], a[128:131], 0
  v_mfma_f32_16x16x32_bf16 v[56:59], v[212:215], a[132:135], v[56:59]
  s_add_u32 s36, s4, 0x2200000
  s_addc_u32 s37, s5, 0
  v_mfma_f32_16x16x32_bf16 v[56:59], v[216:219], a[136:139], v[56:59]
  v_mfma_f32_16x16x32_bf16 v[56:59], v[220:223], a[140:143], v[56:59]
  s_mov_b32 s38, 0x1580000
  v_mfma_f32_16x16x32_bf16 v[60:63], v[208:211], a[192:195], 0
  s_mov_b32 s46, 2097152
  s_lshl_b32 s47, s42, 13
  s_add_u32 m0, s47, 65536
  s_nop 0
  buffer_load_dwordx4 v244, s[16:19], s46 offen offset:0 lds
  v_mfma_f32_16x16x32_bf16 v[60:63], v[212:215], a[196:199], v[60:63]
  s_mov_b32 s39, 0x20000
  v_mfma_f32_16x16x32_bf16 v[60:63], v[216:219], a[200:203], v[60:63]
  v_mfma_f32_16x16x32_bf16 v[60:63], v[220:223], a[204:207], v[60:63]
  s_lshl_b32 s56, s42, 12
  s_waitcnt lgkmcnt(0)
  v_mfma_f32_16x16x32_bf16 v[64:67], v[192:195], a[0:3], 0
  ds_read_b64_tr_b16 v[208:209], v249 offset:16384
  buffer_load_dwordx4 v245, s[16:19], s46 offen offset:1024 lds
  v_mfma_f32_16x16x32_bf16 v[64:67], v[196:199], a[4:7], v[64:67]
  s_add_u32 s6, s56, 81920
  ds_read_b64_tr_b16 v[210:211], v249 offset:16640
  v_mfma_f32_16x16x32_bf16 v[64:67], v[200:203], a[8:11], v[64:67]
  ds_read_b64_tr_b16 v[212:213], v249 offset:18432
  v_mfma_f32_16x16x32_bf16 v[64:67], v[204:207], a[12:15], v[64:67]
  s_mul_i32 s57, s40, 3
  ds_read_b64_tr_b16 v[214:215], v249 offset:18688
  v_mfma_f32_16x16x32_bf16 v[68:71], v[192:195], a[64:67], 0
  ds_read_b64_tr_b16 v[216:217], v249 offset:20480
  v_mfma_f32_16x16x32_bf16 v[68:71], v[196:199], a[68:71], v[68:71]
  ds_read_b64_tr_b16 v[218:219], v249 offset:20736
  buffer_load_dwordx4 v246, s[16:19], s46 offen offset:2048 lds
  v_mfma_f32_16x16x32_bf16 v[68:71], v[200:203], a[72:75], v[68:71]
  s_lshl_b32 s84, s40, 1
  ds_read_b64_tr_b16 v[220:221], v249 offset:22528
  v_mfma_f32_16x16x32_bf16 v[68:71], v[204:207], a[76:79], v[68:71]
  s_add_u32 s84, s84, 22
  ds_read_b64_tr_b16 v[222:223], v249 offset:22784
  v_mfma_f32_16x16x32_bf16 v[72:75], v[192:195], a[128:131], 0
  v_mfma_f32_16x16x32_bf16 v[72:75], v[196:199], a[132:135], v[72:75]
  buffer_load_dwordx4 v247, s[16:19], s46 offen offset:3072 lds
  v_mfma_f32_16x16x32_bf16 v[72:75], v[200:203], a[136:139], v[72:75]
  buffer_store_dwordx4 v[160:163], v252, s[32:35], s50 offen offset:0 sc1
  v_mfma_f32_16x16x32_bf16 v[72:75], v[204:207], a[140:143], v[72:75]
  s_mov_b32 s46, 2621440
  s_cmp_ge_u32 s40, 22
  s_cselect_b32 s57, s84, s57
  v_mfma_f32_16x16x32_bf16 v[76:79], v[192:195], a[192:195], 0
  s_lshl_b32 s47, s42, 13
  v_lshrrev_b32 v226, 4, v232
  v_mfma_f32_16x16x32_bf16 v[76:79], v[196:199], a[196:199], v[76:79]
  s_add_u32 m0, s47, 69632
  v_and_b32 v224, 15, v232
  v_mfma_f32_16x16x32_bf16 v[76:79], v[200:203], a[200:203], v[76:79]
  buffer_load_dwordx4 v244, s[16:19], s46 offen offset:0 lds
  v_mfma_f32_16x16x32_bf16 v[76:79], v[204:207], a[204:207], v[76:79]
  s_waitcnt lgkmcnt(0)
  v_lshrrev_b32 v224, 2, v224
  v_mfma_f32_16x16x32_bf16 v[80:83], v[208:211], a[0:3], 0
  ds_read_b64_tr_b16 v[192:193], v248 offset:24576
  v_mfma_f32_16x16x32_bf16 v[80:83], v[212:215], a[4:7], v[80:83]
  ds_read_b64_tr_b16 v[194:195], v248 offset:24832
  v_lshlrev_b32 v225, 3, v226
  v_mfma_f32_16x16x32_bf16 v[80:83], v[216:219], a[8:11], v[80:83]
  ds_read_b64_tr_b16 v[196:197], v248 offset:26624
  buffer_load_dwordx4 v245, s[16:19], s46 offen offset:1024 lds
  v_mfma_f32_16x16x32_bf16 v[80:83], v[220:223], a[12:15], v[80:83]
  ds_read_b64_tr_b16 v[198:199], v248 offset:26880
  v_add_u32 v225, v224, v225
  v_mfma_f32_16x16x32_bf16 v[84:87], v[208:211], a[64:67], 0
  ds_read_b64_tr_b16 v[200:201], v248 offset:28672
  v_mfma_f32_16x16x32_bf16 v[84:87], v[212:215], a[68:71], v[84:87]
  ds_read_b64_tr_b16 v[202:203], v248 offset:28928
  v_and_b32 v228, 1, v226
  v_mfma_f32_16x16x32_bf16 v[84:87], v[216:219], a[72:75], v[84:87]
  ds_read_b64_tr_b16 v[204:205], v248 offset:30720
  v_mfma_f32_16x16x32_bf16 v[84:87], v[220:223], a[76:79], v[84:87]
  ds_read_b64_tr_b16 v[206:207], v248 offset:30976
  buffer_load_dwordx4 v246, s[16:19], s46 offen offset:2048 lds
  v_mfma_f32_16x16x32_bf16 v[88:91], v[208:211], a[128:131], 0
  v_and_b32 v229, 3, v232
  v_mfma_f32_16x16x32_bf16 v[88:91], v[212:215], a[132:135], v[88:91]
  v_lshlrev_b32 v229, 3, v229
  v_mfma_f32_16x16x32_bf16 v[88:91], v[216:219], a[136:139], v[88:91]
  v_mfma_f32_16x16x32_bf16 v[88:91], v[220:223], a[140:143], v[88:91]
  buffer_load_dwordx4 v247, s[16:19], s46 offen offset:3072 lds
  v_mfma_f32_16x16x32_bf16 v[92:95], v[208:211], a[192:195], 0
  v_lshlrev_b32 v228, 2, v228
  v_mfma_f32_16x16x32_bf16 v[92:95], v[212:215], a[196:199], v[92:95]
  v_xor_b32 v225, v225, v228
  v_mfma_f32_16x16x32_bf16 v[92:95], v[216:219], a[200:203], v[92:95]
  v_mfma_f32_16x16x32_bf16 v[92:95], v[220:223], a[204:207], v[92:95]
  s_waitcnt lgkmcnt(0)
  v_lshlrev_b32 v225, 5, v225
  v_mfma_f32_16x16x32_bf16 v[96:99], v[192:195], a[0:3], 0
  ds_read_b64_tr_b16 v[208:209], v249 offset:24576
  v_mfma_f32_16x16x32_bf16 v[96:99], v[196:199], a[4:7], v[96:99]
  ds_read_b64_tr_b16 v[210:211], v249 offset:24832
  v_add_u32 v225, v225, v229
  v_mfma_f32_16x16x32_bf16 v[96:99], v[200:203], a[8:11], v[96:99]
  ds_read_b64_tr_b16 v[212:213], v249 offset:26624
  v_mfma_f32_16x16x32_bf16 v[96:99], v[204:207], a[12:15], v[96:99]
  ds_read_b64_tr_b16 v[214:215], v249 offset:26880
  v_add_u32 v250, 131072, v225
  v_mfma_f32_16x16x32_bf16 v[100:103], v[192:195], a[64:67], 0
  s_add_u32 s48, s58, 1572864
  ds_read_b64_tr_b16 v[216:217], v249 offset:28672
  buffer_load_dwordx4 a[48:51], v252, s[12:15], s48 offen offset:0 sc1
  v_mfma_f32_16x16x32_bf16 v[100:103], v[196:199], a[68:71], v[100:103]
  buffer_store_dwordx4 v[168:171], v252, s[32:35], s50 offen offset:1024 sc1
  ds_read_b64_tr_b16 v[218:219], v249 offset:28928
  v_mfma_f32_16x16x32_bf16 v[100:103], v[200:203], a[72:75], v[100:103]
  ds_read_b64_tr_b16 v[220:221], v249 offset:30720
  v_xor_b32 v251, 128, v250
  v_mfma_f32_16x16x32_bf16 v[100:103], v[204:207], a[76:79], v[100:103]
  ds_read_b64_tr_b16 v[222:223], v249 offset:30976
  buffer_load_dwordx4 a[52:55], v252, s[12:15], s48 offen offset:1024 sc1
  v_mfma_f32_16x16x32_bf16 v[104:107], v[192:195], a[128:131], 0
  v_lshrrev_b32 v224, 1, v232
  v_mfma_f32_16x16x32_bf16 v[104:107], v[196:199], a[132:135], v[104:107]
  v_lshrrev_b32 v225, 4, v232
  v_mfma_f32_16x16x32_bf16 v[104:107], v[200:203], a[136:139], v[104:107]
  v_mfma_f32_16x16x32_bf16 v[104:107], v[204:207], a[140:143], v[104:107]
  buffer_load_dwordx4 a[56:59], v252, s[12:15], s48 offen offset:2048 sc1
  v_mfma_f32_16x16x32_bf16 v[108:111], v[192:195], a[192:195], 0
  v_and_b32 v225, 1, v225
  v_mfma_f32_16x16x32_bf16 v[108:111], v[196:199], a[196:199], v[108:111]
  v_lshlrev_b32 v225, 2, v225
  v_mfma_f32_16x16x32_bf16 v[108:111], v[200:203], a[200:203], v[108:111]
  v_xor_b32 v224, v224, v225
  v_mfma_f32_16x16x32_bf16 v[108:111], v[204:207], a[204:207], v[108:111]
  s_waitcnt vmcnt(34)
  s_barrier
  v_add_u32 v248, 32768, v248
  v_add_u32 v249, 32768, v249
  buffer_load_dwordx4 a[60:63], v252, s[12:15], s48 offen offset:3072 sc1
  s_waitcnt lgkmcnt(0)
  v_mfma_f32_16x16x32_bf16 v[112:115], v[208:211], a[0:3], 0
  s_lshl_b32 s84, s42, 7
  ds_read_b64_tr_b16 v[192:193], v248 offset:0
  v_mfma_f32_16x16x32_bf16 v[112:115], v[212:215], a[4:7], v[112:115]
  ds_read_b64_tr_b16 v[194:195], v248 offset:256
  v_mfma_f32_16x16x32_bf16 v[112:115], v[216:219], a[8:11], v[112:115]
  s_add_u32 s48, s58, 1576960
  ds_read_b64_tr_b16 v[196:197], v248 offset:2048
  v_add_u32 v224, s84, v224
  v_mfma_f32_16x16x32_bf16 v[112:115], v[220:223], a[12:15], v[112:115]
  ds_read_b64_tr_b16 v[198:199], v248 offset:2304
  buffer_load_dwordx4 a[112:115], v252, s[12:15], s48 offen offset:0 sc1
  v_mfma_f32_16x16x32_bf16 v[116:119], v[208:211], a[64:67], 0
  ds_read_b64_tr_b16 v[200:201], v248 offset:4096
  v_mul_u32_u24 v224, 2752, v224
  v_mfma_f32_16x16x32_bf16 v[116:119], v[212:215], a[68:71], v[116:119]
  ds_read_b64_tr_b16 v[202:203], v248 offset:4352
  v_mfma_f32_16x16x32_bf16 v[116:119], v[216:219], a[72:75], v[116:119]
  ds_read_b64_tr_b16 v[204:205], v248 offset:6144
  buffer_load_dwordx4 a[116:119], v252, s[12:15], s48 offen offset:1024 sc1
  v_mfma_f32_16x16x32_bf16 v[116:119], v[220:223], a[76:79], v[116:119]
  ds_read_b64_tr_b16 v[206:207], v248 offset:6400
  v_and_b32 v225, 1, v232
  v_mfma_f32_16x16x32_bf16 v[120:123], v[208:211], a[128:131], 0
  v_lshlrev_b32 v225, 4, v225
  v_mfma_f32_16x16x32_bf16 v[120:123], v[212:215], a[132:135], v[120:123]
  v_mfma_f32_16x16x32_bf16 v[120:123], v[216:219], a[136:139], v[120:123]
  buffer_load_dwordx4 a[120:123], v252, s[12:15], s48 offen offset:2048 sc1
  v_mfma_f32_16x16x32_bf16 v[120:123], v[220:223], a[140:143], v[120:123]
  v_add_u32 v230, v224, v225
  v_mfma_f32_16x16x32_bf16 v[124:127], v[208:211], a[192:195], 0
  v_add_u32 v231, 87040, v230
  v_mfma_f32_16x16x32_bf16 v[124:127], v[212:215], a[196:199], v[124:127]
  v_mfma_f32_16x16x32_bf16 v[124:127], v[216:219], a[200:203], v[124:127]
  buffer_load_dwordx4 a[124:127], v252, s[12:15], s48 offen offset:3072 sc1
  v_mfma_f32_16x16x32_bf16 v[124:127], v[220:223], a[204:207], v[124:127]
  s_waitcnt lgkmcnt(0)
  v_add_u32 v234, 174080, v230
  v_mfma_f32_16x16x32_bf16 v[0:3], v[192:195], a[16:19], v[0:3]
  buffer_store_dwordx4 v[176:179], v252, s[32:35], s50 offen offset:2048 sc1
  ds_read_b64_tr_b16 v[208:209], v249 offset:0
  v_mfma_f32_16x16x32_bf16 v[0:3], v[196:199], a[20:23], v[0:3]
  s_add_u32 s48, s59, 1572864
  ds_read_b64_tr_b16 v[210:211], v249 offset:256
  v_add_u32 v235, 261120, v230
  v_mfma_f32_16x16x32_bf16 v[0:3], v[200:203], a[24:27], v[0:3]
  ds_read_b64_tr_b16 v[212:213], v249 offset:2048
  buffer_load_dwordx4 a[176:179], v252, s[12:15], s48 offen offset:0 sc1
  v_mfma_f32_16x16x32_bf16 v[0:3], v[204:207], a[28:31], v[0:3]
  s_lshl_b32 s84, s42, 12
  ds_read_b64_tr_b16 v[214:215], v249 offset:2304
  v_mfma_f32_16x16x32_bf16 v[4:7], v[192:195], a[80:83], v[4:7]
  ds_read_b64_tr_b16 v[216:217], v249 offset:4096
  v_add_u32 v239, s84, v252
  v_mfma_f32_16x16x32_bf16 v[4:7], v[196:199], a[84:87], v[4:7]
  ds_read_b64_tr_b16 v[218:219], v249 offset:4352
  buffer_load_dwordx4 a[180:183], v252, s[12:15], s48 offen offset:1024 sc1
  v_mfma_f32_16x16x32_bf16 v[4:7], v[200:203], a[88:91], v[4:7]
  ds_read_b64_tr_b16 v[220:221], v249 offset:6144
  v_add_u32 v238, 81920, v252
  v_mfma_f32_16x16x32_bf16 v[4:7], v[204:207], a[92:95], v[4:7]
  ds_read_b64_tr_b16 v[222:223], v249 offset:6400
  v_mfma_f32_16x16x32_bf16 v[8:11], v[192:195], a[144:147], v[8:11]
  v_mov_b32 v241, 0xf149f2ca
  v_mfma_f32_16x16x32_bf16 v[8:11], v[196:199], a[148:151], v[8:11]
  buffer_load_dwordx4 a[184:187], v252, s[12:15], s48 offen offset:2048 sc1
  v_mfma_f32_16x16x32_bf16 v[8:11], v[200:203], a[152:155], v[8:11]
  v_and_b32 v224, 15, v232
  v_mfma_f32_16x16x32_bf16 v[8:11], v[204:207], a[156:159], v[8:11]
  v_mfma_f32_16x16x32_bf16 v[12:15], v[192:195], a[208:211], v[12:15]
  v_lshlrev_b32 v225, 2, v226
  v_mfma_f32_16x16x32_bf16 v[12:15], v[196:199], a[212:215], v[12:15]
  buffer_load_dwordx4 a[188:191], v252, s[12:15], s48 offen offset:3072 sc1
  v_mfma_f32_16x16x32_bf16 v[12:15], v[200:203], a[216:219], v[12:15]
  v_sub_u32 v224, v224, v225
  v_mfma_f32_16x16x32_bf16 v[12:15], v[204:207], a[220:223], v[12:15]
  s_waitcnt lgkmcnt(0)
  v_mfma_f32_16x16x32_bf16 v[16:19], v[208:211], a[16:19], v[16:19]
  s_add_u32 s48, s59, 1576960
  ds_read_b64_tr_b16 v[192:193], v248 offset:8192
  s_lshl_b32 s84, s42, 5
  v_mfma_f32_16x16x32_bf16 v[16:19], v[212:215], a[20:23], v[16:19]
  ds_read_b64_tr_b16 v[194:195], v248 offset:8448
  buffer_load_dwordx4 a[240:243], v252, s[12:15], s48 offen offset:0 sc1
  v_mfma_f32_16x16x32_bf16 v[16:19], v[216:219], a[24:27], v[16:19]
  s_lshl_b32 s85, s41, 7
  ds_read_b64_tr_b16 v[196:197], v248 offset:10240
  v_mfma_f32_16x16x32_bf16 v[16:19], v[220:223], a[28:31], v[16:19]
  ds_read_b64_tr_b16 v[198:199], v248 offset:10496
  v_mfma_f32_16x16x32_bf16 v[20:23], v[208:211], a[80:83], v[20:23]
  ds_read_b64_tr_b16 v[200:201], v248 offset:12288
  buffer_load_dwordx4 a[244:247], v252, s[12:15], s48 offen offset:1024 sc1
  v_mfma_f32_16x16x32_bf16 v[20:23], v[212:215], a[84:87], v[20:23]
  s_add_u32 s85, s85, s84
  ds_read_b64_tr_b16 v[202:203], v248 offset:12544
  v_mfma_f32_16x16x32_bf16 v[20:23], v[216:219], a[88:91], v[20:23]
  ds_read_b64_tr_b16 v[204:205], v248 offset:14336
  v_add_u32 v236, s85, v224
  v_mfma_f32_16x16x32_bf16 v[20:23], v[220:223], a[92:95], v[20:23]
  ds_read_b64_tr_b16 v[206:207], v248 offset:14592
  v_mfma_f32_16x16x32_bf16 v[24:27], v[208:211], a[144:147], v[24:27]
  s_sub_u32 s85, 15, s41
  buffer_load_dwordx4 a[248:251], v252, s[12:15], s48 offen offset:2048 sc1
  v_mfma_f32_16x16x32_bf16 v[24:27], v[212:215], a[148:151], v[24:27]
  v_mfma_f32_16x16x32_bf16 v[24:27], v[216:219], a[152:155], v[24:27]
  s_lshl_b32 s85, s85, 7
  v_mfma_f32_16x16x32_bf16 v[24:27], v[220:223], a[156:159], v[24:27]
  buffer_store_dwordx4 v[184:187], v252, s[32:35], s50 offen offset:3072 sc1
  v_mfma_f32_16x16x32_bf16 v[28:31], v[208:211], a[208:211], v[28:31]
  s_add_u32 s85, s85, s84
  buffer_load_dwordx4 a[252:255], v252, s[12:15], s48 offen offset:3072 sc1
  v_mfma_f32_16x16x32_bf16 v[28:31], v[212:215], a[212:215], v[28:31]
  v_mfma_f32_16x16x32_bf16 v[28:31], v[216:219], a[216:219], v[28:31]
  v_add_u32 v237, s85, v224
  v_mfma_f32_16x16x32_bf16 v[28:31], v[220:223], a[220:223], v[28:31]
  s_waitcnt lgkmcnt(6)
  v_mfma_f32_16x16x32_bf16 v[32:35], v[192:195], a[16:19], v[32:35]
  ds_read_b64_tr_b16 v[208:209], v249 offset:8192
  s_getpc_b64 s[76:77]
L_pc_attn_kernel:
  s_waitcnt lgkmcnt(1)
  v_mfma_f32_16x16x32_bf16 v[32:35], v[196:199], a[20:23], v[32:35]
  ds_read_b64_tr_b16 v[210:211], v249 offset:8448
  v_mfma_f32_16x16x32_bf16 v[32:35], v[200:203], a[24:27], v[32:35]
  s_add_u32 s60, s76, L_mask00-L_pc_attn_kernel
  s_addc_u32 s61, s77, 0
  ds_read_b64_tr_b16 v[212:213], v249 offset:10240
  v_mfma_f32_16x16x32_bf16 v[32:35], v[204:207], a[28:31], v[32:35]
  ds_read_b64_tr_b16 v[214:215], v249 offset:10496
  v_mfma_f32_16x16x32_bf16 v[36:39], v[192:195], a[80:83], v[36:39]
  s_mov_b32 s46, 3145728
  ds_read_b64_tr_b16 v[216:217], v249 offset:12288
  s_lshl_b32 s47, s42, 13
  s_add_u32 m0, s47, 98304
  s_nop 0
  buffer_load_dwordx4 v244, s[16:19], s46 offen offset:0 lds
  v_mfma_f32_16x16x32_bf16 v[36:39], v[196:199], a[84:87], v[36:39]
  s_add_u32 s68, s76, L_rare00-L_pc_attn_kernel
  s_addc_u32 s69, s77, 0
  ds_read_b64_tr_b16 v[218:219], v249 offset:12544
  v_mfma_f32_16x16x32_bf16 v[36:39], v[200:203], a[88:91], v[36:39]
  s_add_u32 s62, s76, L_mask01-L_pc_attn_kernel
  s_addc_u32 s63, s77, 0
  ds_read_b64_tr_b16 v[220:221], v249 offset:14336
  v_mfma_f32_16x16x32_bf16 v[36:39], v[204:207], a[92:95], v[36:39]
  ds_read_b64_tr_b16 v[222:223], v249 offset:14592
  v_mfma_f32_16x16x32_bf16 v[40:43], v[192:195], a[144:147], v[40:43]
  s_add_u32 s70, s76, L_rare01-L_pc_attn_kernel
  s_addc_u32 s71, s77, 0
  v_mfma_f32_16x16x32_bf16 v[40:43], v[196:199], a[148:151], v[40:43]
  buffer_load_dwordx4 v245, s[16:19], s46 offen offset:1024 lds
  v_mfma_f32_16x16x32_bf16 v[40:43], v[200:203], a[152:155], v[40:43]
  s_add_u32 s64, s76, L_mask10-L_pc_attn_kernel
  s_addc_u32 s65, s77, 0
  v_mfma_f32_16x16x32_bf16 v[40:43], v[204:207], a[156:159], v[40:43]
  v_mfma_f32_16x16x32_bf16 v[44:47], v[192:195], a[208:211], v[44:47]
  s_add_u32 s72, s76, L_rare10-L_pc_attn_kernel
  s_addc_u32 s73, s77, 0
  v_mfma_f32_16x16x32_bf16 v[44:47], v[196:199], a[212:215], v[44:47]
  v_mfma_f32_16x16x32_bf16 v[44:47], v[200:203], a[216:219], v[44:47]
  buffer_load_dwordx4 v246, s[16:19], s46 offen offset:2048 lds
  v_mfma_f32_16x16x32_bf16 v[44:47], v[204:207], a[220:223], v[44:47]
  s_add_u32 s66, s76, L_mask11-L_pc_attn_kernel
  s_addc_u32 s67, s77, 0
  s_waitcnt lgkmcnt(0)
  v_mfma_f32_16x16x32_bf16 v[48:51], v[208:211], a[16:19], v[48:51]
  s_add_u32 s74, s76, L_rare11-L_pc_attn_kernel
  s_addc_u32 s75, s77, 0
  ds_read_b64_tr_b16 v[192:193], v248 offset:16384
  v_mfma_f32_16x16x32_bf16 v[48:51], v[212:215], a[20:23], v[48:51]
  ds_read_b64_tr_b16 v[194:195], v248 offset:16640
  v_mfma_f32_16x16x32_bf16 v[48:51], v[216:219], a[24:27], v[48:51]
  ds_read_b64_tr_b16 v[196:197], v248 offset:18432
  v_mfma_f32_16x16x32_bf16 v[48:51], v[220:223], a[28:31], v[48:51]
  ds_read_b64_tr_b16 v[198:199], v248 offset:18688
  buffer_load_dwordx4 v247, s[16:19], s46 offen offset:3072 lds
  v_mfma_f32_16x16x32_bf16 v[52:55], v[208:211], a[80:83], v[52:55]
  ds_read_b64_tr_b16 v[200:201], v248 offset:20480
  v_mfma_f32_16x16x32_bf16 v[52:55], v[212:215], a[84:87], v[52:55]
  s_mov_b32 s46, 3670016
  ds_read_b64_tr_b16 v[202:203], v248 offset:20736
  v_mfma_f32_16x16x32_bf16 v[52:55], v[216:219], a[88:91], v[52:55]
  s_lshl_b32 s47, s42, 13
  ds_read_b64_tr_b16 v[204:205], v248 offset:22528
  v_mfma_f32_16x16x32_bf16 v[52:55], v[220:223], a[92:95], v[52:55]
  s_add_u32 m0, s47, 102400
  buffer_store_dwordx4 v[132:135], v252, s[32:35], s51 offen offset:0 sc1
  ds_read_b64_tr_b16 v[206:207], v248 offset:22784
  v_mfma_f32_16x16x32_bf16 v[56:59], v[208:211], a[144:147], v[56:59]
  buffer_load_dwordx4 v244, s[16:19], s46 offen offset:0 lds
  v_mfma_f32_16x16x32_bf16 v[56:59], v[212:215], a[148:151], v[56:59]
  s_lshl_b32 s79, s2, 14
  s_load_dwordx2 s[80:81], s[0:1], 40
  s_load_dwordx2 s[82:83], s[0:1], 72
  v_mfma_f32_16x16x32_bf16 v[56:59], v[216:219], a[152:155], v[56:59]
  s_and_b32 s85, s42, 1
  s_lshl_b32 s85, s85, 13
  s_add_u32 s79, s79, s85
  v_mfma_f32_16x16x32_bf16 v[56:59], v[220:223], a[156:159], v[56:59]
  v_mfma_f32_16x16x32_bf16 v[60:63], v[208:211], a[208:211], v[60:63]
  s_lshl_b32 s85, s2, 13
  v_mfma_f32_16x16x32_bf16 v[60:63], v[212:215], a[212:215], v[60:63]
  buffer_load_dwordx4 v245, s[16:19], s46 offen offset:1024 lds
  v_mfma_f32_16x16x32_bf16 v[60:63], v[216:219], a[216:219], v[60:63]
  s_mov_b32 s84, 4194304
  v_mfma_f32_16x16x32_bf16 v[60:63], v[220:223], a[220:223], v[60:63]
  s_waitcnt lgkmcnt(0)
  v_mfma_f32_16x16x32_bf16 v[64:67], v[192:195], a[16:19], v[64:67]
  ds_read_b64_tr_b16 v[208:209], v249 offset:16384
  s_waitcnt lgkmcnt(0)
  v_mfma_f32_16x16x32_bf16 v[64:67], v[196:199], a[20:23], v[64:67]
  ds_read_b64_tr_b16 v[210:211], v249 offset:16640
  v_mfma_f32_16x16x32_bf16 v[64:67], v[200:203], a[24:27], v[64:67]
  ds_read_b64_tr_b16 v[212:213], v249 offset:18432
  buffer_load_dwordx4 v246, s[16:19], s46 offen offset:2048 lds
  v_mfma_f32_16x16x32_bf16 v[64:67], v[204:207], a[28:31], v[64:67]
  ds_read_b64_tr_b16 v[214:215], v249 offset:18688
  v_mfma_f32_16x16x32_bf16 v[68:71], v[192:195], a[80:83], v[68:71]
  ds_read_b64_tr_b16 v[216:217], v249 offset:20480
  v_mfma_f32_16x16x32_bf16 v[68:71], v[196:199], a[84:87], v[68:71]
  ds_read_b64_tr_b16 v[218:219], v249 offset:20736
  v_mfma_f32_16x16x32_bf16 v[68:71], v[200:203], a[88:91], v[68:71]
  ds_read_b64_tr_b16 v[220:221], v249 offset:22528
  v_mfma_f32_16x16x32_bf16 v[68:71], v[204:207], a[92:95], v[68:71]
  ds_read_b64_tr_b16 v[222:223], v249 offset:22784
  buffer_load_dwordx4 v247, s[16:19], s46 offen offset:3072 lds
  v_mfma_f32_16x16x32_bf16 v[72:75], v[192:195], a[144:147], v[72:75]
  s_cmp_lt_u32 s42, 2
  s_cselect_b32 s80, s80, s82
  s_cselect_b32 s81, s81, s83
  s_cselect_b32 s79, s79, s85
  s_cselect_b32 s82, s84, 1409024
  v_mfma_f32_16x16x32_bf16 v[72:75], v[196:199], a[148:151], v[72:75]
  s_cmp_lt_u32 s42, 3
  s_cselect_b32 s82, s82, 0
  s_mov_b32 s83, 0x20000
  v_mfma_f32_16x16x32_bf16 v[72:75], v[200:203], a[152:155], v[72:75]
  v_mfma_f32_16x16x32_bf16 v[72:75], v[204:207], a[156:159], v[72:75]
  v_mfma_f32_16x16x32_bf16 v[76:79], v[192:195], a[208:211], v[76:79]
  v_mfma_f32_16x16x32_bf16 v[76:79], v[196:199], a[212:215], v[76:79]
  v_mfma_f32_16x16x32_bf16 v[76:79], v[200:203], a[216:219], v[76:79]
  v_mfma_f32_16x16x32_bf16 v[76:79], v[204:207], a[220:223], v[76:79]
  s_waitcnt lgkmcnt(0)
  v_mfma_f32_16x16x32_bf16 v[80:83], v[208:211], a[16:19], v[80:83]
  ds_read_b64_tr_b16 v[192:193], v248 offset:24576
  v_mfma_f32_16x16x32_bf16 v[80:83], v[212:215], a[20:23], v[80:83]
  ds_read_b64_tr_b16 v[194:195], v248 offset:24832
  v_mfma_f32_16x16x32_bf16 v[80:83], v[216:219], a[24:27], v[80:83]
  buffer_store_dwordx4 v[140:143], v252, s[32:35], s51 offen offset:1024 sc1
  ds_read_b64_tr_b16 v[196:197], v248 offset:26624
  v_mfma_f32_16x16x32_bf16 v[80:83], v[220:223], a[28:31], v[80:83]
  ds_read_b64_tr_b16 v[198:199], v248 offset:26880
  v_mfma_f32_16x16x32_bf16 v[84:87], v[208:211], a[80:83], v[84:87]
  ds_read_b64_tr_b16 v[200:201], v248 offset:28672
  v_mfma_f32_16x16x32_bf16 v[84:87], v[212:215], a[84:87], v[84:87]
  ds_read_b64_tr_b16 v[202:203], v248 offset:28928
  v_mfma_f32_16x16x32_bf16 v[84:87], v[216:219], a[88:91], v[84:87]
  ds_read_b64_tr_b16 v[204:205], v248 offset:30720
  v_mfma_f32_16x16x32_bf16 v[84:87], v[220:223], a[92:95], v[84:87]
  ds_read_b64_tr_b16 v[206:207], v248 offset:30976
  v_mfma_f32_16x16x32_bf16 v[88:91], v[208:211], a[144:147], v[88:91]
  v_mfma_f32_16x16x32_bf16 v[88:91], v[212:215], a[148:151], v[88:91]
  v_mfma_f32_16x16x32_bf16 v[88:91], v[216:219], a[152:155], v[88:91]
  v_mfma_f32_16x16x32_bf16 v[88:91], v[220:223], a[156:159], v[88:91]
  v_mfma_f32_16x16x32_bf16 v[92:95], v[208:211], a[208:211], v[92:95]
  v_mfma_f32_16x16x32_bf16 v[92:95], v[212:215], a[212:215], v[92:95]
  v_mfma_f32_16x16x32_bf16 v[92:95], v[216:219], a[216:219], v[92:95]
  v_mfma_f32_16x16x32_bf16 v[92:95], v[220:223], a[220:223], v[92:95]
  s_waitcnt lgkmcnt(0)
  v_mfma_f32_16x16x32_bf16 v[96:99], v[192:195], a[16:19], v[96:99]
  ds_read_b64_tr_b16 v[208:209], v249 offset:24576
  v_mfma_f32_16x16x32_bf16 v[96:99], v[196:199], a[20:23], v[96:99]
  ds_read_b64_tr_b16 v[210:211], v249 offset:24832
  v_mfma_f32_16x16x32_bf16 v[96:99], v[200:203], a[24:27], v[96:99]
  ds_read_b64_tr_b16 v[212:213], v249 offset:26624
  v_mfma_f32_16x16x32_bf16 v[96:99], v[204:207], a[28:31], v[96:99]
  ds_read_b64_tr_b16 v[214:215], v249 offset:26880
  v_mfma_f32_16x16x32_bf16 v[100:103], v[192:195], a[80:83], v[100:103]
  ds_read_b64_tr_b16 v[216:217], v249 offset:28672
  v_mfma_f32_16x16x32_bf16 v[100:103], v[196:199], a[84:87], v[100:103]
  ds_read_b64_tr_b16 v[218:219], v249 offset:28928
  v_mfma_f32_16x16x32_bf16 v[100:103], v[200:203], a[88:91], v[100:103]
  ds_read_b64_tr_b16 v[220:221], v249 offset:30720
  v_mfma_f32_16x16x32_bf16 v[100:103], v[204:207], a[92:95], v[100:103]
  ds_read_b64_tr_b16 v[222:223], v249 offset:30976
  v_mfma_f32_16x16x32_bf16 v[104:107], v[192:195], a[144:147], v[104:107]
  v_mfma_f32_16x16x32_bf16 v[104:107], v[196:199], a[148:151], v[104:107]
  v_mfma_f32_16x16x32_bf16 v[104:107], v[200:203], a[152:155], v[104:107]
  v_mfma_f32_16x16x32_bf16 v[104:107], v[204:207], a[156:159], v[104:107]
  v_mfma_f32_16x16x32_bf16 v[108:111], v[192:195], a[208:211], v[108:111]
  v_mfma_f32_16x16x32_bf16 v[108:111], v[196:199], a[212:215], v[108:111]
  buffer_store_dwordx4 v[148:151], v252, s[32:35], s51 offen offset:2048 sc1
  v_mfma_f32_16x16x32_bf16 v[108:111], v[200:203], a[216:219], v[108:111]
  v_mfma_f32_16x16x32_bf16 v[108:111], v[204:207], a[220:223], v[108:111]
  s_waitcnt vmcnt(30)
  s_barrier
  v_add_u32 v248, 32768, v248
  v_add_u32 v249, 32768, v249
  s_waitcnt lgkmcnt(0)
  v_mfma_f32_16x16x32_bf16 v[112:115], v[208:211], a[16:19], v[112:115]
  ds_read_b64_tr_b16 v[192:193], v248 offset:0
  v_mfma_f32_16x16x32_bf16 v[112:115], v[212:215], a[20:23], v[112:115]
  ds_read_b64_tr_b16 v[194:195], v248 offset:256
  v_mfma_f32_16x16x32_bf16 v[112:115], v[216:219], a[24:27], v[112:115]
  ds_read_b64_tr_b16 v[196:197], v248 offset:2048
  v_mfma_f32_16x16x32_bf16 v[112:115], v[220:223], a[28:31], v[112:115]
  ds_read_b64_tr_b16 v[198:199], v248 offset:2304
  v_mfma_f32_16x16x32_bf16 v[116:119], v[208:211], a[80:83], v[116:119]
  s_add_u32 s46, s57, 0
  ds_read_b64_tr_b16 v[200:201], v248 offset:4096
  s_lshl_b32 s46, s46, 5
  s_lshl_b32 s47, s42, 12
  s_add_u32 m0, s47, 131072
  s_nop 0
  buffer_load_dwordx4 v230, s[20:23], s46 offen offset:0 lds
  v_mfma_f32_16x16x32_bf16 v[116:119], v[212:215], a[84:87], v[116:119]
  ds_read_b64_tr_b16 v[202:203], v248 offset:4352
  v_mfma_f32_16x16x32_bf16 v[116:119], v[216:219], a[88:91], v[116:119]
  ds_read_b64_tr_b16 v[204:205], v248 offset:6144
  v_mfma_f32_16x16x32_bf16 v[116:119], v[220:223], a[92:95], v[116:119]
  ds_read_b64_tr_b16 v[206:207], v248 offset:6400
  v_mfma_f32_16x16x32_bf16 v[120:123], v[208:211], a[144:147], v[120:123]
  v_mfma_f32_16x16x32_bf16 v[120:123], v[212:215], a[148:151], v[120:123]
  v_mfma_f32_16x16x32_bf16 v[120:123], v[216:219], a[152:155], v[120:123]
  v_mfma_f32_16x16x32_bf16 v[120:123], v[220:223], a[156:159], v[120:123]
  v_mfma_f32_16x16x32_bf16 v[124:127], v[208:211], a[208:211], v[124:127]
  v_mfma_f32_16x16x32_bf16 v[124:127], v[212:215], a[212:215], v[124:127]
  v_mfma_f32_16x16x32_bf16 v[124:127], v[216:219], a[216:219], v[124:127]
  buffer_load_dwordx4 v231, s[20:23], s46 offen offset:1024 lds
  v_mfma_f32_16x16x32_bf16 v[124:127], v[220:223], a[220:223], v[124:127]
  s_waitcnt lgkmcnt(0)
  v_mfma_f32_16x16x32_bf16 v[0:3], v[192:195], a[32:35], v[0:3]
  ds_read_b64_tr_b16 v[208:209], v249 offset:0
  v_mfma_f32_16x16x32_bf16 v[0:3], v[196:199], a[36:39], v[0:3]
  ds_read_b64_tr_b16 v[210:211], v249 offset:256
  v_mfma_f32_16x16x32_bf16 v[0:3], v[200:203], a[40:43], v[0:3]
  ds_read_b64_tr_b16 v[212:213], v249 offset:2048
  v_mfma_f32_16x16x32_bf16 v[0:3], v[204:207], a[44:47], v[0:3]
  ds_read_b64_tr_b16 v[214:215], v249 offset:2304
  v_mfma_f32_16x16x32_bf16 v[4:7], v[192:195], a[96:99], v[4:7]
  ds_read_b64_tr_b16 v[216:217], v249 offset:4096
  v_mfma_f32_16x16x32_bf16 v[4:7], v[196:199], a[100:103], v[4:7]
  ds_read_b64_tr_b16 v[218:219], v249 offset:4352
  v_mfma_f32_16x16x32_bf16 v[4:7], v[200:203], a[104:107], v[4:7]
  ds_read_b64_tr_b16 v[220:221], v249 offset:6144
  v_mfma_f32_16x16x32_bf16 v[4:7], v[204:207], a[108:111], v[4:7]
  ds_read_b64_tr_b16 v[222:223], v249 offset:6400
  v_mfma_f32_16x16x32_bf16 v[8:11], v[192:195], a[160:163], v[8:11]
  buffer_store_dwordx4 v[156:159], v252, s[32:35], s51 offen offset:3072 sc1
  v_mfma_f32_16x16x32_bf16 v[8:11], v[196:199], a[164:167], v[8:11]
  buffer_load_dwordx4 v234, s[20:23], s46 offen offset:2048 lds
  v_mfma_f32_16x16x32_bf16 v[8:11], v[200:203], a[168:171], v[8:11]
  v_mfma_f32_16x16x32_bf16 v[8:11], v[204:207], a[172:175], v[8:11]
  v_mfma_f32_16x16x32_bf16 v[12:15], v[192:195], a[224:227], v[12:15]
  v_mfma_f32_16x16x32_bf16 v[12:15], v[196:199], a[228:231], v[12:15]
  v_mfma_f32_16x16x32_bf16 v[12:15], v[200:203], a[232:235], v[12:15]
  v_mfma_f32_16x16x32_bf16 v[12:15], v[204:207], a[236:239], v[12:15]
  s_waitcnt lgkmcnt(0)
  v_mfma_f32_16x16x32_bf16 v[16:19], v[208:211], a[32:35], v[16:19]
  ds_read_b64_tr_b16 v[192:193], v248 offset:8192
  v_mfma_f32_16x16x32_bf16 v[16:19], v[212:215], a[36:39], v[16:19]
  ds_read_b64_tr_b16 v[194:195], v248 offset:8448
  v_mfma_f32_16x16x32_bf16 v[16:19], v[216:219], a[40:43], v[16:19]
  ds_read_b64_tr_b16 v[196:197], v248 offset:10240
  v_mfma_f32_16x16x32_bf16 v[16:19], v[220:223], a[44:47], v[16:19]
  ds_read_b64_tr_b16 v[198:199], v248 offset:10496
  v_mfma_f32_16x16x32_bf16 v[20:23], v[208:211], a[96:99], v[20:23]
  ds_read_b64_tr_b16 v[200:201], v248 offset:12288
  buffer_load_dwordx4 v235, s[20:23], s46 offen offset:3072 lds
  v_mfma_f32_16x16x32_bf16 v[20:23], v[212:215], a[100:103], v[20:23]
  ds_read_b64_tr_b16 v[202:203], v248 offset:12544
  v_mfma_f32_16x16x32_bf16 v[20:23], v[216:219], a[104:107], v[20:23]
  ds_read_b64_tr_b16 v[204:205], v248 offset:14336
  v_mfma_f32_16x16x32_bf16 v[20:23], v[220:223], a[108:111], v[20:23]
  ds_read_b64_tr_b16 v[206:207], v248 offset:14592
  v_mfma_f32_16x16x32_bf16 v[24:27], v[208:211], a[160:163], v[24:27]
  v_mfma_f32_16x16x32_bf16 v[24:27], v[212:215], a[164:167], v[24:27]
  v_mfma_f32_16x16x32_bf16 v[24:27], v[216:219], a[168:171], v[24:27]
  v_mfma_f32_16x16x32_bf16 v[24:27], v[220:223], a[172:175], v[24:27]
  v_mfma_f32_16x16x32_bf16 v[28:31], v[208:211], a[224:227], v[28:31]
  v_mfma_f32_16x16x32_bf16 v[28:31], v[212:215], a[228:231], v[28:31]
  v_mfma_f32_16x16x32_bf16 v[28:31], v[216:219], a[232:235], v[28:31]
  s_add_u32 m0, s47, 147456
  v_mfma_f32_16x16x32_bf16 v[28:31], v[220:223], a[236:239], v[28:31]
  s_waitcnt lgkmcnt(0)
  buffer_load_dwordx4 v230, s[24:27], s46 offen offset:0 lds
  v_mfma_f32_16x16x32_bf16 v[32:35], v[192:195], a[32:35], v[32:35]
  ds_read_b64_tr_b16 v[208:209], v249 offset:8192
  v_mfma_f32_16x16x32_bf16 v[32:35], v[196:199], a[36:39], v[32:35]
  ds_read_b64_tr_b16 v[210:211], v249 offset:8448
  v_mfma_f32_16x16x32_bf16 v[32:35], v[200:203], a[40:43], v[32:35]
  ds_read_b64_tr_b16 v[212:213], v249 offset:10240
  v_mfma_f32_16x16x32_bf16 v[32:35], v[204:207], a[44:47], v[32:35]
  buffer_store_dwordx4 v[164:167], v252, s[32:35], s52 offen offset:0 sc1
  ds_read_b64_tr_b16 v[214:215], v249 offset:10496
  v_mfma_f32_16x16x32_bf16 v[36:39], v[192:195], a[96:99], v[36:39]
  ds_read_b64_tr_b16 v[216:217], v249 offset:12288
  v_mfma_f32_16x16x32_bf16 v[36:39], v[196:199], a[100:103], v[36:39]
  ds_read_b64_tr_b16 v[218:219], v249 offset:12544
  v_mfma_f32_16x16x32_bf16 v[36:39], v[200:203], a[104:107], v[36:39]
  ds_read_b64_tr_b16 v[220:221], v249 offset:14336
  v_mfma_f32_16x16x32_bf16 v[36:39], v[204:207], a[108:111], v[36:39]
  ds_read_b64_tr_b16 v[222:223], v249 offset:14592
  v_mfma_f32_16x16x32_bf16 v[40:43], v[192:195], a[160:163], v[40:43]
  v_mfma_f32_16x16x32_bf16 v[40:43], v[196:199], a[164:167], v[40:43]
  buffer_load_dwordx4 v231, s[24:27], s46 offen offset:1024 lds
  v_mfma_f32_16x16x32_bf16 v[40:43], v[200:203], a[168:171], v[40:43]
  v_mfma_f32_16x16x32_bf16 v[40:43], v[204:207], a[172:175], v[40:43]
  v_mfma_f32_16x16x32_bf16 v[44:47], v[192:195], a[224:227], v[44:47]
  v_mfma_f32_16x16x32_bf16 v[44:47], v[196:199], a[228:231], v[44:47]
  v_mfma_f32_16x16x32_bf16 v[44:47], v[200:203], a[232:235], v[44:47]
  v_mfma_f32_16x16x32_bf16 v[44:47], v[204:207], a[236:239], v[44:47]
  s_waitcnt lgkmcnt(0)
  v_mfma_f32_16x16x32_bf16 v[48:51], v[208:211], a[32:35], v[48:51]
  ds_read_b64_tr_b16 v[192:193], v248 offset:16384
  v_mfma_f32_16x16x32_bf16 v[48:51], v[212:215], a[36:39], v[48:51]
  ds_read_b64_tr_b16 v[194:195], v248 offset:16640
  v_mfma_f32_16x16x32_bf16 v[48:51], v[216:219], a[40:43], v[48:51]
  ds_read_b64_tr_b16 v[196:197], v248 offset:18432
  v_mfma_f32_16x16x32_bf16 v[48:51], v[220:223], a[44:47], v[48:51]
  ds_read_b64_tr_b16 v[198:199], v248 offset:18688
  v_mfma_f32_16x16x32_bf16 v[52:55], v[208:211], a[96:99], v[52:55]
  ds_read_b64_tr_b16 v[200:201], v248 offset:20480
  buffer_load_dwordx4 v234, s[24:27], s46 offen offset:2048 lds
  v_mfma_f32_16x16x32_bf16 v[52:55], v[212:215], a[100:103], v[52:55]
  ds_read_b64_tr_b16 v[202:203], v248 offset:20736
  v_mfma_f32_16x16x32_bf16 v[52:55], v[216:219], a[104:107], v[52:55]
  ds_read_b64_tr_b16 v[204:205], v248 offset:22528
  v_mfma_f32_16x16x32_bf16 v[52:55], v[220:223], a[108:111], v[52:55]
  ds_read_b64_tr_b16 v[206:207], v248 offset:22784
  v_mfma_f32_16x16x32_bf16 v[56:59], v[208:211], a[160:163], v[56:59]
  v_mfma_f32_16x16x32_bf16 v[56:59], v[212:215], a[164:167], v[56:59]
  v_mfma_f32_16x16x32_bf16 v[56:59], v[216:219], a[168:171], v[56:59]
  v_mfma_f32_16x16x32_bf16 v[56:59], v[220:223], a[172:175], v[56:59]
  v_mfma_f32_16x16x32_bf16 v[60:63], v[208:211], a[224:227], v[60:63]
  v_mfma_f32_16x16x32_bf16 v[60:63], v[212:215], a[228:231], v[60:63]
  v_mfma_f32_16x16x32_bf16 v[60:63], v[216:219], a[232:235], v[60:63]
  buffer_store_dwordx4 v[172:175], v252, s[32:35], s52 offen offset:1024 sc1
  v_mfma_f32_16x16x32_bf16 v[60:63], v[220:223], a[236:239], v[60:63]
  s_waitcnt lgkmcnt(0)
  buffer_load_dwordx4 v235, s[24:27], s46 offen offset:3072 lds
  v_mfma_f32_16x16x32_bf16 v[64:67], v[192:195], a[32:35], v[64:67]
  ds_read_b64_tr_b16 v[208:209], v249 offset:16384
  v_mfma_f32_16x16x32_bf16 v[64:67], v[196:199], a[36:39], v[64:67]
  ds_read_b64_tr_b16 v[210:211], v249 offset:16640
  v_mfma_f32_16x16x32_bf16 v[64:67], v[200:203], a[40:43], v[64:67]
  ds_read_b64_tr_b16 v[212:213], v249 offset:18432
  v_mfma_f32_16x16x32_bf16 v[64:67], v[204:207], a[44:47], v[64:67]
  ds_read_b64_tr_b16 v[214:215], v249 offset:18688
  v_mfma_f32_16x16x32_bf16 v[68:71], v[192:195], a[96:99], v[68:71]
  ds_read_b64_tr_b16 v[216:217], v249 offset:20480
  v_mfma_f32_16x16x32_bf16 v[68:71], v[196:199], a[100:103], v[68:71]
  ds_read_b64_tr_b16 v[218:219], v249 offset:20736
  v_mfma_f32_16x16x32_bf16 v[68:71], v[200:203], a[104:107], v[68:71]
  ds_read_b64_tr_b16 v[220:221], v249 offset:22528
  v_mfma_f32_16x16x32_bf16 v[68:71], v[204:207], a[108:111], v[68:71]
  ds_read_b64_tr_b16 v[222:223], v249 offset:22784
  v_mfma_f32_16x16x32_bf16 v[72:75], v[192:195], a[160:163], v[72:75]
  v_mfma_f32_16x16x32_bf16 v[72:75], v[196:199], a[164:167], v[72:75]
  v_mfma_f32_16x16x32_bf16 v[72:75], v[200:203], a[168:171], v[72:75]
  v_mfma_f32_16x16x32_bf16 v[72:75], v[204:207], a[172:175], v[72:75]
  v_mfma_f32_16x16x32_bf16 v[76:79], v[192:195], a[224:227], v[76:79]
  v_mfma_f32_16x16x32_bf16 v[76:79], v[196:199], a[228:231], v[76:79]
  v_mfma_f32_16x16x32_bf16 v[76:79], v[200:203], a[232:235], v[76:79]
  v_mfma_f32_16x16x32_bf16 v[76:79], v[204:207], a[236:239], v[76:79]
  s_waitcnt lgkmcnt(0)
  v_mfma_f32_16x16x32_bf16 v[80:83], v[208:211], a[32:35], v[80:83]
  ds_read_b64_tr_b16 v[192:193], v248 offset:24576
  v_mfma_f32_16x16x32_bf16 v[80:83], v[212:215], a[36:39], v[80:83]
  ds_read_b64_tr_b16 v[194:195], v248 offset:24832
  v_mfma_f32_16x16x32_bf16 v[80:83], v[216:219], a[40:43], v[80:83]
  ds_read_b64_tr_b16 v[196:197], v248 offset:26624
  v_mfma_f32_16x16x32_bf16 v[80:83], v[220:223], a[44:47], v[80:83]
  ds_read_b64_tr_b16 v[198:199], v248 offset:26880
  v_mfma_f32_16x16x32_bf16 v[84:87], v[208:211], a[96:99], v[84:87]
  ds_read_b64_tr_b16 v[200:201], v248 offset:28672
  v_mfma_f32_16x16x32_bf16 v[84:87], v[212:215], a[100:103], v[84:87]
  ds_read_b64_tr_b16 v[202:203], v248 offset:28928
  v_mfma_f32_16x16x32_bf16 v[84:87], v[216:219], a[104:107], v[84:87]
  ds_read_b64_tr_b16 v[204:205], v248 offset:30720
  v_mfma_f32_16x16x32_bf16 v[84:87], v[220:223], a[108:111], v[84:87]
  ds_read_b64_tr_b16 v[206:207], v248 offset:30976
  v_mfma_f32_16x16x32_bf16 v[88:91], v[208:211], a[160:163], v[88:91]
  v_mfma_f32_16x16x32_bf16 v[88:91], v[212:215], a[164:167], v[88:91]
  buffer_store_dwordx4 v[180:183], v252, s[32:35], s52 offen offset:2048 sc1
  v_mfma_f32_16x16x32_bf16 v[88:91], v[216:219], a[168:171], v[88:91]
  v_mfma_f32_16x16x32_bf16 v[88:91], v[220:223], a[172:175], v[88:91]
  v_mfma_f32_16x16x32_bf16 v[92:95], v[208:211], a[224:227], v[92:95]
  v_mfma_f32_16x16x32_bf16 v[92:95], v[212:215], a[228:231], v[92:95]
  v_mfma_f32_16x16x32_bf16 v[92:95], v[216:219], a[232:235], v[92:95]
  v_mfma_f32_16x16x32_bf16 v[92:95], v[220:223], a[236:239], v[92:95]
  s_waitcnt lgkmcnt(0)
  v_mfma_f32_16x16x32_bf16 v[96:99], v[192:195], a[32:35], v[96:99]
  ds_read_b64_tr_b16 v[208:209], v249 offset:24576
  v_mfma_f32_16x16x32_bf16 v[96:99], v[196:199], a[36:39], v[96:99]
  ds_read_b64_tr_b16 v[210:211], v249 offset:24832
  v_mfma_f32_16x16x32_bf16 v[96:99], v[200:203], a[40:43], v[96:99]
  ds_read_b64_tr_b16 v[212:213], v249 offset:26624
  v_mfma_f32_16x16x32_bf16 v[96:99], v[204:207], a[44:47], v[96:99]
  ds_read_b64_tr_b16 v[214:215], v249 offset:26880
  v_mfma_f32_16x16x32_bf16 v[100:103], v[192:195], a[96:99], v[100:103]
  ds_read_b64_tr_b16 v[216:217], v249 offset:28672
  v_mfma_f32_16x16x32_bf16 v[100:103], v[196:199], a[100:103], v[100:103]
  ds_read_b64_tr_b16 v[218:219], v249 offset:28928
  v_mfma_f32_16x16x32_bf16 v[100:103], v[200:203], a[104:107], v[100:103]
  ds_read_b64_tr_b16 v[220:221], v249 offset:30720
  v_mfma_f32_16x16x32_bf16 v[100:103], v[204:207], a[108:111], v[100:103]
  ds_read_b64_tr_b16 v[222:223], v249 offset:30976
  v_mfma_f32_16x16x32_bf16 v[104:107], v[192:195], a[160:163], v[104:107]
  v_mfma_f32_16x16x32_bf16 v[104:107], v[196:199], a[164:167], v[104:107]
  v_mfma_f32_16x16x32_bf16 v[104:107], v[200:203], a[168:171], v[104:107]
  v_mfma_f32_16x16x32_bf16 v[104:107], v[204:207], a[172:175], v[104:107]
  v_mfma_f32_16x16x32_bf16 v[108:111], v[192:195], a[224:227], v[108:111]
  v_mfma_f32_16x16x32_bf16 v[108:111], v[196:199], a[228:231], v[108:111]
  v_mfma_f32_16x16x32_bf16 v[108:111], v[200:203], a[232:235], v[108:111]
  v_mfma_f32_16x16x32_bf16 v[108:111], v[204:207], a[236:239], v[108:111]
  s_waitcnt vmcnt(14)
  s_barrier
  v_add_u32 v248, 32768, v248
  v_add_u32 v249, 32768, v249
  s_waitcnt lgkmcnt(0)
  v_mfma_f32_16x16x32_bf16 v[112:115], v[208:211], a[32:35], v[112:115]
  ds_read_b64_tr_b16 v[192:193], v248 offset:0
  v_mfma_f32_16x16x32_bf16 v[112:115], v[212:215], a[36:39], v[112:115]
  ds_read_b64_tr_b16 v[194:195], v248 offset:256
  v_mfma_f32_16x16x32_bf16 v[112:115], v[216:219], a[40:43], v[112:115]
  ds_read_b64_tr_b16 v[196:197], v248 offset:2048
  v_mfma_f32_16x16x32_bf16 v[112:115], v[220:223], a[44:47], v[112:115]
  ds_read_b64_tr_b16 v[198:199], v248 offset:2304
  v_mfma_f32_16x16x32_bf16 v[116:119], v[208:211], a[96:99], v[116:119]
  s_add_u32 s46, s57, 1
  buffer_store_dwordx4 v[188:191], v252, s[32:35], s52 offen offset:3072 sc1
  ds_read_b64_tr_b16 v[200:201], v248 offset:4096
  s_lshl_b32 s46, s46, 5
  s_lshl_b32 s47, s42, 12
  s_add_u32 m0, s47, 65536
  s_nop 0
  buffer_load_dwordx4 v230, s[20:23], s46 offen offset:0 lds
  v_mfma_f32_16x16x32_bf16 v[116:119], v[212:215], a[100:103], v[116:119]
  ds_read_b64_tr_b16 v[202:203], v248 offset:4352
  v_mfma_f32_16x16x32_bf16 v[116:119], v[216:219], a[104:107], v[116:119]
  ds_read_b64_tr_b16 v[204:205], v248 offset:6144
  v_mfma_f32_16x16x32_bf16 v[116:119], v[220:223], a[108:111], v[116:119]
  ds_read_b64_tr_b16 v[206:207], v248 offset:6400
  v_mfma_f32_16x16x32_bf16 v[120:123], v[208:211], a[160:163], v[120:123]
  v_mfma_f32_16x16x32_bf16 v[120:123], v[212:215], a[164:167], v[120:123]
  v_mfma_f32_16x16x32_bf16 v[120:123], v[216:219], a[168:171], v[120:123]
  v_mfma_f32_16x16x32_bf16 v[120:123], v[220:223], a[172:175], v[120:123]
  v_mfma_f32_16x16x32_bf16 v[124:127], v[208:211], a[224:227], v[124:127]
  v_mfma_f32_16x16x32_bf16 v[124:127], v[212:215], a[228:231], v[124:127]
  v_mfma_f32_16x16x32_bf16 v[124:127], v[216:219], a[232:235], v[124:127]
  v_mfma_f32_16x16x32_bf16 v[124:127], v[220:223], a[236:239], v[124:127]
  s_waitcnt lgkmcnt(0)
  v_mfma_f32_16x16x32_bf16 v[0:3], v[192:195], a[48:51], v[0:3]
  ds_read_b64_tr_b16 v[208:209], v249 offset:0
  v_mfma_f32_16x16x32_bf16 v[0:3], v[196:199], a[52:55], v[0:3]
  ds_read_b64_tr_b16 v[210:211], v249 offset:256
  buffer_load_dwordx4 v231, s[20:23], s46 offen offset:1024 lds
  v_mfma_f32_16x16x32_bf16 v[0:3], v[200:203], a[56:59], v[0:3]
  ds_read_b64_tr_b16 v[212:213], v249 offset:2048
  v_mfma_f32_16x16x32_bf16 v[0:3], v[204:207], a[60:63], v[0:3]
  ds_read_b64_tr_b16 v[214:215], v249 offset:2304
  v_mfma_f32_16x16x32_bf16 v[4:7], v[192:195], a[112:115], v[4:7]
  ds_read_b64_tr_b16 v[216:217], v249 offset:4096
  v_mfma_f32_16x16x32_bf16 v[4:7], v[196:199], a[116:119], v[4:7]
  ds_read_b64_tr_b16 v[218:219], v249 offset:4352
  v_mfma_f32_16x16x32_bf16 v[4:7], v[200:203], a[120:123], v[4:7]
  ds_read_b64_tr_b16 v[220:221], v249 offset:6144
  v_mfma_f32_16x16x32_bf16 v[4:7], v[204:207], a[124:127], v[4:7]
  ds_read_b64_tr_b16 v[222:223], v249 offset:6400
  v_mfma_f32_16x16x32_bf16 v[8:11], v[192:195], a[176:179], v[8:11]
  v_mfma_f32_16x16x32_bf16 v[8:11], v[196:199], a[180:183], v[8:11]
  v_mfma_f32_16x16x32_bf16 v[8:11], v[200:203], a[184:187], v[8:11]
  v_mfma_f32_16x16x32_bf16 v[8:11], v[204:207], a[188:191], v[8:11]
  v_mfma_f32_16x16x32_bf16 v[12:15], v[192:195], a[240:243], v[12:15]
  v_mfma_f32_16x16x32_bf16 v[12:15], v[196:199], a[244:247], v[12:15]
  v_mfma_f32_16x16x32_bf16 v[12:15], v[200:203], a[248:251], v[12:15]
  v_mfma_f32_16x16x32_bf16 v[12:15], v[204:207], a[252:255], v[12:15]
  s_waitcnt lgkmcnt(0)
  buffer_load_dwordx4 v234, s[20:23], s46 offen offset:2048 lds
  v_mfma_f32_16x16x32_bf16 v[16:19], v[208:211], a[48:51], v[16:19]
  ds_read_b64_tr_b16 v[192:193], v248 offset:8192
  v_mfma_f32_16x16x32_bf16 v[16:19], v[212:215], a[52:55], v[16:19]
  ds_read_b64_tr_b16 v[194:195], v248 offset:8448
  v_mfma_f32_16x16x32_bf16 v[16:19], v[216:219], a[56:59], v[16:19]
  ds_read_b64_tr_b16 v[196:197], v248 offset:10240
  v_mfma_f32_16x16x32_bf16 v[16:19], v[220:223], a[60:63], v[16:19]
  ds_read_b64_tr_b16 v[198:199], v248 offset:10496
  v_mfma_f32_16x16x32_bf16 v[20:23], v[208:211], a[112:115], v[20:23]
  ds_read_b64_tr_b16 v[200:201], v248 offset:12288
  v_mfma_f32_16x16x32_bf16 v[20:23], v[212:215], a[116:119], v[20:23]
  ds_read_b64_tr_b16 v[202:203], v248 offset:12544
  v_mfma_f32_16x16x32_bf16 v[20:23], v[216:219], a[120:123], v[20:23]
  ds_read_b64_tr_b16 v[204:205], v248 offset:14336
  v_mfma_f32_16x16x32_bf16 v[20:23], v[220:223], a[124:127], v[20:23]
  ds_read_b64_tr_b16 v[206:207], v248 offset:14592
  v_mfma_f32_16x16x32_bf16 v[24:27], v[208:211], a[176:179], v[24:27]
  v_mfma_f32_16x16x32_bf16 v[24:27], v[212:215], a[180:183], v[24:27]
  v_mfma_f32_16x16x32_bf16 v[24:27], v[216:219], a[184:187], v[24:27]
  v_mfma_f32_16x16x32_bf16 v[24:27], v[220:223], a[188:191], v[24:27]
  v_mfma_f32_16x16x32_bf16 v[28:31], v[208:211], a[240:243], v[28:31]
  buffer_load_dwordx4 v235, s[20:23], s46 offen offset:3072 lds
  v_mfma_f32_16x16x32_bf16 v[28:31], v[212:215], a[244:247], v[28:31]
  v_mfma_f32_16x16x32_bf16 v[28:31], v[216:219], a[248:251], v[28:31]
  v_mfma_f32_16x16x32_bf16 v[28:31], v[220:223], a[252:255], v[28:31]
  s_waitcnt lgkmcnt(0)
  v_mfma_f32_16x16x32_bf16 v[32:35], v[192:195], a[48:51], v[32:35]
  ds_read_b64_tr_b16 v[208:209], v249 offset:8192
  v_mfma_f32_16x16x32_bf16 v[32:35], v[196:199], a[52:55], v[32:35]
  ds_read_b64_tr_b16 v[210:211], v249 offset:8448
  v_mfma_f32_16x16x32_bf16 v[32:35], v[200:203], a[56:59], v[32:35]
  ds_read_b64_tr_b16 v[212:213], v249 offset:10240
  v_mfma_f32_16x16x32_bf16 v[32:35], v[204:207], a[60:63], v[32:35]
  ds_read_b64_tr_b16 v[214:215], v249 offset:10496
  v_mfma_f32_16x16x32_bf16 v[36:39], v[192:195], a[112:115], v[36:39]
  ds_read_b64_tr_b16 v[216:217], v249 offset:12288
  v_mfma_f32_16x16x32_bf16 v[36:39], v[196:199], a[116:119], v[36:39]
  ds_read_b64_tr_b16 v[218:219], v249 offset:12544
  v_mfma_f32_16x16x32_bf16 v[36:39], v[200:203], a[120:123], v[36:39]
  ds_read_b64_tr_b16 v[220:221], v249 offset:14336
  v_mfma_f32_16x16x32_bf16 v[36:39], v[204:207], a[124:127], v[36:39]
  ds_read_b64_tr_b16 v[222:223], v249 offset:14592
  v_mfma_f32_16x16x32_bf16 v[40:43], v[192:195], a[176:179], v[40:43]
  v_mfma_f32_16x16x32_bf16 v[40:43], v[196:199], a[180:183], v[40:43]
  s_add_u32 m0, s47, 81920
  v_mfma_f32_16x16x32_bf16 v[40:43], v[200:203], a[184:187], v[40:43]
  buffer_load_dwordx4 v230, s[24:27], s46 offen offset:0 lds
  v_mfma_f32_16x16x32_bf16 v[40:43], v[204:207], a[188:191], v[40:43]
  v_mfma_f32_16x16x32_bf16 v[44:47], v[192:195], a[240:243], v[44:47]
  v_mfma_f32_16x16x32_bf16 v[44:47], v[196:199], a[244:247], v[44:47]
  v_mfma_f32_16x16x32_bf16 v[44:47], v[200:203], a[248:251], v[44:47]
  v_mfma_f32_16x16x32_bf16 v[44:47], v[204:207], a[252:255], v[44:47]
  s_waitcnt lgkmcnt(0)
  v_mfma_f32_16x16x32_bf16 v[48:51], v[208:211], a[48:51], v[48:51]
  ds_read_b64_tr_b16 v[192:193], v248 offset:16384
  v_mfma_f32_16x16x32_bf16 v[48:51], v[212:215], a[52:55], v[48:51]
  ds_read_b64_tr_b16 v[194:195], v248 offset:16640
  v_mfma_f32_16x16x32_bf16 v[48:51], v[216:219], a[56:59], v[48:51]
  ds_read_b64_tr_b16 v[196:197], v248 offset:18432
  v_mfma_f32_16x16x32_bf16 v[48:51], v[220:223], a[60:63], v[48:51]
  ds_read_b64_tr_b16 v[198:199], v248 offset:18688
  v_mfma_f32_16x16x32_bf16 v[52:55], v[208:211], a[112:115], v[52:55]
  ds_read_b64_tr_b16 v[200:201], v248 offset:20480
  v_mfma_f32_16x16x32_bf16 v[52:55], v[212:215], a[116:119], v[52:55]
  ds_read_b64_tr_b16 v[202:203], v248 offset:20736
  v_mfma_f32_16x16x32_bf16 v[52:55], v[216:219], a[120:123], v[52:55]
  ds_read_b64_tr_b16 v[204:205], v248 offset:22528
  v_mfma_f32_16x16x32_bf16 v[52:55], v[220:223], a[124:127], v[52:55]
  ds_read_b64_tr_b16 v[206:207], v248 offset:22784
  buffer_load_dwordx4 v231, s[24:27], s46 offen offset:1024 lds
  v_mfma_f32_16x16x32_bf16 v[56:59], v[208:211], a[176:179], v[56:59]
  v_mfma_f32_16x16x32_bf16 v[56:59], v[212:215], a[180:183], v[56:59]
  v_mfma_f32_16x16x32_bf16 v[56:59], v[216:219], a[184:187], v[56:59]
  v_mfma_f32_16x16x32_bf16 v[56:59], v[220:223], a[188:191], v[56:59]
  v_mfma_f32_16x16x32_bf16 v[60:63], v[208:211], a[240:243], v[60:63]
  v_mfma_f32_16x16x32_bf16 v[60:63], v[212:215], a[244:247], v[60:63]
  v_mfma_f32_16x16x32_bf16 v[60:63], v[216:219], a[248:251], v[60:63]
  v_mfma_f32_16x16x32_bf16 v[60:63], v[220:223], a[252:255], v[60:63]
  s_waitcnt lgkmcnt(0)
  v_mfma_f32_16x16x32_bf16 v[64:67], v[192:195], a[48:51], v[64:67]
  ds_read_b64_tr_b16 v[208:209], v249 offset:16384
  v_mfma_f32_16x16x32_bf16 v[64:67], v[196:199], a[52:55], v[64:67]
  ds_read_b64_tr_b16 v[210:211], v249 offset:16640
  v_mfma_f32_16x16x32_bf16 v[64:67], v[200:203], a[56:59], v[64:67]
  ds_read_b64_tr_b16 v[212:213], v249 offset:18432
  v_mfma_f32_16x16x32_bf16 v[64:67], v[204:207], a[60:63], v[64:67]
  ds_read_b64_tr_b16 v[214:215], v249 offset:18688
  v_mfma_f32_16x16x32_bf16 v[68:71], v[192:195], a[112:115], v[68:71]
  ds_read_b64_tr_b16 v[216:217], v249 offset:20480
  v_mfma_f32_16x16x32_bf16 v[68:71], v[196:199], a[116:119], v[68:71]
  ds_read_b64_tr_b16 v[218:219], v249 offset:20736
  buffer_load_dwordx4 v234, s[24:27], s46 offen offset:2048 lds
  v_mfma_f32_16x16x32_bf16 v[68:71], v[200:203], a[120:123], v[68:71]
  ds_read_b64_tr_b16 v[220:221], v249 offset:22528
  v_mfma_f32_16x16x32_bf16 v[68:71], v[204:207], a[124:127], v[68:71]
  ds_read_b64_tr_b16 v[222:223], v249 offset:22784
  v_mfma_f32_16x16x32_bf16 v[72:75], v[192:195], a[176:179], v[72:75]
  v_mfma_f32_16x16x32_bf16 v[72:75], v[196:199], a[180:183], v[72:75]
  v_mfma_f32_16x16x32_bf16 v[72:75], v[200:203], a[184:187], v[72:75]
  v_mfma_f32_16x16x32_bf16 v[72:75], v[204:207], a[188:191], v[72:75]
  v_mfma_f32_16x16x32_bf16 v[76:79], v[192:195], a[240:243], v[76:79]
  v_mfma_f32_16x16x32_bf16 v[76:79], v[196:199], a[244:247], v[76:79]
  v_mfma_f32_16x16x32_bf16 v[76:79], v[200:203], a[248:251], v[76:79]
  v_mfma_f32_16x16x32_bf16 v[76:79], v[204:207], a[252:255], v[76:79]
  s_waitcnt lgkmcnt(0)
  v_mfma_f32_16x16x32_bf16 v[80:83], v[208:211], a[48:51], v[80:83]
  ds_read_b64_tr_b16 v[192:193], v248 offset:24576
  v_mfma_f32_16x16x32_bf16 v[80:83], v[212:215], a[52:55], v[80:83]
  ds_read_b64_tr_b16 v[194:195], v248 offset:24832
  v_mfma_f32_16x16x32_bf16 v[80:83], v[216:219], a[56:59], v[80:83]
  ds_read_b64_tr_b16 v[196:197], v248 offset:26624
  buffer_load_dwordx4 v235, s[24:27], s46 offen offset:3072 lds
  v_mfma_f32_16x16x32_bf16 v[80:83], v[220:223], a[60:63], v[80:83]
  ds_read_b64_tr_b16 v[198:199], v248 offset:26880
  v_mfma_f32_16x16x32_bf16 v[84:87], v[208:211], a[112:115], v[84:87]
  ds_read_b64_tr_b16 v[200:201], v248 offset:28672
  v_mfma_f32_16x16x32_bf16 v[84:87], v[212:215], a[116:119], v[84:87]
  ds_read_b64_tr_b16 v[202:203], v248 offset:28928
  v_mfma_f32_16x16x32_bf16 v[84:87], v[216:219], a[120:123], v[84:87]
  ds_read_b64_tr_b16 v[204:205], v248 offset:30720
  v_mfma_f32_16x16x32_bf16 v[84:87], v[220:223], a[124:127], v[84:87]
  ds_read_b64_tr_b16 v[206:207], v248 offset:30976
  v_mfma_f32_16x16x32_bf16 v[88:91], v[208:211], a[176:179], v[88:91]
  v_mfma_f32_16x16x32_bf16 v[88:91], v[212:215], a[180:183], v[88:91]
  v_mfma_f32_16x16x32_bf16 v[88:91], v[216:219], a[184:187], v[88:91]
  v_mfma_f32_16x16x32_bf16 v[88:91], v[220:223], a[188:191], v[88:91]
  v_mfma_f32_16x16x32_bf16 v[92:95], v[208:211], a[240:243], v[92:95]
  v_mfma_f32_16x16x32_bf16 v[92:95], v[212:215], a[244:247], v[92:95]
  v_mfma_f32_16x16x32_bf16 v[92:95], v[216:219], a[248:251], v[92:95]
  v_mfma_f32_16x16x32_bf16 v[92:95], v[220:223], a[252:255], v[92:95]
  s_waitcnt lgkmcnt(0)
  v_mfma_f32_16x16x32_bf16 v[96:99], v[192:195], a[48:51], v[96:99]
  ds_read_b64_tr_b16 v[208:209], v249 offset:24576
  v_mfma_f32_16x16x32_bf16 v[96:99], v[196:199], a[52:55], v[96:99]
  ds_read_b64_tr_b16 v[210:211], v249 offset:24832
  v_mfma_f32_16x16x32_bf16 v[96:99], v[200:203], a[56:59], v[96:99]
  ds_read_b64_tr_b16 v[212:213], v249 offset:26624
  v_mfma_f32_16x16x32_bf16 v[96:99], v[204:207], a[60:63], v[96:99]
  ds_read_b64_tr_b16 v[214:215], v249 offset:26880
  v_mfma_f32_16x16x32_bf16 v[100:103], v[192:195], a[112:115], v[100:103]
  ds_read_b64_tr_b16 v[216:217], v249 offset:28672
  v_mfma_f32_16x16x32_bf16 v[100:103], v[196:199], a[116:119], v[100:103]
  ds_read_b64_tr_b16 v[218:219], v249 offset:28928
  v_mfma_f32_16x16x32_bf16 v[100:103], v[200:203], a[120:123], v[100:103]
  ds_read_b64_tr_b16 v[220:221], v249 offset:30720
  v_mfma_f32_16x16x32_bf16 v[100:103], v[204:207], a[124:127], v[100:103]
  ds_read_b64_tr_b16 v[222:223], v249 offset:30976
  v_mfma_f32_16x16x32_bf16 v[104:107], v[192:195], a[176:179], v[104:107]
  v_mfma_f32_16x16x32_bf16 v[104:107], v[196:199], a[180:183], v[104:107]
  v_mfma_f32_16x16x32_bf16 v[104:107], v[200:203], a[184:187], v[104:107]
  v_mfma_f32_16x16x32_bf16 v[104:107], v[204:207], a[188:191], v[104:107]
  v_mfma_f32_16x16x32_bf16 v[108:111], v[192:195], a[240:243], v[108:111]
  v_mfma_f32_16x16x32_bf16 v[108:111], v[196:199], a[244:247], v[108:111]
  v_mfma_f32_16x16x32_bf16 v[108:111], v[200:203], a[248:251], v[108:111]
  v_mfma_f32_16x16x32_bf16 v[108:111], v[204:207], a[252:255], v[108:111]
  s_waitcnt vmcnt(8)
  s_barrier
  s_waitcnt lgkmcnt(4)
  v_mfma_f32_16x16x32_bf16 v[112:115], v[208:211], a[48:51], v[112:115]
  ds_read_b64_tr_b16 v[192:193], v250 offset:0
  v_mfma_f32_16x16x32_bf16 v[112:115], v[212:215], a[52:55], v[112:115]
  s_cmp_lg_u32 s42, 0
  s_cbranch_scc1 L_sig_kv
  s_add_u32 s84, s40, 32
  s_lshl_b32 s84, s84, 2
  v_mov_b32 v224, s84
  v_mov_b32 v225, 1
  s_mov_b64 exec, 1
  global_atomic_add v224, v225, s[100:101] sc1
  s_mov_b64 exec, -1
L_sig_kv:
  ds_read_b64_tr_b16 v[194:195], v251 offset:0
  s_waitcnt lgkmcnt(2)
  v_mfma_f32_16x16x32_bf16 v[112:115], v[216:219], a[56:59], v[112:115]
  ds_read_b64_tr_b16 v[196:197], v250 offset:1024
  v_mfma_f32_16x16x32_bf16 v[112:115], v[220:223], a[60:63], v[112:115]
  ds_read_b64_tr_b16 v[198:199], v251 offset:1024
  v_mfma_f32_16x16x32_bf16 v[116:119], v[208:211], a[112:115], v[116:119]
  s_add_u32 s46, s57, 2
  ds_read_b64_tr_b16 v[200:201], v250 offset:2048
  s_lshl_b32 s46, s46, 5
  s_lshl_b32 s47, s42, 12
  s_cmp_lt_u32 s40, 22
  s_cselect_b32 s46, s46, 0x40000000
  s_add_u32 m0, s47, 98304
  s_nop 0
  buffer_load_dwordx4 v230, s[20:23], s46 offen offset:0 lds
  v_mfma_f32_16x16x32_bf16 v[116:119], v[212:215], a[116:119], v[116:119]
  s_lshl_b32 s84, s40, 19
  ds_read_b64_tr_b16 v[202:203], v251 offset:2048
  v_mfma_f32_16x16x32_bf16 v[116:119], v[216:219], a[120:123], v[116:119]
  s_add_u32 s85, s84, 0x200000
  ds_read_b64_tr_b16 v[204:205], v250 offset:3072
  v_mfma_f32_16x16x32_bf16 v[116:119], v[220:223], a[124:127], v[116:119]
  ds_read_b64_tr_b16 v[206:207], v251 offset:3072
  v_mfma_f32_16x16x32_bf16 v[120:123], v[208:211], a[176:179], v[120:123]
  s_add_u32 s28, s4, s85
  s_addc_u32 s29, s5, 0
  v_mfma_f32_16x16x32_bf16 v[120:123], v[212:215], a[180:183], v[120:123]
  v_mfma_f32_16x16x32_bf16 v[120:123], v[216:219], a[184:187], v[120:123]
  s_lshl_b32 s30, s44, 14
  v_mfma_f32_16x16x32_bf16 v[120:123], v[220:223], a[188:191], v[120:123]
  v_mfma_f32_16x16x32_bf16 v[124:127], v[208:211], a[240:243], v[124:127]
  s_mov_b32 s31, 0x20000
  v_mfma_f32_16x16x32_bf16 v[124:127], v[212:215], a[244:247], v[124:127]
  v_mfma_f32_16x16x32_bf16 v[124:127], v[216:219], a[248:251], v[124:127]
  v_mfma_f32_16x16x32_bf16 v[124:127], v[220:223], a[252:255], v[124:127]
  s_add_u32 s85, s84, 0x1200000
  buffer_load_dwordx4 v231, s[20:23], s46 offen offset:1024 lds
  s_waitcnt lgkmcnt(0)
  v_mfma_f32_16x16x32_bf16 v[128:131], v[192:195], a[0:3], 0
  ds_read_b64_tr_b16 v[208:209], v250 offset:16384
  v_mfma_f32_16x16x32_bf16 v[128:131], v[196:199], a[4:7], v[128:131]
  s_add_u32 s32, s4, s85
  s_addc_u32 s33, s5, 0
  ds_read_b64_tr_b16 v[210:211], v251 offset:16384
  v_mfma_f32_16x16x32_bf16 v[128:131], v[200:203], a[8:11], v[128:131]
  ds_read_b64_tr_b16 v[212:213], v250 offset:17408
  v_mfma_f32_16x16x32_bf16 v[128:131], v[204:207], a[12:15], v[128:131]
  s_lshl_b32 s34, s44, 14
  ds_read_b64_tr_b16 v[214:215], v251 offset:17408
  v_mfma_f32_16x16x32_bf16 v[132:135], v[192:195], a[64:67], 0
  ds_read_b64_tr_b16 v[216:217], v250 offset:18432
  v_mfma_f32_16x16x32_bf16 v[132:135], v[196:199], a[68:71], v[132:135]
  s_mov_b32 s35, 0x20000
  ds_read_b64_tr_b16 v[218:219], v251 offset:18432
  v_mfma_f32_16x16x32_bf16 v[132:135], v[200:203], a[72:75], v[132:135]
  ds_read_b64_tr_b16 v[220:221], v250 offset:19456
  v_mfma_f32_16x16x32_bf16 v[132:135], v[204:207], a[76:79], v[132:135]
  ds_read_b64_tr_b16 v[222:223], v251 offset:19456
  v_mfma_f32_16x16x32_bf16 v[136:139], v[192:195], a[128:131], 0
  v_mfma_f32_16x16x32_bf16 v[136:139], v[196:199], a[132:135], v[136:139]
  v_mfma_f32_16x16x32_bf16 v[136:139], v[200:203], a[136:139], v[136:139]
  buffer_load_dwordx4 v234, s[20:23], s46 offen offset:2048 lds
  v_mfma_f32_16x16x32_bf16 v[136:139], v[204:207], a[140:143], v[136:139]
  v_cvt_pk_bf16_f32 v0, v0, v1
  v_cvt_pk_bf16_f32 v1, v2, v3
  v_mfma_f32_16x16x32_bf16 v[140:143], v[192:195], a[192:195], 0
  v_mfma_f32_16x16x32_bf16 v[140:143], v[196:199], a[196:199], v[140:143]
  v_cvt_pk_bf16_f32 v2, v16, v17
  v_mfma_f32_16x16x32_bf16 v[140:143], v[200:203], a[200:203], v[140:143]
  v_cvt_pk_bf16_f32 v3, v18, v19
  v_mfma_f32_16x16x32_bf16 v[140:143], v[204:207], a[204:207], v[140:143]
  s_waitcnt lgkmcnt(0)
  v_mfma_f32_16x16x32_bf16 v[144:147], v[208:211], a[0:3], 0
  ds_read_b64_tr_b16 v[192:193], v250 offset:4096
  v_cvt_pk_bf16_f32 v4, v4, v5
  v_mfma_f32_16x16x32_bf16 v[144:147], v[212:215], a[4:7], v[144:147]
  ds_read_b64_tr_b16 v[194:195], v251 offset:4096
  v_cvt_pk_bf16_f32 v5, v6, v7
  v_mfma_f32_16x16x32_bf16 v[144:147], v[216:219], a[8:11], v[144:147]
  ds_read_b64_tr_b16 v[196:197], v250 offset:5120
  v_mfma_f32_16x16x32_bf16 v[144:147], v[220:223], a[12:15], v[144:147]
  ds_read_b64_tr_b16 v[198:199], v251 offset:5120
  v_cvt_pk_bf16_f32 v6, v20, v21
  v_mfma_f32_16x16x32_bf16 v[148:151], v[208:211], a[64:67], 0
  ds_read_b64_tr_b16 v[200:201], v250 offset:6144
  v_cvt_pk_bf16_f32 v7, v22, v23
  v_mfma_f32_16x16x32_bf16 v[148:151], v[212:215], a[68:71], v[148:151]
  ds_read_b64_tr_b16 v[202:203], v251 offset:6144
  buffer_load_dwordx4 v235, s[20:23], s46 offen offset:3072 lds
  v_mfma_f32_16x16x32_bf16 v[148:151], v[216:219], a[72:75], v[148:151]
  ds_read_b64_tr_b16 v[204:205], v250 offset:7168
  v_cvt_pk_bf16_f32 v8, v8, v9
  v_mfma_f32_16x16x32_bf16 v[148:151], v[220:223], a[76:79], v[148:151]
  ds_read_b64_tr_b16 v[206:207], v251 offset:7168
  v_mfma_f32_16x16x32_bf16 v[152:155], v[208:211], a[128:131], 0
  v_cvt_pk_bf16_f32 v9, v10, v11
  v_mfma_f32_16x16x32_bf16 v[152:155], v[212:215], a[132:135], v[152:155]
  v_cvt_pk_bf16_f32 v10, v24, v25
  v_mfma_f32_16x16x32_bf16 v[152:155], v[216:219], a[136:139], v[152:155]
  v_mfma_f32_16x16x32_bf16 v[152:155], v[220:223], a[140:143], v[152:155]
  v_cvt_pk_bf16_f32 v11, v26, v27
  v_mfma_f32_16x16x32_bf16 v[156:159], v[208:211], a[192:195], 0
  v_cvt_pk_bf16_f32 v12, v12, v13
  v_mfma_f32_16x16x32_bf16 v[156:159], v[212:215], a[196:199], v[156:159]
  v_mfma_f32_16x16x32_bf16 v[156:159], v[216:219], a[200:203], v[156:159]
  v_cvt_pk_bf16_f32 v13, v14, v15
  v_mfma_f32_16x16x32_bf16 v[156:159], v[220:223], a[204:207], v[156:159]
  s_waitcnt lgkmcnt(0)
  v_cvt_pk_bf16_f32 v14, v28, v29
  v_mfma_f32_16x16x32_bf16 v[128:131], v[192:195], a[16:19], v[128:131]
  s_add_u32 m0, s47, 114688
  ds_read_b64_tr_b16 v[208:209], v250 offset:20480
  v_mfma_f32_16x16x32_bf16 v[128:131], v[196:199], a[20:23], v[128:131]
  ds_read_b64_tr_b16 v[210:211], v251 offset:20480
  buffer_load_dwordx4 v230, s[24:27], s46 offen offset:0 lds
  v_mfma_f32_16x16x32_bf16 v[128:131], v[200:203], a[24:27], v[128:131]
  ds_read_b64_tr_b16 v[212:213], v250 offset:21504
  v_cvt_pk_bf16_f32 v15, v30, v31
  v_mfma_f32_16x16x32_bf16 v[128:131], v[204:207], a[28:31], v[128:131]
  ds_read_b64_tr_b16 v[214:215], v251 offset:21504
  v_cvt_pk_bf16_f32 v32, v32, v33
  v_mfma_f32_16x16x32_bf16 v[132:135], v[192:195], a[80:83], v[132:135]
  ds_read_b64_tr_b16 v[216:217], v250 offset:22528
  v_cvt_pk_bf16_f32 v33, v34, v35
  v_mfma_f32_16x16x32_bf16 v[132:135], v[196:199], a[84:87], v[132:135]
  ds_read_b64_tr_b16 v[218:219], v251 offset:22528
  v_mfma_f32_16x16x32_bf16 v[132:135], v[200:203], a[88:91], v[132:135]
  ds_read_b64_tr_b16 v[220:221], v250 offset:23552
  v_cvt_pk_bf16_f32 v34, v48, v49
  v_mfma_f32_16x16x32_bf16 v[132:135], v[204:207], a[92:95], v[132:135]
  ds_read_b64_tr_b16 v[222:223], v251 offset:23552
  v_cvt_pk_bf16_f32 v35, v50, v51
  v_mfma_f32_16x16x32_bf16 v[136:139], v[192:195], a[144:147], v[136:139]
  v_mfma_f32_16x16x32_bf16 v[136:139], v[196:199], a[148:151], v[136:139]
  v_cvt_pk_bf16_f32 v36, v36, v37
  v_mfma_f32_16x16x32_bf16 v[136:139], v[200:203], a[152:155], v[136:139]
  v_cvt_pk_bf16_f32 v37, v38, v39
  v_mfma_f32_16x16x32_bf16 v[136:139], v[204:207], a[156:159], v[136:139]
  v_mfma_f32_16x16x32_bf16 v[140:143], v[192:195], a[208:211], v[140:143]
  buffer_load_dwordx4 v231, s[24:27], s46 offen offset:1024 lds
  v_mfma_f32_16x16x32_bf16 v[140:143], v[196:199], a[212:215], v[140:143]
  v_cvt_pk_bf16_f32 v38, v52, v53
  v_cvt_pk_bf16_f32 v39, v54, v55
  v_mfma_f32_16x16x32_bf16 v[140:143], v[200:203], a[216:219], v[140:143]
  v_mfma_f32_16x16x32_bf16 v[140:143], v[204:207], a[220:223], v[140:143]
  s_waitcnt lgkmcnt(0)
  v_cvt_pk_bf16_f32 v40, v40, v41
  v_mfma_f32_16x16x32_bf16 v[144:147], v[208:211], a[16:19], v[144:147]
  ds_read_b64_tr_b16 v[192:193], v250 offset:8192
  v_mfma_f32_16x16x32_bf16 v[144:147], v[212:215], a[20:23], v[144:147]
  ds_read_b64_tr_b16 v[194:195], v251 offset:8192
  v_cvt_pk_bf16_f32 v41, v42, v43
  v_mfma_f32_16x16x32_bf16 v[144:147], v[216:219], a[24:27], v[144:147]
  ds_read_b64_tr_b16 v[196:197], v250 offset:9216
  v_cvt_pk_bf16_f32 v42, v56, v57
  v_mfma_f32_16x16x32_bf16 v[144:147], v[220:223], a[28:31], v[144:147]
  ds_read_b64_tr_b16 v[198:199], v251 offset:9216
  v_mfma_f32_16x16x32_bf16 v[148:151], v[208:211], a[80:83], v[148:151]
  ds_read_b64_tr_b16 v[200:201], v250 offset:10240
  v_cvt_pk_bf16_f32 v43, v58, v59
  v_mfma_f32_16x16x32_bf16 v[148:151], v[212:215], a[84:87], v[148:151]
  ds_read_b64_tr_b16 v[202:203], v251 offset:10240
  v_cvt_pk_bf16_f32 v44, v44, v45
  v_mfma_f32_16x16x32_bf16 v[148:151], v[216:219], a[88:91], v[148:151]
  ds_read_b64_tr_b16 v[204:205], v250 offset:11264
  v_mfma_f32_16x16x32_bf16 v[148:151], v[220:223], a[92:95], v[148:151]
  ds_read_b64_tr_b16 v[206:207], v251 offset:11264
  buffer_load_dwordx4 v234, s[24:27], s46 offen offset:2048 lds
  v_mfma_f32_16x16x32_bf16 v[152:155], v[208:211], a[144:147], v[152:155]
  v_cvt_pk_bf16_f32 v45, v46, v47
  v_cvt_pk_bf16_f32 v46, v60, v61
  v_mfma_f32_16x16x32_bf16 v[152:155], v[212:215], a[148:151], v[152:155]
  v_mfma_f32_16x16x32_bf16 v[152:155], v[216:219], a[152:155], v[152:155]
  v_cvt_pk_bf16_f32 v47, v62, v63
  v_mfma_f32_16x16x32_bf16 v[152:155], v[220:223], a[156:159], v[152:155]
  v_mfma_f32_16x16x32_bf16 v[156:159], v[208:211], a[208:211], v[156:159]
  v_cvt_pk_bf16_f32 v64, v64, v65
  v_mfma_f32_16x16x32_bf16 v[156:159], v[212:215], a[212:215], v[156:159]
  v_cvt_pk_bf16_f32 v65, v66, v67
  v_mfma_f32_16x16x32_bf16 v[156:159], v[216:219], a[216:219], v[156:159]
  v_mfma_f32_16x16x32_bf16 v[156:159], v[220:223], a[220:223], v[156:159]
  s_waitcnt lgkmcnt(0)
  v_cvt_pk_bf16_f32 v66, v80, v81
  v_mfma_f32_16x16x32_bf16 v[128:131], v[192:195], a[32:35], v[128:131]
  ds_read_b64_tr_b16 v[208:209], v250 offset:24576
  v_cvt_pk_bf16_f32 v67, v82, v83
  v_mfma_f32_16x16x32_bf16 v[128:131], v[196:199], a[36:39], v[128:131]
  ds_read_b64_tr_b16 v[210:211], v251 offset:24576
  v_mfma_f32_16x16x32_bf16 v[128:131], v[200:203], a[40:43], v[128:131]
  ds_read_b64_tr_b16 v[212:213], v250 offset:25600
  buffer_load_dwordx4 v235, s[24:27], s46 offen offset:3072 lds
  v_mfma_f32_16x16x32_bf16 v[128:131], v[204:207], a[44:47], v[128:131]
  ds_read_b64_tr_b16 v[214:215], v251 offset:25600
  v_cvt_pk_bf16_f32 v68, v68, v69
  v_mfma_f32_16x16x32_bf16 v[132:135], v[192:195], a[96:99], v[132:135]
  ds_read_b64_tr_b16 v[216:217], v250 offset:26624
  v_cvt_pk_bf16_f32 v69, v70, v71
  v_mfma_f32_16x16x32_bf16 v[132:135], v[196:199], a[100:103], v[132:135]
  ds_read_b64_tr_b16 v[218:219], v251 offset:26624
  v_cvt_pk_bf16_f32 v70, v84, v85
  v_mfma_f32_16x16x32_bf16 v[132:135], v[200:203], a[104:107], v[132:135]
  ds_read_b64_tr_b16 v[220:221], v250 offset:27648
  v_cvt_pk_bf16_f32 v71, v86, v87
  v_mfma_f32_16x16x32_bf16 v[132:135], v[204:207], a[108:111], v[132:135]
  ds_read_b64_tr_b16 v[222:223], v251 offset:27648
  v_mfma_f32_16x16x32_bf16 v[136:139], v[192:195], a[160:163], v[136:139]
  v_cvt_pk_bf16_f32 v72, v72, v73
  v_mfma_f32_16x16x32_bf16 v[136:139], v[196:199], a[164:167], v[136:139]
  v_mfma_f32_16x16x32_bf16 v[136:139], v[200:203], a[168:171], v[136:139]
  v_cvt_pk_bf16_f32 v73, v74, v75
  v_mfma_f32_16x16x32_bf16 v[136:139], v[204:207], a[172:175], v[136:139]
  v_cvt_pk_bf16_f32 v74, v88, v89
  v_mfma_f32_16x16x32_bf16 v[140:143], v[192:195], a[224:227], v[140:143]
  v_mfma_f32_16x16x32_bf16 v[140:143], v[196:199], a[228:231], v[140:143]
  v_cvt_pk_bf16_f32 v75, v90, v91
  v_mfma_f32_16x16x32_bf16 v[140:143], v[200:203], a[232:235], v[140:143]
  v_cvt_pk_bf16_f32 v76, v76, v77
  v_mfma_f32_16x16x32_bf16 v[140:143], v[204:207], a[236:239], v[140:143]
  s_waitcnt lgkmcnt(0)
  v_mfma_f32_16x16x32_bf16 v[144:147], v[208:211], a[32:35], v[144:147]
  ds_read_b64_tr_b16 v[192:193], v250 offset:12288
  v_cvt_pk_bf16_f32 v77, v78, v79
  v_mfma_f32_16x16x32_bf16 v[144:147], v[212:215], a[36:39], v[144:147]
  ds_read_b64_tr_b16 v[194:195], v251 offset:12288
  v_cvt_pk_bf16_f32 v78, v92, v93
  v_mfma_f32_16x16x32_bf16 v[144:147], v[216:219], a[40:43], v[144:147]
  ds_read_b64_tr_b16 v[196:197], v250 offset:13312
  v_mfma_f32_16x16x32_bf16 v[144:147], v[220:223], a[44:47], v[144:147]
  ds_read_b64_tr_b16 v[198:199], v251 offset:13312
  v_cvt_pk_bf16_f32 v79, v94, v95
  v_mfma_f32_16x16x32_bf16 v[148:151], v[208:211], a[96:99], v[148:151]
  ds_read_b64_tr_b16 v[200:201], v250 offset:14336
  v_mfma_f32_16x16x32_bf16 v[148:151], v[212:215], a[100:103], v[148:151]
  ds_read_b64_tr_b16 v[202:203], v251 offset:14336
  v_cvt_pk_bf16_f32 v96, v96, v97
  v_mfma_f32_16x16x32_bf16 v[148:151], v[216:219], a[104:107], v[148:151]
  ds_read_b64_tr_b16 v[204:205], v250 offset:15360
  v_cvt_pk_bf16_f32 v97, v98, v99
  v_mfma_f32_16x16x32_bf16 v[148:151], v[220:223], a[108:111], v[148:151]
  ds_read_b64_tr_b16 v[206:207], v251 offset:15360
  v_mfma_f32_16x16x32_bf16 v[152:155], v[208:211], a[160:163], v[152:155]
  v_cvt_pk_bf16_f32 v98, v112, v113
  v_mfma_f32_16x16x32_bf16 v[152:155], v[212:215], a[164:167], v[152:155]
  v_cvt_pk_bf16_f32 v99, v114, v115
  v_mfma_f32_16x16x32_bf16 v[152:155], v[216:219], a[168:171], v[152:155]
  v_mfma_f32_16x16x32_bf16 v[152:155], v[220:223], a[172:175], v[152:155]
  v_cvt_pk_bf16_f32 v100, v100, v101
  v_mfma_f32_16x16x32_bf16 v[156:159], v[208:211], a[224:227], v[156:159]
  v_cvt_pk_bf16_f32 v101, v102, v103
  v_mfma_f32_16x16x32_bf16 v[156:159], v[212:215], a[228:231], v[156:159]
  v_mfma_f32_16x16x32_bf16 v[156:159], v[216:219], a[232:235], v[156:159]
  v_cvt_pk_bf16_f32 v102, v116, v117
  v_mfma_f32_16x16x32_bf16 v[156:159], v[220:223], a[236:239], v[156:159]
  s_waitcnt lgkmcnt(0)
  v_cvt_pk_bf16_f32 v103, v118, v119
  v_mfma_f32_16x16x32_bf16 v[128:131], v[192:195], a[48:51], v[128:131]
  ds_read_b64_tr_b16 v[208:209], v250 offset:28672
  v_mfma_f32_16x16x32_bf16 v[128:131], v[196:199], a[52:55], v[128:131]
  ds_read_b64_tr_b16 v[210:211], v251 offset:28672
  v_cvt_pk_bf16_f32 v104, v104, v105
  v_mfma_f32_16x16x32_bf16 v[128:131], v[200:203], a[56:59], v[128:131]
  ds_read_b64_tr_b16 v[212:213], v250 offset:29696
  v_mfma_f32_16x16x32_bf16 v[128:131], v[204:207], a[60:63], v[128:131]
  ds_read_b64_tr_b16 v[214:215], v251 offset:29696
  v_cvt_pk_bf16_f32 v105, v106, v107
  v_mfma_f32_16x16x32_bf16 v[132:135], v[192:195], a[112:115], v[132:135]
  ds_read_b64_tr_b16 v[216:217], v250 offset:30720
  v_cvt_pk_bf16_f32 v106, v120, v121
  v_mfma_f32_16x16x32_bf16 v[132:135], v[196:199], a[116:119], v[132:135]
  ds_read_b64_tr_b16 v[218:219], v251 offset:30720
  v_mfma_f32_16x16x32_bf16 v[132:135], v[200:203], a[120:123], v[132:135]
  ds_read_b64_tr_b16 v[220:221], v250 offset:31744
  v_cvt_pk_bf16_f32 v107, v122, v123
  v_mfma_f32_16x16x32_bf16 v[132:135], v[204:207], a[124:127], v[132:135]
  ds_read_b64_tr_b16 v[222:223], v251 offset:31744
  v_cvt_pk_bf16_f32 v108, v108, v109
  v_mfma_f32_16x16x32_bf16 v[136:139], v[192:195], a[176:179], v[136:139]
  v_mfma_f32_16x16x32_bf16 v[136:139], v[196:199], a[180:183], v[136:139]
  v_cvt_pk_bf16_f32 v109, v110, v111
  v_mfma_f32_16x16x32_bf16 v[136:139], v[200:203], a[184:187], v[136:139]
  v_cvt_pk_bf16_f32 v110, v124, v125
  v_mfma_f32_16x16x32_bf16 v[136:139], v[204:207], a[188:191], v[136:139]
  v_mfma_f32_16x16x32_bf16 v[140:143], v[192:195], a[240:243], v[140:143]
  v_cvt_pk_bf16_f32 v111, v126, v127
  v_mfma_f32_16x16x32_bf16 v[140:143], v[196:199], a[244:247], v[140:143]
  v_mfma_f32_16x16x32_bf16 v[140:143], v[200:203], a[248:251], v[140:143]
  v_mfma_f32_16x16x32_bf16 v[140:143], v[204:207], a[252:255], v[140:143]
  s_waitcnt vmcnt(8)
  s_barrier
  v_add_u32 v250, 0xffff0000, v250
  v_add_u32 v251, 0xffff0000, v251
  s_waitcnt lgkmcnt(0)
  v_mfma_f32_16x16x32_bf16 v[144:147], v[208:211], a[48:51], v[144:147]
  ds_read_b64_tr_b16 v[192:193], v250 offset:0
  v_mfma_f32_16x16x32_bf16 v[144:147], v[212:215], a[52:55], v[144:147]
  ds_read_b64_tr_b16 v[194:195], v251 offset:0
  v_mfma_f32_16x16x32_bf16 v[144:147], v[216:219], a[56:59], v[144:147]
  ds_read_b64_tr_b16 v[196:197], v250 offset:1024
  v_mfma_f32_16x16x32_bf16 v[144:147], v[220:223], a[60:63], v[144:147]
  ds_read_b64_tr_b16 v[198:199], v251 offset:1024
  v_mfma_f32_16x16x32_bf16 v[148:151], v[208:211], a[112:115], v[148:151]
  ds_read_b64_tr_b16 v[200:201], v250 offset:2048
  v_mfma_f32_16x16x32_bf16 v[148:151], v[212:215], a[116:119], v[148:151]
  ds_read_b64_tr_b16 v[202:203], v251 offset:2048
  v_mfma_f32_16x16x32_bf16 v[148:151], v[216:219], a[120:123], v[148:151]
  s_add_u32 s84, s40, 32
  ds_read_b64_tr_b16 v[204:205], v250 offset:3072
  v_mfma_f32_16x16x32_bf16 v[148:151], v[220:223], a[124:127], v[148:151]
  ds_read_b64_tr_b16 v[206:207], v251 offset:3072
  v_mfma_f32_16x16x32_bf16 v[152:155], v[208:211], a[176:179], v[152:155]
  s_lshl_b32 s84, s84, 2
  v_mfma_f32_16x16x32_bf16 v[152:155], v[212:215], a[180:183], v[152:155]
  v_mfma_f32_16x16x32_bf16 v[152:155], v[216:219], a[184:187], v[152:155]
  v_mov_b32 v227, s84
  v_mfma_f32_16x16x32_bf16 v[152:155], v[220:223], a[188:191], v[152:155]
  v_mfma_f32_16x16x32_bf16 v[156:159], v[208:211], a[240:243], v[156:159]
  v_mfma_f32_16x16x32_bf16 v[156:159], v[212:215], a[244:247], v[156:159]
  v_mfma_f32_16x16x32_bf16 v[156:159], v[216:219], a[248:251], v[156:159]
  v_mfma_f32_16x16x32_bf16 v[156:159], v[220:223], a[252:255], v[156:159]
  s_waitcnt lgkmcnt(0)
  v_mfma_f32_16x16x32_bf16 v[16:19], v[192:195], a[0:3], 0
  global_load_dword v226, v227, s[100:101] sc1
  ds_read_b64_tr_b16 v[208:209], v250 offset:16384
  v_mfma_f32_16x16x32_bf16 v[16:19], v[196:199], a[4:7], v[16:19]
  ds_read_b64_tr_b16 v[210:211], v251 offset:16384
  v_mfma_f32_16x16x32_bf16 v[16:19], v[200:203], a[8:11], v[16:19]
  ds_read_b64_tr_b16 v[212:213], v250 offset:17408
  v_mfma_f32_16x16x32_bf16 v[16:19], v[204:207], a[12:15], v[16:19]
  ds_read_b64_tr_b16 v[214:215], v251 offset:17408
  v_mfma_f32_16x16x32_bf16 v[20:23], v[192:195], a[64:67], 0
  ds_read_b64_tr_b16 v[216:217], v250 offset:18432
  v_mfma_f32_16x16x32_bf16 v[20:23], v[196:199], a[68:71], v[20:23]
  ds_read_b64_tr_b16 v[218:219], v251 offset:18432
  v_mfma_f32_16x16x32_bf16 v[20:23], v[200:203], a[72:75], v[20:23]
  ds_read_b64_tr_b16 v[220:221], v250 offset:19456
  v_mfma_f32_16x16x32_bf16 v[20:23], v[204:207], a[76:79], v[20:23]
  ds_read_b64_tr_b16 v[222:223], v251 offset:19456
  v_mfma_f32_16x16x32_bf16 v[24:27], v[192:195], a[128:131], 0
  v_mfma_f32_16x16x32_bf16 v[24:27], v[196:199], a[132:135], v[24:27]
  v_mfma_f32_16x16x32_bf16 v[24:27], v[200:203], a[136:139], v[24:27]
  v_mfma_f32_16x16x32_bf16 v[24:27], v[204:207], a[140:143], v[24:27]
  v_mfma_f32_16x16x32_bf16 v[28:31], v[192:195], a[192:195], 0
  v_mfma_f32_16x16x32_bf16 v[28:31], v[196:199], a[196:199], v[28:31]
  v_mfma_f32_16x16x32_bf16 v[28:31], v[200:203], a[200:203], v[28:31]
  v_mfma_f32_16x16x32_bf16 v[28:31], v[204:207], a[204:207], v[28:31]
  s_waitcnt lgkmcnt(0)
  v_mfma_f32_16x16x32_bf16 v[48:51], v[208:211], a[0:3], 0
  ds_read_b64_tr_b16 v[192:193], v250 offset:4096
  v_mfma_f32_16x16x32_bf16 v[48:51], v[212:215], a[4:7], v[48:51]
  ds_read_b64_tr_b16 v[194:195], v251 offset:4096
  v_mfma_f32_16x16x32_bf16 v[48:51], v[216:219], a[8:11], v[48:51]
  ds_read_b64_tr_b16 v[196:197], v250 offset:5120
  v_mfma_f32_16x16x32_bf16 v[48:51], v[220:223], a[12:15], v[48:51]
  ds_read_b64_tr_b16 v[198:199], v251 offset:5120
  v_mfma_f32_16x16x32_bf16 v[52:55], v[208:211], a[64:67], 0
  ds_read_b64_tr_b16 v[200:201], v250 offset:6144
  v_mfma_f32_16x16x32_bf16 v[52:55], v[212:215], a[68:71], v[52:55]
  ds_read_b64_tr_b16 v[202:203], v251 offset:6144
  v_mfma_f32_16x16x32_bf16 v[52:55], v[216:219], a[72:75], v[52:55]
  ds_read_b64_tr_b16 v[204:205], v250 offset:7168
  v_mfma_f32_16x16x32_bf16 v[52:55], v[220:223], a[76:79], v[52:55]
  ds_read_b64_tr_b16 v[206:207], v251 offset:7168
  v_mfma_f32_16x16x32_bf16 v[56:59], v[208:211], a[128:131], 0
  s_add_u32 s46, s57, 0
  s_lshr_b32 s47, s46, 1
  v_mfma_f32_16x16x32_bf16 v[56:59], v[212:215], a[132:135], v[56:59]
  s_add_u32 s47, s47, 128
  v_mfma_f32_16x16x32_bf16 v[56:59], v[216:219], a[136:139], v[56:59]
  s_lshl_b32 s47, s47, 10
  s_and_b32 s46, s46, 1
  v_mfma_f32_16x16x32_bf16 v[56:59], v[220:223], a[140:143], v[56:59]
  s_lshl_b32 s46, s46, 3
  v_mfma_f32_16x16x32_bf16 v[60:63], v[208:211], a[192:195], 0
  s_add_u32 s47, s47, s46
  v_mfma_f32_16x16x32_bf16 v[60:63], v[212:215], a[196:199], v[60:63]
  v_mul_f32 v160, 0xbfb8aa3b, v128
  v_mul_f32 v161, 0xbfb8aa3b, v129
  v_mfma_f32_16x16x32_bf16 v[60:63], v[216:219], a[200:203], v[60:63]
  v_mul_f32 v162, 0xbfb8aa3b, v130
  v_mfma_f32_16x16x32_bf16 v[60:63], v[220:223], a[204:207], v[60:63]
  s_waitcnt lgkmcnt(0)
  v_mul_f32 v163, 0xbfb8aa3b, v131
  v_mfma_f32_16x16x32_bf16 v[16:19], v[192:195], a[16:19], v[16:19]
  ds_read_b64_tr_b16 v[208:209], v250 offset:20480
  v_mfma_f32_16x16x32_bf16 v[16:19], v[196:199], a[20:23], v[16:19]
  ds_read_b64_tr_b16 v[210:211], v251 offset:20480
  v_mfma_f32_16x16x32_bf16 v[16:19], v[200:203], a[24:27], v[16:19]
  ds_read_b64_tr_b16 v[212:213], v250 offset:21504
  v_mfma_f32_16x16x32_bf16 v[16:19], v[204:207], a[28:31], v[16:19]
  ds_read_b64_tr_b16 v[214:215], v251 offset:21504
  v_mfma_f32_16x16x32_bf16 v[20:23], v[192:195], a[80:83], v[20:23]
  ds_read_b64_tr_b16 v[216:217], v250 offset:22528
  v_mfma_f32_16x16x32_bf16 v[20:23], v[196:199], a[84:87], v[20:23]
  ds_read_b64_tr_b16 v[218:219], v251 offset:22528
  v_mfma_f32_16x16x32_bf16 v[20:23], v[200:203], a[88:91], v[20:23]
  ds_read_b64_tr_b16 v[220:221], v250 offset:23552
  v_mfma_f32_16x16x32_bf16 v[20:23], v[204:207], a[92:95], v[20:23]
  ds_read_b64_tr_b16 v[222:223], v251 offset:23552
  v_mfma_f32_16x16x32_bf16 v[24:27], v[192:195], a[144:147], v[24:27]
  v_exp_f32 v160, v160
  v_mfma_f32_16x16x32_bf16 v[24:27], v[196:199], a[148:151], v[24:27]
  v_exp_f32 v161, v161
  v_mfma_f32_16x16x32_bf16 v[24:27], v[200:203], a[152:155], v[24:27]
  v_exp_f32 v162, v162
  v_mfma_f32_16x16x32_bf16 v[24:27], v[204:207], a[156:159], v[24:27]
  v_exp_f32 v163, v163
  v_mfma_f32_16x16x32_bf16 v[28:31], v[192:195], a[208:211], v[28:31]
  v_add_f32 v160, 1.0, v160
  v_add_f32 v161, 1.0, v161
  v_mfma_f32_16x16x32_bf16 v[28:31], v[196:199], a[212:215], v[28:31]
  v_add_f32 v162, 1.0, v162
  v_add_f32 v163, 1.0, v163
  v_mfma_f32_16x16x32_bf16 v[28:31], v[200:203], a[216:219], v[28:31]
  v_rcp_f32 v160, v160
  v_mfma_f32_16x16x32_bf16 v[28:31], v[204:207], a[220:223], v[28:31]
  s_waitcnt lgkmcnt(0)
  v_rcp_f32 v161, v161
  v_mfma_f32_16x16x32_bf16 v[48:51], v[208:211], a[16:19], v[48:51]
  ds_read_b64_tr_b16 v[192:193], v250 offset:8192
  v_mfma_f32_16x16x32_bf16 v[48:51], v[212:215], a[20:23], v[48:51]
  ds_read_b64_tr_b16 v[194:195], v251 offset:8192
  v_mfma_f32_16x16x32_bf16 v[48:51], v[216:219], a[24:27], v[48:51]
  ds_read_b64_tr_b16 v[196:197], v250 offset:9216
  v_mfma_f32_16x16x32_bf16 v[48:51], v[220:223], a[28:31], v[48:51]
  ds_read_b64_tr_b16 v[198:199], v251 offset:9216
  v_mfma_f32_16x16x32_bf16 v[52:55], v[208:211], a[80:83], v[52:55]
  ds_read_b64_tr_b16 v[200:201], v250 offset:10240
  v_mfma_f32_16x16x32_bf16 v[52:55], v[212:215], a[84:87], v[52:55]
  ds_read_b64_tr_b16 v[202:203], v251 offset:10240
  v_mfma_f32_16x16x32_bf16 v[52:55], v[216:219], a[88:91], v[52:55]
  ds_read_b64_tr_b16 v[204:205], v250 offset:11264
  v_mfma_f32_16x16x32_bf16 v[52:55], v[220:223], a[92:95], v[52:55]
  ds_read_b64_tr_b16 v[206:207], v251 offset:11264
  v_mfma_f32_16x16x32_bf16 v[56:59], v[208:211], a[144:147], v[56:59]
  v_rcp_f32 v162, v162
  v_mfma_f32_16x16x32_bf16 v[56:59], v[212:215], a[148:151], v[56:59]
  v_rcp_f32 v163, v163
  v_mfma_f32_16x16x32_bf16 v[56:59], v[216:219], a[152:155], v[56:59]
  v_mul_f32 v128, v128, v144
  v_mul_f32 v129, v129, v145
  v_mfma_f32_16x16x32_bf16 v[56:59], v[220:223], a[156:159], v[56:59]
  v_mul_f32 v130, v130, v146
  v_mul_f32 v131, v131, v147
  v_mfma_f32_16x16x32_bf16 v[60:63], v[208:211], a[208:211], v[60:63]
  s_waitcnt vmcnt(0)
  v_cmp_gt_u32 vcc, 8, v226
  s_nop 4
  s_cbranch_vccnz L_spin_kv
L_back_kv:
  v_mfma_f32_16x16x32_bf16 v[60:63], v[212:215], a[212:215], v[60:63]
  v_mul_f32 v160, v160, v128
  v_mul_f32 v161, v161, v129
  v_mfma_f32_16x16x32_bf16 v[60:63], v[216:219], a[216:219], v[60:63]
  v_mul_f32 v162, v162, v130
  v_mul_f32 v163, v163, v131
  v_mfma_f32_16x16x32_bf16 v[60:63], v[220:223], a[220:223], v[60:63]
  s_lshr_b32 s46, s58, 12
  v_cvt_pk_bf16_f32 v164, v160, v161
  v_cvt_pk_bf16_f32 v165, v162, v163
  s_waitcnt lgkmcnt(0)
  v_mfma_f32_16x16x32_bf16 v[16:19], v[192:195], a[32:35], v[16:19]
  s_mov_b32 s52, 0
  ds_read_b64_tr_b16 v[208:209], v250 offset:24576
  s_mov_b32 s53, 0
  s_mov_b32 s54, s56
  s_mov_b32 s55, s6
  s_mov_b32 m0, s54
  s_add_u32 s49, s54, 16384
  buffer_load_dwordx4 v239, s[28:31], s52 offen offset:0 sc1 lds
  v_mfma_f32_16x16x32_bf16 v[16:19], v[196:199], a[36:39], v[16:19]
  s_add_u32 s46, s46, 0
  ds_read_b64_tr_b16 v[210:211], v251 offset:24576
  s_mul_i32 s46, s46, 176128
  v_mfma_f32_16x16x32_bf16 v[16:19], v[200:203], a[40:43], v[16:19]
  s_add_u32 s46, s46, s47
  ds_read_b64_tr_b16 v[212:213], v250 offset:25600
  v_mfma_f32_16x16x32_bf16 v[16:19], v[204:207], a[44:47], v[16:19]
  ds_read_b64_tr_b16 v[214:215], v251 offset:25600
  v_mfma_f32_16x16x32_bf16 v[20:23], v[192:195], a[96:99], v[20:23]
  ds_read_b64_tr_b16 v[216:217], v250 offset:26624
  v_mfma_f32_16x16x32_bf16 v[20:23], v[196:199], a[100:103], v[20:23]
  ds_read_b64_tr_b16 v[218:219], v251 offset:26624
  buffer_load_dwordx4 v239, s[28:31], s52 offen offset:1024 sc1 lds
  v_mfma_f32_16x16x32_bf16 v[20:23], v[200:203], a[104:107], v[20:23]
  ds_read_b64_tr_b16 v[220:221], v250 offset:27648
  v_mfma_f32_16x16x32_bf16 v[20:23], v[204:207], a[108:111], v[20:23]
  ds_read_b64_tr_b16 v[222:223], v251 offset:27648
  v_mfma_f32_16x16x32_bf16 v[24:27], v[192:195], a[160:163], v[24:27]
  buffer_store_dwordx2 v[164:165], v252, s[36:39], s46 offen sc1
  v_mfma_f32_16x16x32_bf16 v[24:27], v[196:199], a[164:167], v[24:27]
  v_mul_f32 v168, 0xbfb8aa3b, v132
  v_mul_f32 v169, 0xbfb8aa3b, v133
  v_mfma_f32_16x16x32_bf16 v[24:27], v[200:203], a[168:171], v[24:27]
  buffer_load_dwordx4 v239, s[28:31], s52 offen offset:2048 sc1 lds
  v_mfma_f32_16x16x32_bf16 v[24:27], v[204:207], a[172:175], v[24:27]
  v_mul_f32 v170, 0xbfb8aa3b, v134
  v_mul_f32 v171, 0xbfb8aa3b, v135
  v_mfma_f32_16x16x32_bf16 v[28:31], v[192:195], a[224:227], v[28:31]
  v_exp_f32 v168, v168
  v_mfma_f32_16x16x32_bf16 v[28:31], v[196:199], a[228:231], v[28:31]
  v_exp_f32 v169, v169
  v_mfma_f32_16x16x32_bf16 v[28:31], v[200:203], a[232:235], v[28:31]
  v_exp_f32 v170, v170
  v_mfma_f32_16x16x32_bf16 v[28:31], v[204:207], a[236:239], v[28:31]
  s_waitcnt lgkmcnt(0)
  buffer_load_dwordx4 v239, s[28:31], s52 offen offset:3072 sc1 lds
  v_mfma_f32_16x16x32_bf16 v[48:51], v[208:211], a[32:35], v[48:51]
  s_add_u32 s52, s52, 16384
  ds_read_b64_tr_b16 v[192:193], v250 offset:12288
  v_mfma_f32_16x16x32_bf16 v[48:51], v[212:215], a[36:39], v[48:51]
  s_cmp_ge_u32 s49, 81920
  s_cselect_b32 s54, s56, s49
  ds_read_b64_tr_b16 v[194:195], v251 offset:12288
  v_mfma_f32_16x16x32_bf16 v[48:51], v[216:219], a[40:43], v[48:51]
  s_mov_b32 m0, s54
  ds_read_b64_tr_b16 v[196:197], v250 offset:13312
  v_mfma_f32_16x16x32_bf16 v[48:51], v[220:223], a[44:47], v[48:51]
  s_add_u32 s49, s54, 16384
  ds_read_b64_tr_b16 v[198:199], v251 offset:13312
  v_mfma_f32_16x16x32_bf16 v[52:55], v[208:211], a[96:99], v[52:55]
  ds_read_b64_tr_b16 v[200:201], v250 offset:14336
  buffer_load_dwordx4 v239, s[28:31], s52 offen offset:0 sc1 lds
  v_mfma_f32_16x16x32_bf16 v[52:55], v[212:215], a[100:103], v[52:55]
  ds_read_b64_tr_b16 v[202:203], v251 offset:14336
  v_mfma_f32_16x16x32_bf16 v[52:55], v[216:219], a[104:107], v[52:55]
  ds_read_b64_tr_b16 v[204:205], v250 offset:15360
  v_mfma_f32_16x16x32_bf16 v[52:55], v[220:223], a[108:111], v[52:55]
  ds_read_b64_tr_b16 v[206:207], v251 offset:15360
  v_mfma_f32_16x16x32_bf16 v[56:59], v[208:211], a[160:163], v[56:59]
  v_exp_f32 v171, v171
  v_mfma_f32_16x16x32_bf16 v[56:59], v[212:215], a[164:167], v[56:59]
  buffer_load_dwordx4 v239, s[28:31], s52 offen offset:1024 sc1 lds
  v_mfma_f32_16x16x32_bf16 v[56:59], v[216:219], a[168:171], v[56:59]
  v_add_f32 v168, 1.0, v168
  v_add_f32 v169, 1.0, v169
  v_mfma_f32_16x16x32_bf16 v[56:59], v[220:223], a[172:175], v[56:59]
  v_add_f32 v170, 1.0, v170
  v_add_f32 v171, 1.0, v171
  v_mfma_f32_16x16x32_bf16 v[60:63], v[208:211], a[224:227], v[60:63]
  v_rcp_f32 v168, v168
  v_mfma_f32_16x16x32_bf16 v[60:63], v[212:215], a[228:231], v[60:63]
  v_rcp_f32 v169, v169
  v_mfma_f32_16x16x32_bf16 v[60:63], v[216:219], a[232:235], v[60:63]
  buffer_load_dwordx4 v239, s[28:31], s52 offen offset:2048 sc1 lds
  v_mfma_f32_16x16x32_bf16 v[60:63], v[220:223], a[236:239], v[60:63]
  s_waitcnt lgkmcnt(0)
  v_rcp_f32 v170, v170
  v_mfma_f32_16x16x32_bf16 v[16:19], v[192:195], a[48:51], v[16:19]
  ds_read_b64_tr_b16 v[208:209], v250 offset:28672
  v_mfma_f32_16x16x32_bf16 v[16:19], v[196:199], a[52:55], v[16:19]
  ds_read_b64_tr_b16 v[210:211], v251 offset:28672
  v_mfma_f32_16x16x32_bf16 v[16:19], v[200:203], a[56:59], v[16:19]
  ds_read_b64_tr_b16 v[212:213], v250 offset:29696
  v_mfma_f32_16x16x32_bf16 v[16:19], v[204:207], a[60:63], v[16:19]
  ds_read_b64_tr_b16 v[214:215], v251 offset:29696
  buffer_load_dwordx4 v239, s[28:31], s52 offen offset:3072 sc1 lds
  v_mfma_f32_16x16x32_bf16 v[20:23], v[192:195], a[112:115], v[20:23]
  s_add_u32 s52, s52, 16384
  ds_read_b64_tr_b16 v[216:217], v250 offset:30720
  v_mfma_f32_16x16x32_bf16 v[20:23], v[196:199], a[116:119], v[20:23]
  s_cmp_ge_u32 s49, 81920
  s_cselect_b32 s54, s56, s49
  ds_read_b64_tr_b16 v[218:219], v251 offset:30720
  v_mfma_f32_16x16x32_bf16 v[20:23], v[200:203], a[120:123], v[20:23]
  s_mov_b32 m0, s54
  ds_read_b64_tr_b16 v[220:221], v250 offset:31744
  v_mfma_f32_16x16x32_bf16 v[20:23], v[204:207], a[124:127], v[20:23]
  s_add_u32 s49, s54, 16384
  ds_read_b64_tr_b16 v[222:223], v251 offset:31744
  v_mfma_f32_16x16x32_bf16 v[24:27], v[192:195], a[176:179], v[24:27]
  buffer_load_dwordx4 v239, s[28:31], s52 offen offset:0 sc1 lds
  v_mfma_f32_16x16x32_bf16 v[24:27], v[196:199], a[180:183], v[24:27]
  v_rcp_f32 v171, v171
  v_mfma_f32_16x16x32_bf16 v[24:27], v[200:203], a[184:187], v[24:27]
  v_mul_f32 v132, v132, v148
  v_mul_f32 v133, v133, v149
  v_mfma_f32_16x16x32_bf16 v[24:27], v[204:207], a[188:191], v[24:27]
  v_mul_f32 v134, v134, v150
  v_mul_f32 v135, v135, v151
  v_mfma_f32_16x16x32_bf16 v[28:31], v[192:195], a[240:243], v[28:31]
  v_mul_f32 v168, v168, v132
  v_mul_f32 v169, v169, v133
  v_mfma_f32_16x16x32_bf16 v[28:31], v[196:199], a[244:247], v[28:31]
  buffer_load_dwordx4 v239, s[28:31], s52 offen offset:1024 sc1 lds
  v_mfma_f32_16x16x32_bf16 v[28:31], v[200:203], a[248:251], v[28:31]
  v_mul_f32 v170, v170, v134
  v_mul_f32 v171, v171, v135
  v_mfma_f32_16x16x32_bf16 v[28:31], v[204:207], a[252:255], v[28:31]
  s_lshr_b32 s46, s58, 12
  v_cvt_pk_bf16_f32 v172, v168, v169
  v_cvt_pk_bf16_f32 v173, v170, v171
  s_waitcnt lgkmcnt(0)
  v_mfma_f32_16x16x32_bf16 v[48:51], v[208:211], a[48:51], v[48:51]
  s_add_u32 s46, s46, 1
  s_mul_i32 s46, s46, 176128
  s_add_u32 s46, s46, s47
  v_mfma_f32_16x16x32_bf16 v[48:51], v[212:215], a[52:55], v[48:51]
  buffer_store_dwordx2 v[172:173], v252, s[36:39], s46 offen sc1
  v_mfma_f32_16x16x32_bf16 v[48:51], v[216:219], a[56:59], v[48:51]
  buffer_load_dwordx4 v239, s[28:31], s52 offen offset:2048 sc1 lds
  v_mfma_f32_16x16x32_bf16 v[48:51], v[220:223], a[60:63], v[48:51]
  v_mul_f32 v160, 0xbfb8aa3b, v136
  v_mul_f32 v161, 0xbfb8aa3b, v137
  v_mfma_f32_16x16x32_bf16 v[52:55], v[208:211], a[112:115], v[52:55]
  v_mul_f32 v162, 0xbfb8aa3b, v138
  v_mul_f32 v163, 0xbfb8aa3b, v139
  v_mfma_f32_16x16x32_bf16 v[52:55], v[212:215], a[116:119], v[52:55]
  v_exp_f32 v160, v160
  v_mfma_f32_16x16x32_bf16 v[52:55], v[216:219], a[120:123], v[52:55]
  v_exp_f32 v161, v161
  v_mfma_f32_16x16x32_bf16 v[52:55], v[220:223], a[124:127], v[52:55]
  buffer_load_dwordx4 v239, s[28:31], s52 offen offset:3072 sc1 lds
  s_add_u32 s52, s52, 16384
  s_cmp_ge_u32 s49, 81920
  s_cselect_b32 s54, s56, s49
  v_mfma_f32_16x16x32_bf16 v[56:59], v[208:211], a[176:179], v[56:59]
  v_exp_f32 v162, v162
  v_mfma_f32_16x16x32_bf16 v[56:59], v[212:215], a[180:183], v[56:59]
  v_exp_f32 v163, v163
  v_mfma_f32_16x16x32_bf16 v[56:59], v[216:219], a[184:187], v[56:59]
  v_add_f32 v160, 1.0, v160
  v_add_f32 v161, 1.0, v161
  v_mfma_f32_16x16x32_bf16 v[56:59], v[220:223], a[188:191], v[56:59]
  v_add_f32 v162, 1.0, v162
  v_add_f32 v163, 1.0, v163
  v_mfma_f32_16x16x32_bf16 v[60:63], v[208:211], a[240:243], v[60:63]
  v_rcp_f32 v160, v160
  v_mfma_f32_16x16x32_bf16 v[60:63], v[212:215], a[244:247], v[60:63]
  v_rcp_f32 v161, v161
  v_mfma_f32_16x16x32_bf16 v[60:63], v[216:219], a[248:251], v[60:63]
  v_rcp_f32 v162, v162
  v_mfma_f32_16x16x32_bf16 v[60:63], v[220:223], a[252:255], v[60:63]
  s_lshr_b32 s46, s59, 12
  v_rcp_f32 v163, v163
  v_mul_f32 v136, v136, v152
  v_mul_f32 v137, v137, v153
  v_mul_f32 v138, v138, v154
  v_mul_f32 v139, v139, v155
  v_mul_f32 v160, v160, v136
  v_mul_f32 v161, v161, v137
  v_mul_f32 v162, v162, v138
  v_mul_f32 v163, v163, v139
  v_cvt_pk_bf16_f32 v164, v160, v161
  v_cvt_pk_bf16_f32 v165, v162, v163
  s_add_u32 s46, s46, 0
  s_mul_i32 s46, s46, 176128
  s_add_u32 s46, s46, s47
  buffer_store_dwordx2 v[164:165], v252, s[36:39], s46 offen sc1
  v_mul_f32 v168, 0xbfb8aa3b, v140
  v_mul_f32 v169, 0xbfb8aa3b, v141
  v_mul_f32 v170, 0xbfb8aa3b, v142
  v_mul_f32 v171, 0xbfb8aa3b, v143
  v_exp_f32 v168, v168
  v_exp_f32 v169, v169
  v_exp_f32 v170, v170
  v_exp_f32 v171, v171
  v_add_f32 v168, 1.0, v168
  v_add_f32 v169, 1.0, v169
  v_add_f32 v170, 1.0, v170
  v_add_f32 v171, 1.0, v171
  v_rcp_f32 v168, v168
  v_rcp_f32 v169, v169
  v_rcp_f32 v170, v170
  v_rcp_f32 v171, v171
  v_mul_f32 v140, v140, v156
  v_mul_f32 v141, v141, v157
  v_mul_f32 v142, v142, v158
  v_mul_f32 v143, v143, v159
  v_mul_f32 v168, v168, v140
  v_mul_f32 v169, v169, v141
  v_mul_f32 v170, v170, v142
  v_mul_f32 v171, v171, v143
  v_cvt_pk_bf16_f32 v172, v168, v169
  v_cvt_pk_bf16_f32 v173, v170, v171
  s_lshr_b32 s46, s59, 12
  s_add_u32 s46, s46, 1
  s_mul_i32 s46, s46, 176128
  s_add_u32 s46, s46, s47
  buffer_store_dwordx2 v[172:173], v252, s[36:39], s46 offen sc1
  s_cmp_ge_u32 s40, 22
  s_cbranch_scc1 L_nogu2
  s_waitcnt vmcnt(17)
  s_barrier
  v_add_u32 v250, 0x8000, v250
  v_add_u32 v251, 0x8000, v251
  ds_read_b64_tr_b16 v[192:193], v250 offset:0
  ds_read_b64_tr_b16 v[194:195], v251 offset:0
  ds_read_b64_tr_b16 v[196:197], v250 offset:1024
  ds_read_b64_tr_b16 v[198:199], v251 offset:1024
  ds_read_b64_tr_b16 v[200:201], v250 offset:2048
  ds_read_b64_tr_b16 v[202:203], v251 offset:2048
  ds_read_b64_tr_b16 v[204:205], v250 offset:3072
  ds_read_b64_tr_b16 v[206:207], v251 offset:3072
  s_waitcnt lgkmcnt(0)
  v_mfma_f32_16x16x32_bf16 v[128:131], v[192:195], a[0:3], 0
  ds_read_b64_tr_b16 v[208:209], v250 offset:16384
  v_mfma_f32_16x16x32_bf16 v[128:131], v[196:199], a[4:7], v[128:131]
  ds_read_b64_tr_b16 v[210:211], v251 offset:16384
  v_mfma_f32_16x16x32_bf16 v[128:131], v[200:203], a[8:11], v[128:131]
  ds_read_b64_tr_b16 v[212:213], v250 offset:17408
  v_mfma_f32_16x16x32_bf16 v[128:131], v[204:207], a[12:15], v[128:131]
  ds_read_b64_tr_b16 v[214:215], v251 offset:17408
  v_mfma_f32_16x16x32_bf16 v[132:135], v[192:195], a[64:67], 0
  s_add_u32 s46, s57, 1
  ds_read_b64_tr_b16 v[216:217], v250 offset:18432
  s_lshr_b32 s47, s46, 1
  v_mfma_f32_16x16x32_bf16 v[132:135], v[196:199], a[68:71], v[132:135]
  s_add_u32 s47, s47, 128
  ds_read_b64_tr_b16 v[218:219], v251 offset:18432
  v_mfma_f32_16x16x32_bf16 v[132:135], v[200:203], a[72:75], v[132:135]
  s_lshl_b32 s47, s47, 10
  ds_read_b64_tr_b16 v[220:221], v250 offset:19456
  s_and_b32 s46, s46, 1
  v_mfma_f32_16x16x32_bf16 v[132:135], v[204:207], a[76:79], v[132:135]
  s_lshl_b32 s46, s46, 3
  ds_read_b64_tr_b16 v[222:223], v251 offset:19456
  v_mfma_f32_16x16x32_bf16 v[136:139], v[192:195], a[128:131], 0
  s_add_u32 s47, s47, s46
  v_mfma_f32_16x16x32_bf16 v[136:139], v[196:199], a[132:135], v[136:139]
  v_mul_f32 v160, 0xbfb8aa3b, v16
  v_mul_f32 v161, 0xbfb8aa3b, v17
  v_mfma_f32_16x16x32_bf16 v[136:139], v[200:203], a[136:139], v[136:139]
  v_mul_f32 v162, 0xbfb8aa3b, v18
  v_mfma_f32_16x16x32_bf16 v[136:139], v[204:207], a[140:143], v[136:139]
  v_mul_f32 v163, 0xbfb8aa3b, v19
  v_mfma_f32_16x16x32_bf16 v[140:143], v[192:195], a[192:195], 0
  v_exp_f32 v160, v160
  v_mfma_f32_16x16x32_bf16 v[140:143], v[196:199], a[196:199], v[140:143]
  v_exp_f32 v161, v161
  v_mfma_f32_16x16x32_bf16 v[140:143], v[200:203], a[200:203], v[140:143]
  v_exp_f32 v162, v162
  v_mfma_f32_16x16x32_bf16 v[140:143], v[204:207], a[204:207], v[140:143]
  s_waitcnt lgkmcnt(0)
  v_exp_f32 v163, v163
  v_mfma_f32_16x16x32_bf16 v[144:147], v[208:211], a[0:3], 0
  ds_read_b64_tr_b16 v[192:193], v250 offset:4096
  v_add_f32 v160, 1.0, v160
  v_mfma_f32_16x16x32_bf16 v[144:147], v[212:215], a[4:7], v[144:147]
  ds_read_b64_tr_b16 v[194:195], v251 offset:4096
  v_add_f32 v161, 1.0, v161
  v_mfma_f32_16x16x32_bf16 v[144:147], v[216:219], a[8:11], v[144:147]
  ds_read_b64_tr_b16 v[196:197], v250 offset:5120
  v_add_f32 v162, 1.0, v162
  v_mfma_f32_16x16x32_bf16 v[144:147], v[220:223], a[12:15], v[144:147]
  ds_read_b64_tr_b16 v[198:199], v251 offset:5120
  v_add_f32 v163, 1.0, v163
  v_mfma_f32_16x16x32_bf16 v[148:151], v[208:211], a[64:67], 0
  ds_read_b64_tr_b16 v[200:201], v250 offset:6144
  v_mfma_f32_16x16x32_bf16 v[148:151], v[212:215], a[68:71], v[148:151]
  ds_read_b64_tr_b16 v[202:203], v251 offset:6144
  v_mfma_f32_16x16x32_bf16 v[148:151], v[216:219], a[72:75], v[148:151]
  ds_read_b64_tr_b16 v[204:205], v250 offset:7168
  v_mfma_f32_16x16x32_bf16 v[148:151], v[220:223], a[76:79], v[148:151]
  ds_read_b64_tr_b16 v[206:207], v251 offset:7168
  v_mfma_f32_16x16x32_bf16 v[152:155], v[208:211], a[128:131], 0
  v_rcp_f32 v160, v160
  v_mfma_f32_16x16x32_bf16 v[152:155], v[212:215], a[132:135], v[152:155]
  v_rcp_f32 v161, v161
  v_mfma_f32_16x16x32_bf16 v[152:155], v[216:219], a[136:139], v[152:155]
  v_rcp_f32 v162, v162
  v_mfma_f32_16x16x32_bf16 v[152:155], v[220:223], a[140:143], v[152:155]
  v_rcp_f32 v163, v163
  v_mfma_f32_16x16x32_bf16 v[156:159], v[208:211], a[192:195], 0
  v_mul_f32 v16, v16, v48
  v_mul_f32 v17, v17, v49
  v_mfma_f32_16x16x32_bf16 v[156:159], v[212:215], a[196:199], v[156:159]
  v_mul_f32 v18, v18, v50
  v_mul_f32 v19, v19, v51
  v_mfma_f32_16x16x32_bf16 v[156:159], v[216:219], a[200:203], v[156:159]
  v_mul_f32 v160, v160, v16
  v_mul_f32 v161, v161, v17
  v_mfma_f32_16x16x32_bf16 v[156:159], v[220:223], a[204:207], v[156:159]
  s_waitcnt lgkmcnt(0)
  v_mul_f32 v162, v162, v18
  v_mul_f32 v163, v163, v19
  v_mfma_f32_16x16x32_bf16 v[128:131], v[192:195], a[16:19], v[128:131]
  ds_read_b64_tr_b16 v[208:209], v250 offset:20480
  v_cvt_pk_bf16_f32 v164, v160, v161
  v_mfma_f32_16x16x32_bf16 v[128:131], v[196:199], a[20:23], v[128:131]
  s_lshr_b32 s46, s58, 12
  ds_read_b64_tr_b16 v[210:211], v251 offset:20480
  v_cvt_pk_bf16_f32 v165, v162, v163
  v_mfma_f32_16x16x32_bf16 v[128:131], v[200:203], a[24:27], v[128:131]
  s_add_u32 s46, s46, 0
  ds_read_b64_tr_b16 v[212:213], v250 offset:21504
  s_mul_i32 s46, s46, 176128
  v_mfma_f32_16x16x32_bf16 v[128:131], v[204:207], a[28:31], v[128:131]
  s_add_u32 s46, s46, s47
  ds_read_b64_tr_b16 v[214:215], v251 offset:21504
  v_mfma_f32_16x16x32_bf16 v[132:135], v[192:195], a[80:83], v[132:135]
  ds_read_b64_tr_b16 v[216:217], v250 offset:22528
  v_mfma_f32_16x16x32_bf16 v[132:135], v[196:199], a[84:87], v[132:135]
  ds_read_b64_tr_b16 v[218:219], v251 offset:22528
  v_mfma_f32_16x16x32_bf16 v[132:135], v[200:203], a[88:91], v[132:135]
  ds_read_b64_tr_b16 v[220:221], v250 offset:23552
  v_mfma_f32_16x16x32_bf16 v[132:135], v[204:207], a[92:95], v[132:135]
  ds_read_b64_tr_b16 v[222:223], v251 offset:23552
  v_mfma_f32_16x16x32_bf16 v[136:139], v[192:195], a[144:147], v[136:139]
  buffer_store_dwordx2 v[164:165], v252, s[36:39], s46 offen sc1
  v_mfma_f32_16x16x32_bf16 v[136:139], v[196:199], a[148:151], v[136:139]
  v_mul_f32 v168, 0xbfb8aa3b, v20
  v_mul_f32 v169, 0xbfb8aa3b, v21
  v_mfma_f32_16x16x32_bf16 v[136:139], v[200:203], a[152:155], v[136:139]
  v_mul_f32 v170, 0xbfb8aa3b, v22
  v_mul_f32 v171, 0xbfb8aa3b, v23
  v_mfma_f32_16x16x32_bf16 v[136:139], v[204:207], a[156:159], v[136:139]
  v_exp_f32 v168, v168
  v_mfma_f32_16x16x32_bf16 v[140:143], v[192:195], a[208:211], v[140:143]
  v_exp_f32 v169, v169
  v_mfma_f32_16x16x32_bf16 v[140:143], v[196:199], a[212:215], v[140:143]
  v_exp_f32 v170, v170
  v_mfma_f32_16x16x32_bf16 v[140:143], v[200:203], a[216:219], v[140:143]
  v_exp_f32 v171, v171
  v_mfma_f32_16x16x32_bf16 v[140:143], v[204:207], a[220:223], v[140:143]
  s_waitcnt lgkmcnt(0)
  v_add_f32 v168, 1.0, v168
  v_add_f32 v169, 1.0, v169
  v_mfma_f32_16x16x32_bf16 v[144:147], v[208:211], a[16:19], v[144:147]
  ds_read_b64_tr_b16 v[192:193], v250 offset:8192
  v_add_f32 v170, 1.0, v170
  v_mfma_f32_16x16x32_bf16 v[144:147], v[212:215], a[20:23], v[144:147]
  ds_read_b64_tr_b16 v[194:195], v251 offset:8192
  v_add_f32 v171, 1.0, v171
  v_mfma_f32_16x16x32_bf16 v[144:147], v[216:219], a[24:27], v[144:147]
  ds_read_b64_tr_b16 v[196:197], v250 offset:9216
  v_accvgpr_write_b32 a0, v0
  v_mfma_f32_16x16x32_bf16 v[144:147], v[220:223], a[28:31], v[144:147]
  ds_read_b64_tr_b16 v[198:199], v251 offset:9216
  v_accvgpr_write_b32 a1, v1
  v_mfma_f32_16x16x32_bf16 v[148:151], v[208:211], a[80:83], v[148:151]
  ds_read_b64_tr_b16 v[200:201], v250 offset:10240
  v_accvgpr_write_b32 a2, v2
  v_mfma_f32_16x16x32_bf16 v[148:151], v[212:215], a[84:87], v[148:151]
  ds_read_b64_tr_b16 v[202:203], v251 offset:10240
  v_accvgpr_write_b32 a3, v3
  v_mfma_f32_16x16x32_bf16 v[148:151], v[216:219], a[88:91], v[148:151]
  ds_read_b64_tr_b16 v[204:205], v250 offset:11264
  v_accvgpr_write_b32 a4, v32
  v_mfma_f32_16x16x32_bf16 v[148:151], v[220:223], a[92:95], v[148:151]
  ds_read_b64_tr_b16 v[206:207], v251 offset:11264
  v_accvgpr_write_b32 a5, v33
  v_mfma_f32_16x16x32_bf16 v[152:155], v[208:211], a[144:147], v[152:155]
  v_rcp_f32 v168, v168
  v_mfma_f32_16x16x32_bf16 v[152:155], v[212:215], a[148:151], v[152:155]
  v_rcp_f32 v169, v169
  v_mfma_f32_16x16x32_bf16 v[152:155], v[216:219], a[152:155], v[152:155]
  v_rcp_f32 v170, v170
  v_mfma_f32_16x16x32_bf16 v[152:155], v[220:223], a[156:159], v[152:155]
  v_rcp_f32 v171, v171
  v_mfma_f32_16x16x32_bf16 v[156:159], v[208:211], a[208:211], v[156:159]
  v_mul_f32 v20, v20, v52
  v_mul_f32 v21, v21, v53
  v_mfma_f32_16x16x32_bf16 v[156:159], v[212:215], a[212:215], v[156:159]
  v_mul_f32 v22, v22, v54
  v_mul_f32 v23, v23, v55
  v_mfma_f32_16x16x32_bf16 v[156:159], v[216:219], a[216:219], v[156:159]
  v_mul_f32 v168, v168, v20
  v_mul_f32 v169, v169, v21
  v_mfma_f32_16x16x32_bf16 v[156:159], v[220:223], a[220:223], v[156:159]
  s_waitcnt lgkmcnt(0)
  v_mul_f32 v170, v170, v22
  v_mul_f32 v171, v171, v23
  v_mfma_f32_16x16x32_bf16 v[128:131], v[192:195], a[32:35], v[128:131]
  ds_read_b64_tr_b16 v[208:209], v250 offset:24576
  v_cvt_pk_bf16_f32 v172, v168, v169
  v_mfma_f32_16x16x32_bf16 v[128:131], v[196:199], a[36:39], v[128:131]
  s_lshr_b32 s46, s58, 12
  ds_read_b64_tr_b16 v[210:211], v251 offset:24576
  v_cvt_pk_bf16_f32 v173, v170, v171
  v_mfma_f32_16x16x32_bf16 v[128:131], v[200:203], a[40:43], v[128:131]
  s_add_u32 s46, s46, 1
  ds_read_b64_tr_b16 v[212:213], v250 offset:25600
  s_mul_i32 s46, s46, 176128
  v_mfma_f32_16x16x32_bf16 v[128:131], v[204:207], a[44:47], v[128:131]
  s_add_u32 s46, s46, s47
  ds_read_b64_tr_b16 v[214:215], v251 offset:25600
  v_accvgpr_write_b32 a6, v34
  v_mfma_f32_16x16x32_bf16 v[132:135], v[192:195], a[96:99], v[132:135]
  ds_read_b64_tr_b16 v[216:217], v250 offset:26624
  v_accvgpr_write_b32 a7, v35
  v_mfma_f32_16x16x32_bf16 v[132:135], v[196:199], a[100:103], v[132:135]
  ds_read_b64_tr_b16 v[218:219], v251 offset:26624
  v_accvgpr_write_b32 a8, v64
  v_mfma_f32_16x16x32_bf16 v[132:135], v[200:203], a[104:107], v[132:135]
  ds_read_b64_tr_b16 v[220:221], v250 offset:27648
  v_accvgpr_write_b32 a9, v65
  v_mfma_f32_16x16x32_bf16 v[132:135], v[204:207], a[108:111], v[132:135]
  ds_read_b64_tr_b16 v[222:223], v251 offset:27648
  v_accvgpr_write_b32 a10, v66
  v_mfma_f32_16x16x32_bf16 v[136:139], v[192:195], a[160:163], v[136:139]
  buffer_store_dwordx2 v[172:173], v252, s[36:39], s46 offen sc1
  v_mfma_f32_16x16x32_bf16 v[136:139], v[196:199], a[164:167], v[136:139]
  v_mul_f32 v160, 0xbfb8aa3b, v24
  v_mul_f32 v161, 0xbfb8aa3b, v25
  v_mfma_f32_16x16x32_bf16 v[136:139], v[200:203], a[168:171], v[136:139]
  v_mul_f32 v162, 0xbfb8aa3b, v26
  v_mul_f32 v163, 0xbfb8aa3b, v27
  v_mfma_f32_16x16x32_bf16 v[136:139], v[204:207], a[172:175], v[136:139]
  v_exp_f32 v160, v160
  v_mfma_f32_16x16x32_bf16 v[140:143], v[192:195], a[224:227], v[140:143]
  v_exp_f32 v161, v161
  v_mfma_f32_16x16x32_bf16 v[140:143], v[196:199], a[228:231], v[140:143]
  v_exp_f32 v162, v162
  v_mfma_f32_16x16x32_bf16 v[140:143], v[200:203], a[232:235], v[140:143]
  v_exp_f32 v163, v163
  v_mfma_f32_16x16x32_bf16 v[140:143], v[204:207], a[236:239], v[140:143]
  s_waitcnt lgkmcnt(0)
  v_add_f32 v160, 1.0, v160
  v_add_f32 v161, 1.0, v161
  v_mfma_f32_16x16x32_bf16 v[144:147], v[208:211], a[32:35], v[144:147]
  ds_read_b64_tr_b16 v[192:193], v250 offset:12288
  v_add_f32 v162, 1.0, v162
  v_mfma_f32_16x16x32_bf16 v[144:147], v[212:215], a[36:39], v[144:147]
  ds_read_b64_tr_b16 v[194:195], v251 offset:12288
  v_add_f32 v163, 1.0, v163
  v_mfma_f32_16x16x32_bf16 v[144:147], v[216:219], a[40:43], v[144:147]
  ds_read_b64_tr_b16 v[196:197], v250 offset:13312
  v_accvgpr_write_b32 a11, v67
  v_mfma_f32_16x16x32_bf16 v[144:147], v[220:223], a[44:47], v[144:147]
  ds_read_b64_tr_b16 v[198:199], v251 offset:13312
  v_accvgpr_write_b32 a12, v96
  v_mfma_f32_16x16x32_bf16 v[148:151], v[208:211], a[96:99], v[148:151]
  ds_read_b64_tr_b16 v[200:201], v250 offset:14336
  v_accvgpr_write_b32 a13, v97
  v_mfma_f32_16x16x32_bf16 v[148:151], v[212:215], a[100:103], v[148:151]
  ds_read_b64_tr_b16 v[202:203], v251 offset:14336
  v_accvgpr_write_b32 a14, v98
  v_mfma_f32_16x16x32_bf16 v[148:151], v[216:219], a[104:107], v[148:151]
  ds_read_b64_tr_b16 v[204:205], v250 offset:15360
  v_accvgpr_write_b32 a15, v99
  v_mfma_f32_16x16x32_bf16 v[148:151], v[220:223], a[108:111], v[148:151]
  ds_read_b64_tr_b16 v[206:207], v251 offset:15360
  v_accvgpr_write_b32 a64, v4
  v_mfma_f32_16x16x32_bf16 v[152:155], v[208:211], a[160:163], v[152:155]
  v_rcp_f32 v160, v160
  v_mfma_f32_16x16x32_bf16 v[152:155], v[212:215], a[164:167], v[152:155]
  v_rcp_f32 v161, v161
  v_mfma_f32_16x16x32_bf16 v[152:155], v[216:219], a[168:171], v[152:155]
  v_rcp_f32 v162, v162
  v_mfma_f32_16x16x32_bf16 v[152:155], v[220:223], a[172:175], v[152:155]
  v_rcp_f32 v163, v163
  v_mfma_f32_16x16x32_bf16 v[156:159], v[208:211], a[224:227], v[156:159]
  v_mul_f32 v24, v24, v56
  v_mul_f32 v25, v25, v57
  v_mfma_f32_16x16x32_bf16 v[156:159], v[212:215], a[228:231], v[156:159]
  v_mul_f32 v26, v26, v58
  v_mul_f32 v27, v27, v59
  v_mfma_f32_16x16x32_bf16 v[156:159], v[216:219], a[232:235], v[156:159]
  v_mul_f32 v160, v160, v24
  v_mul_f32 v161, v161, v25
  v_mfma_f32_16x16x32_bf16 v[156:159], v[220:223], a[236:239], v[156:159]
  s_waitcnt lgkmcnt(0)
  v_mul_f32 v162, v162, v26
  v_mul_f32 v163, v163, v27
  v_mfma_f32_16x16x32_bf16 v[128:131], v[192:195], a[48:51], v[128:131]
  ds_read_b64_tr_b16 v[208:209], v250 offset:28672
  v_cvt_pk_bf16_f32 v164, v160, v161
  v_mfma_f32_16x16x32_bf16 v[128:131], v[196:199], a[52:55], v[128:131]
  s_lshr_b32 s46, s59, 12
  ds_read_b64_tr_b16 v[210:211], v251 offset:28672
  v_cvt_pk_bf16_f32 v165, v162, v163
  v_mfma_f32_16x16x32_bf16 v[128:131], v[200:203], a[56:59], v[128:131]
  s_add_u32 s46, s46, 0
  ds_read_b64_tr_b16 v[212:213], v250 offset:29696
  s_mul_i32 s46, s46, 176128
  v_mfma_f32_16x16x32_bf16 v[128:131], v[204:207], a[60:63], v[128:131]
  s_add_u32 s46, s46, s47
  ds_read_b64_tr_b16 v[214:215], v251 offset:29696
  v_accvgpr_write_b32 a65, v5
  v_mfma_f32_16x16x32_bf16 v[132:135], v[192:195], a[112:115], v[132:135]
  ds_read_b64_tr_b16 v[216:217], v250 offset:30720
  v_accvgpr_write_b32 a66, v6
  v_mfma_f32_16x16x32_bf16 v[132:135], v[196:199], a[116:119], v[132:135]
  ds_read_b64_tr_b16 v[218:219], v251 offset:30720
  v_accvgpr_write_b32 a67, v7
  v_mfma_f32_16x16x32_bf16 v[132:135], v[200:203], a[120:123], v[132:135]
  ds_read_b64_tr_b16 v[220:221], v250 offset:31744
  v_accvgpr_write_b32 a68, v36
  v_mfma_f32_16x16x32_bf16 v[132:135], v[204:207], a[124:127], v[132:135]
  ds_read_b64_tr_b16 v[222:223], v251 offset:31744
  v_accvgpr_write_b32 a69, v37
  v_mfma_f32_16x16x32_bf16 v[136:139], v[192:195], a[176:179], v[136:139]
  buffer_store_dwordx2 v[164:165], v252, s[36:39], s46 offen sc1
  v_mfma_f32_16x16x32_bf16 v[136:139], v[196:199], a[180:183], v[136:139]
  v_mul_f32 v168, 0xbfb8aa3b, v28
  v_mul_f32 v169, 0xbfb8aa3b, v29
  v_mfma_f32_16x16x32_bf16 v[136:139], v[200:203], a[184:187], v[136:139]
  v_mul_f32 v170, 0xbfb8aa3b, v30
  v_mul_f32 v171, 0xbfb8aa3b, v31
  v_mfma_f32_16x16x32_bf16 v[136:139], v[204:207], a[188:191], v[136:139]
  v_exp_f32 v168, v168
  v_mfma_f32_16x16x32_bf16 v[140:143], v[192:195], a[240:243], v[140:143]
  v_exp_f32 v169, v169
  v_mfma_f32_16x16x32_bf16 v[140:143], v[196:199], a[244:247], v[140:143]
  v_exp_f32 v170, v170
  v_mfma_f32_16x16x32_bf16 v[140:143], v[200:203], a[248:251], v[140:143]
  v_exp_f32 v171, v171
  v_mfma_f32_16x16x32_bf16 v[140:143], v[204:207], a[252:255], v[140:143]
  s_waitcnt lgkmcnt(0)
  v_add_f32 v168, 1.0, v168
  v_add_f32 v169, 1.0, v169
  v_mfma_f32_16x16x32_bf16 v[144:147], v[208:211], a[48:51], v[144:147]
  v_add_f32 v170, 1.0, v170
  v_add_f32 v171, 1.0, v171
  v_mfma_f32_16x16x32_bf16 v[144:147], v[212:215], a[52:55], v[144:147]
  v_rcp_f32 v168, v168
  v_mfma_f32_16x16x32_bf16 v[144:147], v[216:219], a[56:59], v[144:147]
  v_rcp_f32 v169, v169
  v_mfma_f32_16x16x32_bf16 v[144:147], v[220:223], a[60:63], v[144:147]
  v_rcp_f32 v170, v170
  v_mfma_f32_16x16x32_bf16 v[148:151], v[208:211], a[112:115], v[148:151]
  v_rcp_f32 v171, v171
  v_mfma_f32_16x16x32_bf16 v[148:151], v[212:215], a[116:119], v[148:151]
  v_mul_f32 v28, v28, v60
  v_mul_f32 v29, v29, v61
  v_mfma_f32_16x16x32_bf16 v[148:151], v[216:219], a[120:123], v[148:151]
  v_mul_f32 v30, v30, v62
  v_mul_f32 v31, v31, v63
  v_mfma_f32_16x16x32_bf16 v[148:151], v[220:223], a[124:127], v[148:151]
  v_mul_f32 v168, v168, v28
  v_mul_f32 v169, v169, v29
  v_mfma_f32_16x16x32_bf16 v[152:155], v[208:211], a[176:179], v[152:155]
  v_mul_f32 v170, v170, v30
  v_mul_f32 v171, v171, v31
  v_mfma_f32_16x16x32_bf16 v[152:155], v[212:215], a[180:183], v[152:155]
  s_lshr_b32 s46, s59, 12
  v_cvt_pk_bf16_f32 v172, v168, v169
  v_cvt_pk_bf16_f32 v173, v170, v171
  v_mfma_f32_16x16x32_bf16 v[152:155], v[216:219], a[184:187], v[152:155]
  s_add_u32 s46, s46, 1
  s_mul_i32 s46, s46, 176128
  s_add_u32 s46, s46, s47
  v_mfma_f32_16x16x32_bf16 v[152:155], v[220:223], a[188:191], v[152:155]
  buffer_store_dwordx2 v[172:173], v252, s[36:39], s46 offen sc1
  v_mfma_f32_16x16x32_bf16 v[156:159], v[208:211], a[240:243], v[156:159]
  v_accvgpr_write_b32 a70, v38
  v_accvgpr_write_b32 a71, v39
  v_mfma_f32_16x16x32_bf16 v[156:159], v[212:215], a[244:247], v[156:159]
  v_accvgpr_write_b32 a72, v68
  v_accvgpr_write_b32 a73, v69
  v_mfma_f32_16x16x32_bf16 v[156:159], v[216:219], a[248:251], v[156:159]
  v_accvgpr_write_b32 a74, v70
  v_accvgpr_write_b32 a75, v71
  v_mfma_f32_16x16x32_bf16 v[156:159], v[220:223], a[252:255], v[156:159]
  v_accvgpr_write_b32 a76, v100
  v_accvgpr_write_b32 a77, v101
  v_accvgpr_write_b32 a78, v102
  v_accvgpr_write_b32 a79, v103
  v_accvgpr_write_b32 a128, v8
  v_accvgpr_write_b32 a129, v9
  v_accvgpr_write_b32 a130, v10
  v_accvgpr_write_b32 a131, v11
  v_accvgpr_write_b32 a132, v40
  v_accvgpr_write_b32 a133, v41
  v_accvgpr_write_b32 a134, v42
  v_accvgpr_write_b32 a135, v43
  v_accvgpr_write_b32 a136, v72
  v_accvgpr_write_b32 a137, v73
  v_accvgpr_write_b32 a138, v74
  v_accvgpr_write_b32 a139, v75
  v_accvgpr_write_b32 a140, v104
  v_accvgpr_write_b32 a141, v105
  v_accvgpr_write_b32 a142, v106
  v_accvgpr_write_b32 a143, v107
  v_accvgpr_write_b32 a192, v12
  v_accvgpr_write_b32 a193, v13
  v_accvgpr_write_b32 a194, v14
  v_accvgpr_write_b32 a195, v15
  v_accvgpr_write_b32 a196, v44
  v_accvgpr_write_b32 a197, v45
  v_accvgpr_write_b32 a198, v46
  v_accvgpr_write_b32 a199, v47
  v_accvgpr_write_b32 a200, v76
  v_accvgpr_write_b32 a201, v77
  v_accvgpr_write_b32 a202, v78
  v_accvgpr_write_b32 a203, v79
  v_accvgpr_write_b32 a204, v108
  v_accvgpr_write_b32 a205, v109
  v_accvgpr_write_b32 a206, v110
  v_accvgpr_write_b32 a207, v111
  s_add_u32 s46, s57, 2
  s_lshr_b32 s47, s46, 1
  s_add_u32 s47, s47, 128
  s_lshl_b32 s47, s47, 10
  s_and_b32 s46, s46, 1
  s_lshl_b32 s46, s46, 3
  s_add_u32 s47, s47, s46
  v_mul_f32 v160, 0xbfb8aa3b, v128
  v_mul_f32 v161, 0xbfb8aa3b, v129
  v_mul_f32 v162, 0xbfb8aa3b, v130
  v_mul_f32 v163, 0xbfb8aa3b, v131
  v_exp_f32 v160, v160
  v_exp_f32 v161, v161
  v_exp_f32 v162, v162
  v_exp_f32 v163, v163
  v_add_f32 v160, 1.0, v160
  v_add_f32 v161, 1.0, v161
  v_add_f32 v162, 1.0, v162
  v_add_f32 v163, 1.0, v163
  v_rcp_f32 v160, v160
  v_rcp_f32 v161, v161
  v_rcp_f32 v162, v162
  v_rcp_f32 v163, v163
  v_mul_f32 v128, v128, v144
  v_mul_f32 v129, v129, v145
  v_mul_f32 v130, v130, v146
  v_mul_f32 v131, v131, v147
  v_mul_f32 v160, v160, v128
  v_mul_f32 v161, v161, v129
  v_mul_f32 v162, v162, v130
  v_mul_f32 v163, v163, v131
  v_cvt_pk_bf16_f32 v164, v160, v161
  v_cvt_pk_bf16_f32 v165, v162, v163
  s_lshr_b32 s46, s58, 12
  s_add_u32 s46, s46, 0
  s_mul_i32 s46, s46, 176128
  s_add_u32 s46, s46, s47
  buffer_store_dwordx2 v[164:165], v252, s[36:39], s46 offen sc1
  v_mul_f32 v168, 0xbfb8aa3b, v132
  v_mul_f32 v169, 0xbfb8aa3b, v133
  v_mul_f32 v170, 0xbfb8aa3b, v134
  v_mul_f32 v171, 0xbfb8aa3b, v135
  v_exp_f32 v168, v168
  v_exp_f32 v169, v169
  v_exp_f32 v170, v170
  v_exp_f32 v171, v171
  v_add_f32 v168, 1.0, v168
  v_add_f32 v169, 1.0, v169
  v_add_f32 v170, 1.0, v170
  v_add_f32 v171, 1.0, v171
  v_rcp_f32 v168, v168
  v_rcp_f32 v169, v169
  v_rcp_f32 v170, v170
  v_rcp_f32 v171, v171
  v_mul_f32 v132, v132, v148
  v_mul_f32 v133, v133, v149
  v_mul_f32 v134, v134, v150
  v_mul_f32 v135, v135, v151
  v_mul_f32 v168, v168, v132
  v_mul_f32 v169, v169, v133
  v_mul_f32 v170, v170, v134
  v_mul_f32 v171, v171, v135
  v_cvt_pk_bf16_f32 v172, v168, v169
  v_cvt_pk_bf16_f32 v173, v170, v171
  s_lshr_b32 s46, s58, 12
  s_add_u32 s46, s46, 1
  s_mul_i32 s46, s46, 176128
  s_add_u32 s46, s46, s47
  buffer_store_dwordx2 v[172:173], v252, s[36:39], s46 offen sc1
  v_mul_f32 v160, 0xbfb8aa3b, v136
  v_mul_f32 v161, 0xbfb8aa3b, v137
  v_mul_f32 v162, 0xbfb8aa3b, v138
  v_mul_f32 v163, 0xbfb8aa3b, v139
  v_exp_f32 v160, v160
  v_exp_f32 v161, v161
  v_exp_f32 v162, v162
  v_exp_f32 v163, v163
  v_add_f32 v160, 1.0, v160
  v_add_f32 v161, 1.0, v161
  v_add_f32 v162, 1.0, v162
  v_add_f32 v163, 1.0, v163
  v_rcp_f32 v160, v160
  v_rcp_f32 v161, v161
  v_rcp_f32 v162, v162
  v_rcp_f32 v163, v163
  v_mul_f32 v136, v136, v152
  v_mul_f32 v137, v137, v153
  v_mul_f32 v138, v138, v154
  v_mul_f32 v139, v139, v155
  v_mul_f32 v160, v160, v136
  v_mul_f32 v161, v161, v137
  v_mul_f32 v162, v162, v138
  v_mul_f32 v163, v163, v139
  v_cvt_pk_bf16_f32 v164, v160, v161
  v_cvt_pk_bf16_f32 v165, v162, v163
  s_lshr_b32 s46, s59, 12
  s_add_u32 s46, s46, 0
  s_mul_i32 s46, s46, 176128
  s_add_u32 s46, s46, s47
  buffer_store_dwordx2 v[164:165], v252, s[36:39], s46 offen sc1
  v_mul_f32 v168, 0xbfb8aa3b, v140
  v_mul_f32 v169, 0xbfb8aa3b, v141
  v_mul_f32 v170, 0xbfb8aa3b, v142
  v_mul_f32 v171, 0xbfb8aa3b, v143
  v_exp_f32 v168, v168
  v_exp_f32 v169, v169
  v_exp_f32 v170, v170
  v_exp_f32 v171, v171
  v_add_f32 v168, 1.0, v168
  v_add_f32 v169, 1.0, v169
  v_add_f32 v170, 1.0, v170
  v_add_f32 v171, 1.0, v171
  v_rcp_f32 v168, v168
  v_rcp_f32 v169, v169
  v_rcp_f32 v170, v170
  v_rcp_f32 v171, v171
  v_mul_f32 v140, v140, v156
  v_mul_f32 v141, v141, v157
  v_mul_f32 v142, v142, v158
  v_mul_f32 v143, v143, v159
  v_mul_f32 v168, v168, v140
  v_mul_f32 v169, v169, v141
  v_mul_f32 v170, v170, v142
  v_mul_f32 v171, v171, v143
  v_cvt_pk_bf16_f32 v172, v168, v169
  v_cvt_pk_bf16_f32 v173, v170, v171
  s_lshr_b32 s46, s59, 12
  s_add_u32 s46, s46, 1
  s_mul_i32 s46, s46, 176128
  s_add_u32 s46, s46, s47
  buffer_store_dwordx2 v[172:173], v252, s[36:39], s46 offen sc1
  s_branch L_attn
L_nogu2:
  v_accvgpr_write_b32 a0, v0
  v_accvgpr_write_b32 a1, v1
  v_accvgpr_write_b32 a2, v2
  v_accvgpr_write_b32 a3, v3
  v_accvgpr_write_b32 a4, v32
  v_accvgpr_write_b32 a5, v33
  v_accvgpr_write_b32 a6, v34
  v_accvgpr_write_b32 a7, v35
  v_accvgpr_write_b32 a8, v64
  v_accvgpr_write_b32 a9, v65
  v_accvgpr_write_b32 a10, v66
  v_accvgpr_write_b32 a11, v67
  v_accvgpr_write_b32 a12, v96
  v_accvgpr_write_b32 a13, v97
  v_accvgpr_write_b32 a14, v98
  v_accvgpr_write_b32 a15, v99
  v_accvgpr_write_b32 a64, v4
  v_accvgpr_write_b32 a65, v5
  v_accvgpr_write_b32 a66, v6
  v_accvgpr_write_b32 a67, v7
  v_accvgpr_write_b32 a68, v36
  v_accvgpr_write_b32 a69, v37
  v_accvgpr_write_b32 a70, v38
  v_accvgpr_write_b32 a71, v39
  v_accvgpr_write_b32 a72, v68
  v_accvgpr_write_b32 a73, v69
  v_accvgpr_write_b32 a74, v70
  v_accvgpr_write_b32 a75, v71
  v_accvgpr_write_b32 a76, v100
  v_accvgpr_write_b32 a77, v101
  v_accvgpr_write_b32 a78, v102
  v_accvgpr_write_b32 a79, v103
  v_accvgpr_write_b32 a128, v8
  v_accvgpr_write_b32 a129, v9
  v_accvgpr_write_b32 a130, v10
  v_accvgpr_write_b32 a131, v11
  v_accvgpr_write_b32 a132, v40
  v_accvgpr_write_b32 a133, v41
  v_accvgpr_write_b32 a134, v42
  v_accvgpr_write_b32 a135, v43
  v_accvgpr_write_b32 a136, v72
  v_accvgpr_write_b32 a137, v73
  v_accvgpr_write_b32 a138, v74
  v_accvgpr_write_b32 a139, v75
  v_accvgpr_write_b32 a140, v104
  v_accvgpr_write_b32 a141, v105
  v_accvgpr_write_b32 a142, v106
  v_accvgpr_write_b32 a143, v107
  v_accvgpr_write_b32 a192, v12
  v_accvgpr_write_b32 a193, v13
  v_accvgpr_write_b32 a194, v14
  v_accvgpr_write_b32 a195, v15
  v_accvgpr_write_b32 a196, v44
  v_accvgpr_write_b32 a197, v45
  v_accvgpr_write_b32 a198, v46
  v_accvgpr_write_b32 a199, v47
  v_accvgpr_write_b32 a200, v76
  v_accvgpr_write_b32 a201, v77
  v_accvgpr_write_b32 a202, v78
  v_accvgpr_write_b32 a203, v79
  v_accvgpr_write_b32 a204, v108
  v_accvgpr_write_b32 a205, v109
  v_accvgpr_write_b32 a206, v110
  v_accvgpr_write_b32 a207, v111
  s_add_u32 s46, s57, 1
  s_lshr_b32 s47, s46, 1
  s_add_u32 s47, s47, 128
  s_lshl_b32 s47, s47, 10
  s_and_b32 s46, s46, 1
  s_lshl_b32 s46, s46, 3
  s_add_u32 s47, s47, s46
  v_mul_f32 v160, 0xbfb8aa3b, v16
  v_mul_f32 v161, 0xbfb8aa3b, v17
  v_mul_f32 v162, 0xbfb8aa3b, v18
  v_mul_f32 v163, 0xbfb8aa3b, v19
  v_exp_f32 v160, v160
  v_exp_f32 v161, v161
  v_exp_f32 v162, v162
  v_exp_f32 v163, v163
  v_add_f32 v160, 1.0, v160
  v_add_f32 v161, 1.0, v161
  v_add_f32 v162, 1.0, v162
  v_add_f32 v163, 1.0, v163
  v_rcp_f32 v160, v160
  v_rcp_f32 v161, v161
  v_rcp_f32 v162, v162
  v_rcp_f32 v163, v163
  v_mul_f32 v16, v16, v48
  v_mul_f32 v17, v17, v49
  v_mul_f32 v18, v18, v50
  v_mul_f32 v19, v19, v51
  v_mul_f32 v160, v160, v16
  v_mul_f32 v161, v161, v17
  v_mul_f32 v162, v162, v18
  v_mul_f32 v163, v163, v19
  v_cvt_pk_bf16_f32 v164, v160, v161
  v_cvt_pk_bf16_f32 v165, v162, v163
  s_lshr_b32 s46, s58, 12
  s_add_u32 s46, s46, 0
  s_mul_i32 s46, s46, 176128
  s_add_u32 s46, s46, s47
  buffer_store_dwordx2 v[164:165], v252, s[36:39], s46 offen sc1
  v_mul_f32 v168, 0xbfb8aa3b, v20
  v_mul_f32 v169, 0xbfb8aa3b, v21
  v_mul_f32 v170, 0xbfb8aa3b, v22
  v_mul_f32 v171, 0xbfb8aa3b, v23
  v_exp_f32 v168, v168
  v_exp_f32 v169, v169
  v_exp_f32 v170, v170
  v_exp_f32 v171, v171
  v_add_f32 v168, 1.0, v168
  v_add_f32 v169, 1.0, v169
  v_add_f32 v170, 1.0, v170
  v_add_f32 v171, 1.0, v171
  v_rcp_f32 v168, v168
  v_rcp_f32 v169, v169
  v_rcp_f32 v170, v170
  v_rcp_f32 v171, v171
  v_mul_f32 v20, v20, v52
  v_mul_f32 v21, v21, v53
  v_mul_f32 v22, v22, v54
  v_mul_f32 v23, v23, v55
  v_mul_f32 v168, v168, v20
  v_mul_f32 v169, v169, v21
  v_mul_f32 v170, v170, v22
  v_mul_f32 v171, v171, v23
  v_cvt_pk_bf16_f32 v172, v168, v169
  v_cvt_pk_bf16_f32 v173, v170, v171
  s_lshr_b32 s46, s58, 12
  s_add_u32 s46, s46, 1
  s_mul_i32 s46, s46, 176128
  s_add_u32 s46, s46, s47
  buffer_store_dwordx2 v[172:173], v252, s[36:39], s46 offen sc1
  v_mul_f32 v160, 0xbfb8aa3b, v24
  v_mul_f32 v161, 0xbfb8aa3b, v25
  v_mul_f32 v162, 0xbfb8aa3b, v26
  v_mul_f32 v163, 0xbfb8aa3b, v27
  v_exp_f32 v160, v160
  v_exp_f32 v161, v161
  v_exp_f32 v162, v162
  v_exp_f32 v163, v163
  v_add_f32 v160, 1.0, v160
  v_add_f32 v161, 1.0, v161
  v_add_f32 v162, 1.0, v162
  v_add_f32 v163, 1.0, v163
  v_rcp_f32 v160, v160
  v_rcp_f32 v161, v161
  v_rcp_f32 v162, v162
  v_rcp_f32 v163, v163
  v_mul_f32 v24, v24, v56
  v_mul_f32 v25, v25, v57
  v_mul_f32 v26, v26, v58
  v_mul_f32 v27, v27, v59
  v_mul_f32 v160, v160, v24
  v_mul_f32 v161, v161, v25
  v_mul_f32 v162, v162, v26
  v_mul_f32 v163, v163, v27
  v_cvt_pk_bf16_f32 v164, v160, v161
  v_cvt_pk_bf16_f32 v165, v162, v163
  s_lshr_b32 s46, s59, 12
  s_add_u32 s46, s46, 0
  s_mul_i32 s46, s46, 176128
  s_add_u32 s46, s46, s47
  buffer_store_dwordx2 v[164:165], v252, s[36:39], s46 offen sc1
  v_mul_f32 v168, 0xbfb8aa3b, v28
  v_mul_f32 v169, 0xbfb8aa3b, v29
  v_mul_f32 v170, 0xbfb8aa3b, v30
  v_mul_f32 v171, 0xbfb8aa3b, v31
  v_exp_f32 v168, v168
  v_exp_f32 v169, v169
  v_exp_f32 v170, v170
  v_exp_f32 v171, v171
  v_add_f32 v168, 1.0, v168
  v_add_f32 v169, 1.0, v169
  v_add_f32 v170, 1.0, v170
  v_add_f32 v171, 1.0, v171
  v_rcp_f32 v168, v168
  v_rcp_f32 v169, v169
  v_rcp_f32 v170, v170
  v_rcp_f32 v171, v171
  v_mul_f32 v28, v28, v60
  v_mul_f32 v29, v29, v61
  v_mul_f32 v30, v30, v62
  v_mul_f32 v31, v31, v63
  v_mul_f32 v168, v168, v28
  v_mul_f32 v169, v169, v29
  v_mul_f32 v170, v170, v30
  v_mul_f32 v171, v171, v31
  v_cvt_pk_bf16_f32 v172, v168, v169
  v_cvt_pk_bf16_f32 v173, v170, v171
  s_lshr_b32 s46, s59, 12
  s_add_u32 s46, s46, 1
  s_mul_i32 s46, s46, 176128
  s_add_u32 s46, s46, s47
  buffer_store_dwordx2 v[172:173], v252, s[36:39], s46 offen sc1
  s_cmp_lg_u32 s40, 31
  s_cbranch_scc1 L_nopad
  v_mov_b32 v160, 0
  v_mov_b32 v161, 0
  v_mov_b32 v162, 0
  v_mov_b32 v163, 0
  s_lshr_b32 s46, s58, 12
  s_add_u32 s46, s46, 0
  s_mul_i32 s46, s46, 176128
  s_add_u32 s46, s46, 175104
  buffer_store_dwordx4 v[160:163], v252, s[36:39], s46 offen sc1
  s_lshr_b32 s46, s58, 12
  s_add_u32 s46, s46, 1
  s_mul_i32 s46, s46, 176128
  s_add_u32 s46, s46, 175104
  buffer_store_dwordx4 v[160:163], v252, s[36:39], s46 offen sc1
  s_lshr_b32 s46, s59, 12
  s_add_u32 s46, s46, 0
  s_mul_i32 s46, s46, 176128
  s_add_u32 s46, s46, 175104
  buffer_store_dwordx4 v[160:163], v252, s[36:39], s46 offen sc1
  s_lshr_b32 s46, s59, 12
  s_add_u32 s46, s46, 1
  s_mul_i32 s46, s46, 176128
  s_add_u32 s46, s46, 175104
  buffer_store_dwordx4 v[160:163], v252, s[36:39], s46 offen sc1
  s_nop 1
L_nopad:
L_attn:
  s_mov_b32 s45, -1
  s_mov_b32 s50, 0
  s_mov_b32 s51, 0
  v_mov_b32 v234, v252
  v_mov_b32 v192, 0
  v_mov_b32 v193, 0
  v_mov_b32 v194, 0
  v_mov_b32 v195, 0
  v_mov_b32 v196, 0
  v_mov_b32 v197, 0
  v_mov_b32 v198, 0
  v_mov_b32 v199, 0
  v_mov_b32 v200, 0
  v_mov_b32 v201, 0
  v_mov_b32 v202, 0
  v_mov_b32 v203, 0
  v_mov_b32 v204, 0
  v_mov_b32 v205, 0
  v_mov_b32 v206, 0
  v_mov_b32 v207, 0
  v_lshlrev_b32 v246, 3, v252
  v_mov_b32 v242, 0x3f803f80
  v_accvgpr_write_b32 a248, v242
  v_accvgpr_write_b32 a249, v242
  v_accvgpr_write_b32 a250, v242
  v_accvgpr_write_b32 a251, v242
  s_waitcnt vmcnt(0)
  s_barrier
  ds_read_b128 a[48:51], v234 offset:0
  ds_read_b128 a[52:55], v234 offset:1024
  ds_read_b128 a[56:59], v234 offset:2048
  ds_read_b128 a[60:63], v234 offset:3072
  ds_read_b128 a[112:115], v234 offset:4096
  buffer_load_dword v247, v246, s[80:83], s79 offen
  s_waitcnt lgkmcnt(1)
  v_mfma_f32_16x16x32_bf16 v[0:3], a[48:51], a[0:3], v[192:195]
  s_mov_b32 m0, s55
  v_mfma_f32_16x16x32_bf16 v[0:3], a[52:55], a[4:7], v[0:3]
  s_add_u32 s49, s55, 16384
  v_mfma_f32_16x16x32_bf16 v[0:3], a[56:59], a[8:11], v[0:3]
  buffer_load_dwordx4 v239, s[32:35], s53 offen offset:0 sc1 lds
  v_mfma_f32_16x16x32_bf16 v[0:3], a[60:63], a[12:15], v[0:3]
  v_accvgpr_write_b32 a16, 0
  v_accvgpr_write_b32 a17, 0
  v_mfma_f32_16x16x32_bf16 v[4:7], a[48:51], a[64:67], v[196:199]
  v_accvgpr_write_b32 a18, 0
  v_accvgpr_write_b32 a19, 0
  v_mfma_f32_16x16x32_bf16 v[4:7], a[52:55], a[68:71], v[4:7]
  buffer_load_dwordx4 v239, s[32:35], s53 offen offset:1024 sc1 lds
  v_mfma_f32_16x16x32_bf16 v[4:7], a[56:59], a[72:75], v[4:7]
  v_accvgpr_write_b32 a20, 0
  v_accvgpr_write_b32 a21, 0
  v_mfma_f32_16x16x32_bf16 v[4:7], a[60:63], a[76:79], v[4:7]
  ds_read_b128 a[116:119], v234 offset:5120
  v_accvgpr_write_b32 a22, 0
  v_mfma_f32_16x16x32_bf16 v[64:67], a[48:51], a[128:131], v[200:203]
  ds_read_b128 a[120:123], v234 offset:6144
  v_accvgpr_write_b32 a23, 0
  v_mfma_f32_16x16x32_bf16 v[64:67], a[52:55], a[132:135], v[64:67]
  ds_read_b128 a[124:127], v234 offset:7168
  v_accvgpr_write_b32 a24, 0
  v_mfma_f32_16x16x32_bf16 v[64:67], a[56:59], a[136:139], v[64:67]
  buffer_load_dwordx4 v239, s[32:35], s53 offen offset:2048 sc1 lds
  v_mfma_f32_16x16x32_bf16 v[64:67], a[60:63], a[140:143], v[64:67]
  v_accvgpr_write_b32 a25, 0
  v_accvgpr_write_b32 a26, 0
  v_mfma_f32_16x16x32_bf16 v[68:71], a[48:51], a[192:195], v[204:207]
  buffer_load_dwordx4 v239, s[32:35], s53 offen offset:3072 sc1 lds
  v_mfma_f32_16x16x32_bf16 v[68:71], a[52:55], a[196:199], v[68:71]
  s_add_u32 s53, s53, 16384
  s_cmp_ge_u32 s49, 147456
  s_cselect_b32 s55, s6, s49
  v_mfma_f32_16x16x32_bf16 v[68:71], a[56:59], a[200:203], v[68:71]
  s_mov_b32 m0, s54
  v_accvgpr_write_b32 a27, 0
  v_accvgpr_write_b32 a28, 0
  v_mfma_f32_16x16x32_bf16 v[68:71], a[60:63], a[204:207], v[68:71]
  s_add_u32 s49, s54, 16384
  buffer_load_dwordx4 v239, s[28:31], s52 offen offset:0 sc1 lds
  s_waitcnt lgkmcnt(0)
  v_mfma_f32_16x16x32_bf16 v[8:11], a[112:115], a[0:3], v[192:195]
  v_accvgpr_write_b32 a29, 0
  v_accvgpr_write_b32 a30, 0
  v_mfma_f32_16x16x32_bf16 v[8:11], a[116:119], a[4:7], v[8:11]
  v_accvgpr_write_b32 a31, 0
  v_accvgpr_write_b32 a32, 0
  v_mfma_f32_16x16x32_bf16 v[8:11], a[120:123], a[8:11], v[8:11]
  v_accvgpr_write_b32 a33, 0
  v_accvgpr_write_b32 a34, 0
  v_mfma_f32_16x16x32_bf16 v[8:11], a[124:127], a[12:15], v[8:11]
  buffer_load_dwordx4 v239, s[28:31], s52 offen offset:1024 sc1 lds
  v_mfma_f32_16x16x32_bf16 v[12:15], a[112:115], a[64:67], v[196:199]
  v_accvgpr_write_b32 a35, 0
  v_accvgpr_write_b32 a36, 0
  v_mfma_f32_16x16x32_bf16 v[12:15], a[116:119], a[68:71], v[12:15]
  buffer_load_dwordx4 v239, s[28:31], s52 offen offset:2048 sc1 lds
  v_mfma_f32_16x16x32_bf16 v[12:15], a[120:123], a[72:75], v[12:15]
  ds_read_b128 a[48:51], v234 offset:8192
  v_accvgpr_write_b32 a37, 0
  v_mfma_f32_16x16x32_bf16 v[12:15], a[124:127], a[76:79], v[12:15]
  ds_read_b128 a[52:55], v234 offset:9216
  v_accvgpr_write_b32 a38, 0
  v_mfma_f32_16x16x32_bf16 v[72:75], a[112:115], a[128:131], v[200:203]
  ds_read_b128 a[56:59], v234 offset:10240
  v_accvgpr_write_b32 a39, 0
  v_mfma_f32_16x16x32_bf16 v[72:75], a[116:119], a[132:135], v[72:75]
  ds_read_b128 a[60:63], v234 offset:11264
  v_accvgpr_write_b32 a40, 0
  v_mfma_f32_16x16x32_bf16 v[72:75], a[120:123], a[136:139], v[72:75]
  buffer_load_dwordx4 v239, s[28:31], s52 offen offset:3072 sc1 lds
  v_mfma_f32_16x16x32_bf16 v[72:75], a[124:127], a[140:143], v[72:75]
  s_add_u32 s52, s52, 16384
  s_cmp_ge_u32 s49, 81920
  s_cselect_b32 s54, s56, s49
  v_mfma_f32_16x16x32_bf16 v[76:79], a[112:115], a[192:195], v[204:207]
  s_mov_b32 m0, s55
  v_accvgpr_write_b32 a41, 0
  v_accvgpr_write_b32 a42, 0
  v_mfma_f32_16x16x32_bf16 v[76:79], a[116:119], a[196:199], v[76:79]
  s_add_u32 s49, s55, 16384
  buffer_load_dwordx4 v239, s[32:35], s53 offen offset:0 sc1 lds
  v_mfma_f32_16x16x32_bf16 v[76:79], a[120:123], a[200:203], v[76:79]
  v_accvgpr_write_b32 a43, 0
  v_accvgpr_write_b32 a44, 0
  v_mfma_f32_16x16x32_bf16 v[76:79], a[124:127], a[204:207], v[76:79]
  s_waitcnt lgkmcnt(0)
  v_accvgpr_write_b32 a45, 0
  v_accvgpr_write_b32 a46, 0
  v_mfma_f32_16x16x32_bf16 v[16:19], a[48:51], a[0:3], v[192:195]
  s_add_u32 s48, s45, 3
  buffer_load_dwordx4 v239, s[32:35], s53 offen offset:1024 sc1 lds
  v_mfma_f32_16x16x32_bf16 v[16:19], a[52:55], a[4:7], v[16:19]
  s_cmp_ge_i32 s48, s43
  s_cselect_b64 s[8:9], -1, 0
  v_accvgpr_write_b32 a47, 0
  v_accvgpr_write_b32 a80, 0
  v_mfma_f32_16x16x32_bf16 v[16:19], a[56:59], a[8:11], v[16:19]
  v_accvgpr_write_b32 a81, 0
  v_accvgpr_write_b32 a82, 0
  v_mfma_f32_16x16x32_bf16 v[16:19], a[60:63], a[12:15], v[16:19]
  v_accvgpr_write_b32 a83, 0
  v_accvgpr_write_b32 a84, 0
  v_mfma_f32_16x16x32_bf16 v[20:23], a[48:51], a[64:67], v[196:199]
  buffer_load_dwordx4 v239, s[32:35], s53 offen offset:2048 sc1 lds
  v_mfma_f32_16x16x32_bf16 v[20:23], a[52:55], a[68:71], v[20:23]
  v_accvgpr_write_b32 a85, 0
  v_accvgpr_write_b32 a86, 0
  v_mfma_f32_16x16x32_bf16 v[20:23], a[56:59], a[72:75], v[20:23]
  ds_read_b128 a[112:115], v234 offset:12288
  v_accvgpr_write_b32 a87, 0
  v_mfma_f32_16x16x32_bf16 v[20:23], a[60:63], a[76:79], v[20:23]
  ds_read_b128 a[116:119], v234 offset:13312
  v_accvgpr_write_b32 a88, 0
  v_mfma_f32_16x16x32_bf16 v[80:83], a[48:51], a[128:131], v[200:203]
  ds_read_b128 a[120:123], v234 offset:14336
  v_accvgpr_write_b32 a89, 0
  v_mfma_f32_16x16x32_bf16 v[80:83], a[52:55], a[132:135], v[80:83]
  ds_read_b128 a[124:127], v234 offset:15360
  v_accvgpr_write_b32 a90, 0
  v_mfma_f32_16x16x32_bf16 v[80:83], a[56:59], a[136:139], v[80:83]
  buffer_load_dwordx4 v239, s[32:35], s53 offen offset:3072 sc1 lds
  v_mfma_f32_16x16x32_bf16 v[80:83], a[60:63], a[140:143], v[80:83]
  s_add_u32 s53, s53, 16384
  s_cmp_ge_u32 s49, 147456
  s_cselect_b32 s55, s6, s49
  s_mov_b32 m0, s54
  v_mfma_f32_16x16x32_bf16 v[84:87], a[48:51], a[192:195], v[204:207]
  s_add_u32 s49, s54, 16384
  buffer_load_dwordx4 v239, s[28:31], s52 offen offset:0 sc1 lds
  v_mfma_f32_16x16x32_bf16 v[84:87], a[52:55], a[196:199], v[84:87]
  v_accvgpr_write_b32 a91, 0
  v_accvgpr_write_b32 a92, 0
  v_mfma_f32_16x16x32_bf16 v[84:87], a[56:59], a[200:203], v[84:87]
  buffer_load_dwordx4 v239, s[28:31], s52 offen offset:1024 sc1 lds
  v_mfma_f32_16x16x32_bf16 v[84:87], a[60:63], a[204:207], v[84:87]
  s_waitcnt lgkmcnt(0)
  v_accvgpr_write_b32 a93, 0
  v_accvgpr_write_b32 a94, 0
  v_mfma_f32_16x16x32_bf16 v[24:27], a[112:115], a[0:3], v[192:195]
  s_add_u32 s50, s50, 16384
  v_accvgpr_write_b32 a95, 0
  v_accvgpr_write_b32 a96, 0
  v_mfma_f32_16x16x32_bf16 v[24:27], a[116:119], a[4:7], v[24:27]
  s_cmp_ge_u32 s50, 81920
  s_cselect_b32 s50, 0, s50
  v_accvgpr_write_b32 a97, 0
  v_mfma_f32_16x16x32_bf16 v[24:27], a[120:123], a[8:11], v[24:27]
  v_add_u32 v234, s50, v252
  v_accvgpr_write_b32 a98, 0
  v_mfma_f32_16x16x32_bf16 v[24:27], a[124:127], a[12:15], v[24:27]
  buffer_load_dwordx4 v239, s[28:31], s52 offen offset:2048 sc1 lds
  v_mfma_f32_16x16x32_bf16 v[28:31], a[112:115], a[64:67], v[196:199]
  ds_read_b128 a[48:51], v234 offset:0
  v_accvgpr_write_b32 a99, 0
  v_mfma_f32_16x16x32_bf16 v[28:31], a[116:119], a[68:71], v[28:31]
  buffer_load_dwordx4 v239, s[28:31], s52 offen offset:3072 sc1 lds
  v_mfma_f32_16x16x32_bf16 v[28:31], a[120:123], a[72:75], v[28:31]
  s_add_u32 s52, s52, 16384
  ds_read_b128 a[52:55], v234 offset:1024
  v_accvgpr_write_b32 a100, 0
  v_mfma_f32_16x16x32_bf16 v[28:31], a[124:127], a[76:79], v[28:31]
  s_cmp_ge_u32 s49, 81920
  s_cselect_b32 s54, s56, s49
  v_accvgpr_write_b32 a101, 0
  v_mfma_f32_16x16x32_bf16 v[88:91], a[112:115], a[128:131], v[200:203]
  ds_read_b128 a[56:59], v234 offset:2048
  v_accvgpr_write_b32 a102, 0
  v_mfma_f32_16x16x32_bf16 v[88:91], a[116:119], a[132:135], v[88:91]
  v_accvgpr_write_b32 a103, 0
  v_accvgpr_write_b32 a104, 0
  v_mfma_f32_16x16x32_bf16 v[88:91], a[120:123], a[136:139], v[88:91]
  ds_read_b128 a[60:63], v234 offset:3072
  v_accvgpr_write_b32 a105, 0
  v_mfma_f32_16x16x32_bf16 v[88:91], a[124:127], a[140:143], v[88:91]
  v_accvgpr_write_b32 a106, 0
  v_accvgpr_write_b32 a107, 0
  v_mfma_f32_16x16x32_bf16 v[92:95], a[112:115], a[192:195], v[204:207]
  v_accvgpr_write_b32 a108, 0
  v_accvgpr_write_b32 a109, 0
  v_mfma_f32_16x16x32_bf16 v[92:95], a[116:119], a[196:199], v[92:95]
  ds_read_b128 a[112:115], v234 offset:4096
  v_accvgpr_write_b32 a110, 0
  v_mfma_f32_16x16x32_bf16 v[92:95], a[120:123], a[200:203], v[92:95]
  v_accvgpr_write_b32 a111, 0
  v_mfma_f32_16x16x32_bf16 v[92:95], a[124:127], a[204:207], v[92:95]
  s_mov_b64 vcc, s[8:9]
  s_cbranch_vccnz L_stub1
L_back1:
  s_add_u32 s45, s45, 1
  v_max3_f32 v242, v0, v1, v2
  v_max3_f32 v242, v242, v3, v8
  v_max3_f32 v242, v242, v9, v10
  v_max3_f32 v242, v242, v11, v16
  v_max3_f32 v242, v242, v17, v18
  v_max3_f32 v242, v242, v19, v24
  v_max3_f32 v242, v242, v25, v26
  v_max_f32 v242, v242, v27
  v_mov_b32 v243, v242
  s_nop 1
  v_permlane16_swap_b32 v242, v243
  v_max_f32 v242, v242, v243
  v_mov_b32 v243, v242
  s_nop 1
  v_permlane32_swap_b32 v242, v243
  v_max_f32 v242, v242, v243
  v_sub_f32 v0, v0, v242
  v_sub_f32 v1, v1, v242
  v_sub_f32 v2, v2, v242
  v_sub_f32 v3, v3, v242
  v_sub_f32 v8, v8, v242
  v_sub_f32 v9, v9, v242
  v_sub_f32 v10, v10, v242
  v_sub_f32 v11, v11, v242
  v_sub_f32 v16, v16, v242
  v_sub_f32 v17, v17, v242
  v_sub_f32 v18, v18, v242
  v_sub_f32 v19, v19, v242
  v_sub_f32 v24, v24, v242
  v_sub_f32 v25, v25, v242
  v_sub_f32 v26, v26, v242
  v_sub_f32 v27, v27, v242
  v_sub_f32 v192, 0, v242
  v_sub_f32 v193, 0, v242
  v_sub_f32 v194, 0, v242
  v_sub_f32 v195, 0, v242
  v_mov_b32 v230, 0
  v_max3_f32 v244, v4, v5, v6
  v_max3_f32 v244, v244, v7, v12
  v_max3_f32 v244, v244, v13, v14
  v_max3_f32 v244, v244, v15, v20
  v_max3_f32 v244, v244, v21, v22
  v_max3_f32 v244, v244, v23, v28
  v_max3_f32 v244, v244, v29, v30
  v_max_f32 v244, v244, v31
  v_mov_b32 v245, v244
  s_nop 1
  v_permlane16_swap_b32 v244, v245
  v_max_f32 v244, v244, v245
  v_mov_b32 v245, v244
  s_nop 1
  v_permlane32_swap_b32 v244, v245
  v_max_f32 v244, v244, v245
  v_sub_f32 v4, v4, v244
  v_sub_f32 v5, v5, v244
  v_sub_f32 v6, v6, v244
  v_sub_f32 v7, v7, v244
  v_sub_f32 v12, v12, v244
  v_sub_f32 v13, v13, v244
  v_sub_f32 v14, v14, v244
  v_sub_f32 v15, v15, v244
  v_sub_f32 v20, v20, v244
  v_sub_f32 v21, v21, v244
  v_sub_f32 v22, v22, v244
  v_sub_f32 v23, v23, v244
  v_sub_f32 v28, v28, v244
  v_sub_f32 v29, v29, v244
  v_sub_f32 v30, v30, v244
  v_sub_f32 v31, v31, v244
  v_sub_f32 v196, 0, v244
  v_sub_f32 v197, 0, v244
  v_sub_f32 v198, 0, v244
  v_sub_f32 v199, 0, v244
  v_mov_b32 v231, 0
  v_max3_f32 v242, v64, v65, v66
  v_max3_f32 v242, v242, v67, v72
  v_max3_f32 v242, v242, v73, v74
  v_max3_f32 v242, v242, v75, v80
  v_max3_f32 v242, v242, v81, v82
  v_max3_f32 v242, v242, v83, v88
  v_max3_f32 v242, v242, v89, v90
  v_max_f32 v242, v242, v91
  v_mov_b32 v243, v242
  s_nop 1
  v_permlane16_swap_b32 v242, v243
  v_max_f32 v242, v242, v243
  v_mov_b32 v243, v242
  s_nop 1
  v_permlane32_swap_b32 v242, v243
  v_max_f32 v242, v242, v243
  v_sub_f32 v64, v64, v242
  v_sub_f32 v65, v65, v242
  v_sub_f32 v66, v66, v242
  v_sub_f32 v67, v67, v242
  v_sub_f32 v72, v72, v242
  v_sub_f32 v73, v73, v242
  v_sub_f32 v74, v74, v242
  v_sub_f32 v75, v75, v242
  v_sub_f32 v80, v80, v242
  v_sub_f32 v81, v81, v242
  v_sub_f32 v82, v82, v242
  v_sub_f32 v83, v83, v242
  v_sub_f32 v88, v88, v242
  v_sub_f32 v89, v89, v242
  v_sub_f32 v90, v90, v242
  v_sub_f32 v91, v91, v242
  v_sub_f32 v200, 0, v242
  v_sub_f32 v201, 0, v242
  v_sub_f32 v202, 0, v242
  v_sub_f32 v203, 0, v242
  v_mov_b32 v232, 0
  v_max3_f32 v244, v68, v69, v70
  v_max3_f32 v244, v244, v71, v76
  v_max3_f32 v244, v244, v77, v78
  v_max3_f32 v244, v244, v79, v84
  v_max3_f32 v244, v244, v85, v86
  v_max3_f32 v244, v244, v87, v92
  v_max3_f32 v244, v244, v93, v94
  v_max_f32 v244, v244, v95
  v_mov_b32 v245, v244
  s_nop 1
  v_permlane16_swap_b32 v244, v245
  v_max_f32 v244, v244, v245
  v_mov_b32 v245, v244
  s_nop 1
  v_permlane32_swap_b32 v244, v245
  v_max_f32 v244, v244, v245
  v_sub_f32 v68, v68, v244
  v_sub_f32 v69, v69, v244
  v_sub_f32 v70, v70, v244
  v_sub_f32 v71, v71, v244
  v_sub_f32 v76, v76, v244
  v_sub_f32 v77, v77, v244
  v_sub_f32 v78, v78, v244
  v_sub_f32 v79, v79, v244
  v_sub_f32 v84, v84, v244
  v_sub_f32 v85, v85, v244
  v_sub_f32 v86, v86, v244
  v_sub_f32 v87, v87, v244
  v_sub_f32 v92, v92, v244
  v_sub_f32 v93, v93, v244
  v_sub_f32 v94, v94, v244
  v_sub_f32 v95, v95, v244
  v_sub_f32 v204, 0, v244
  v_sub_f32 v205, 0, v244
  v_sub_f32 v206, 0, v244
  v_sub_f32 v207, 0, v244
  v_mov_b32 v233, 0
  s_waitcnt lgkmcnt(1)
  v_mfma_f32_16x16x32_bf16 v[32:35], a[48:51], a[0:3], v[192:195]
  v_exp_f32 v224, v0
  v_exp_f32 v225, v1
  v_mfma_f32_16x16x32_bf16 v[32:35], a[52:55], a[4:7], v[32:35]
  v_cvt_pk_bf16_f32 v128, v224, v225
  v_exp_f32 v226, v2
  v_mfma_f32_16x16x32_bf16 v[32:35], a[56:59], a[8:11], v[32:35]
  v_exp_f32 v227, v3
  v_mfma_f32_16x16x32_bf16 v[32:35], a[60:63], a[12:15], v[32:35]
  v_cvt_pk_bf16_f32 v129, v226, v227
  v_exp_f32 v228, v8
  v_mfma_f32_16x16x32_bf16 v[36:39], a[48:51], a[64:67], v[196:199]
  v_exp_f32 v229, v9
  v_exp_f32 v224, v10
  v_mfma_f32_16x16x32_bf16 v[36:39], a[52:55], a[68:71], v[36:39]
  v_cvt_pk_bf16_f32 v130, v228, v229
  v_exp_f32 v225, v11
  v_mfma_f32_16x16x32_bf16 v[36:39], a[56:59], a[72:75], v[36:39]
  v_cvt_pk_bf16_f32 v131, v224, v225
  v_exp_f32 v226, v16
  v_mfma_f32_16x16x32_bf16 v[36:39], a[60:63], a[76:79], v[36:39]
  ds_read_b128 a[116:119], v234 offset:5120
  v_exp_f32 v227, v17
  v_mfma_f32_16x16x32_bf16 v[96:99], a[48:51], a[128:131], v[200:203]
  ds_read_b128 a[120:123], v234 offset:6144
  v_cvt_pk_bf16_f32 v136, v226, v227
  v_exp_f32 v228, v18
  v_exp_f32 v229, v19
  v_mfma_f32_16x16x32_bf16 v[96:99], a[52:55], a[132:135], v[96:99]
  ds_read_b128 a[124:127], v234 offset:7168
  v_cvt_pk_bf16_f32 v137, v228, v229
  v_exp_f32 v224, v24
  v_mfma_f32_16x16x32_bf16 v[96:99], a[56:59], a[136:139], v[96:99]
  v_exp_f32 v225, v25
  v_mfma_f32_16x16x32_bf16 v[96:99], a[60:63], a[140:143], v[96:99]
  v_cvt_pk_bf16_f32 v138, v224, v225
  v_exp_f32 v226, v26
  v_mfma_f32_16x16x32_bf16 v[100:103], a[48:51], a[192:195], v[204:207]
  v_exp_f32 v227, v27
  v_mfma_f32_16x16x32_bf16 v[100:103], a[52:55], a[196:199], v[100:103]
  v_cvt_pk_bf16_f32 v139, v226, v227
  v_exp_f32 v228, v4
  v_exp_f32 v229, v5
  v_mfma_f32_16x16x32_bf16 v[100:103], a[56:59], a[200:203], v[100:103]
  v_cvt_pk_bf16_f32 v132, v228, v229
  v_exp_f32 v224, v6
  v_mfma_f32_16x16x32_bf16 v[100:103], a[60:63], a[204:207], v[100:103]
  v_exp_f32 v225, v7
  v_mfma_f32_16x16x32_bf16 v[208:211], a[248:251], v[128:131], 0
  v_accvgpr_write_b32 a144, 0
  v_accvgpr_write_b32 a145, 0
  v_mfma_f32_16x16x32_bf16 v[208:211], a[248:251], v[136:139], v[208:211]
  s_waitcnt lgkmcnt(0)
  v_accvgpr_write_b32 a146, 0
  v_accvgpr_write_b32 a147, 0
  v_mfma_f32_16x16x32_bf16 v[40:43], a[112:115], a[0:3], v[192:195]
  v_cvt_pk_bf16_f32 v133, v224, v225
  v_exp_f32 v226, v12
  v_mfma_f32_16x16x32_bf16 v[40:43], a[116:119], a[4:7], v[40:43]
  v_exp_f32 v227, v13
  v_exp_f32 v228, v14
  v_mfma_f32_16x16x32_bf16 v[40:43], a[120:123], a[8:11], v[40:43]
  v_cvt_pk_bf16_f32 v134, v226, v227
  v_exp_f32 v229, v15
  v_mfma_f32_16x16x32_bf16 v[40:43], a[124:127], a[12:15], v[40:43]
  v_cvt_pk_bf16_f32 v135, v228, v229
  v_exp_f32 v224, v20
  v_mfma_f32_16x16x32_bf16 v[44:47], a[112:115], a[64:67], v[196:199]
  v_exp_f32 v225, v21
  v_mfma_f32_16x16x32_bf16 v[44:47], a[116:119], a[68:71], v[44:47]
  v_cvt_pk_bf16_f32 v140, v224, v225
  v_exp_f32 v226, v22
  v_exp_f32 v227, v23
  v_mfma_f32_16x16x32_bf16 v[44:47], a[120:123], a[72:75], v[44:47]
  ds_read_b128 a[48:51], v234 offset:8192
  v_cvt_pk_bf16_f32 v141, v226, v227
  v_exp_f32 v228, v28
  v_mfma_f32_16x16x32_bf16 v[44:47], a[124:127], a[76:79], v[44:47]
  ds_read_b128 a[52:55], v234 offset:9216
  v_exp_f32 v229, v29
  v_mfma_f32_16x16x32_bf16 v[104:107], a[112:115], a[128:131], v[200:203]
  ds_read_b128 a[56:59], v234 offset:10240
  v_cvt_pk_bf16_f32 v142, v228, v229
  v_exp_f32 v224, v30
  v_mfma_f32_16x16x32_bf16 v[104:107], a[116:119], a[132:135], v[104:107]
  ds_read_b128 a[60:63], v234 offset:11264
  v_exp_f32 v225, v31
  v_mfma_f32_16x16x32_bf16 v[104:107], a[120:123], a[136:139], v[104:107]
  v_cvt_pk_bf16_f32 v143, v224, v225
  v_exp_f32 v226, v64
  v_exp_f32 v227, v65
  v_mfma_f32_16x16x32_bf16 v[104:107], a[124:127], a[140:143], v[104:107]
  v_cvt_pk_bf16_f32 v160, v226, v227
  v_exp_f32 v228, v66
  v_mfma_f32_16x16x32_bf16 v[212:215], a[248:251], v[132:135], 0
  v_accvgpr_write_b32 a148, 0
  v_accvgpr_write_b32 a149, 0
  v_mfma_f32_16x16x32_bf16 v[212:215], a[248:251], v[140:143], v[212:215]
  v_accvgpr_write_b32 a150, 0
  v_accvgpr_write_b32 a151, 0
  v_mfma_f32_16x16x32_bf16 v[108:111], a[112:115], a[192:195], v[204:207]
  v_exp_f32 v229, v67
  v_mfma_f32_16x16x32_bf16 v[108:111], a[116:119], a[196:199], v[108:111]
  v_cvt_pk_bf16_f32 v161, v228, v229
  v_exp_f32 v224, v72
  v_mfma_f32_16x16x32_bf16 v[108:111], a[120:123], a[200:203], v[108:111]
  v_exp_f32 v225, v73
  v_exp_f32 v226, v74
  v_mfma_f32_16x16x32_bf16 v[108:111], a[124:127], a[204:207], v[108:111]
  s_waitcnt lgkmcnt(0)
  v_cvt_pk_bf16_f32 v162, v224, v225
  v_exp_f32 v227, v75
  v_mfma_f32_16x16x32_bf16 v[48:51], a[48:51], a[0:3], v[192:195]
  s_add_u32 s48, s45, 3
  v_cvt_pk_bf16_f32 v163, v226, v227
  v_exp_f32 v228, v80
  v_mfma_f32_16x16x32_bf16 v[48:51], a[52:55], a[4:7], v[48:51]
  s_cmp_ge_i32 s48, s43
  s_cselect_b64 s[8:9], -1, 0
  v_exp_f32 v229, v81
  v_mfma_f32_16x16x32_bf16 v[48:51], a[56:59], a[8:11], v[48:51]
  v_cvt_pk_bf16_f32 v168, v228, v229
  v_exp_f32 v224, v82
  v_exp_f32 v225, v83
  v_mfma_f32_16x16x32_bf16 v[48:51], a[60:63], a[12:15], v[48:51]
  v_cvt_pk_bf16_f32 v169, v224, v225
  v_exp_f32 v226, v88
  v_mfma_f32_16x16x32_bf16 v[52:55], a[48:51], a[64:67], v[196:199]
  v_exp_f32 v227, v89
  v_mfma_f32_16x16x32_bf16 v[52:55], a[52:55], a[68:71], v[52:55]
  v_cvt_pk_bf16_f32 v170, v226, v227
  v_exp_f32 v228, v90
  v_mfma_f32_16x16x32_bf16 v[52:55], a[56:59], a[72:75], v[52:55]
  ds_read_b128 a[112:115], v234 offset:12288
  v_exp_f32 v229, v91
  v_mfma_f32_16x16x32_bf16 v[52:55], a[60:63], a[76:79], v[52:55]
  ds_read_b128 a[116:119], v234 offset:13312
  v_cvt_pk_bf16_f32 v171, v228, v229
  v_exp_f32 v224, v68
  v_exp_f32 v225, v69
  v_mfma_f32_16x16x32_bf16 v[112:115], a[48:51], a[128:131], v[200:203]
  ds_read_b128 a[120:123], v234 offset:14336
  v_cvt_pk_bf16_f32 v164, v224, v225
  v_exp_f32 v226, v70
  v_mfma_f32_16x16x32_bf16 v[112:115], a[52:55], a[132:135], v[112:115]
  ds_read_b128 a[124:127], v234 offset:15360
  v_exp_f32 v227, v71
  v_mfma_f32_16x16x32_bf16 v[112:115], a[56:59], a[136:139], v[112:115]
  v_cvt_pk_bf16_f32 v165, v226, v227
  v_exp_f32 v228, v76
  v_mfma_f32_16x16x32_bf16 v[112:115], a[60:63], a[140:143], v[112:115]
  v_exp_f32 v229, v77
  v_exp_f32 v224, v78
  v_mfma_f32_16x16x32_bf16 v[216:219], a[248:251], v[160:163], 0
  v_accvgpr_write_b32 a152, 0
  v_accvgpr_write_b32 a153, 0
  v_mfma_f32_16x16x32_bf16 v[216:219], a[248:251], v[168:171], v[216:219]
  v_accvgpr_write_b32 a154, 0
  v_accvgpr_write_b32 a155, 0
  v_mfma_f32_16x16x32_bf16 v[116:119], a[48:51], a[192:195], v[204:207]
  v_cvt_pk_bf16_f32 v166, v228, v229
  v_exp_f32 v225, v79
  v_mfma_f32_16x16x32_bf16 v[116:119], a[52:55], a[196:199], v[116:119]
  v_cvt_pk_bf16_f32 v167, v224, v225
  v_exp_f32 v226, v84
  v_mfma_f32_16x16x32_bf16 v[116:119], a[56:59], a[200:203], v[116:119]
  v_exp_f32 v227, v85
  v_mfma_f32_16x16x32_bf16 v[116:119], a[60:63], a[204:207], v[116:119]
  s_waitcnt lgkmcnt(0)
  v_cvt_pk_bf16_f32 v172, v226, v227
  v_exp_f32 v228, v86
  v_exp_f32 v229, v87
  v_mfma_f32_16x16x32_bf16 v[56:59], a[112:115], a[0:3], v[192:195]
  s_add_u32 s50, s50, 16384
  v_cvt_pk_bf16_f32 v173, v228, v229
  v_exp_f32 v224, v92
  v_mfma_f32_16x16x32_bf16 v[56:59], a[116:119], a[4:7], v[56:59]
  s_cmp_ge_u32 s50, 81920
  s_cselect_b32 s50, 0, s50
  v_exp_f32 v225, v93
  v_mfma_f32_16x16x32_bf16 v[56:59], a[120:123], a[8:11], v[56:59]
  v_add_u32 v234, s50, v252
  v_exp_f32 v226, v94
  v_mfma_f32_16x16x32_bf16 v[56:59], a[124:127], a[12:15], v[56:59]
  v_exp_f32 v227, v95
  v_mfma_f32_16x16x32_bf16 v[60:63], a[112:115], a[64:67], v[196:199]
  ds_read_b128 a[48:51], v234 offset:0
  v_cvt_pk_bf16_f32 v174, v224, v225
  v_mfma_f32_16x16x32_bf16 v[60:63], a[116:119], a[68:71], v[60:63]
  v_cvt_pk_bf16_f32 v175, v226, v227
  v_accvgpr_write_b32 a156, 0
  v_mfma_f32_16x16x32_bf16 v[60:63], a[120:123], a[72:75], v[60:63]
  ds_read_b128 a[52:55], v234 offset:1024
  v_accvgpr_write_b32 a157, 0
  v_mfma_f32_16x16x32_bf16 v[60:63], a[124:127], a[76:79], v[60:63]
  v_accvgpr_write_b32 a158, 0
  v_accvgpr_write_b32 a159, 0
  v_mfma_f32_16x16x32_bf16 v[220:223], a[248:251], v[164:167], 0
  v_accvgpr_write_b32 a160, 0
  v_accvgpr_write_b32 a161, 0
  v_mfma_f32_16x16x32_bf16 v[220:223], a[248:251], v[172:175], v[220:223]
  v_accvgpr_write_b32 a162, 0
  v_accvgpr_write_b32 a163, 0
  v_mfma_f32_16x16x32_bf16 v[120:123], a[112:115], a[128:131], v[200:203]
  ds_read_b128 a[56:59], v234 offset:2048
  v_accvgpr_write_b32 a164, 0
  v_mfma_f32_16x16x32_bf16 v[120:123], a[116:119], a[132:135], v[120:123]
  v_accvgpr_write_b32 a165, 0
  v_accvgpr_write_b32 a166, 0
  v_mfma_f32_16x16x32_bf16 v[120:123], a[120:123], a[136:139], v[120:123]
  ds_read_b128 a[60:63], v234 offset:3072
  v_accvgpr_write_b32 a167, 0
  v_mfma_f32_16x16x32_bf16 v[120:123], a[124:127], a[140:143], v[120:123]
  v_accvgpr_write_b32 a168, 0
  v_accvgpr_write_b32 a169, 0
  v_max3_f32 v242, v208, v212, v216
  v_mfma_f32_16x16x32_bf16 v[124:127], a[112:115], a[192:195], v[204:207]
  v_accvgpr_write_b32 a170, 0
  v_accvgpr_write_b32 a171, 0
  v_max_f32 v242, v242, v220
  v_mfma_f32_16x16x32_bf16 v[124:127], a[116:119], a[196:199], v[124:127]
  ds_read_b128 a[112:115], v234 offset:4096
  v_accvgpr_write_b32 a172, 0
  v_cmp_ngt_f32 vcc, 0x4b800000, v242
  v_mfma_f32_16x16x32_bf16 v[124:127], a[120:123], a[200:203], v[124:127]
  v_accvgpr_write_b32 a173, 0
  v_accvgpr_write_b32 a174, 0
  v_mfma_f32_16x16x32_bf16 v[124:127], a[124:127], a[204:207], v[124:127]
  v_accvgpr_write_b32 a175, 0
  v_accvgpr_write_b32 a208, 0
  v_accvgpr_write_b32 a209, 0
  v_accvgpr_write_b32 a210, 0
  v_accvgpr_write_b32 a211, 0
  v_accvgpr_write_b32 a212, 0
  v_accvgpr_write_b32 a213, 0
  v_accvgpr_write_b32 a214, 0
  v_accvgpr_write_b32 a215, 0
  v_accvgpr_write_b32 a216, 0
  v_accvgpr_write_b32 a217, 0
  v_accvgpr_write_b32 a218, 0
  v_accvgpr_write_b32 a219, 0
  v_accvgpr_write_b32 a220, 0
  v_accvgpr_write_b32 a221, 0
  v_accvgpr_write_b32 a222, 0
  v_accvgpr_write_b32 a223, 0
  v_accvgpr_write_b32 a224, 0
  v_accvgpr_write_b32 a225, 0
  v_accvgpr_write_b32 a226, 0
  v_accvgpr_write_b32 a227, 0
  v_accvgpr_write_b32 a228, 0
  v_accvgpr_write_b32 a229, 0
  v_accvgpr_write_b32 a230, 0
  v_accvgpr_write_b32 a231, 0
  v_accvgpr_write_b32 a232, 0
  v_accvgpr_write_b32 a233, 0
  v_accvgpr_write_b32 a234, 0
  v_accvgpr_write_b32 a235, 0
  v_accvgpr_write_b32 a236, 0
  v_accvgpr_write_b32 a237, 0
  v_accvgpr_write_b32 a238, 0
  v_accvgpr_write_b32 a239, 0
  s_or_b64 vcc, vcc, s[8:9]
  s_cbranch_vccnz L_stub2
L_back2:
  s_add_u32 s45, s45, 1
  s_waitcnt vmcnt(0)
  s_barrier
  s_cmp_le_u32 s43, 2
  s_cbranch_scc1 L_TX
L_TD:
  s_waitcnt lgkmcnt(1)
  v_mfma_f32_16x16x32_bf16 v[0:3], a[48:51], a[0:3], v[192:195]
  s_mov_b32 m0, s55
  v_add_u32 v235, s51, v238
  v_exp_f32 v224, v32
  v_mfma_f32_16x16x32_bf16 v[0:3], a[52:55], a[4:7], v[0:3]
  s_add_u32 s51, s51, 16384
  v_exp_f32 v225, v33
  v_mfma_f32_16x16x32_bf16 v[0:3], a[56:59], a[8:11], v[0:3]
  s_and_b32 s51, s51, 0xffff
  v_cvt_pk_bf16_f32 v144, v224, v225
  s_add_u32 s49, s55, 16384
  buffer_load_dwordx4 v239, s[32:35], s53 offen offset:0 sc1 lds
  v_mfma_f32_16x16x32_bf16 v[0:3], a[60:63], a[12:15], v[0:3]
  v_exp_f32 v226, v34
  v_mfma_f32_16x16x32_bf16 v[4:7], a[48:51], a[64:67], v[196:199]
  ds_read_b128 a[116:119], v234 offset:5120
  v_add_f32 v230, v230, v208
  v_mfma_f32_16x16x32_bf16 v[4:7], a[52:55], a[68:71], v[4:7]
  v_exp_f32 v227, v35
  v_mfma_f32_16x16x32_bf16 v[4:7], a[56:59], a[72:75], v[4:7]
  ds_read_b128 a[120:123], v234 offset:6144
  v_cvt_pk_bf16_f32 v145, v226, v227
  v_mfma_f32_16x16x32_bf16 v[4:7], a[60:63], a[76:79], v[4:7]
  v_exp_f32 v228, v40
  v_mfma_f32_16x16x32_bf16 v[64:67], a[48:51], a[128:131], v[200:203]
  ds_read_b128 a[124:127], v234 offset:7168
  v_mfma_f32_16x16x32_bf16 v[64:67], a[52:55], a[132:135], v[64:67]
  v_exp_f32 v229, v41
  v_mfma_f32_16x16x32_bf16 v[64:67], a[56:59], a[136:139], v[64:67]
  v_exp_f32 v224, v42
  v_mfma_f32_16x16x32_bf16 v[64:67], a[60:63], a[140:143], v[64:67]
  v_cvt_pk_bf16_f32 v146, v228, v229
  v_mfma_f32_16x16x32_bf16 v[68:71], a[48:51], a[192:195], v[204:207]
  v_exp_f32 v225, v43
  v_mfma_f32_16x16x32_bf16 v[68:71], a[52:55], a[196:199], v[68:71]
  v_cvt_pk_bf16_f32 v147, v224, v225
  v_mfma_f32_16x16x32_bf16 v[68:71], a[56:59], a[200:203], v[68:71]
  v_exp_f32 v226, v48
  v_mfma_f32_16x16x32_bf16 v[68:71], a[60:63], a[204:207], v[68:71]
  s_waitcnt lgkmcnt(0)
  buffer_load_dwordx4 v239, s[32:35], s53 offen offset:1024 sc1 lds
  v_mfma_f32_16x16x32_bf16 v[8:11], a[112:115], a[0:3], v[192:195]
  v_exp_f32 v227, v49
  v_mfma_f32_16x16x32_bf16 v[8:11], a[116:119], a[4:7], v[8:11]
  ds_read_b128 a[48:51], v234 offset:8192
  v_cvt_pk_bf16_f32 v152, v226, v227
  v_mfma_f32_16x16x32_bf16 v[8:11], a[120:123], a[8:11], v[8:11]
  v_exp_f32 v228, v50
  v_mfma_f32_16x16x32_bf16 v[8:11], a[124:127], a[12:15], v[8:11]
  v_exp_f32 v229, v51
  v_mfma_f32_16x16x32_bf16 v[12:15], a[112:115], a[64:67], v[196:199]
  ds_read_b128 a[52:55], v234 offset:9216
  v_cvt_pk_bf16_f32 v153, v228, v229
  v_mfma_f32_16x16x32_bf16 v[12:15], a[116:119], a[68:71], v[12:15]
  v_exp_f32 v224, v56
  v_mfma_f32_16x16x32_bf16 v[12:15], a[120:123], a[72:75], v[12:15]
  ds_read_b128 a[56:59], v234 offset:10240
  buffer_load_dwordx4 v239, s[32:35], s53 offen offset:2048 sc1 lds
  v_mfma_f32_16x16x32_bf16 v[12:15], a[124:127], a[76:79], v[12:15]
  v_exp_f32 v225, v57
  v_mfma_f32_16x16x32_bf16 v[72:75], a[112:115], a[128:131], v[200:203]
  ds_read_b128 a[60:63], v234 offset:11264
  v_cvt_pk_bf16_f32 v154, v224, v225
  v_mfma_f32_16x16x32_bf16 v[72:75], a[116:119], a[132:135], v[72:75]
  v_exp_f32 v226, v58
  v_mfma_f32_16x16x32_bf16 v[72:75], a[120:123], a[136:139], v[72:75]
  buffer_load_dwordx4 v239, s[32:35], s53 offen offset:3072 sc1 lds
  v_mfma_f32_16x16x32_bf16 v[72:75], a[124:127], a[140:143], v[72:75]
  s_add_u32 s53, s53, 16384
  v_exp_f32 v227, v59
  v_mfma_f32_16x16x32_bf16 v[76:79], a[112:115], a[192:195], v[204:207]
  s_cmp_ge_u32 s49, 147456
  s_cselect_b32 s55, s6, s49
  v_cvt_pk_bf16_f32 v155, v226, v227
  v_mfma_f32_16x16x32_bf16 v[76:79], a[116:119], a[196:199], v[76:79]
  s_mov_b32 m0, s54
  v_exp_f32 v228, v36
  v_mfma_f32_16x16x32_bf16 v[76:79], a[120:123], a[200:203], v[76:79]
  s_add_u32 s49, s54, 16384
  v_exp_f32 v229, v37
  v_mfma_f32_16x16x32_bf16 v[76:79], a[124:127], a[204:207], v[76:79]
  v_cvt_pk_bf16_f32 v148, v228, v229
  v_mfma_f32_16x16x32_bf16 v[208:211], a[248:251], v[144:147], 0
  buffer_load_dwordx4 v239, s[28:31], s52 offen offset:0 sc1 lds
  v_mfma_f32_16x16x32_bf16 v[208:211], a[248:251], v[152:155], v[208:211]
  s_waitcnt lgkmcnt(0)
  v_add_f32 v231, v231, v212
  v_mfma_f32_16x16x32_bf16 v[16:19], a[48:51], a[0:3], v[192:195]
  v_exp_f32 v224, v38
  v_mfma_f32_16x16x32_bf16 v[16:19], a[52:55], a[4:7], v[16:19]
  ds_read_b128 a[112:115], v234 offset:12288
  v_mfma_f32_16x16x32_bf16 v[16:19], a[56:59], a[8:11], v[16:19]
  v_exp_f32 v225, v39
  v_mfma_f32_16x16x32_bf16 v[16:19], a[60:63], a[12:15], v[16:19]
  ds_read_b128 a[116:119], v234 offset:13312
  v_cvt_pk_bf16_f32 v149, v224, v225
  v_mfma_f32_16x16x32_bf16 v[20:23], a[48:51], a[64:67], v[196:199]
  v_exp_f32 v226, v44
  v_mfma_f32_16x16x32_bf16 v[20:23], a[52:55], a[68:71], v[20:23]
  ds_read_b128 a[120:123], v234 offset:14336
  buffer_load_dwordx4 v239, s[28:31], s52 offen offset:1024 sc1 lds
  v_mfma_f32_16x16x32_bf16 v[20:23], a[56:59], a[72:75], v[20:23]
  v_exp_f32 v227, v45
  v_mfma_f32_16x16x32_bf16 v[20:23], a[60:63], a[76:79], v[20:23]
  v_exp_f32 v228, v46
  v_mfma_f32_16x16x32_bf16 v[80:83], a[48:51], a[128:131], v[200:203]
  ds_read_b128 a[124:127], v234 offset:15360
  v_cvt_pk_bf16_f32 v150, v226, v227
  v_mfma_f32_16x16x32_bf16 v[80:83], a[52:55], a[132:135], v[80:83]
  v_exp_f32 v229, v47
  v_mfma_f32_16x16x32_bf16 v[80:83], a[56:59], a[136:139], v[80:83]
  v_cvt_pk_bf16_f32 v151, v228, v229
  v_mfma_f32_16x16x32_bf16 v[80:83], a[60:63], a[140:143], v[80:83]
  v_exp_f32 v224, v52
  v_mfma_f32_16x16x32_bf16 v[84:87], a[48:51], a[192:195], v[204:207]
  buffer_load_dwordx4 v239, s[28:31], s52 offen offset:2048 sc1 lds
  v_mfma_f32_16x16x32_bf16 v[84:87], a[52:55], a[196:199], v[84:87]
  v_exp_f32 v225, v53
  v_mfma_f32_16x16x32_bf16 v[84:87], a[56:59], a[200:203], v[84:87]
  v_cvt_pk_bf16_f32 v156, v224, v225
  v_mfma_f32_16x16x32_bf16 v[84:87], a[60:63], a[204:207], v[84:87]
  s_waitcnt lgkmcnt(0)
  v_exp_f32 v226, v54
  v_mfma_f32_16x16x32_bf16 v[24:27], a[112:115], a[0:3], v[192:195]
  v_exp_f32 v227, v55
  v_mfma_f32_16x16x32_bf16 v[24:27], a[116:119], a[4:7], v[24:27]
  v_cvt_pk_bf16_f32 v157, v226, v227
  v_mfma_f32_16x16x32_bf16 v[24:27], a[120:123], a[8:11], v[24:27]
  v_exp_f32 v228, v60
  v_mfma_f32_16x16x32_bf16 v[24:27], a[124:127], a[12:15], v[24:27]
  buffer_load_dwordx4 v239, s[28:31], s52 offen offset:3072 sc1 lds
  v_mfma_f32_16x16x32_bf16 v[28:31], a[112:115], a[64:67], v[196:199]
  s_add_u32 s52, s52, 16384
  v_exp_f32 v229, v61
  v_mfma_f32_16x16x32_bf16 v[28:31], a[116:119], a[68:71], v[28:31]
  s_cmp_ge_u32 s49, 81920
  s_cselect_b32 s54, s56, s49
  v_cvt_pk_bf16_f32 v158, v228, v229
  v_mfma_f32_16x16x32_bf16 v[28:31], a[120:123], a[72:75], v[28:31]
  s_mov_b32 m0, s55
  v_exp_f32 v224, v62
  v_mfma_f32_16x16x32_bf16 v[28:31], a[124:127], a[76:79], v[28:31]
  s_add_u32 s49, s55, 16384
  ds_read_b128 a[176:179], v235 offset:0
  v_mfma_f32_16x16x32_bf16 v[88:91], a[112:115], a[128:131], v[200:203]
  v_exp_f32 v225, v63
  v_mfma_f32_16x16x32_bf16 v[88:91], a[116:119], a[132:135], v[88:91]
  ds_read_b128 a[180:183], v235 offset:1024
  v_cvt_pk_bf16_f32 v159, v224, v225
  v_mfma_f32_16x16x32_bf16 v[88:91], a[120:123], a[136:139], v[88:91]
  v_exp_f32 v226, v96
  v_mfma_f32_16x16x32_bf16 v[88:91], a[124:127], a[140:143], v[88:91]
  v_exp_f32 v227, v97
  v_mfma_f32_16x16x32_bf16 v[212:215], a[248:251], v[148:151], 0
  buffer_load_dwordx4 v239, s[32:35], s53 offen offset:0 sc1 lds
  v_mfma_f32_16x16x32_bf16 v[212:215], a[248:251], v[156:159], v[212:215]
  v_add_f32 v232, v232, v216
  v_mfma_f32_16x16x32_bf16 v[92:95], a[112:115], a[192:195], v[204:207]
  v_cvt_pk_bf16_f32 v176, v226, v227
  v_mfma_f32_16x16x32_bf16 v[92:95], a[116:119], a[196:199], v[92:95]
  v_exp_f32 v228, v98
  v_mfma_f32_16x16x32_bf16 v[92:95], a[120:123], a[200:203], v[92:95]
  ds_read_b128 a[184:187], v235 offset:2048
  v_mfma_f32_16x16x32_bf16 v[92:95], a[124:127], a[204:207], v[92:95]
  s_waitcnt lgkmcnt(1)
  v_exp_f32 v229, v99
  v_mfma_f32_16x16x32_bf16 a[16:19], a[176:179], v[128:131], a[16:19]
  s_add_u32 s48, s45, 3
  ds_read_b128 a[188:191], v235 offset:3072
  v_cvt_pk_bf16_f32 v177, v228, v229
  v_mfma_f32_16x16x32_bf16 a[16:19], a[180:183], v[136:139], a[16:19]
  s_cmp_ge_i32 s48, s43
  s_cselect_b64 s[8:9], -1, 0
  v_exp_f32 v224, v104
  v_mfma_f32_16x16x32_bf16 a[80:83], a[176:179], v[132:135], a[80:83]
  buffer_load_dwordx4 v239, s[32:35], s53 offen offset:1024 sc1 lds
  v_mfma_f32_16x16x32_bf16 a[80:83], a[180:183], v[140:143], a[80:83]
  v_exp_f32 v225, v105
  v_mfma_f32_16x16x32_bf16 a[144:147], a[176:179], v[160:163], a[144:147]
  v_exp_f32 v226, v106
  v_mfma_f32_16x16x32_bf16 a[144:147], a[180:183], v[168:171], a[144:147]
  v_cvt_pk_bf16_f32 v178, v224, v225
  v_mfma_f32_16x16x32_bf16 a[208:211], a[176:179], v[164:167], a[208:211]
  v_exp_f32 v227, v107
  v_mfma_f32_16x16x32_bf16 a[208:211], a[180:183], v[172:175], a[208:211]
  s_waitcnt lgkmcnt(0)
  ds_read_b128 a[240:243], v235 offset:4096
  v_cvt_pk_bf16_f32 v179, v226, v227
  v_mfma_f32_16x16x32_bf16 a[20:23], a[184:187], v[128:131], a[20:23]
  v_exp_f32 v228, v112
  v_mfma_f32_16x16x32_bf16 a[20:23], a[188:191], v[136:139], a[20:23]
  ds_read_b128 a[244:247], v235 offset:5120
  buffer_load_dwordx4 v239, s[32:35], s53 offen offset:2048 sc1 lds
  v_mfma_f32_16x16x32_bf16 a[84:87], a[184:187], v[132:135], a[84:87]
  v_exp_f32 v229, v113
  v_mfma_f32_16x16x32_bf16 a[84:87], a[188:191], v[140:143], a[84:87]
  v_cvt_pk_bf16_f32 v184, v228, v229
  v_mfma_f32_16x16x32_bf16 a[148:151], a[184:187], v[160:163], a[148:151]
  v_exp_f32 v224, v114
  v_mfma_f32_16x16x32_bf16 a[148:151], a[188:191], v[168:171], a[148:151]
  v_exp_f32 v225, v115
  v_mfma_f32_16x16x32_bf16 a[212:215], a[184:187], v[164:167], a[212:215]
  ds_read_b128 a[176:179], v235 offset:6144
  v_cvt_pk_bf16_f32 v185, v224, v225
  v_mfma_f32_16x16x32_bf16 a[212:215], a[188:191], v[172:175], a[212:215]
  s_waitcnt lgkmcnt(1)
  v_exp_f32 v226, v120
  v_mfma_f32_16x16x32_bf16 a[24:27], a[240:243], v[128:131], a[24:27]
  ds_read_b128 a[180:183], v235 offset:7168
  v_mfma_f32_16x16x32_bf16 a[24:27], a[244:247], v[136:139], a[24:27]
  v_exp_f32 v227, v121
  v_mfma_f32_16x16x32_bf16 a[88:91], a[240:243], v[132:135], a[88:91]
  v_cvt_pk_bf16_f32 v186, v226, v227
  v_mfma_f32_16x16x32_bf16 a[88:91], a[244:247], v[140:143], a[88:91]
  v_exp_f32 v228, v122
  v_mfma_f32_16x16x32_bf16 a[152:155], a[240:243], v[160:163], a[152:155]
  buffer_load_dwordx4 v239, s[32:35], s53 offen offset:3072 sc1 lds
  v_mfma_f32_16x16x32_bf16 a[152:155], a[244:247], v[168:171], a[152:155]
  s_add_u32 s53, s53, 16384
  v_exp_f32 v229, v123
  v_mfma_f32_16x16x32_bf16 a[216:219], a[240:243], v[164:167], a[216:219]
  s_cmp_ge_u32 s49, 147456
  s_cselect_b32 s55, s6, s49
  ds_read_b128 a[184:187], v235 offset:8192
  v_cvt_pk_bf16_f32 v187, v228, v229
  v_mfma_f32_16x16x32_bf16 a[216:219], a[244:247], v[172:175], a[216:219]
  s_mov_b32 m0, s54
  v_exp_f32 v224, v100
  v_mfma_f32_16x16x32_bf16 v[216:219], a[248:251], v[176:179], 0
  s_add_u32 s49, s54, 16384
  buffer_load_dwordx4 v239, s[28:31], s52 offen offset:0 sc1 lds
  v_mfma_f32_16x16x32_bf16 v[216:219], a[248:251], v[184:187], v[216:219]
  s_waitcnt lgkmcnt(1)
  v_add_f32 v233, v233, v220
  v_mfma_f32_16x16x32_bf16 a[28:31], a[176:179], v[128:131], a[28:31]
  v_exp_f32 v225, v101
  v_mfma_f32_16x16x32_bf16 a[28:31], a[180:183], v[136:139], a[28:31]
  ds_read_b128 a[188:191], v235 offset:9216
  v_cvt_pk_bf16_f32 v180, v224, v225
  v_mfma_f32_16x16x32_bf16 a[92:95], a[176:179], v[132:135], a[92:95]
  v_exp_f32 v226, v102
  v_mfma_f32_16x16x32_bf16 a[92:95], a[180:183], v[140:143], a[92:95]
  buffer_load_dwordx4 v239, s[28:31], s52 offen offset:1024 sc1 lds
  v_mfma_f32_16x16x32_bf16 a[156:159], a[176:179], v[160:163], a[156:159]
  v_exp_f32 v227, v103
  v_mfma_f32_16x16x32_bf16 a[156:159], a[180:183], v[168:171], a[156:159]
  ds_read_b128 a[240:243], v235 offset:10240
  v_cvt_pk_bf16_f32 v181, v226, v227
  v_mfma_f32_16x16x32_bf16 a[220:223], a[176:179], v[164:167], a[220:223]
  v_exp_f32 v228, v108
  v_mfma_f32_16x16x32_bf16 a[220:223], a[180:183], v[172:175], a[220:223]
  s_waitcnt lgkmcnt(1)
  ds_read_b128 a[244:247], v235 offset:11264
  v_mfma_f32_16x16x32_bf16 a[32:35], a[184:187], v[128:131], a[32:35]
  v_exp_f32 v229, v109
  v_mfma_f32_16x16x32_bf16 a[32:35], a[188:191], v[136:139], a[32:35]
  v_exp_f32 v224, v110
  v_mfma_f32_16x16x32_bf16 a[96:99], a[184:187], v[132:135], a[96:99]
  v_cvt_pk_bf16_f32 v182, v228, v229
  v_mfma_f32_16x16x32_bf16 a[96:99], a[188:191], v[140:143], a[96:99]
  v_exp_f32 v225, v111
  v_mfma_f32_16x16x32_bf16 a[160:163], a[184:187], v[160:163], a[160:163]
  v_cvt_pk_bf16_f32 v183, v224, v225
  buffer_load_dwordx4 v239, s[28:31], s52 offen offset:2048 sc1 lds
  v_mfma_f32_16x16x32_bf16 a[160:163], a[188:191], v[168:171], a[160:163]
  v_exp_f32 v226, v116
  v_mfma_f32_16x16x32_bf16 a[224:227], a[184:187], v[164:167], a[224:227]
  ds_read_b128 a[176:179], v235 offset:12288
  v_mfma_f32_16x16x32_bf16 a[224:227], a[188:191], v[172:175], a[224:227]
  s_waitcnt lgkmcnt(1)
  v_exp_f32 v227, v117
  v_mfma_f32_16x16x32_bf16 a[36:39], a[240:243], v[128:131], a[36:39]
  ds_read_b128 a[180:183], v235 offset:13312
  v_cvt_pk_bf16_f32 v188, v226, v227
  v_mfma_f32_16x16x32_bf16 a[36:39], a[244:247], v[136:139], a[36:39]
  v_exp_f32 v228, v118
  v_mfma_f32_16x16x32_bf16 a[100:103], a[240:243], v[132:135], a[100:103]
  v_exp_f32 v229, v119
  v_mfma_f32_16x16x32_bf16 a[100:103], a[244:247], v[140:143], a[100:103]
  v_cvt_pk_bf16_f32 v189, v228, v229
  v_mfma_f32_16x16x32_bf16 a[164:167], a[240:243], v[160:163], a[164:167]
  v_exp_f32 v224, v124
  v_mfma_f32_16x16x32_bf16 a[164:167], a[244:247], v[168:171], a[164:167]
  buffer_load_dwordx4 v239, s[28:31], s52 offen offset:3072 sc1 lds
  v_mfma_f32_16x16x32_bf16 a[228:231], a[240:243], v[164:167], a[228:231]
  s_add_u32 s52, s52, 16384
  v_exp_f32 v225, v125
  v_mfma_f32_16x16x32_bf16 a[228:231], a[244:247], v[172:175], a[228:231]
  s_cmp_ge_u32 s49, 81920
  s_cselect_b32 s54, s56, s49
  ds_read_b128 a[184:187], v235 offset:14336
  v_cvt_pk_bf16_f32 v190, v224, v225
  s_waitcnt lgkmcnt(1)
  v_mfma_f32_16x16x32_bf16 a[40:43], a[176:179], v[128:131], a[40:43]
  s_add_u32 s50, s50, 16384
  v_exp_f32 v226, v126
  v_mfma_f32_16x16x32_bf16 a[40:43], a[180:183], v[136:139], a[40:43]
  s_cmp_ge_u32 s50, 81920
  s_cselect_b32 s50, 0, s50
  ds_read_b128 a[188:191], v235 offset:15360
  v_mfma_f32_16x16x32_bf16 a[104:107], a[176:179], v[132:135], a[104:107]
  v_add_u32 v234, s50, v252
  v_exp_f32 v227, v127
  v_mfma_f32_16x16x32_bf16 a[104:107], a[180:183], v[140:143], a[104:107]
  v_cvt_pk_bf16_f32 v191, v226, v227
  v_mfma_f32_16x16x32_bf16 a[168:171], a[176:179], v[160:163], a[168:171]
  ds_read_b128 a[48:51], v234 offset:0
  v_mfma_f32_16x16x32_bf16 a[168:171], a[180:183], v[168:171], a[168:171]
  v_mfma_f32_16x16x32_bf16 v[220:223], a[248:251], v[180:183], 0
  v_mfma_f32_16x16x32_bf16 v[220:223], a[248:251], v[188:191], v[220:223]
  v_mfma_f32_16x16x32_bf16 a[232:235], a[176:179], v[164:167], a[232:235]
  ds_read_b128 a[52:55], v234 offset:1024
  v_mfma_f32_16x16x32_bf16 a[232:235], a[180:183], v[172:175], a[232:235]
  s_waitcnt lgkmcnt(2)
  v_mfma_f32_16x16x32_bf16 a[44:47], a[184:187], v[128:131], a[44:47]
  ds_read_b128 a[56:59], v234 offset:2048
  v_mfma_f32_16x16x32_bf16 a[44:47], a[188:191], v[136:139], a[44:47]
  v_max3_f32 v242, v208, v212, v216
  v_mfma_f32_16x16x32_bf16 a[108:111], a[184:187], v[132:135], a[108:111]
  ds_read_b128 a[60:63], v234 offset:3072
  v_max_f32 v242, v242, v220
  v_mfma_f32_16x16x32_bf16 a[108:111], a[188:191], v[140:143], a[108:111]
  v_cmp_ngt_f32 vcc, 0x4b800000, v242
  v_mfma_f32_16x16x32_bf16 a[172:175], a[184:187], v[160:163], a[172:175]
  ds_read_b128 a[112:115], v234 offset:4096
  v_mfma_f32_16x16x32_bf16 a[172:175], a[188:191], v[168:171], a[172:175]
  v_mfma_f32_16x16x32_bf16 a[236:239], a[184:187], v[164:167], a[236:239]
  v_mfma_f32_16x16x32_bf16 a[236:239], a[188:191], v[172:175], a[236:239]
  s_or_b64 vcc, vcc, s[8:9]
  s_cbranch_vccnz L_stub3
L_back3:
  s_add_u32 s45, s45, 1
  s_waitcnt lgkmcnt(1)
  v_mfma_f32_16x16x32_bf16 v[32:35], a[48:51], a[0:3], v[192:195]
  v_add_u32 v235, s51, v238
  v_exp_f32 v224, v0
  v_mfma_f32_16x16x32_bf16 v[32:35], a[52:55], a[4:7], v[32:35]
  s_add_u32 s51, s51, 16384
  v_exp_f32 v225, v1
  v_mfma_f32_16x16x32_bf16 v[32:35], a[56:59], a[8:11], v[32:35]
  s_and_b32 s51, s51, 0xffff
  v_cvt_pk_bf16_f32 v128, v224, v225
  v_mfma_f32_16x16x32_bf16 v[32:35], a[60:63], a[12:15], v[32:35]
  v_exp_f32 v226, v2
  v_mfma_f32_16x16x32_bf16 v[36:39], a[48:51], a[64:67], v[196:199]
  ds_read_b128 a[116:119], v234 offset:5120
  v_mfma_f32_16x16x32_bf16 v[36:39], a[52:55], a[68:71], v[36:39]
  v_exp_f32 v227, v3
  v_mfma_f32_16x16x32_bf16 v[36:39], a[56:59], a[72:75], v[36:39]
  ds_read_b128 a[120:123], v234 offset:6144
  v_cvt_pk_bf16_f32 v129, v226, v227
  v_mfma_f32_16x16x32_bf16 v[36:39], a[60:63], a[76:79], v[36:39]
  v_exp_f32 v228, v8
  v_mfma_f32_16x16x32_bf16 v[96:99], a[48:51], a[128:131], v[200:203]
  ds_read_b128 a[124:127], v234 offset:7168
  v_mfma_f32_16x16x32_bf16 v[96:99], a[52:55], a[132:135], v[96:99]
  v_exp_f32 v229, v9
  v_mfma_f32_16x16x32_bf16 v[96:99], a[56:59], a[136:139], v[96:99]
  v_exp_f32 v224, v10
  v_mfma_f32_16x16x32_bf16 v[96:99], a[60:63], a[140:143], v[96:99]
  v_cvt_pk_bf16_f32 v130, v228, v229
  v_mfma_f32_16x16x32_bf16 v[100:103], a[48:51], a[192:195], v[204:207]
  v_exp_f32 v225, v11
  v_mfma_f32_16x16x32_bf16 v[100:103], a[52:55], a[196:199], v[100:103]
  v_cvt_pk_bf16_f32 v131, v224, v225
  v_mfma_f32_16x16x32_bf16 v[100:103], a[56:59], a[200:203], v[100:103]
  v_exp_f32 v226, v16
  v_mfma_f32_16x16x32_bf16 v[100:103], a[60:63], a[204:207], v[100:103]
  s_waitcnt lgkmcnt(0)
  v_add_f32 v230, v230, v208
  v_mfma_f32_16x16x32_bf16 v[40:43], a[112:115], a[0:3], v[192:195]
  v_exp_f32 v227, v17
  v_mfma_f32_16x16x32_bf16 v[40:43], a[116:119], a[4:7], v[40:43]
  ds_read_b128 a[48:51], v234 offset:8192
  v_cvt_pk_bf16_f32 v136, v226, v227
  v_mfma_f32_16x16x32_bf16 v[40:43], a[120:123], a[8:11], v[40:43]
  v_exp_f32 v228, v18
  v_mfma_f32_16x16x32_bf16 v[40:43], a[124:127], a[12:15], v[40:43]
  v_exp_f32 v229, v19
  v_mfma_f32_16x16x32_bf16 v[44:47], a[112:115], a[64:67], v[196:199]
  ds_read_b128 a[52:55], v234 offset:9216
  v_cvt_pk_bf16_f32 v137, v228, v229
  v_mfma_f32_16x16x32_bf16 v[44:47], a[116:119], a[68:71], v[44:47]
  v_exp_f32 v224, v24
  v_mfma_f32_16x16x32_bf16 v[44:47], a[120:123], a[72:75], v[44:47]
  ds_read_b128 a[56:59], v234 offset:10240
  v_mfma_f32_16x16x32_bf16 v[44:47], a[124:127], a[76:79], v[44:47]
  v_exp_f32 v225, v25
  v_mfma_f32_16x16x32_bf16 v[104:107], a[112:115], a[128:131], v[200:203]
  ds_read_b128 a[60:63], v234 offset:11264
  v_cvt_pk_bf16_f32 v138, v224, v225
  v_mfma_f32_16x16x32_bf16 v[104:107], a[116:119], a[132:135], v[104:107]
  v_exp_f32 v226, v26
  v_mfma_f32_16x16x32_bf16 v[104:107], a[120:123], a[136:139], v[104:107]
  v_add_f32 v231, v231, v212
  v_mfma_f32_16x16x32_bf16 v[104:107], a[124:127], a[140:143], v[104:107]
  v_exp_f32 v227, v27
  v_mfma_f32_16x16x32_bf16 v[108:111], a[112:115], a[192:195], v[204:207]
  v_cvt_pk_bf16_f32 v139, v226, v227
  v_mfma_f32_16x16x32_bf16 v[108:111], a[116:119], a[196:199], v[108:111]
  v_exp_f32 v228, v4
  v_mfma_f32_16x16x32_bf16 v[108:111], a[120:123], a[200:203], v[108:111]
  v_exp_f32 v229, v5
  v_mfma_f32_16x16x32_bf16 v[108:111], a[124:127], a[204:207], v[108:111]
  v_cvt_pk_bf16_f32 v132, v228, v229
  v_mfma_f32_16x16x32_bf16 v[208:211], a[248:251], v[128:131], 0
  v_add_f32 v232, v232, v216
  v_mfma_f32_16x16x32_bf16 v[208:211], a[248:251], v[136:139], v[208:211]
  s_waitcnt lgkmcnt(0)
  v_add_f32 v233, v233, v220
  v_mfma_f32_16x16x32_bf16 v[48:51], a[48:51], a[0:3], v[192:195]
  v_exp_f32 v224, v6
  v_mfma_f32_16x16x32_bf16 v[48:51], a[52:55], a[4:7], v[48:51]
  ds_read_b128 a[112:115], v234 offset:12288
  v_mfma_f32_16x16x32_bf16 v[48:51], a[56:59], a[8:11], v[48:51]
  v_exp_f32 v225, v7
  v_mfma_f32_16x16x32_bf16 v[48:51], a[60:63], a[12:15], v[48:51]
  ds_read_b128 a[116:119], v234 offset:13312
  v_cvt_pk_bf16_f32 v133, v224, v225
  v_mfma_f32_16x16x32_bf16 v[52:55], a[48:51], a[64:67], v[196:199]
  v_exp_f32 v226, v12
  v_mfma_f32_16x16x32_bf16 v[52:55], a[52:55], a[68:71], v[52:55]
  ds_read_b128 a[120:123], v234 offset:14336
  v_mfma_f32_16x16x32_bf16 v[52:55], a[56:59], a[72:75], v[52:55]
  v_exp_f32 v227, v13
  v_mfma_f32_16x16x32_bf16 v[52:55], a[60:63], a[76:79], v[52:55]
  v_exp_f32 v228, v14
  v_mfma_f32_16x16x32_bf16 v[112:115], a[48:51], a[128:131], v[200:203]
  ds_read_b128 a[124:127], v234 offset:15360
  v_cvt_pk_bf16_f32 v134, v226, v227
  v_mfma_f32_16x16x32_bf16 v[112:115], a[52:55], a[132:135], v[112:115]
  v_exp_f32 v229, v15
  v_mfma_f32_16x16x32_bf16 v[112:115], a[56:59], a[136:139], v[112:115]
  v_cvt_pk_bf16_f32 v135, v228, v229
  v_mfma_f32_16x16x32_bf16 v[112:115], a[60:63], a[140:143], v[112:115]
  v_exp_f32 v224, v20
  v_mfma_f32_16x16x32_bf16 v[116:119], a[48:51], a[192:195], v[204:207]
  v_mfma_f32_16x16x32_bf16 v[116:119], a[52:55], a[196:199], v[116:119]
  v_exp_f32 v225, v21
  v_mfma_f32_16x16x32_bf16 v[116:119], a[56:59], a[200:203], v[116:119]
  v_cvt_pk_bf16_f32 v140, v224, v225
  v_mfma_f32_16x16x32_bf16 v[116:119], a[60:63], a[204:207], v[116:119]
  s_waitcnt lgkmcnt(0)
  v_exp_f32 v226, v22
  v_mfma_f32_16x16x32_bf16 v[56:59], a[112:115], a[0:3], v[192:195]
  v_exp_f32 v227, v23
  v_mfma_f32_16x16x32_bf16 v[56:59], a[116:119], a[4:7], v[56:59]
  v_cvt_pk_bf16_f32 v141, v226, v227
  v_mfma_f32_16x16x32_bf16 v[56:59], a[120:123], a[8:11], v[56:59]
  v_exp_f32 v228, v28
  v_mfma_f32_16x16x32_bf16 v[56:59], a[124:127], a[12:15], v[56:59]
  v_mfma_f32_16x16x32_bf16 v[60:63], a[112:115], a[64:67], v[196:199]
  v_exp_f32 v229, v29
  v_mfma_f32_16x16x32_bf16 v[60:63], a[116:119], a[68:71], v[60:63]
  v_cvt_pk_bf16_f32 v142, v228, v229
  v_mfma_f32_16x16x32_bf16 v[60:63], a[120:123], a[72:75], v[60:63]
  v_exp_f32 v224, v30
  v_mfma_f32_16x16x32_bf16 v[60:63], a[124:127], a[76:79], v[60:63]
  ds_read_b128 a[176:179], v235 offset:0
  v_mfma_f32_16x16x32_bf16 v[120:123], a[112:115], a[128:131], v[200:203]
  v_exp_f32 v225, v31
  v_mfma_f32_16x16x32_bf16 v[120:123], a[116:119], a[132:135], v[120:123]
  ds_read_b128 a[180:183], v235 offset:1024
  v_cvt_pk_bf16_f32 v143, v224, v225
  v_mfma_f32_16x16x32_bf16 v[120:123], a[120:123], a[136:139], v[120:123]
  v_exp_f32 v226, v64
  v_mfma_f32_16x16x32_bf16 v[120:123], a[124:127], a[140:143], v[120:123]
  v_exp_f32 v227, v65
  v_mfma_f32_16x16x32_bf16 v[212:215], a[248:251], v[132:135], 0
  v_mfma_f32_16x16x32_bf16 v[212:215], a[248:251], v[140:143], v[212:215]
  v_mfma_f32_16x16x32_bf16 v[124:127], a[112:115], a[192:195], v[204:207]
  v_cvt_pk_bf16_f32 v160, v226, v227
  v_mfma_f32_16x16x32_bf16 v[124:127], a[116:119], a[196:199], v[124:127]
  v_exp_f32 v228, v66
  v_mfma_f32_16x16x32_bf16 v[124:127], a[120:123], a[200:203], v[124:127]
  ds_read_b128 a[184:187], v235 offset:2048
  v_mfma_f32_16x16x32_bf16 v[124:127], a[124:127], a[204:207], v[124:127]
  s_waitcnt lgkmcnt(1)
  v_exp_f32 v229, v67
  v_mfma_f32_16x16x32_bf16 a[16:19], a[176:179], v[144:147], a[16:19]
  s_add_u32 s48, s45, 3
  ds_read_b128 a[188:191], v235 offset:3072
  v_cvt_pk_bf16_f32 v161, v228, v229
  v_mfma_f32_16x16x32_bf16 a[16:19], a[180:183], v[152:155], a[16:19]
  s_cmp_ge_i32 s48, s43
  s_cselect_b64 s[8:9], -1, 0
  v_exp_f32 v224, v72
  v_mfma_f32_16x16x32_bf16 a[80:83], a[176:179], v[148:151], a[80:83]
  v_mfma_f32_16x16x32_bf16 a[80:83], a[180:183], v[156:159], a[80:83]
  v_exp_f32 v225, v73
  v_mfma_f32_16x16x32_bf16 a[144:147], a[176:179], v[176:179], a[144:147]
  v_exp_f32 v226, v74
  v_mfma_f32_16x16x32_bf16 a[144:147], a[180:183], v[184:187], a[144:147]
  v_cvt_pk_bf16_f32 v162, v224, v225
  v_mfma_f32_16x16x32_bf16 a[208:211], a[176:179], v[180:183], a[208:211]
  v_exp_f32 v227, v75
  v_mfma_f32_16x16x32_bf16 a[208:211], a[180:183], v[188:191], a[208:211]
  s_waitcnt lgkmcnt(0)
  ds_read_b128 a[240:243], v235 offset:4096
  v_cvt_pk_bf16_f32 v163, v226, v227
  v_mfma_f32_16x16x32_bf16 a[20:23], a[184:187], v[144:147], a[20:23]
  v_exp_f32 v228, v80
  v_mfma_f32_16x16x32_bf16 a[20:23], a[188:191], v[152:155], a[20:23]
  ds_read_b128 a[244:247], v235 offset:5120
  v_mfma_f32_16x16x32_bf16 a[84:87], a[184:187], v[148:151], a[84:87]
  v_exp_f32 v229, v81
  v_mfma_f32_16x16x32_bf16 a[84:87], a[188:191], v[156:159], a[84:87]
  v_cvt_pk_bf16_f32 v168, v228, v229
  v_mfma_f32_16x16x32_bf16 a[148:151], a[184:187], v[176:179], a[148:151]
  v_exp_f32 v224, v82
  v_mfma_f32_16x16x32_bf16 a[148:151], a[188:191], v[184:187], a[148:151]
  v_exp_f32 v225, v83
  v_mfma_f32_16x16x32_bf16 a[212:215], a[184:187], v[180:183], a[212:215]
  ds_read_b128 a[176:179], v235 offset:6144
  v_cvt_pk_bf16_f32 v169, v224, v225
  v_mfma_f32_16x16x32_bf16 a[212:215], a[188:191], v[188:191], a[212:215]
  s_waitcnt lgkmcnt(1)
  v_exp_f32 v226, v88
  v_mfma_f32_16x16x32_bf16 a[24:27], a[240:243], v[144:147], a[24:27]
  ds_read_b128 a[180:183], v235 offset:7168
  v_mfma_f32_16x16x32_bf16 a[24:27], a[244:247], v[152:155], a[24:27]
  v_exp_f32 v227, v89
  v_mfma_f32_16x16x32_bf16 a[88:91], a[240:243], v[148:151], a[88:91]
  v_cvt_pk_bf16_f32 v170, v226, v227
  v_mfma_f32_16x16x32_bf16 a[88:91], a[244:247], v[156:159], a[88:91]
  v_exp_f32 v228, v90
  v_mfma_f32_16x16x32_bf16 a[152:155], a[240:243], v[176:179], a[152:155]
  v_mfma_f32_16x16x32_bf16 a[152:155], a[244:247], v[184:187], a[152:155]
  v_exp_f32 v229, v91
  v_mfma_f32_16x16x32_bf16 a[216:219], a[240:243], v[180:183], a[216:219]
  ds_read_b128 a[184:187], v235 offset:8192
  v_cvt_pk_bf16_f32 v171, v228, v229
  v_mfma_f32_16x16x32_bf16 a[216:219], a[244:247], v[188:191], a[216:219]
  v_exp_f32 v224, v68
  v_mfma_f32_16x16x32_bf16 v[216:219], a[248:251], v[160:163], 0
  v_mfma_f32_16x16x32_bf16 v[216:219], a[248:251], v[168:171], v[216:219]
  s_waitcnt lgkmcnt(1)
  v_mfma_f32_16x16x32_bf16 a[28:31], a[176:179], v[144:147], a[28:31]
  v_exp_f32 v225, v69
  v_mfma_f32_16x16x32_bf16 a[28:31], a[180:183], v[152:155], a[28:31]
  ds_read_b128 a[188:191], v235 offset:9216
  v_cvt_pk_bf16_f32 v164, v224, v225
  v_mfma_f32_16x16x32_bf16 a[92:95], a[176:179], v[148:151], a[92:95]
  v_exp_f32 v226, v70
  v_mfma_f32_16x16x32_bf16 a[92:95], a[180:183], v[156:159], a[92:95]
  v_mfma_f32_16x16x32_bf16 a[156:159], a[176:179], v[176:179], a[156:159]
  v_exp_f32 v227, v71
  v_mfma_f32_16x16x32_bf16 a[156:159], a[180:183], v[184:187], a[156:159]
  ds_read_b128 a[240:243], v235 offset:10240
  v_cvt_pk_bf16_f32 v165, v226, v227
  v_mfma_f32_16x16x32_bf16 a[220:223], a[176:179], v[180:183], a[220:223]
  v_exp_f32 v228, v76
  v_mfma_f32_16x16x32_bf16 a[220:223], a[180:183], v[188:191], a[220:223]
  s_waitcnt lgkmcnt(1)
  ds_read_b128 a[244:247], v235 offset:11264
  v_mfma_f32_16x16x32_bf16 a[32:35], a[184:187], v[144:147], a[32:35]
  v_exp_f32 v229, v77
  v_mfma_f32_16x16x32_bf16 a[32:35], a[188:191], v[152:155], a[32:35]
  v_exp_f32 v224, v78
  v_mfma_f32_16x16x32_bf16 a[96:99], a[184:187], v[148:151], a[96:99]
  v_cvt_pk_bf16_f32 v166, v228, v229
  v_mfma_f32_16x16x32_bf16 a[96:99], a[188:191], v[156:159], a[96:99]
  v_exp_f32 v225, v79
  v_mfma_f32_16x16x32_bf16 a[160:163], a[184:187], v[176:179], a[160:163]
  v_cvt_pk_bf16_f32 v167, v224, v225
  v_mfma_f32_16x16x32_bf16 a[160:163], a[188:191], v[184:187], a[160:163]
  v_exp_f32 v226, v84
  v_mfma_f32_16x16x32_bf16 a[224:227], a[184:187], v[180:183], a[224:227]
  ds_read_b128 a[176:179], v235 offset:12288
  v_mfma_f32_16x16x32_bf16 a[224:227], a[188:191], v[188:191], a[224:227]
  s_waitcnt lgkmcnt(1)
  v_exp_f32 v227, v85
  v_mfma_f32_16x16x32_bf16 a[36:39], a[240:243], v[144:147], a[36:39]
  ds_read_b128 a[180:183], v235 offset:13312
  v_cvt_pk_bf16_f32 v172, v226, v227
  v_mfma_f32_16x16x32_bf16 a[36:39], a[244:247], v[152:155], a[36:39]
  v_exp_f32 v228, v86
  v_mfma_f32_16x16x32_bf16 a[100:103], a[240:243], v[148:151], a[100:103]
  v_exp_f32 v229, v87
  v_mfma_f32_16x16x32_bf16 a[100:103], a[244:247], v[156:159], a[100:103]
  v_cvt_pk_bf16_f32 v173, v228, v229
  v_mfma_f32_16x16x32_bf16 a[164:167], a[240:243], v[176:179], a[164:167]
  v_exp_f32 v224, v92
  v_mfma_f32_16x16x32_bf16 a[164:167], a[244:247], v[184:187], a[164:167]
  v_mfma_f32_16x16x32_bf16 a[228:231], a[240:243], v[180:183], a[228:231]
  v_exp_f32 v225, v93
  v_mfma_f32_16x16x32_bf16 a[228:231], a[244:247], v[188:191], a[228:231]
  s_waitcnt lgkmcnt(0)
  ds_read_b128 a[184:187], v235 offset:14336
  v_cvt_pk_bf16_f32 v174, v224, v225
  v_mfma_f32_16x16x32_bf16 a[40:43], a[176:179], v[144:147], a[40:43]
  s_add_u32 s50, s50, 16384
  v_exp_f32 v226, v94
  v_mfma_f32_16x16x32_bf16 a[40:43], a[180:183], v[152:155], a[40:43]
  s_cmp_ge_u32 s50, 81920
  s_cselect_b32 s50, 0, s50
  ds_read_b128 a[188:191], v235 offset:15360
  v_mfma_f32_16x16x32_bf16 a[104:107], a[176:179], v[148:151], a[104:107]
  v_add_u32 v234, s50, v252
  v_exp_f32 v227, v95
  v_mfma_f32_16x16x32_bf16 a[104:107], a[180:183], v[156:159], a[104:107]
  v_cvt_pk_bf16_f32 v175, v226, v227
  v_mfma_f32_16x16x32_bf16 a[168:171], a[176:179], v[176:179], a[168:171]
  ds_read_b128 a[48:51], v234 offset:0
  v_mfma_f32_16x16x32_bf16 a[168:171], a[180:183], v[184:187], a[168:171]
  v_mfma_f32_16x16x32_bf16 v[220:223], a[248:251], v[164:167], 0
  v_mfma_f32_16x16x32_bf16 v[220:223], a[248:251], v[172:175], v[220:223]
  v_mfma_f32_16x16x32_bf16 a[232:235], a[176:179], v[180:183], a[232:235]
  ds_read_b128 a[52:55], v234 offset:1024
  v_mfma_f32_16x16x32_bf16 a[232:235], a[180:183], v[188:191], a[232:235]
  s_waitcnt lgkmcnt(2)
  v_mfma_f32_16x16x32_bf16 a[44:47], a[184:187], v[144:147], a[44:47]
  ds_read_b128 a[56:59], v234 offset:2048
  v_mfma_f32_16x16x32_bf16 a[44:47], a[188:191], v[152:155], a[44:47]
  v_max3_f32 v242, v208, v212, v216
  v_mfma_f32_16x16x32_bf16 a[108:111], a[184:187], v[148:151], a[108:111]
  ds_read_b128 a[60:63], v234 offset:3072
  v_max_f32 v242, v242, v220
  v_mfma_f32_16x16x32_bf16 a[108:111], a[188:191], v[156:159], a[108:111]
  v_cmp_ngt_f32 vcc, 0x4b800000, v242
  v_mfma_f32_16x16x32_bf16 a[172:175], a[184:187], v[176:179], a[172:175]
  ds_read_b128 a[112:115], v234 offset:4096
  v_mfma_f32_16x16x32_bf16 a[172:175], a[188:191], v[184:187], a[172:175]
  v_mfma_f32_16x16x32_bf16 a[236:239], a[184:187], v[180:183], a[236:239]
  v_mfma_f32_16x16x32_bf16 a[236:239], a[188:191], v[188:191], a[236:239]
  s_or_b64 vcc, vcc, s[8:9]
  s_cbranch_vccnz L_stub4
L_back4:
  s_add_u32 s45, s45, 1
  s_waitcnt vmcnt(0)
  s_barrier
  s_add_u32 s48, s45, 1
  s_cmp_lt_u32 s48, s43
  s_cbranch_scc1 L_TD
L_TX:
  s_waitcnt lgkmcnt(1)
  v_mfma_f32_16x16x32_bf16 v[64:67], a[48:51], a[128:131], v[200:203]
  s_mov_b32 m0, s55
  v_add_u32 v235, s51, v238
  ds_read_b128 a[116:119], v234 offset:5120
  ds_read_b128 a[120:123], v234 offset:6144
  v_exp_f32 v224, v32
  v_mfma_f32_16x16x32_bf16 v[64:67], a[52:55], a[132:135], v[64:67]
  s_add_u32 s51, s51, 16384
  ds_read_b128 a[124:127], v234 offset:7168
  v_exp_f32 v225, v33
  v_mfma_f32_16x16x32_bf16 v[64:67], a[56:59], a[136:139], v[64:67]
  s_and_b32 s51, s51, 0xffff
  v_exp_f32 v226, v34
  v_mfma_f32_16x16x32_bf16 v[64:67], a[60:63], a[140:143], v[64:67]
  s_add_u32 s49, s55, 16384
  v_exp_f32 v227, v35
  v_mfma_f32_16x16x32_bf16 v[68:71], a[48:51], a[192:195], v[204:207]
  v_cvt_pk_bf16_f32 v144, v224, v225
  v_cvt_pk_bf16_f32 v145, v226, v227
  buffer_load_dwordx4 v239, s[32:35], s53 offen offset:0 sc1 lds
  v_mfma_f32_16x16x32_bf16 v[68:71], a[52:55], a[196:199], v[68:71]
  ds_read_b128 a[48:51], v234 offset:8192
  v_exp_f32 v228, v40
  v_mfma_f32_16x16x32_bf16 v[68:71], a[56:59], a[200:203], v[68:71]
  ds_read_b128 a[52:55], v234 offset:9216
  v_exp_f32 v229, v41
  v_mfma_f32_16x16x32_bf16 v[68:71], a[60:63], a[204:207], v[68:71]
  s_waitcnt lgkmcnt(2)
  ds_read_b128 a[56:59], v234 offset:10240
  v_exp_f32 v224, v42
  v_mfma_f32_16x16x32_bf16 v[72:75], a[112:115], a[128:131], v[200:203]
  ds_read_b128 a[60:63], v234 offset:11264
  v_cvt_pk_bf16_f32 v146, v228, v229
  buffer_load_dwordx4 v239, s[32:35], s53 offen offset:1024 sc1 lds
  v_mfma_f32_16x16x32_bf16 v[72:75], a[116:119], a[132:135], v[72:75]
  v_exp_f32 v225, v43
  v_mfma_f32_16x16x32_bf16 v[72:75], a[120:123], a[136:139], v[72:75]
  v_exp_f32 v226, v48
  v_mfma_f32_16x16x32_bf16 v[72:75], a[124:127], a[140:143], v[72:75]
  v_exp_f32 v227, v49
  v_mfma_f32_16x16x32_bf16 v[76:79], a[112:115], a[192:195], v[204:207]
  v_cvt_pk_bf16_f32 v147, v224, v225
  v_cvt_pk_bf16_f32 v152, v226, v227
  buffer_load_dwordx4 v239, s[32:35], s53 offen offset:2048 sc1 lds
  v_mfma_f32_16x16x32_bf16 v[76:79], a[116:119], a[196:199], v[76:79]
  ds_read_b128 a[112:115], v234 offset:12288
  v_exp_f32 v228, v50
  v_mfma_f32_16x16x32_bf16 v[76:79], a[120:123], a[200:203], v[76:79]
  ds_read_b128 a[116:119], v234 offset:13312
  v_exp_f32 v229, v51
  v_mfma_f32_16x16x32_bf16 v[76:79], a[124:127], a[204:207], v[76:79]
  s_waitcnt lgkmcnt(2)
  ds_read_b128 a[120:123], v234 offset:14336
  v_cvt_pk_bf16_f32 v153, v228, v229
  v_exp_f32 v224, v56
  v_mfma_f32_16x16x32_bf16 v[80:83], a[48:51], a[128:131], v[200:203]
  ds_read_b128 a[124:127], v234 offset:15360
  ds_read_b128 a[176:179], v235 offset:0
  v_add_f32 v230, v230, v208
  v_mfma_f32_16x16x32_bf16 v[80:83], a[52:55], a[132:135], v[80:83]
  v_exp_f32 v225, v57
  v_mfma_f32_16x16x32_bf16 v[80:83], a[56:59], a[136:139], v[80:83]
  v_exp_f32 v226, v58
  v_mfma_f32_16x16x32_bf16 v[80:83], a[60:63], a[140:143], v[80:83]
  v_exp_f32 v227, v59
  v_mfma_f32_16x16x32_bf16 v[84:87], a[48:51], a[192:195], v[204:207]
  ds_read_b128 a[180:183], v235 offset:1024
  v_cvt_pk_bf16_f32 v154, v224, v225
  v_cvt_pk_bf16_f32 v155, v226, v227
  v_mfma_f32_16x16x32_bf16 v[84:87], a[52:55], a[196:199], v[84:87]
  v_exp_f32 v228, v36
  v_mfma_f32_16x16x32_bf16 v[84:87], a[56:59], a[200:203], v[84:87]
  v_exp_f32 v229, v37
  v_mfma_f32_16x16x32_bf16 v[84:87], a[60:63], a[204:207], v[84:87]
  v_exp_f32 v224, v38
  v_mfma_f32_16x16x32_bf16 v[208:211], a[248:251], v[144:147], 0
  buffer_load_dwordx4 v239, s[32:35], s53 offen offset:3072 sc1 lds
  v_mfma_f32_16x16x32_bf16 v[208:211], a[248:251], v[152:155], v[208:211]
  s_add_u32 s53, s53, 16384
  v_add_f32 v231, v231, v212
  s_waitcnt lgkmcnt(2)
  v_mfma_f32_16x16x32_bf16 v[88:91], a[112:115], a[128:131], v[200:203]
  s_cmp_ge_u32 s49, 147456
  s_cselect_b32 s55, s6, s49
  v_exp_f32 v225, v39
  v_mfma_f32_16x16x32_bf16 v[88:91], a[116:119], a[132:135], v[88:91]
  s_mov_b32 m0, s54
  ds_read_b128 a[184:187], v235 offset:2048
  v_cvt_pk_bf16_f32 v148, v228, v229
  v_cvt_pk_bf16_f32 v149, v224, v225
  v_mfma_f32_16x16x32_bf16 v[88:91], a[120:123], a[136:139], v[88:91]
  s_add_u32 s49, s54, 16384
  v_exp_f32 v226, v44
  v_mfma_f32_16x16x32_bf16 v[88:91], a[124:127], a[140:143], v[88:91]
  v_exp_f32 v227, v45
  v_mfma_f32_16x16x32_bf16 v[92:95], a[112:115], a[192:195], v[204:207]
  v_exp_f32 v228, v46
  v_mfma_f32_16x16x32_bf16 v[92:95], a[116:119], a[196:199], v[92:95]
  ds_read_b128 a[188:191], v235 offset:3072
  v_cvt_pk_bf16_f32 v150, v226, v227
  buffer_load_dwordx4 v239, s[28:31], s52 offen offset:0 sc1 lds
  v_mfma_f32_16x16x32_bf16 v[92:95], a[120:123], a[200:203], v[92:95]
  v_exp_f32 v229, v47
  v_mfma_f32_16x16x32_bf16 v[92:95], a[124:127], a[204:207], v[92:95]
  s_waitcnt lgkmcnt(2)
  v_exp_f32 v224, v52
  v_mfma_f32_16x16x32_bf16 a[16:19], a[176:179], v[128:131], a[16:19]
  v_exp_f32 v225, v53
  v_mfma_f32_16x16x32_bf16 a[16:19], a[180:183], v[136:139], a[16:19]
  ds_read_b128 a[240:243], v235 offset:4096
  v_cvt_pk_bf16_f32 v151, v228, v229
  v_cvt_pk_bf16_f32 v156, v224, v225
  v_mfma_f32_16x16x32_bf16 a[80:83], a[176:179], v[132:135], a[80:83]
  v_exp_f32 v226, v54
  v_mfma_f32_16x16x32_bf16 a[80:83], a[180:183], v[140:143], a[80:83]
  v_exp_f32 v227, v55
  v_mfma_f32_16x16x32_bf16 a[144:147], a[176:179], v[160:163], a[144:147]
  v_exp_f32 v228, v60
  v_mfma_f32_16x16x32_bf16 a[144:147], a[180:183], v[168:171], a[144:147]
  ds_read_b128 a[244:247], v235 offset:5120
  v_cvt_pk_bf16_f32 v157, v226, v227
  buffer_load_dwordx4 v239, s[28:31], s52 offen offset:1024 sc1 lds
  v_mfma_f32_16x16x32_bf16 a[208:211], a[176:179], v[164:167], a[208:211]
  v_exp_f32 v229, v61
  v_mfma_f32_16x16x32_bf16 a[208:211], a[180:183], v[172:175], a[208:211]
  s_waitcnt lgkmcnt(2)
  v_exp_f32 v224, v62
  v_mfma_f32_16x16x32_bf16 a[20:23], a[184:187], v[128:131], a[20:23]
  v_exp_f32 v225, v63
  v_mfma_f32_16x16x32_bf16 a[20:23], a[188:191], v[136:139], a[20:23]
  ds_read_b128 a[176:179], v235 offset:6144
  v_cvt_pk_bf16_f32 v158, v228, v229
  v_cvt_pk_bf16_f32 v159, v224, v225
  v_mfma_f32_16x16x32_bf16 a[84:87], a[184:187], v[132:135], a[84:87]
  v_exp_f32 v226, v96
  v_mfma_f32_16x16x32_bf16 a[84:87], a[188:191], v[140:143], a[84:87]
  v_exp_f32 v227, v97
  v_mfma_f32_16x16x32_bf16 v[212:215], a[248:251], v[148:151], 0
  buffer_load_dwordx4 v239, s[28:31], s52 offen offset:2048 sc1 lds
  v_mfma_f32_16x16x32_bf16 v[212:215], a[248:251], v[156:159], v[212:215]
  v_add_f32 v232, v232, v216
  v_mfma_f32_16x16x32_bf16 a[148:151], a[184:187], v[160:163], a[148:151]
  v_exp_f32 v228, v98
  v_mfma_f32_16x16x32_bf16 a[148:151], a[188:191], v[168:171], a[148:151]
  v_exp_f32 v229, v99
  v_mfma_f32_16x16x32_bf16 a[212:215], a[184:187], v[164:167], a[212:215]
  ds_read_b128 a[180:183], v235 offset:7168
  v_cvt_pk_bf16_f32 v176, v226, v227
  v_cvt_pk_bf16_f32 v177, v228, v229
  v_mfma_f32_16x16x32_bf16 a[212:215], a[188:191], v[172:175], a[212:215]
  s_waitcnt lgkmcnt(2)
  v_exp_f32 v224, v104
  v_mfma_f32_16x16x32_bf16 a[24:27], a[240:243], v[128:131], a[24:27]
  s_add_u32 s48, s45, 3
  v_exp_f32 v225, v105
  v_mfma_f32_16x16x32_bf16 a[24:27], a[244:247], v[136:139], a[24:27]
  s_cmp_ge_i32 s48, s44
  s_cselect_b64 s[8:9], -1, 0
  v_exp_f32 v226, v106
  v_mfma_f32_16x16x32_bf16 a[88:91], a[240:243], v[132:135], a[88:91]
  ds_read_b128 a[184:187], v235 offset:8192
  v_cvt_pk_bf16_f32 v178, v224, v225
  buffer_load_dwordx4 v239, s[28:31], s52 offen offset:3072 sc1 lds
  v_mfma_f32_16x16x32_bf16 a[88:91], a[244:247], v[140:143], a[88:91]
  s_add_u32 s52, s52, 16384
  v_exp_f32 v227, v107
  v_mfma_f32_16x16x32_bf16 a[152:155], a[240:243], v[160:163], a[152:155]
  s_cmp_ge_u32 s49, 81920
  s_cselect_b32 s54, s56, s49
  v_exp_f32 v228, v112
  v_mfma_f32_16x16x32_bf16 a[152:155], a[244:247], v[168:171], a[152:155]
  s_mov_b32 m0, s55
  v_exp_f32 v229, v113
  v_mfma_f32_16x16x32_bf16 a[216:219], a[240:243], v[164:167], a[216:219]
  s_add_u32 s49, s55, 16384
  ds_read_b128 a[188:191], v235 offset:9216
  v_cvt_pk_bf16_f32 v179, v226, v227
  v_cvt_pk_bf16_f32 v184, v228, v229
  v_mfma_f32_16x16x32_bf16 a[216:219], a[244:247], v[172:175], a[216:219]
  s_waitcnt lgkmcnt(2)
  v_exp_f32 v224, v114
  v_mfma_f32_16x16x32_bf16 a[28:31], a[176:179], v[128:131], a[28:31]
  v_exp_f32 v225, v115
  v_mfma_f32_16x16x32_bf16 a[28:31], a[180:183], v[136:139], a[28:31]
  v_exp_f32 v226, v120
  v_mfma_f32_16x16x32_bf16 a[92:95], a[176:179], v[132:135], a[92:95]
  ds_read_b128 a[240:243], v235 offset:10240
  v_cvt_pk_bf16_f32 v185, v224, v225
  buffer_load_dwordx4 v239, s[32:35], s53 offen offset:0 sc1 lds
  v_mfma_f32_16x16x32_bf16 a[92:95], a[180:183], v[140:143], a[92:95]
  v_exp_f32 v227, v121
  v_mfma_f32_16x16x32_bf16 a[156:159], a[176:179], v[160:163], a[156:159]
  v_exp_f32 v228, v122
  v_mfma_f32_16x16x32_bf16 a[156:159], a[180:183], v[168:171], a[156:159]
  v_exp_f32 v229, v123
  v_mfma_f32_16x16x32_bf16 a[220:223], a[176:179], v[164:167], a[220:223]
  ds_read_b128 a[244:247], v235 offset:11264
  v_cvt_pk_bf16_f32 v186, v226, v227
  v_cvt_pk_bf16_f32 v187, v228, v229
  v_mfma_f32_16x16x32_bf16 a[220:223], a[180:183], v[172:175], a[220:223]
  v_exp_f32 v224, v100
  v_mfma_f32_16x16x32_bf16 v[216:219], a[248:251], v[176:179], 0
  buffer_load_dwordx4 v239, s[32:35], s53 offen offset:1024 sc1 lds
  v_mfma_f32_16x16x32_bf16 v[216:219], a[248:251], v[184:187], v[216:219]
  s_waitcnt lgkmcnt(2)
  v_add_f32 v233, v233, v220
  v_mfma_f32_16x16x32_bf16 a[32:35], a[184:187], v[128:131], a[32:35]
  v_exp_f32 v225, v101
  v_mfma_f32_16x16x32_bf16 a[32:35], a[188:191], v[136:139], a[32:35]
  v_exp_f32 v226, v102
  v_mfma_f32_16x16x32_bf16 a[96:99], a[184:187], v[132:135], a[96:99]
  v_exp_f32 v227, v103
  v_mfma_f32_16x16x32_bf16 a[96:99], a[188:191], v[140:143], a[96:99]
  ds_read_b128 a[176:179], v235 offset:12288
  v_cvt_pk_bf16_f32 v180, v224, v225
  v_cvt_pk_bf16_f32 v181, v226, v227
  buffer_load_dwordx4 v239, s[32:35], s53 offen offset:2048 sc1 lds
  v_mfma_f32_16x16x32_bf16 a[160:163], a[184:187], v[160:163], a[160:163]
  v_exp_f32 v228, v108
  v_mfma_f32_16x16x32_bf16 a[160:163], a[188:191], v[168:171], a[160:163]
  v_exp_f32 v229, v109
  v_mfma_f32_16x16x32_bf16 a[224:227], a[184:187], v[164:167], a[224:227]
  v_exp_f32 v224, v110
  v_mfma_f32_16x16x32_bf16 a[224:227], a[188:191], v[172:175], a[224:227]
  s_waitcnt lgkmcnt(1)
  ds_read_b128 a[180:183], v235 offset:13312
  v_cvt_pk_bf16_f32 v182, v228, v229
  buffer_load_dwordx4 v239, s[32:35], s53 offen offset:3072 sc1 lds
  v_mfma_f32_16x16x32_bf16 a[36:39], a[240:243], v[128:131], a[36:39]
  s_add_u32 s53, s53, 16384
  v_exp_f32 v225, v111
  v_mfma_f32_16x16x32_bf16 a[36:39], a[244:247], v[136:139], a[36:39]
  s_cmp_ge_u32 s49, 147456
  s_cselect_b32 s55, s6, s49
  v_exp_f32 v226, v116
  v_mfma_f32_16x16x32_bf16 a[100:103], a[240:243], v[132:135], a[100:103]
  s_mov_b32 m0, s54
  v_exp_f32 v227, v117
  v_mfma_f32_16x16x32_bf16 a[100:103], a[244:247], v[140:143], a[100:103]
  s_add_u32 s49, s54, 16384
  ds_read_b128 a[184:187], v235 offset:14336
  v_cvt_pk_bf16_f32 v183, v224, v225
  v_cvt_pk_bf16_f32 v188, v226, v227
  v_mfma_f32_16x16x32_bf16 a[164:167], a[240:243], v[160:163], a[164:167]
  v_exp_f32 v228, v118
  v_mfma_f32_16x16x32_bf16 a[164:167], a[244:247], v[168:171], a[164:167]
  v_exp_f32 v229, v119
  v_mfma_f32_16x16x32_bf16 a[228:231], a[240:243], v[164:167], a[228:231]
  v_exp_f32 v224, v124
  v_mfma_f32_16x16x32_bf16 a[228:231], a[244:247], v[172:175], a[228:231]
  s_waitcnt lgkmcnt(1)
  ds_read_b128 a[188:191], v235 offset:15360
  v_cvt_pk_bf16_f32 v189, v228, v229
  buffer_load_dwordx4 v239, s[28:31], s52 offen offset:0 sc1 lds
  v_mfma_f32_16x16x32_bf16 a[40:43], a[176:179], v[128:131], a[40:43]
  s_add_u32 s50, s50, 16384
  v_exp_f32 v225, v125
  v_mfma_f32_16x16x32_bf16 a[40:43], a[180:183], v[136:139], a[40:43]
  s_cmp_ge_u32 s50, 81920
  s_cselect_b32 s50, 0, s50
  v_exp_f32 v226, v126
  v_mfma_f32_16x16x32_bf16 a[104:107], a[176:179], v[132:135], a[104:107]
  v_add_u32 v234, s50, v252
  v_exp_f32 v227, v127
  v_mfma_f32_16x16x32_bf16 a[104:107], a[180:183], v[140:143], a[104:107]
  v_cvt_pk_bf16_f32 v190, v224, v225
  v_cvt_pk_bf16_f32 v191, v226, v227
  v_mfma_f32_16x16x32_bf16 a[168:171], a[176:179], v[160:163], a[168:171]
  ds_read_b128 a[48:51], v234 offset:0
  v_mfma_f32_16x16x32_bf16 a[168:171], a[180:183], v[168:171], a[168:171]
  buffer_load_dwordx4 v239, s[28:31], s52 offen offset:1024 sc1 lds
  v_mfma_f32_16x16x32_bf16 v[220:223], a[248:251], v[180:183], 0
  v_mfma_f32_16x16x32_bf16 v[220:223], a[248:251], v[188:191], v[220:223]
  buffer_load_dwordx4 v239, s[28:31], s52 offen offset:2048 sc1 lds
  v_mfma_f32_16x16x32_bf16 a[232:235], a[176:179], v[164:167], a[232:235]
  ds_read_b128 a[52:55], v234 offset:1024
  v_mfma_f32_16x16x32_bf16 a[232:235], a[180:183], v[172:175], a[232:235]
  s_waitcnt lgkmcnt(2)
  buffer_load_dwordx4 v239, s[28:31], s52 offen offset:3072 sc1 lds
  v_mfma_f32_16x16x32_bf16 a[44:47], a[184:187], v[128:131], a[44:47]
  s_add_u32 s52, s52, 16384
  ds_read_b128 a[56:59], v234 offset:2048
  v_mfma_f32_16x16x32_bf16 a[44:47], a[188:191], v[136:139], a[44:47]
  s_cmp_ge_u32 s49, 81920
  s_cselect_b32 s54, s56, s49
  v_max3_f32 v242, v208, v212, v216
  v_mfma_f32_16x16x32_bf16 a[108:111], a[184:187], v[132:135], a[108:111]
  ds_read_b128 a[60:63], v234 offset:3072
  v_max_f32 v242, v242, v220
  v_mfma_f32_16x16x32_bf16 a[108:111], a[188:191], v[140:143], a[108:111]
  v_cmp_ngt_f32 vcc, 0x4b800000, v242
  v_mfma_f32_16x16x32_bf16 a[172:175], a[184:187], v[160:163], a[172:175]
  ds_read_b128 a[112:115], v234 offset:4096
  v_mfma_f32_16x16x32_bf16 a[172:175], a[188:191], v[168:171], a[172:175]
  v_mfma_f32_16x16x32_bf16 a[236:239], a[184:187], v[164:167], a[236:239]
  v_mfma_f32_16x16x32_bf16 a[236:239], a[188:191], v[172:175], a[236:239]
  s_or_b64 vcc, vcc, s[8:9]
  s_cbranch_vccnz L_stub5
L_back5:
  s_add_u32 s45, s45, 1
  s_waitcnt lgkmcnt(1)
  v_mfma_f32_16x16x32_bf16 v[96:99], a[48:51], a[128:131], v[200:203]
  v_add_u32 v235, s51, v238
  ds_read_b128 a[116:119], v234 offset:5120
  ds_read_b128 a[120:123], v234 offset:6144
  v_exp_f32 v226, v64
  v_mfma_f32_16x16x32_bf16 v[96:99], a[52:55], a[132:135], v[96:99]
  s_add_u32 s51, s51, 16384
  ds_read_b128 a[124:127], v234 offset:7168
  v_mfma_f32_16x16x32_bf16 v[96:99], a[56:59], a[136:139], v[96:99]
  s_and_b32 s51, s51, 0xffff
  v_exp_f32 v227, v65
  v_mfma_f32_16x16x32_bf16 v[96:99], a[60:63], a[140:143], v[96:99]
  v_cvt_pk_bf16_f32 v160, v226, v227
  v_add_f32 v231, v231, v212
  v_mfma_f32_16x16x32_bf16 v[100:103], a[48:51], a[192:195], v[204:207]
  v_add_f32 v230, v230, v208
  v_add_f32 v232, v232, v216
  v_mfma_f32_16x16x32_bf16 v[100:103], a[52:55], a[196:199], v[100:103]
  ds_read_b128 a[48:51], v234 offset:8192
  v_exp_f32 v228, v66
  v_mfma_f32_16x16x32_bf16 v[100:103], a[56:59], a[200:203], v[100:103]
  ds_read_b128 a[52:55], v234 offset:9216
  v_add_f32 v233, v233, v220
  v_mfma_f32_16x16x32_bf16 v[100:103], a[60:63], a[204:207], v[100:103]
  s_waitcnt lgkmcnt(2)
  v_exp_f32 v229, v67
  v_mfma_f32_16x16x32_bf16 v[104:107], a[112:115], a[128:131], v[200:203]
  ds_read_b128 a[56:59], v234 offset:10240
  v_cvt_pk_bf16_f32 v161, v228, v229
  v_mfma_f32_16x16x32_bf16 v[104:107], a[116:119], a[132:135], v[104:107]
  ds_read_b128 a[60:63], v234 offset:11264
  v_rcp_f32 v230, v230
  v_mfma_f32_16x16x32_bf16 v[104:107], a[120:123], a[136:139], v[104:107]
  v_exp_f32 v224, v72
  v_mfma_f32_16x16x32_bf16 v[104:107], a[124:127], a[140:143], v[104:107]
  s_lshr_b32 s10, s58, 12
  v_rcp_f32 v231, v231
  s_mul_i32 s10, s10, 176128
  v_mfma_f32_16x16x32_bf16 v[108:111], a[112:115], a[192:195], v[204:207]
  s_lshl_b32 s11, s40, 12
  v_mfma_f32_16x16x32_bf16 v[108:111], a[116:119], a[196:199], v[108:111]
  s_add_u32 s10, s10, s11
  ds_read_b128 a[112:115], v234 offset:12288
  v_exp_f32 v225, v73
  v_mfma_f32_16x16x32_bf16 v[108:111], a[120:123], a[200:203], v[108:111]
  s_add_u32 s11, s10, 176128
  ds_read_b128 a[116:119], v234 offset:13312
  v_cvt_pk_bf16_f32 v162, v224, v225
  v_mfma_f32_16x16x32_bf16 v[108:111], a[124:127], a[204:207], v[108:111]
  s_waitcnt lgkmcnt(2)
  v_exp_f32 v226, v74
  v_mfma_f32_16x16x32_bf16 v[112:115], a[48:51], a[128:131], v[200:203]
  ds_read_b128 a[120:123], v234 offset:14336
  v_mfma_f32_16x16x32_bf16 v[112:115], a[52:55], a[132:135], v[112:115]
  ds_read_b128 a[124:127], v234 offset:15360
  v_mfma_f32_16x16x32_bf16 v[112:115], a[56:59], a[136:139], v[112:115]
  v_exp_f32 v227, v75
  v_mfma_f32_16x16x32_bf16 v[112:115], a[60:63], a[140:143], v[112:115]
  v_cvt_pk_bf16_f32 v163, v226, v227
  v_mfma_f32_16x16x32_bf16 v[116:119], a[48:51], a[192:195], v[204:207]
  v_mfma_f32_16x16x32_bf16 v[116:119], a[52:55], a[196:199], v[116:119]
  v_exp_f32 v228, v80
  v_mfma_f32_16x16x32_bf16 v[116:119], a[56:59], a[200:203], v[116:119]
  v_mfma_f32_16x16x32_bf16 v[116:119], a[60:63], a[204:207], v[116:119]
  s_waitcnt lgkmcnt(0)
  v_exp_f32 v229, v81
  v_mfma_f32_16x16x32_bf16 v[120:123], a[112:115], a[128:131], v[200:203]
  ds_read_b128 a[176:179], v235 offset:0
  v_cvt_pk_bf16_f32 v168, v228, v229
  v_mfma_f32_16x16x32_bf16 v[120:123], a[116:119], a[132:135], v[120:123]
  ds_read_b128 a[180:183], v235 offset:1024
  v_mfma_f32_16x16x32_bf16 v[120:123], a[120:123], a[136:139], v[120:123]
  v_exp_f32 v224, v82
  v_mfma_f32_16x16x32_bf16 v[120:123], a[124:127], a[140:143], v[120:123]
  v_mfma_f32_16x16x32_bf16 v[124:127], a[112:115], a[192:195], v[204:207]
  v_exp_f32 v225, v83
  v_mfma_f32_16x16x32_bf16 v[124:127], a[116:119], a[196:199], v[124:127]
  v_cvt_pk_bf16_f32 v169, v224, v225
  v_mfma_f32_16x16x32_bf16 v[124:127], a[120:123], a[200:203], v[124:127]
  v_mfma_f32_16x16x32_bf16 v[124:127], a[124:127], a[204:207], v[124:127]
  s_waitcnt lgkmcnt(0)
  v_exp_f32 v226, v88
  v_mfma_f32_16x16x32_bf16 a[16:19], a[176:179], v[144:147], a[16:19]
  ds_read_b128 a[184:187], v235 offset:2048
  v_mfma_f32_16x16x32_bf16 a[16:19], a[180:183], v[152:155], a[16:19]
  ds_read_b128 a[188:191], v235 offset:3072
  v_mfma_f32_16x16x32_bf16 a[80:83], a[176:179], v[148:151], a[80:83]
  v_exp_f32 v227, v89
  v_mfma_f32_16x16x32_bf16 a[80:83], a[180:183], v[156:159], a[80:83]
  v_cvt_pk_bf16_f32 v170, v226, v227
  v_mfma_f32_16x16x32_bf16 a[144:147], a[176:179], v[176:179], a[144:147]
  v_exp_f32 v228, v90
  v_mfma_f32_16x16x32_bf16 a[144:147], a[180:183], v[184:187], a[144:147]
  v_mfma_f32_16x16x32_bf16 a[208:211], a[176:179], v[180:183], a[208:211]
  v_mfma_f32_16x16x32_bf16 a[208:211], a[180:183], v[188:191], a[208:211]
  s_waitcnt lgkmcnt(0)
  v_exp_f32 v229, v91
  v_mfma_f32_16x16x32_bf16 a[20:23], a[184:187], v[144:147], a[20:23]
  ds_read_b128 a[240:243], v235 offset:4096
  v_cvt_pk_bf16_f32 v171, v228, v229
  v_mfma_f32_16x16x32_bf16 a[20:23], a[188:191], v[152:155], a[20:23]
  ds_read_b128 a[244:247], v235 offset:5120
  v_mfma_f32_16x16x32_bf16 v[216:219], a[248:251], v[160:163], 0
  v_mfma_f32_16x16x32_bf16 v[216:219], a[248:251], v[168:171], v[216:219]
  v_mfma_f32_16x16x32_bf16 a[84:87], a[184:187], v[148:151], a[84:87]
  v_exp_f32 v224, v68
  v_mfma_f32_16x16x32_bf16 a[84:87], a[188:191], v[156:159], a[84:87]
  v_mfma_f32_16x16x32_bf16 a[148:151], a[184:187], v[176:179], a[148:151]
  v_exp_f32 v225, v69
  v_mfma_f32_16x16x32_bf16 a[148:151], a[188:191], v[184:187], a[148:151]
  v_cvt_pk_bf16_f32 v164, v224, v225
  v_mfma_f32_16x16x32_bf16 a[212:215], a[184:187], v[180:183], a[212:215]
  ds_read_b128 a[176:179], v235 offset:6144
  v_mfma_f32_16x16x32_bf16 a[212:215], a[188:191], v[188:191], a[212:215]
  s_waitcnt lgkmcnt(1)
  v_exp_f32 v226, v70
  v_accvgpr_read_b32 v0, a16
  v_accvgpr_read_b32 v1, a17
  v_mfma_f32_16x16x32_bf16 a[24:27], a[240:243], v[144:147], a[24:27]
  s_add_u32 s48, s45, 3
  ds_read_b128 a[180:183], v235 offset:7168
  v_accvgpr_read_b32 v2, a18
  v_accvgpr_read_b32 v3, a19
  v_accvgpr_read_b32 v4, a20
  v_mfma_f32_16x16x32_bf16 a[24:27], a[244:247], v[152:155], a[24:27]
  s_cmp_ge_i32 s48, s44
  s_cselect_b64 s[8:9], -1, 0
  v_exp_f32 v227, v71
  v_accvgpr_read_b32 v5, a21
  v_accvgpr_read_b32 v6, a22
  v_mfma_f32_16x16x32_bf16 a[88:91], a[240:243], v[148:151], a[88:91]
  v_cvt_pk_bf16_f32 v165, v226, v227
  v_accvgpr_read_b32 v7, a23
  v_mul_f32 v0, v0, v230
  v_mfma_f32_16x16x32_bf16 a[88:91], a[244:247], v[156:159], a[88:91]
  v_mul_f32 v1, v1, v230
  v_mul_f32 v2, v2, v230
  v_mfma_f32_16x16x32_bf16 a[152:155], a[240:243], v[176:179], a[152:155]
  v_exp_f32 v228, v76
  v_mul_f32 v3, v3, v230
  v_mul_f32 v4, v4, v230
  v_mfma_f32_16x16x32_bf16 a[152:155], a[244:247], v[184:187], a[152:155]
  v_mul_f32 v5, v5, v230
  v_mul_f32 v6, v6, v230
  v_mfma_f32_16x16x32_bf16 a[216:219], a[240:243], v[180:183], a[216:219]
  ds_read_b128 a[184:187], v235 offset:8192
  v_mul_f32 v7, v7, v230
  v_cvt_pk_bf16_f32 v8, v0, v1
  v_mfma_f32_16x16x32_bf16 a[216:219], a[244:247], v[188:191], a[216:219]
  s_waitcnt lgkmcnt(1)
  v_exp_f32 v229, v77
  v_cvt_pk_bf16_f32 v9, v2, v3
  v_cvt_pk_bf16_f32 v10, v4, v5
  v_mfma_f32_16x16x32_bf16 a[28:31], a[176:179], v[144:147], a[28:31]
  ds_read_b128 a[188:191], v235 offset:9216
  v_cvt_pk_bf16_f32 v166, v228, v229
  v_cvt_pk_bf16_f32 v11, v6, v7
  v_mfma_f32_16x16x32_bf16 a[28:31], a[180:183], v[152:155], a[28:31]
  v_exp_f32 v224, v78
  buffer_store_dwordx4 v[8:11], v252, s[36:39], s10 offen offset:0 sc1
  v_mfma_f32_16x16x32_bf16 a[92:95], a[176:179], v[148:151], a[92:95]
  v_accvgpr_read_b32 v12, a80
  v_accvgpr_read_b32 v13, a81
  v_accvgpr_read_b32 v14, a82
  v_accvgpr_read_b32 v15, a83
  v_mfma_f32_16x16x32_bf16 a[92:95], a[180:183], v[156:159], a[92:95]
  v_accvgpr_read_b32 v16, a84
  v_accvgpr_read_b32 v17, a85
  v_accvgpr_read_b32 v18, a86
  v_mfma_f32_16x16x32_bf16 a[156:159], a[176:179], v[176:179], a[156:159]
  v_exp_f32 v225, v79
  v_accvgpr_read_b32 v19, a87
  v_mul_f32 v12, v12, v231
  v_mfma_f32_16x16x32_bf16 a[156:159], a[180:183], v[184:187], a[156:159]
  v_cvt_pk_bf16_f32 v167, v224, v225
  v_mul_f32 v13, v13, v231
  v_mul_f32 v14, v14, v231
  v_mfma_f32_16x16x32_bf16 a[220:223], a[176:179], v[180:183], a[220:223]
  ds_read_b128 a[240:243], v235 offset:10240
  v_mul_f32 v15, v15, v231
  v_mul_f32 v16, v16, v231
  v_mfma_f32_16x16x32_bf16 a[220:223], a[180:183], v[188:191], a[220:223]
  s_waitcnt lgkmcnt(1)
  v_exp_f32 v226, v84
  v_mul_f32 v17, v17, v231
  v_mul_f32 v18, v18, v231
  v_mfma_f32_16x16x32_bf16 a[32:35], a[184:187], v[144:147], a[32:35]
  ds_read_b128 a[244:247], v235 offset:11264
  v_mul_f32 v19, v19, v231
  v_cvt_pk_bf16_f32 v20, v12, v13
  v_accvgpr_read_b32 v24, a24
  v_mfma_f32_16x16x32_bf16 a[32:35], a[188:191], v[152:155], a[32:35]
  v_exp_f32 v227, v85
  v_cvt_pk_bf16_f32 v21, v14, v15
  v_cvt_pk_bf16_f32 v22, v16, v17
  v_mfma_f32_16x16x32_bf16 a[96:99], a[184:187], v[148:151], a[96:99]
  v_cvt_pk_bf16_f32 v172, v226, v227
  v_cvt_pk_bf16_f32 v23, v18, v19
  buffer_store_dwordx4 v[20:23], v252, s[36:39], s11 offen offset:0 sc1
  v_mfma_f32_16x16x32_bf16 a[96:99], a[188:191], v[156:159], a[96:99]
  v_accvgpr_read_b32 v25, a25
  v_accvgpr_read_b32 v26, a26
  v_accvgpr_read_b32 v27, a27
  v_accvgpr_read_b32 v28, a28
  v_mfma_f32_16x16x32_bf16 a[160:163], a[184:187], v[176:179], a[160:163]
  v_exp_f32 v228, v86
  v_accvgpr_read_b32 v29, a29
  v_accvgpr_read_b32 v30, a30
  v_mfma_f32_16x16x32_bf16 a[160:163], a[188:191], v[184:187], a[160:163]
  v_accvgpr_read_b32 v31, a31
  v_mul_f32 v24, v24, v230
  v_mul_f32 v25, v25, v230
  v_mul_f32 v26, v26, v230
  v_mfma_f32_16x16x32_bf16 a[224:227], a[184:187], v[180:183], a[224:227]
  v_exp_f32 v229, v87
  v_mul_f32 v27, v27, v230
  v_mul_f32 v28, v28, v230
  v_mfma_f32_16x16x32_bf16 a[224:227], a[188:191], v[188:191], a[224:227]
  s_waitcnt lgkmcnt(0)
  ds_read_b128 a[176:179], v235 offset:12288
  v_cvt_pk_bf16_f32 v173, v228, v229
  v_mul_f32 v29, v29, v230
  v_mul_f32 v30, v30, v230
  v_mfma_f32_16x16x32_bf16 a[36:39], a[240:243], v[144:147], a[36:39]
  ds_read_b128 a[180:183], v235 offset:13312
  v_mul_f32 v31, v31, v230
  v_cvt_pk_bf16_f32 v32, v24, v25
  v_cvt_pk_bf16_f32 v33, v26, v27
  v_mfma_f32_16x16x32_bf16 a[36:39], a[244:247], v[152:155], a[36:39]
  v_exp_f32 v224, v92
  v_cvt_pk_bf16_f32 v34, v28, v29
  v_cvt_pk_bf16_f32 v35, v30, v31
  v_mfma_f32_16x16x32_bf16 a[100:103], a[240:243], v[148:151], a[100:103]
  buffer_store_dwordx4 v[32:35], v252, s[36:39], s10 offen offset:1024 sc1
  v_accvgpr_read_b32 v36, a88
  v_accvgpr_read_b32 v37, a89
  v_mfma_f32_16x16x32_bf16 a[100:103], a[244:247], v[156:159], a[100:103]
  v_accvgpr_read_b32 v38, a90
  v_accvgpr_read_b32 v39, a91
  v_accvgpr_read_b32 v40, a92
  v_accvgpr_read_b32 v41, a93
  v_mfma_f32_16x16x32_bf16 a[164:167], a[240:243], v[176:179], a[164:167]
  v_exp_f32 v225, v93
  v_accvgpr_read_b32 v42, a94
  v_accvgpr_read_b32 v43, a95
  v_mfma_f32_16x16x32_bf16 a[164:167], a[244:247], v[184:187], a[164:167]
  v_cvt_pk_bf16_f32 v174, v224, v225
  v_mul_f32 v36, v36, v231
  v_mul_f32 v37, v37, v231
  v_mul_f32 v38, v38, v231
  v_mfma_f32_16x16x32_bf16 a[228:231], a[240:243], v[180:183], a[228:231]
  v_exp_f32 v226, v94
  v_mul_f32 v39, v39, v231
  v_mul_f32 v40, v40, v231
  v_mfma_f32_16x16x32_bf16 a[228:231], a[244:247], v[188:191], a[228:231]
  s_waitcnt lgkmcnt(0)
  ds_read_b128 a[184:187], v235 offset:14336
  v_mul_f32 v41, v41, v231
  v_mul_f32 v42, v42, v231
  v_accvgpr_read_b32 v0, a32
  v_mfma_f32_16x16x32_bf16 a[40:43], a[176:179], v[144:147], a[40:43]
  s_add_u32 s50, s50, 16384
  ds_read_b128 a[188:191], v235 offset:15360
  v_mul_f32 v43, v43, v231
  v_cvt_pk_bf16_f32 v44, v36, v37
  v_accvgpr_read_b32 v1, a33
  v_mfma_f32_16x16x32_bf16 a[40:43], a[180:183], v[152:155], a[40:43]
  s_cmp_ge_u32 s50, 81920
  s_cselect_b32 s50, 0, s50
  v_exp_f32 v227, v95
  v_cvt_pk_bf16_f32 v45, v38, v39
  v_mfma_f32_16x16x32_bf16 a[104:107], a[176:179], v[148:151], a[104:107]
  v_add_u32 v234, s50, v252
  v_cvt_pk_bf16_f32 v175, v226, v227
  v_cvt_pk_bf16_f32 v46, v40, v41
  v_cvt_pk_bf16_f32 v47, v42, v43
  v_mfma_f32_16x16x32_bf16 a[104:107], a[180:183], v[156:159], a[104:107]
  buffer_store_dwordx4 v[44:47], v252, s[36:39], s11 offen offset:1024 sc1
  v_accvgpr_read_b32 v2, a34
  v_accvgpr_read_b32 v3, a35
  v_mfma_f32_16x16x32_bf16 v[220:223], a[248:251], v[164:167], 0
  v_accvgpr_read_b32 v4, a36
  v_accvgpr_read_b32 v5, a37
  v_accvgpr_read_b32 v6, a38
  v_accvgpr_read_b32 v7, a39
  v_mfma_f32_16x16x32_bf16 v[220:223], a[248:251], v[172:175], v[220:223]
  v_mul_f32 v0, v0, v230
  v_mul_f32 v1, v1, v230
  v_mul_f32 v2, v2, v230
  v_mul_f32 v3, v3, v230
  v_mfma_f32_16x16x32_bf16 a[168:171], a[176:179], v[176:179], a[168:171]
  ds_read_b128 a[48:51], v234 offset:0
  v_mul_f32 v4, v4, v230
  v_mul_f32 v5, v5, v230
  v_mul_f32 v6, v6, v230
  v_mfma_f32_16x16x32_bf16 a[168:171], a[180:183], v[184:187], a[168:171]
  ds_read_b128 a[52:55], v234 offset:1024
  v_mul_f32 v7, v7, v230
  v_cvt_pk_bf16_f32 v8, v0, v1
  v_cvt_pk_bf16_f32 v9, v2, v3
  v_mfma_f32_16x16x32_bf16 a[232:235], a[176:179], v[180:183], a[232:235]
  ds_read_b128 a[56:59], v234 offset:2048
  v_cvt_pk_bf16_f32 v10, v4, v5
  v_cvt_pk_bf16_f32 v11, v6, v7
  v_mfma_f32_16x16x32_bf16 a[232:235], a[180:183], v[188:191], a[232:235]
  s_waitcnt lgkmcnt(3)
  ds_read_b128 a[60:63], v234 offset:3072
  buffer_store_dwordx4 v[8:11], v252, s[36:39], s10 offen offset:2048 sc1
  v_accvgpr_read_b32 v12, a96
  v_max_f32 v242, v216, v220
  v_mfma_f32_16x16x32_bf16 a[44:47], a[184:187], v[144:147], a[44:47]
  ds_read_b128 a[112:115], v234 offset:4096
  v_accvgpr_read_b32 v13, a97
  v_accvgpr_read_b32 v14, a98
  v_accvgpr_read_b32 v15, a99
  v_cmp_ngt_f32 vcc, 0x4b800000, v242
  v_mfma_f32_16x16x32_bf16 a[44:47], a[188:191], v[152:155], a[44:47]
  ds_read_b128 a[116:119], v234 offset:5120
  v_accvgpr_read_b32 v16, a100
  v_accvgpr_read_b32 v17, a101
  v_accvgpr_read_b32 v18, a102
  v_mfma_f32_16x16x32_bf16 a[108:111], a[184:187], v[148:151], a[108:111]
  ds_read_b128 a[120:123], v234 offset:6144
  v_accvgpr_read_b32 v19, a103
  v_mul_f32 v12, v12, v231
  v_mul_f32 v13, v13, v231
  v_mfma_f32_16x16x32_bf16 a[108:111], a[188:191], v[156:159], a[108:111]
  ds_read_b128 a[124:127], v234 offset:7168
  v_mul_f32 v14, v14, v231
  v_mul_f32 v15, v15, v231
  v_mul_f32 v16, v16, v231
  v_mfma_f32_16x16x32_bf16 a[172:175], a[184:187], v[176:179], a[172:175]
  ds_read_b128 a[16:19], v234 offset:8192
  v_mul_f32 v17, v17, v231
  v_mul_f32 v18, v18, v231
  v_mul_f32 v19, v19, v231
  v_mfma_f32_16x16x32_bf16 a[172:175], a[188:191], v[184:187], a[172:175]
  v_cvt_pk_bf16_f32 v20, v12, v13
  v_cvt_pk_bf16_f32 v21, v14, v15
  v_cvt_pk_bf16_f32 v22, v16, v17
  v_mfma_f32_16x16x32_bf16 a[236:239], a[184:187], v[180:183], a[236:239]
  v_cvt_pk_bf16_f32 v23, v18, v19
  buffer_store_dwordx4 v[20:23], v252, s[36:39], s11 offen offset:2048 sc1
  v_mfma_f32_16x16x32_bf16 a[236:239], a[188:191], v[188:191], a[236:239]
  s_or_b64 vcc, vcc, s[8:9]
  s_cbranch_vccnz L_stub6
L_back6:
  s_add_u32 s45, s45, 1
  v_accvgpr_read_b32 v24, a40
  v_accvgpr_read_b32 v25, a41
  v_accvgpr_read_b32 v26, a42
  v_accvgpr_read_b32 v27, a43
  v_accvgpr_read_b32 v28, a44
  v_accvgpr_read_b32 v29, a45
  v_accvgpr_read_b32 v30, a46
  v_accvgpr_read_b32 v31, a47
  v_mul_f32 v24, v24, v230
  v_mul_f32 v25, v25, v230
  v_mul_f32 v26, v26, v230
  v_mul_f32 v27, v27, v230
  v_mul_f32 v28, v28, v230
  v_mul_f32 v29, v29, v230
  v_mul_f32 v30, v30, v230
  v_mul_f32 v31, v31, v230
  v_cvt_pk_bf16_f32 v32, v24, v25
  v_cvt_pk_bf16_f32 v33, v26, v27
  v_cvt_pk_bf16_f32 v34, v28, v29
  v_cvt_pk_bf16_f32 v35, v30, v31
  buffer_store_dwordx4 v[32:35], v252, s[36:39], s10 offen offset:3072 sc1
  v_accvgpr_read_b32 v36, a104
  v_accvgpr_read_b32 v37, a105
  v_accvgpr_read_b32 v38, a106
  v_accvgpr_read_b32 v39, a107
  v_accvgpr_read_b32 v40, a108
  v_accvgpr_read_b32 v41, a109
  v_accvgpr_read_b32 v42, a110
  v_accvgpr_read_b32 v43, a111
  v_mul_f32 v36, v36, v231
  v_mul_f32 v37, v37, v231
  v_mul_f32 v38, v38, v231
  v_mul_f32 v39, v39, v231
  v_mul_f32 v40, v40, v231
  v_mul_f32 v41, v41, v231
  v_mul_f32 v42, v42, v231
  v_mul_f32 v43, v43, v231
  v_cvt_pk_bf16_f32 v44, v36, v37
  v_cvt_pk_bf16_f32 v45, v38, v39
  v_cvt_pk_bf16_f32 v46, v40, v41
  v_cvt_pk_bf16_f32 v47, v42, v43
  buffer_store_dwordx4 v[44:47], v252, s[36:39], s11 offen offset:3072 sc1
  s_waitcnt vmcnt(0)
  s_barrier
  s_cmp_lg_u32 s42, 0
  s_cbranch_scc1 L_sig_ca
  s_add_u32 s82, s4, 0x4002000
  s_addc_u32 s83, s5, 0
  s_lshl_b32 s84, s41, 7
  v_mov_b32 v246, s84
  v_mov_b32 v247, 1
  s_mov_b64 exec, 1
  global_atomic_add v246, v247, s[82:83] sc1
  s_mov_b64 exec, -1
L_sig_ca:
  s_add_u32 s48, s45, 1
  s_cmp_ge_u32 s48, s44
  s_cbranch_scc1 L_TE
L_TS:
  s_waitcnt lgkmcnt(5)
  v_mfma_f32_16x16x32_bf16 v[64:67], a[48:51], a[128:131], v[200:203]
  s_mov_b32 m0, s55
  v_exp_f32 v226, v96
  v_mfma_f32_16x16x32_bf16 v[64:67], a[52:55], a[132:135], v[64:67]
  s_add_u32 s49, s55, 16384
  v_exp_f32 v227, v97
  v_mfma_f32_16x16x32_bf16 v[64:67], a[56:59], a[136:139], v[64:67]
  ds_read_b128 a[20:23], v234 offset:9216
  v_cvt_pk_bf16_f32 v176, v226, v227
  buffer_load_dwordx4 v239, s[32:35], s53 offen offset:0 sc1 lds
  v_mfma_f32_16x16x32_bf16 v[64:67], a[60:63], a[140:143], v[64:67]
  v_exp_f32 v228, v98
  v_mfma_f32_16x16x32_bf16 v[68:71], a[48:51], a[192:195], v[204:207]
  v_add_u32 v235, s51, v238
  ds_read_b128 a[24:27], v234 offset:10240
  v_add_f32 v232, v232, v216
  v_mfma_f32_16x16x32_bf16 v[68:71], a[52:55], a[196:199], v[68:71]
  s_add_u32 s51, s51, 16384
  v_exp_f32 v229, v99
  v_mfma_f32_16x16x32_bf16 v[68:71], a[56:59], a[200:203], v[68:71]
  s_and_b32 s51, s51, 0xffff
  ds_read_b128 a[28:31], v234 offset:11264
  v_cvt_pk_bf16_f32 v177, v228, v229
  v_mfma_f32_16x16x32_bf16 v[68:71], a[60:63], a[204:207], v[68:71]
  s_waitcnt lgkmcnt(4)
  v_exp_f32 v224, v104
  v_mfma_f32_16x16x32_bf16 v[72:75], a[112:115], a[128:131], v[200:203]
  v_exp_f32 v225, v105
  v_mfma_f32_16x16x32_bf16 v[72:75], a[116:119], a[132:135], v[72:75]
  ds_read_b128 a[80:83], v234 offset:12288
  v_cvt_pk_bf16_f32 v178, v224, v225
  v_mfma_f32_16x16x32_bf16 v[72:75], a[120:123], a[136:139], v[72:75]
  v_exp_f32 v226, v106
  v_mfma_f32_16x16x32_bf16 v[72:75], a[124:127], a[140:143], v[72:75]
  ds_read_b128 a[84:87], v234 offset:13312
  buffer_load_dwordx4 v239, s[32:35], s53 offen offset:1024 sc1 lds
  v_mfma_f32_16x16x32_bf16 v[76:79], a[112:115], a[192:195], v[204:207]
  v_exp_f32 v227, v107
  v_mfma_f32_16x16x32_bf16 v[76:79], a[116:119], a[196:199], v[76:79]
  ds_read_b128 a[88:91], v234 offset:14336
  v_cvt_pk_bf16_f32 v179, v226, v227
  v_mfma_f32_16x16x32_bf16 v[76:79], a[120:123], a[200:203], v[76:79]
  v_exp_f32 v228, v112
  v_mfma_f32_16x16x32_bf16 v[76:79], a[124:127], a[204:207], v[76:79]
  s_waitcnt lgkmcnt(3)
  v_exp_f32 v229, v113
  v_mfma_f32_16x16x32_bf16 v[80:83], a[16:19], a[128:131], v[200:203]
  ds_read_b128 a[92:95], v234 offset:15360
  v_cvt_pk_bf16_f32 v184, v228, v229
  v_mfma_f32_16x16x32_bf16 v[80:83], a[20:23], a[132:135], v[80:83]
  v_exp_f32 v224, v114
  v_mfma_f32_16x16x32_bf16 v[80:83], a[24:27], a[136:139], v[80:83]
  ds_read_b128 a[176:179], v235 offset:0
  buffer_load_dwordx4 v239, s[32:35], s53 offen offset:2048 sc1 lds
  v_mfma_f32_16x16x32_bf16 v[80:83], a[28:31], a[140:143], v[80:83]
  v_exp_f32 v225, v115
  v_mfma_f32_16x16x32_bf16 v[84:87], a[16:19], a[192:195], v[204:207]
  ds_read_b128 a[180:183], v235 offset:1024
  v_cvt_pk_bf16_f32 v185, v224, v225
  v_mfma_f32_16x16x32_bf16 v[84:87], a[20:23], a[196:199], v[84:87]
  v_exp_f32 v226, v120
  v_mfma_f32_16x16x32_bf16 v[84:87], a[24:27], a[200:203], v[84:87]
  v_exp_f32 v227, v121
  v_mfma_f32_16x16x32_bf16 v[84:87], a[28:31], a[204:207], v[84:87]
  s_waitcnt lgkmcnt(2)
  ds_read_b128 a[184:187], v235 offset:2048
  v_cvt_pk_bf16_f32 v186, v226, v227
  v_mfma_f32_16x16x32_bf16 v[88:91], a[80:83], a[128:131], v[200:203]
  v_exp_f32 v228, v122
  v_mfma_f32_16x16x32_bf16 v[88:91], a[84:87], a[132:135], v[88:91]
  ds_read_b128 a[188:191], v235 offset:3072
  buffer_load_dwordx4 v239, s[32:35], s53 offen offset:3072 sc1 lds
  v_mfma_f32_16x16x32_bf16 v[88:91], a[88:91], a[136:139], v[88:91]
  s_add_u32 s53, s53, 16384
  v_exp_f32 v229, v123
  v_mfma_f32_16x16x32_bf16 v[88:91], a[92:95], a[140:143], v[88:91]
  s_cmp_ge_u32 s49, 147456
  s_cselect_b32 s55, s6, s49
  ds_read_b128 a[240:243], v235 offset:4096
  v_cvt_pk_bf16_f32 v187, v228, v229
  v_mfma_f32_16x16x32_bf16 v[92:95], a[80:83], a[192:195], v[204:207]
  s_mov_b32 m0, s54
  v_exp_f32 v224, v100
  v_mfma_f32_16x16x32_bf16 v[92:95], a[84:87], a[196:199], v[92:95]
  s_add_u32 s49, s54, 16384
  v_exp_f32 v225, v101
  v_mfma_f32_16x16x32_bf16 v[92:95], a[88:91], a[200:203], v[92:95]
  ds_read_b128 a[244:247], v235 offset:5120
  v_cvt_pk_bf16_f32 v180, v224, v225
  v_mfma_f32_16x16x32_bf16 v[92:95], a[92:95], a[204:207], v[92:95]
  v_exp_f32 v226, v102
  v_mfma_f32_16x16x32_bf16 v[216:219], a[248:251], v[176:179], 0
  buffer_load_dwordx4 v239, s[28:31], s52 offen offset:0 sc1 lds
  v_mfma_f32_16x16x32_bf16 v[216:219], a[248:251], v[184:187], v[216:219]
  s_waitcnt lgkmcnt(4)
  v_add_f32 v233, v233, v220
  v_mfma_f32_16x16x32_bf16 a[144:147], a[176:179], v[160:163], a[144:147]
  s_add_u32 s48, s45, 3
  ds_read_b128 a[32:35], v235 offset:6144
  buffer_load_dwordx4 v239, s[28:31], s52 offen offset:1024 sc1 lds
  v_mfma_f32_16x16x32_bf16 a[144:147], a[180:183], v[168:171], a[144:147]
  s_cmp_ge_i32 s48, s44
  s_cselect_b64 s[8:9], -1, 0
  v_exp_f32 v227, v103
  v_mfma_f32_16x16x32_bf16 a[208:211], a[176:179], v[164:167], a[208:211]
  ds_read_b128 a[36:39], v235 offset:7168
  v_cvt_pk_bf16_f32 v181, v226, v227
  v_mfma_f32_16x16x32_bf16 a[208:211], a[180:183], v[172:175], a[208:211]
  s_waitcnt lgkmcnt(4)
  v_exp_f32 v228, v108
  v_mfma_f32_16x16x32_bf16 a[148:151], a[184:187], v[160:163], a[148:151]
  v_exp_f32 v229, v109
  v_mfma_f32_16x16x32_bf16 a[148:151], a[188:191], v[168:171], a[148:151]
  ds_read_b128 a[40:43], v235 offset:8192
  v_cvt_pk_bf16_f32 v182, v228, v229
  v_mfma_f32_16x16x32_bf16 a[212:215], a[184:187], v[164:167], a[212:215]
  v_exp_f32 v224, v110
  v_mfma_f32_16x16x32_bf16 a[212:215], a[188:191], v[172:175], a[212:215]
  s_waitcnt lgkmcnt(3)
  ds_read_b128 a[44:47], v235 offset:9216
  buffer_load_dwordx4 v239, s[28:31], s52 offen offset:2048 sc1 lds
  v_mfma_f32_16x16x32_bf16 a[152:155], a[240:243], v[160:163], a[152:155]
  v_exp_f32 v225, v111
  v_mfma_f32_16x16x32_bf16 a[152:155], a[244:247], v[168:171], a[152:155]
  ds_read_b128 a[96:99], v235 offset:10240
  v_cvt_pk_bf16_f32 v183, v224, v225
  v_mfma_f32_16x16x32_bf16 a[216:219], a[240:243], v[164:167], a[216:219]
  v_exp_f32 v226, v116
  v_mfma_f32_16x16x32_bf16 a[216:219], a[244:247], v[172:175], a[216:219]
  s_waitcnt lgkmcnt(3)
  v_exp_f32 v227, v117
  v_mfma_f32_16x16x32_bf16 a[156:159], a[32:35], v[160:163], a[156:159]
  ds_read_b128 a[100:103], v235 offset:11264
  v_cvt_pk_bf16_f32 v188, v226, v227
  v_mfma_f32_16x16x32_bf16 a[156:159], a[36:39], v[168:171], a[156:159]
  v_exp_f32 v228, v118
  v_mfma_f32_16x16x32_bf16 a[220:223], a[32:35], v[164:167], a[220:223]
  ds_read_b128 a[176:179], v235 offset:12288
  buffer_load_dwordx4 v239, s[28:31], s52 offen offset:3072 sc1 lds
  v_mfma_f32_16x16x32_bf16 a[220:223], a[36:39], v[172:175], a[220:223]
  s_add_u32 s52, s52, 16384
  v_exp_f32 v229, v119
  s_cmp_ge_u32 s49, 81920
  s_cselect_b32 s54, s56, s49
  s_mov_b32 m0, s55
  s_waitcnt lgkmcnt(3)
  v_mfma_f32_16x16x32_bf16 a[160:163], a[40:43], v[160:163], a[160:163]
  s_add_u32 s49, s55, 16384
  ds_read_b128 a[180:183], v235 offset:13312
  v_cvt_pk_bf16_f32 v189, v228, v229
  buffer_load_dwordx4 v239, s[32:35], s53 offen offset:0 sc1 lds
  v_mfma_f32_16x16x32_bf16 a[160:163], a[44:47], v[168:171], a[160:163]
  v_exp_f32 v224, v124
  v_mfma_f32_16x16x32_bf16 a[224:227], a[40:43], v[164:167], a[224:227]
  v_exp_f32 v225, v125
  v_mfma_f32_16x16x32_bf16 a[224:227], a[44:47], v[172:175], a[224:227]
  s_waitcnt lgkmcnt(2)
  ds_read_b128 a[184:187], v235 offset:14336
  v_cvt_pk_bf16_f32 v190, v224, v225
  v_mfma_f32_16x16x32_bf16 a[164:167], a[96:99], v[160:163], a[164:167]
  s_add_u32 s50, s50, 16384
  v_exp_f32 v226, v126
  v_mfma_f32_16x16x32_bf16 a[164:167], a[100:103], v[168:171], a[164:167]
  s_cmp_ge_u32 s50, 81920
  s_cselect_b32 s50, 0, s50
  ds_read_b128 a[188:191], v235 offset:15360
  v_mfma_f32_16x16x32_bf16 a[228:231], a[96:99], v[164:167], a[228:231]
  v_add_u32 v234, s50, v252
  v_exp_f32 v227, v127
  v_mfma_f32_16x16x32_bf16 a[228:231], a[100:103], v[172:175], a[228:231]
  s_waitcnt lgkmcnt(2)
  v_cvt_pk_bf16_f32 v191, v226, v227
  buffer_load_dwordx4 v239, s[32:35], s53 offen offset:1024 sc1 lds
  v_mfma_f32_16x16x32_bf16 a[168:171], a[176:179], v[160:163], a[168:171]
  ds_read_b128 a[48:51], v234 offset:0
  v_mfma_f32_16x16x32_bf16 a[168:171], a[180:183], v[168:171], a[168:171]
  ds_read_b128 a[52:55], v234 offset:1024
  v_mfma_f32_16x16x32_bf16 v[220:223], a[248:251], v[180:183], 0
  buffer_load_dwordx4 v239, s[32:35], s53 offen offset:2048 sc1 lds
  v_mfma_f32_16x16x32_bf16 v[220:223], a[248:251], v[188:191], v[220:223]
  v_mfma_f32_16x16x32_bf16 a[232:235], a[176:179], v[164:167], a[232:235]
  ds_read_b128 a[56:59], v234 offset:2048
  buffer_load_dwordx4 v239, s[32:35], s53 offen offset:3072 sc1 lds
  v_mfma_f32_16x16x32_bf16 a[232:235], a[180:183], v[172:175], a[232:235]
  s_add_u32 s53, s53, 16384
  ds_read_b128 a[60:63], v234 offset:3072
  s_waitcnt lgkmcnt(4)
  v_mfma_f32_16x16x32_bf16 a[172:175], a[184:187], v[160:163], a[172:175]
  s_cmp_ge_u32 s49, 147456
  s_cselect_b32 s55, s6, s49
  ds_read_b128 a[112:115], v234 offset:4096
  v_mfma_f32_16x16x32_bf16 a[172:175], a[188:191], v[168:171], a[172:175]
  ds_read_b128 a[116:119], v234 offset:5120
  v_max_f32 v242, v216, v220
  v_mfma_f32_16x16x32_bf16 a[236:239], a[184:187], v[164:167], a[236:239]
  ds_read_b128 a[120:123], v234 offset:6144
  v_cmp_ngt_f32 vcc, 0x4b800000, v242
  v_mfma_f32_16x16x32_bf16 a[236:239], a[188:191], v[172:175], a[236:239]
  ds_read_b128 a[124:127], v234 offset:7168
  ds_read_b128 a[16:19], v234 offset:8192
  s_or_b64 vcc, vcc, s[8:9]
  s_cbranch_vccnz L_stub7
L_back7:
  s_add_u32 s45, s45, 1
  s_waitcnt lgkmcnt(5)
  v_mfma_f32_16x16x32_bf16 v[96:99], a[48:51], a[128:131], v[200:203]
  s_mov_b32 m0, s54
  v_exp_f32 v226, v64
  v_mfma_f32_16x16x32_bf16 v[96:99], a[52:55], a[132:135], v[96:99]
  s_add_u32 s49, s54, 16384
  v_exp_f32 v227, v65
  v_mfma_f32_16x16x32_bf16 v[96:99], a[56:59], a[136:139], v[96:99]
  ds_read_b128 a[20:23], v234 offset:9216
  v_cvt_pk_bf16_f32 v160, v226, v227
  buffer_load_dwordx4 v239, s[28:31], s52 offen offset:0 sc1 lds
  v_mfma_f32_16x16x32_bf16 v[96:99], a[60:63], a[140:143], v[96:99]
  v_exp_f32 v228, v66
  v_mfma_f32_16x16x32_bf16 v[100:103], a[48:51], a[192:195], v[204:207]
  v_add_u32 v235, s51, v238
  ds_read_b128 a[24:27], v234 offset:10240
  v_add_f32 v232, v232, v216
  v_mfma_f32_16x16x32_bf16 v[100:103], a[52:55], a[196:199], v[100:103]
  s_add_u32 s51, s51, 16384
  v_exp_f32 v229, v67
  v_mfma_f32_16x16x32_bf16 v[100:103], a[56:59], a[200:203], v[100:103]
  s_and_b32 s51, s51, 0xffff
  ds_read_b128 a[28:31], v234 offset:11264
  v_cvt_pk_bf16_f32 v161, v228, v229
  v_mfma_f32_16x16x32_bf16 v[100:103], a[60:63], a[204:207], v[100:103]
  s_waitcnt lgkmcnt(4)
  v_exp_f32 v224, v72
  v_mfma_f32_16x16x32_bf16 v[104:107], a[112:115], a[128:131], v[200:203]
  v_exp_f32 v225, v73
  v_mfma_f32_16x16x32_bf16 v[104:107], a[116:119], a[132:135], v[104:107]
  ds_read_b128 a[80:83], v234 offset:12288
  v_cvt_pk_bf16_f32 v162, v224, v225
  v_mfma_f32_16x16x32_bf16 v[104:107], a[120:123], a[136:139], v[104:107]
  v_exp_f32 v226, v74
  v_mfma_f32_16x16x32_bf16 v[104:107], a[124:127], a[140:143], v[104:107]
  ds_read_b128 a[84:87], v234 offset:13312
  buffer_load_dwordx4 v239, s[28:31], s52 offen offset:1024 sc1 lds
  v_mfma_f32_16x16x32_bf16 v[108:111], a[112:115], a[192:195], v[204:207]
  v_exp_f32 v227, v75
  v_mfma_f32_16x16x32_bf16 v[108:111], a[116:119], a[196:199], v[108:111]
  ds_read_b128 a[88:91], v234 offset:14336
  v_cvt_pk_bf16_f32 v163, v226, v227
  v_mfma_f32_16x16x32_bf16 v[108:111], a[120:123], a[200:203], v[108:111]
  v_exp_f32 v228, v80
  v_mfma_f32_16x16x32_bf16 v[108:111], a[124:127], a[204:207], v[108:111]
  s_waitcnt lgkmcnt(3)
  v_exp_f32 v229, v81
  v_mfma_f32_16x16x32_bf16 v[112:115], a[16:19], a[128:131], v[200:203]
  ds_read_b128 a[92:95], v234 offset:15360
  v_cvt_pk_bf16_f32 v168, v228, v229
  v_mfma_f32_16x16x32_bf16 v[112:115], a[20:23], a[132:135], v[112:115]
  v_exp_f32 v224, v82
  v_mfma_f32_16x16x32_bf16 v[112:115], a[24:27], a[136:139], v[112:115]
  ds_read_b128 a[176:179], v235 offset:0
  buffer_load_dwordx4 v239, s[28:31], s52 offen offset:2048 sc1 lds
  v_mfma_f32_16x16x32_bf16 v[112:115], a[28:31], a[140:143], v[112:115]
  v_exp_f32 v225, v83
  v_mfma_f32_16x16x32_bf16 v[116:119], a[16:19], a[192:195], v[204:207]
  ds_read_b128 a[180:183], v235 offset:1024
  v_cvt_pk_bf16_f32 v169, v224, v225
  v_mfma_f32_16x16x32_bf16 v[116:119], a[20:23], a[196:199], v[116:119]
  v_exp_f32 v226, v88
  v_mfma_f32_16x16x32_bf16 v[116:119], a[24:27], a[200:203], v[116:119]
  v_exp_f32 v227, v89
  v_mfma_f32_16x16x32_bf16 v[116:119], a[28:31], a[204:207], v[116:119]
  s_waitcnt lgkmcnt(2)
  ds_read_b128 a[184:187], v235 offset:2048
  v_cvt_pk_bf16_f32 v170, v226, v227
  v_mfma_f32_16x16x32_bf16 v[120:123], a[80:83], a[128:131], v[200:203]
  v_exp_f32 v228, v90
  v_mfma_f32_16x16x32_bf16 v[120:123], a[84:87], a[132:135], v[120:123]
  ds_read_b128 a[188:191], v235 offset:3072
  buffer_load_dwordx4 v239, s[28:31], s52 offen offset:3072 sc1 lds
  v_mfma_f32_16x16x32_bf16 v[120:123], a[88:91], a[136:139], v[120:123]
  s_add_u32 s52, s52, 16384
  v_exp_f32 v229, v91
  v_mfma_f32_16x16x32_bf16 v[120:123], a[92:95], a[140:143], v[120:123]
  s_cmp_ge_u32 s49, 81920
  s_cselect_b32 s54, s56, s49
  ds_read_b128 a[240:243], v235 offset:4096
  v_cvt_pk_bf16_f32 v171, v228, v229
  v_mfma_f32_16x16x32_bf16 v[124:127], a[80:83], a[192:195], v[204:207]
  v_exp_f32 v224, v68
  v_mfma_f32_16x16x32_bf16 v[124:127], a[84:87], a[196:199], v[124:127]
  v_exp_f32 v225, v69
  v_mfma_f32_16x16x32_bf16 v[124:127], a[88:91], a[200:203], v[124:127]
  ds_read_b128 a[244:247], v235 offset:5120
  v_cvt_pk_bf16_f32 v164, v224, v225
  v_mfma_f32_16x16x32_bf16 v[124:127], a[92:95], a[204:207], v[124:127]
  v_exp_f32 v226, v70
  v_mfma_f32_16x16x32_bf16 v[216:219], a[248:251], v[160:163], 0
  v_add_f32 v233, v233, v220
  v_mfma_f32_16x16x32_bf16 v[216:219], a[248:251], v[168:171], v[216:219]
  s_waitcnt lgkmcnt(4)
  v_mfma_f32_16x16x32_bf16 a[144:147], a[176:179], v[176:179], a[144:147]
  s_add_u32 s48, s45, 3
  ds_read_b128 a[32:35], v235 offset:6144
  v_mfma_f32_16x16x32_bf16 a[144:147], a[180:183], v[184:187], a[144:147]
  s_cmp_ge_i32 s48, s44
  s_cselect_b64 s[8:9], -1, 0
  v_exp_f32 v227, v71
  v_mfma_f32_16x16x32_bf16 a[208:211], a[176:179], v[180:183], a[208:211]
  ds_read_b128 a[36:39], v235 offset:7168
  v_cvt_pk_bf16_f32 v165, v226, v227
  v_mfma_f32_16x16x32_bf16 a[208:211], a[180:183], v[188:191], a[208:211]
  s_waitcnt lgkmcnt(4)
  v_exp_f32 v228, v76
  v_mfma_f32_16x16x32_bf16 a[148:151], a[184:187], v[176:179], a[148:151]
  v_exp_f32 v229, v77
  v_mfma_f32_16x16x32_bf16 a[148:151], a[188:191], v[184:187], a[148:151]
  ds_read_b128 a[40:43], v235 offset:8192
  v_cvt_pk_bf16_f32 v166, v228, v229
  v_mfma_f32_16x16x32_bf16 a[212:215], a[184:187], v[180:183], a[212:215]
  v_exp_f32 v224, v78
  v_mfma_f32_16x16x32_bf16 a[212:215], a[188:191], v[188:191], a[212:215]
  s_waitcnt lgkmcnt(3)
  ds_read_b128 a[44:47], v235 offset:9216
  v_mfma_f32_16x16x32_bf16 a[152:155], a[240:243], v[176:179], a[152:155]
  v_exp_f32 v225, v79
  v_mfma_f32_16x16x32_bf16 a[152:155], a[244:247], v[184:187], a[152:155]
  ds_read_b128 a[96:99], v235 offset:10240
  v_cvt_pk_bf16_f32 v167, v224, v225
  v_mfma_f32_16x16x32_bf16 a[216:219], a[240:243], v[180:183], a[216:219]
  v_exp_f32 v226, v84
  v_mfma_f32_16x16x32_bf16 a[216:219], a[244:247], v[188:191], a[216:219]
  s_waitcnt lgkmcnt(3)
  v_exp_f32 v227, v85
  v_mfma_f32_16x16x32_bf16 a[156:159], a[32:35], v[176:179], a[156:159]
  ds_read_b128 a[100:103], v235 offset:11264
  v_cvt_pk_bf16_f32 v172, v226, v227
  v_mfma_f32_16x16x32_bf16 a[156:159], a[36:39], v[184:187], a[156:159]
  v_exp_f32 v228, v86
  v_mfma_f32_16x16x32_bf16 a[220:223], a[32:35], v[180:183], a[220:223]
  ds_read_b128 a[176:179], v235 offset:12288
  v_mfma_f32_16x16x32_bf16 a[220:223], a[36:39], v[188:191], a[220:223]
  s_waitcnt lgkmcnt(3)
  v_exp_f32 v229, v87
  v_mfma_f32_16x16x32_bf16 a[160:163], a[40:43], v[176:179], a[160:163]
  ds_read_b128 a[180:183], v235 offset:13312
  v_cvt_pk_bf16_f32 v173, v228, v229
  v_mfma_f32_16x16x32_bf16 a[160:163], a[44:47], v[184:187], a[160:163]
  v_exp_f32 v224, v92
  v_mfma_f32_16x16x32_bf16 a[224:227], a[40:43], v[180:183], a[224:227]
  v_exp_f32 v225, v93
  v_mfma_f32_16x16x32_bf16 a[224:227], a[44:47], v[188:191], a[224:227]
  s_waitcnt lgkmcnt(2)
  ds_read_b128 a[184:187], v235 offset:14336
  v_cvt_pk_bf16_f32 v174, v224, v225
  v_mfma_f32_16x16x32_bf16 a[164:167], a[96:99], v[176:179], a[164:167]
  s_add_u32 s50, s50, 16384
  v_exp_f32 v226, v94
  v_mfma_f32_16x16x32_bf16 a[164:167], a[100:103], v[184:187], a[164:167]
  s_cmp_ge_u32 s50, 81920
  s_cselect_b32 s50, 0, s50
  ds_read_b128 a[188:191], v235 offset:15360
  v_mfma_f32_16x16x32_bf16 a[228:231], a[96:99], v[180:183], a[228:231]
  v_add_u32 v234, s50, v252
  v_exp_f32 v227, v95
  v_mfma_f32_16x16x32_bf16 a[228:231], a[100:103], v[188:191], a[228:231]
  s_waitcnt lgkmcnt(2)
  v_cvt_pk_bf16_f32 v175, v226, v227
  v_mfma_f32_16x16x32_bf16 a[168:171], a[176:179], v[176:179], a[168:171]
  ds_read_b128 a[48:51], v234 offset:0
  v_mfma_f32_16x16x32_bf16 a[168:171], a[180:183], v[184:187], a[168:171]
  ds_read_b128 a[52:55], v234 offset:1024
  v_mfma_f32_16x16x32_bf16 v[220:223], a[248:251], v[164:167], 0
  v_mfma_f32_16x16x32_bf16 v[220:223], a[248:251], v[172:175], v[220:223]
  v_mfma_f32_16x16x32_bf16 a[232:235], a[176:179], v[180:183], a[232:235]
  ds_read_b128 a[56:59], v234 offset:2048
  v_mfma_f32_16x16x32_bf16 a[232:235], a[180:183], v[188:191], a[232:235]
  s_waitcnt lgkmcnt(3)
  ds_read_b128 a[60:63], v234 offset:3072
  v_mfma_f32_16x16x32_bf16 a[172:175], a[184:187], v[176:179], a[172:175]
  ds_read_b128 a[112:115], v234 offset:4096
  v_mfma_f32_16x16x32_bf16 a[172:175], a[188:191], v[184:187], a[172:175]
  ds_read_b128 a[116:119], v234 offset:5120
  v_max_f32 v242, v216, v220
  v_mfma_f32_16x16x32_bf16 a[236:239], a[184:187], v[180:183], a[236:239]
  ds_read_b128 a[120:123], v234 offset:6144
  v_cmp_ngt_f32 vcc, 0x4b800000, v242
  v_mfma_f32_16x16x32_bf16 a[236:239], a[188:191], v[188:191], a[236:239]
  ds_read_b128 a[124:127], v234 offset:7168
  ds_read_b128 a[16:19], v234 offset:8192
  s_or_b64 vcc, vcc, s[8:9]
  s_cbranch_vccnz L_stub8
L_back8:
  s_add_u32 s45, s45, 1
  s_waitcnt vmcnt(0)
  s_barrier
  s_add_u32 s48, s45, 1
  s_cmp_lt_u32 s48, s44
  s_cbranch_scc1 L_TS
L_TE:
  v_add_u32 v235, s51, v238
  s_add_u32 s51, s51, 16384
  s_and_b32 s51, s51, 0xffff
  ds_read_b128 a[176:179], v235 offset:0
  ds_read_b128 a[180:183], v235 offset:1024
  ds_read_b128 a[184:187], v235 offset:2048
  ds_read_b128 a[188:191], v235 offset:3072
  ds_read_b128 a[240:243], v235 offset:4096
  ds_read_b128 a[244:247], v235 offset:5120
  s_waitcnt lgkmcnt(4)
  v_mfma_f32_16x16x32_bf16 a[144:147], a[176:179], v[160:163], a[144:147]
  v_exp_f32 v226, v96
  v_mfma_f32_16x16x32_bf16 a[144:147], a[180:183], v[168:171], a[144:147]
  v_exp_f32 v227, v97
  v_add_f32 v232, v232, v216
  v_mfma_f32_16x16x32_bf16 a[208:211], a[176:179], v[164:167], a[208:211]
  v_cvt_pk_bf16_f32 v176, v226, v227
  v_exp_f32 v228, v98
  v_mfma_f32_16x16x32_bf16 a[208:211], a[180:183], v[172:175], a[208:211]
  s_waitcnt lgkmcnt(2)
  v_exp_f32 v229, v99
  v_mfma_f32_16x16x32_bf16 a[148:151], a[184:187], v[160:163], a[148:151]
  ds_read_b128 a[32:35], v235 offset:6144
  v_cvt_pk_bf16_f32 v177, v228, v229
  v_exp_f32 v224, v104
  v_mfma_f32_16x16x32_bf16 a[148:151], a[188:191], v[168:171], a[148:151]
  ds_read_b128 a[36:39], v235 offset:7168
  v_exp_f32 v225, v105
  v_mfma_f32_16x16x32_bf16 a[212:215], a[184:187], v[164:167], a[212:215]
  v_cvt_pk_bf16_f32 v178, v224, v225
  v_exp_f32 v226, v106
  v_mfma_f32_16x16x32_bf16 a[212:215], a[188:191], v[172:175], a[212:215]
  s_waitcnt lgkmcnt(2)
  v_exp_f32 v227, v107
  v_mfma_f32_16x16x32_bf16 a[152:155], a[240:243], v[160:163], a[152:155]
  ds_read_b128 a[40:43], v235 offset:8192
  v_cvt_pk_bf16_f32 v179, v226, v227
  v_exp_f32 v228, v112
  v_mfma_f32_16x16x32_bf16 a[152:155], a[244:247], v[168:171], a[152:155]
  ds_read_b128 a[44:47], v235 offset:9216
  v_exp_f32 v229, v113
  v_mfma_f32_16x16x32_bf16 a[216:219], a[240:243], v[164:167], a[216:219]
  v_cvt_pk_bf16_f32 v184, v228, v229
  v_exp_f32 v224, v114
  v_mfma_f32_16x16x32_bf16 a[216:219], a[244:247], v[172:175], a[216:219]
  s_waitcnt lgkmcnt(2)
  v_exp_f32 v225, v115
  v_mfma_f32_16x16x32_bf16 a[156:159], a[32:35], v[160:163], a[156:159]
  ds_read_b128 a[96:99], v235 offset:10240
  v_cvt_pk_bf16_f32 v185, v224, v225
  v_exp_f32 v226, v120
  v_mfma_f32_16x16x32_bf16 a[156:159], a[36:39], v[168:171], a[156:159]
  ds_read_b128 a[100:103], v235 offset:11264
  v_exp_f32 v227, v121
  v_mfma_f32_16x16x32_bf16 a[220:223], a[32:35], v[164:167], a[220:223]
  v_cvt_pk_bf16_f32 v186, v226, v227
  v_exp_f32 v228, v122
  v_mfma_f32_16x16x32_bf16 a[220:223], a[36:39], v[172:175], a[220:223]
  s_waitcnt lgkmcnt(2)
  v_exp_f32 v229, v123
  v_mfma_f32_16x16x32_bf16 a[160:163], a[40:43], v[160:163], a[160:163]
  ds_read_b128 a[176:179], v235 offset:12288
  v_cvt_pk_bf16_f32 v187, v228, v229
  v_exp_f32 v224, v100
  v_mfma_f32_16x16x32_bf16 a[160:163], a[44:47], v[168:171], a[160:163]
  ds_read_b128 a[180:183], v235 offset:13312
  v_exp_f32 v225, v101
  v_mfma_f32_16x16x32_bf16 v[216:219], a[248:251], v[176:179], 0
  v_add_f32 v233, v233, v220
  v_mfma_f32_16x16x32_bf16 v[216:219], a[248:251], v[184:187], v[216:219]
  v_mfma_f32_16x16x32_bf16 a[224:227], a[40:43], v[164:167], a[224:227]
  v_cvt_pk_bf16_f32 v180, v224, v225
  v_exp_f32 v226, v102
  v_mfma_f32_16x16x32_bf16 a[224:227], a[44:47], v[172:175], a[224:227]
  s_waitcnt lgkmcnt(2)
  v_exp_f32 v227, v103
  v_mfma_f32_16x16x32_bf16 a[164:167], a[96:99], v[160:163], a[164:167]
  ds_read_b128 a[184:187], v235 offset:14336
  v_cvt_pk_bf16_f32 v181, v226, v227
  v_exp_f32 v228, v108
  v_mfma_f32_16x16x32_bf16 a[164:167], a[100:103], v[168:171], a[164:167]
  ds_read_b128 a[188:191], v235 offset:15360
  v_exp_f32 v229, v109
  v_mfma_f32_16x16x32_bf16 a[228:231], a[96:99], v[164:167], a[228:231]
  v_cvt_pk_bf16_f32 v182, v228, v229
  v_exp_f32 v224, v110
  v_mfma_f32_16x16x32_bf16 a[228:231], a[100:103], v[172:175], a[228:231]
  s_waitcnt lgkmcnt(2)
  v_exp_f32 v225, v111
  v_mfma_f32_16x16x32_bf16 a[168:171], a[176:179], v[160:163], a[168:171]
  v_cvt_pk_bf16_f32 v183, v224, v225
  v_exp_f32 v226, v116
  v_mfma_f32_16x16x32_bf16 a[168:171], a[180:183], v[168:171], a[168:171]
  v_exp_f32 v227, v117
  v_mfma_f32_16x16x32_bf16 a[232:235], a[176:179], v[164:167], a[232:235]
  v_cvt_pk_bf16_f32 v188, v226, v227
  v_exp_f32 v228, v118
  v_mfma_f32_16x16x32_bf16 a[232:235], a[180:183], v[172:175], a[232:235]
  s_waitcnt lgkmcnt(0)
  v_exp_f32 v229, v119
  v_mfma_f32_16x16x32_bf16 a[172:175], a[184:187], v[160:163], a[172:175]
  v_exp_f32 v224, v124
  v_mfma_f32_16x16x32_bf16 a[172:175], a[188:191], v[168:171], a[172:175]
  v_exp_f32 v225, v125
  v_mfma_f32_16x16x32_bf16 a[236:239], a[184:187], v[164:167], a[236:239]
  v_exp_f32 v226, v126
  v_mfma_f32_16x16x32_bf16 a[236:239], a[188:191], v[172:175], a[236:239]
  v_cvt_pk_bf16_f32 v189, v228, v229
  v_cvt_pk_bf16_f32 v190, v224, v225
  v_exp_f32 v227, v127
  s_nop 0
  v_cvt_pk_bf16_f32 v191, v226, v227
  v_mfma_f32_16x16x32_bf16 v[220:223], a[248:251], v[180:183], 0
  s_nop 0
  v_mfma_f32_16x16x32_bf16 v[220:223], a[248:251], v[188:191], v[220:223]
  s_nop 7
  v_max_f32 v242, v216, v220
  v_cmp_ngt_f32 vcc, 0x4b800000, v242
  s_cbranch_vccnz L_stub9
L_back9:
  s_add_u32 s45, s45, 1
  v_add_u32 v235, s51, v238
  s_add_u32 s51, s51, 16384
  s_and_b32 s51, s51, 0xffff
  ds_read_b128 a[176:179], v235 offset:0
  ds_read_b128 a[180:183], v235 offset:1024
  ds_read_b128 a[184:187], v235 offset:2048
  ds_read_b128 a[188:191], v235 offset:3072
  ds_read_b128 a[240:243], v235 offset:4096
  ds_read_b128 a[244:247], v235 offset:5120
  s_waitcnt lgkmcnt(4)
  v_mfma_f32_16x16x32_bf16 a[144:147], a[176:179], v[176:179], a[144:147]
  v_mfma_f32_16x16x32_bf16 a[144:147], a[180:183], v[184:187], a[144:147]
  v_mfma_f32_16x16x32_bf16 a[208:211], a[176:179], v[180:183], a[208:211]
  v_add_f32 v232, v232, v216
  v_mfma_f32_16x16x32_bf16 a[208:211], a[180:183], v[188:191], a[208:211]
  s_waitcnt lgkmcnt(2)
  v_add_f32 v233, v233, v220
  v_mfma_f32_16x16x32_bf16 a[148:151], a[184:187], v[176:179], a[148:151]
  ds_read_b128 a[32:35], v235 offset:6144
  v_mfma_f32_16x16x32_bf16 a[148:151], a[188:191], v[184:187], a[148:151]
  ds_read_b128 a[36:39], v235 offset:7168
  v_mfma_f32_16x16x32_bf16 a[212:215], a[184:187], v[180:183], a[212:215]
  v_mfma_f32_16x16x32_bf16 a[212:215], a[188:191], v[188:191], a[212:215]
  s_waitcnt lgkmcnt(2)
  v_mfma_f32_16x16x32_bf16 a[152:155], a[240:243], v[176:179], a[152:155]
  ds_read_b128 a[40:43], v235 offset:8192
  v_rcp_f32 v232, v232
  v_mfma_f32_16x16x32_bf16 a[152:155], a[244:247], v[184:187], a[152:155]
  ds_read_b128 a[44:47], v235 offset:9216
  v_rcp_f32 v233, v233
  v_mfma_f32_16x16x32_bf16 a[216:219], a[240:243], v[180:183], a[216:219]
  s_lshr_b32 s10, s59, 12
  v_mfma_f32_16x16x32_bf16 a[216:219], a[244:247], v[188:191], a[216:219]
  s_mul_i32 s10, s10, 176128
  v_accvgpr_read_b32 v64, a144
  v_accvgpr_read_b32 v65, a145
  v_accvgpr_read_b32 v66, a146
  v_accvgpr_read_b32 v67, a147
  s_waitcnt lgkmcnt(2)
  v_mfma_f32_16x16x32_bf16 a[156:159], a[32:35], v[176:179], a[156:159]
  s_lshl_b32 s11, s40, 12
  ds_read_b128 a[96:99], v235 offset:10240
  v_accvgpr_read_b32 v68, a148
  v_accvgpr_read_b32 v69, a149
  v_accvgpr_read_b32 v70, a150
  v_mfma_f32_16x16x32_bf16 a[156:159], a[36:39], v[184:187], a[156:159]
  s_add_u32 s10, s10, s11
  ds_read_b128 a[100:103], v235 offset:11264
  v_accvgpr_read_b32 v71, a151
  v_mul_f32 v64, v64, v232
  v_mul_f32 v65, v65, v232
  v_mfma_f32_16x16x32_bf16 a[220:223], a[32:35], v[180:183], a[220:223]
  s_add_u32 s11, s10, 176128
  v_mul_f32 v66, v66, v232
  v_mul_f32 v67, v67, v232
  v_mul_f32 v68, v68, v232
  v_mul_f32 v69, v69, v232
  v_mfma_f32_16x16x32_bf16 a[220:223], a[36:39], v[188:191], a[220:223]
  s_waitcnt lgkmcnt(2)
  v_mul_f32 v70, v70, v232
  v_mul_f32 v71, v71, v232
  v_cvt_pk_bf16_f32 v72, v64, v65
  v_cvt_pk_bf16_f32 v73, v66, v67
  v_mfma_f32_16x16x32_bf16 a[160:163], a[40:43], v[176:179], a[160:163]
  ds_read_b128 a[176:179], v235 offset:12288
  v_cvt_pk_bf16_f32 v74, v68, v69
  v_cvt_pk_bf16_f32 v75, v70, v71
  v_mfma_f32_16x16x32_bf16 a[160:163], a[44:47], v[184:187], a[160:163]
  ds_read_b128 a[180:183], v235 offset:13312
  buffer_store_dwordx4 v[72:75], v252, s[36:39], s10 offen offset:0 sc1
  v_accvgpr_read_b32 v76, a208
  v_mfma_f32_16x16x32_bf16 a[224:227], a[40:43], v[180:183], a[224:227]
  v_accvgpr_read_b32 v77, a209
  v_accvgpr_read_b32 v78, a210
  v_accvgpr_read_b32 v79, a211
  v_accvgpr_read_b32 v80, a212
  v_mfma_f32_16x16x32_bf16 a[224:227], a[44:47], v[188:191], a[224:227]
  s_waitcnt lgkmcnt(2)
  v_accvgpr_read_b32 v81, a213
  v_accvgpr_read_b32 v82, a214
  v_accvgpr_read_b32 v83, a215
  v_mul_f32 v76, v76, v233
  v_mfma_f32_16x16x32_bf16 a[164:167], a[96:99], v[176:179], a[164:167]
  ds_read_b128 a[184:187], v235 offset:14336
  v_mul_f32 v77, v77, v233
  v_mul_f32 v78, v78, v233
  v_mul_f32 v79, v79, v233
  v_mfma_f32_16x16x32_bf16 a[164:167], a[100:103], v[184:187], a[164:167]
  ds_read_b128 a[188:191], v235 offset:15360
  v_mul_f32 v80, v80, v233
  v_mul_f32 v81, v81, v233
  v_mul_f32 v82, v82, v233
  v_mfma_f32_16x16x32_bf16 a[228:231], a[96:99], v[180:183], a[228:231]
  v_mul_f32 v83, v83, v233
  v_cvt_pk_bf16_f32 v84, v76, v77
  v_cvt_pk_bf16_f32 v85, v78, v79
  v_cvt_pk_bf16_f32 v86, v80, v81
  v_mfma_f32_16x16x32_bf16 a[228:231], a[100:103], v[188:191], a[228:231]
  s_waitcnt lgkmcnt(2)
  v_cvt_pk_bf16_f32 v87, v82, v83
  buffer_store_dwordx4 v[84:87], v252, s[36:39], s11 offen offset:0 sc1
  v_accvgpr_read_b32 v88, a152
  v_mfma_f32_16x16x32_bf16 a[168:171], a[176:179], v[176:179], a[168:171]
  v_accvgpr_read_b32 v89, a153
  v_accvgpr_read_b32 v90, a154
  v_accvgpr_read_b32 v91, a155
  v_accvgpr_read_b32 v92, a156
  v_mfma_f32_16x16x32_bf16 a[168:171], a[180:183], v[184:187], a[168:171]
  v_accvgpr_read_b32 v93, a157
  v_accvgpr_read_b32 v94, a158
  v_accvgpr_read_b32 v95, a159
  v_mul_f32 v88, v88, v232
  v_mfma_f32_16x16x32_bf16 a[232:235], a[176:179], v[180:183], a[232:235]
  v_mul_f32 v89, v89, v232
  v_mul_f32 v90, v90, v232
  v_mul_f32 v91, v91, v232
  v_mul_f32 v92, v92, v232
  v_mfma_f32_16x16x32_bf16 a[232:235], a[180:183], v[188:191], a[232:235]
  s_waitcnt lgkmcnt(0)
  v_mul_f32 v93, v93, v232
  v_mul_f32 v94, v94, v232
  v_mul_f32 v95, v95, v232
  v_cvt_pk_bf16_f32 v96, v88, v89
  v_mfma_f32_16x16x32_bf16 a[172:175], a[184:187], v[176:179], a[172:175]
  v_cvt_pk_bf16_f32 v97, v90, v91
  v_cvt_pk_bf16_f32 v98, v92, v93
  v_cvt_pk_bf16_f32 v99, v94, v95
  v_accvgpr_read_b32 v64, a160
  v_mfma_f32_16x16x32_bf16 a[172:175], a[188:191], v[184:187], a[172:175]
  buffer_store_dwordx4 v[96:99], v252, s[36:39], s10 offen offset:1024 sc1
  v_accvgpr_read_b32 v100, a216
  v_accvgpr_read_b32 v101, a217
  v_mfma_f32_16x16x32_bf16 a[236:239], a[184:187], v[180:183], a[236:239]
  v_accvgpr_read_b32 v102, a218
  v_accvgpr_read_b32 v103, a219
  v_accvgpr_read_b32 v104, a220
  v_accvgpr_read_b32 v105, a221
  v_mfma_f32_16x16x32_bf16 a[236:239], a[188:191], v[188:191], a[236:239]
  v_accvgpr_read_b32 v106, a222
  v_accvgpr_read_b32 v107, a223
  v_mul_f32 v100, v100, v233
  v_mul_f32 v101, v101, v233
  v_mul_f32 v102, v102, v233
  v_mul_f32 v103, v103, v233
  v_mul_f32 v104, v104, v233
  v_mul_f32 v105, v105, v233
  v_mul_f32 v106, v106, v233
  v_mul_f32 v107, v107, v233
  v_cvt_pk_bf16_f32 v108, v100, v101
  v_cvt_pk_bf16_f32 v109, v102, v103
  v_cvt_pk_bf16_f32 v110, v104, v105
  v_cvt_pk_bf16_f32 v111, v106, v107
  buffer_store_dwordx4 v[108:111], v252, s[36:39], s11 offen offset:1024 sc1
  v_accvgpr_read_b32 v65, a161
  v_accvgpr_read_b32 v66, a162
  v_accvgpr_read_b32 v67, a163
  v_accvgpr_read_b32 v68, a164
  v_accvgpr_read_b32 v69, a165
  v_accvgpr_read_b32 v70, a166
  v_accvgpr_read_b32 v71, a167
  v_mul_f32 v64, v64, v232
  v_mul_f32 v65, v65, v232
  v_mul_f32 v66, v66, v232
  v_mul_f32 v67, v67, v232
  v_mul_f32 v68, v68, v232
  v_mul_f32 v69, v69, v232
  v_mul_f32 v70, v70, v232
  v_mul_f32 v71, v71, v232
  v_cvt_pk_bf16_f32 v72, v64, v65
  v_cvt_pk_bf16_f32 v73, v66, v67
  v_cvt_pk_bf16_f32 v74, v68, v69
  v_cvt_pk_bf16_f32 v75, v70, v71
  buffer_store_dwordx4 v[72:75], v252, s[36:39], s10 offen offset:2048 sc1
  v_accvgpr_read_b32 v76, a224
  v_accvgpr_read_b32 v77, a225
  v_accvgpr_read_b32 v78, a226
  v_accvgpr_read_b32 v79, a227
  v_accvgpr_read_b32 v80, a228
  v_accvgpr_read_b32 v81, a229
  v_accvgpr_read_b32 v82, a230
  v_accvgpr_read_b32 v83, a231
  v_mul_f32 v76, v76, v233
  v_mul_f32 v77, v77, v233
  v_mul_f32 v78, v78, v233
  v_mul_f32 v79, v79, v233
  v_mul_f32 v80, v80, v233
  v_mul_f32 v81, v81, v233
  v_mul_f32 v82, v82, v233
  v_mul_f32 v83, v83, v233
  v_cvt_pk_bf16_f32 v84, v76, v77
  v_cvt_pk_bf16_f32 v85, v78, v79
  v_cvt_pk_bf16_f32 v86, v80, v81
  v_cvt_pk_bf16_f32 v87, v82, v83
  buffer_store_dwordx4 v[84:87], v252, s[36:39], s11 offen offset:2048 sc1
  s_add_u32 s45, s45, 1
  v_accvgpr_read_b32 v88, a168
  v_accvgpr_read_b32 v89, a169
  v_accvgpr_read_b32 v90, a170
  v_accvgpr_read_b32 v91, a171
  v_accvgpr_read_b32 v92, a172
  v_accvgpr_read_b32 v93, a173
  v_accvgpr_read_b32 v94, a174
  v_accvgpr_read_b32 v95, a175
  v_mul_f32 v88, v88, v232
  v_mul_f32 v89, v89, v232
  v_mul_f32 v90, v90, v232
  v_mul_f32 v91, v91, v232
  v_mul_f32 v92, v92, v232
  v_mul_f32 v93, v93, v232
  v_mul_f32 v94, v94, v232
  v_mul_f32 v95, v95, v232
  v_cvt_pk_bf16_f32 v96, v88, v89
  v_cvt_pk_bf16_f32 v97, v90, v91
  v_cvt_pk_bf16_f32 v98, v92, v93
  v_cvt_pk_bf16_f32 v99, v94, v95
  buffer_store_dwordx4 v[96:99], v252, s[36:39], s10 offen offset:3072 sc1
  v_accvgpr_read_b32 v100, a232
  v_accvgpr_read_b32 v101, a233
  v_accvgpr_read_b32 v102, a234
  v_accvgpr_read_b32 v103, a235
  v_accvgpr_read_b32 v104, a236
  v_accvgpr_read_b32 v105, a237
  v_accvgpr_read_b32 v106, a238
  v_accvgpr_read_b32 v107, a239
  v_mul_f32 v100, v100, v233
  v_mul_f32 v101, v101, v233
  v_mul_f32 v102, v102, v233
  v_mul_f32 v103, v103, v233
  v_mul_f32 v104, v104, v233
  v_mul_f32 v105, v105, v233
  v_mul_f32 v106, v106, v233
  v_mul_f32 v107, v107, v233
  v_cvt_pk_bf16_f32 v108, v100, v101
  v_cvt_pk_bf16_f32 v109, v102, v103
  v_cvt_pk_bf16_f32 v110, v104, v105
  v_cvt_pk_bf16_f32 v111, v106, v107
  buffer_store_dwordx4 v[108:111], v252, s[36:39], s11 offen offset:3072 sc1
  s_barrier
  s_branch L_k3_entry
L_stub1:
  s_add_u32 s48, s45, 3
  s_cmp_ge_i32 s48, s43
  s_cbranch_scc0 L_nomask1_0
  s_swappc_b64 s[76:77], s[60:61]
L_nomask1_0:
  s_add_u32 s48, s45, 3
  s_cmp_ge_i32 s48, s44
  s_cbranch_scc0 L_nomask1_1
  s_swappc_b64 s[76:77], s[64:65]
L_nomask1_1:
  s_branch L_back1
L_stub2:
  v_cmp_ngt_f32 vcc, 0x4b800000, v242
  s_nop 4
  s_cbranch_vccz L_norare2
  s_swappc_b64 s[76:77], s[68:69]
  s_swappc_b64 s[76:77], s[72:73]
L_norare2:
  s_add_u32 s48, s45, 3
  s_cmp_ge_i32 s48, s43
  s_cbranch_scc0 L_nomask2_0
  s_swappc_b64 s[76:77], s[62:63]
L_nomask2_0:
  s_add_u32 s48, s45, 3
  s_cmp_ge_i32 s48, s44
  s_cbranch_scc0 L_nomask2_1
  s_swappc_b64 s[76:77], s[66:67]
L_nomask2_1:
  s_branch L_back2
L_stub3:
  v_cmp_ngt_f32 vcc, 0x4b800000, v242
  s_nop 4
  s_cbranch_vccz L_norare3
  s_swappc_b64 s[76:77], s[70:71]
  s_swappc_b64 s[76:77], s[74:75]
L_norare3:
  s_add_u32 s48, s45, 3
  s_cmp_ge_i32 s48, s43
  s_cbranch_scc0 L_nomask3_0
  s_swappc_b64 s[76:77], s[60:61]
L_nomask3_0:
  s_add_u32 s48, s45, 3
  s_cmp_ge_i32 s48, s44
  s_cbranch_scc0 L_nomask3_1
  s_swappc_b64 s[76:77], s[64:65]
L_nomask3_1:
  s_branch L_back3
L_stub4:
  v_cmp_ngt_f32 vcc, 0x4b800000, v242
  s_nop 4
  s_cbranch_vccz L_norare4
  s_swappc_b64 s[76:77], s[68:69]
  s_swappc_b64 s[76:77], s[72:73]
L_norare4:
  s_add_u32 s48, s45, 3
  s_cmp_ge_i32 s48, s43
  s_cbranch_scc0 L_nomask4_0
  s_swappc_b64 s[76:77], s[62:63]
L_nomask4_0:
  s_add_u32 s48, s45, 3
  s_cmp_ge_i32 s48, s44
  s_cbranch_scc0 L_nomask4_1
  s_swappc_b64 s[76:77], s[66:67]
L_nomask4_1:
  s_branch L_back4
L_stub5:
  v_cmp_ngt_f32 vcc, 0x4b800000, v242
  s_nop 4
  s_cbranch_vccz L_norare5
  s_swappc_b64 s[76:77], s[70:71]
  s_swappc_b64 s[76:77], s[74:75]
L_norare5:
  s_add_u32 s48, s45, 3
  s_cmp_ge_i32 s48, s44
  s_cbranch_scc0 L_nomask5_1
  s_swappc_b64 s[76:77], s[64:65]
L_nomask5_1:
  s_branch L_back5
L_stub6:
  v_cmp_ngt_f32 vcc, 0x4b800000, v242
  s_nop 4
  s_cbranch_vccz L_norare6
  s_swappc_b64 s[76:77], s[72:73]
L_norare6:
  s_add_u32 s48, s45, 3
  s_cmp_ge_i32 s48, s44
  s_cbranch_scc0 L_nomask6_1
  s_swappc_b64 s[76:77], s[66:67]
L_nomask6_1:
  s_branch L_back6
L_stub7:
  v_cmp_ngt_f32 vcc, 0x4b800000, v242
  s_nop 4
  s_cbranch_vccz L_norare7
  s_swappc_b64 s[76:77], s[74:75]
L_norare7:
  s_add_u32 s48, s45, 3
  s_cmp_ge_i32 s48, s44
  s_cbranch_scc0 L_nomask7_1
  s_swappc_b64 s[76:77], s[64:65]
L_nomask7_1:
  s_branch L_back7
L_stub8:
  v_cmp_ngt_f32 vcc, 0x4b800000, v242
  s_nop 4
  s_cbranch_vccz L_norare8
  s_swappc_b64 s[76:77], s[72:73]
L_norare8:
  s_add_u32 s48, s45, 3
  s_cmp_ge_i32 s48, s44
  s_cbranch_scc0 L_nomask8_1
  s_swappc_b64 s[76:77], s[66:67]
L_nomask8_1:
  s_branch L_back8
L_stub9:
  v_cmp_ngt_f32 vcc, 0x4b800000, v242
  s_nop 4
  s_cbranch_vccz L_norare9
  s_swappc_b64 s[76:77], s[74:75]
L_norare9:
  s_branch L_back9
L_mask00:
  s_nop 7
  s_add_u32 s49, s45, 1
  s_lshl_b32 s49, s49, 6
  v_subrev_u32 v242, s49, v236
  v_cmp_ge_i32 s[78:79], v242, 0
  v_cmp_ge_i32 s[80:81], v242, 1
  v_cmp_ge_i32 s[82:83], v242, 2
  v_cmp_ge_i32 s[84:85], v242, 3
  v_cndmask_b32 v0, v241, v0, s[78:79]
  v_cndmask_b32 v1, v241, v1, s[80:81]
  v_cndmask_b32 v2, v241, v2, s[82:83]
  v_cndmask_b32 v3, v241, v3, s[84:85]
  v_cmp_ge_i32 s[78:79], v242, -16
  v_cmp_ge_i32 s[80:81], v242, -15
  v_cmp_ge_i32 s[82:83], v242, -14
  v_cmp_ge_i32 s[84:85], v242, -13
  v_cndmask_b32 v4, v241, v4, s[78:79]
  v_cndmask_b32 v5, v241, v5, s[80:81]
  v_cndmask_b32 v6, v241, v6, s[82:83]
  v_cndmask_b32 v7, v241, v7, s[84:85]
  v_cmp_ge_i32 s[78:79], v242, 16
  v_cmp_ge_i32 s[80:81], v242, 17
  v_cmp_ge_i32 s[82:83], v242, 18
  v_cmp_ge_i32 s[84:85], v242, 19
  v_cndmask_b32 v8, v241, v8, s[78:79]
  v_cndmask_b32 v9, v241, v9, s[80:81]
  v_cndmask_b32 v10, v241, v10, s[82:83]
  v_cndmask_b32 v11, v241, v11, s[84:85]
  v_cmp_ge_i32 s[78:79], v242, 0
  v_cmp_ge_i32 s[80:81], v242, 1
  v_cmp_ge_i32 s[82:83], v242, 2
  v_cmp_ge_i32 s[84:85], v242, 3
  v_cndmask_b32 v12, v241, v12, s[78:79]
  v_cndmask_b32 v13, v241, v13, s[80:81]
  v_cndmask_b32 v14, v241, v14, s[82:83]
  v_cndmask_b32 v15, v241, v15, s[84:85]
  v_cmp_ge_i32 s[78:79], v242, 32
  v_cmp_ge_i32 s[80:81], v242, 33
  v_cmp_ge_i32 s[82:83], v242, 34
  v_cmp_ge_i32 s[84:85], v242, 35
  v_cndmask_b32 v16, v241, v16, s[78:79]
  v_cndmask_b32 v17, v241, v17, s[80:81]
  v_cndmask_b32 v18, v241, v18, s[82:83]
  v_cndmask_b32 v19, v241, v19, s[84:85]
  v_cmp_ge_i32 s[78:79], v242, 16
  v_cmp_ge_i32 s[80:81], v242, 17
  v_cmp_ge_i32 s[82:83], v242, 18
  v_cmp_ge_i32 s[84:85], v242, 19
  v_cndmask_b32 v20, v241, v20, s[78:79]
  v_cndmask_b32 v21, v241, v21, s[80:81]
  v_cndmask_b32 v22, v241, v22, s[82:83]
  v_cndmask_b32 v23, v241, v23, s[84:85]
  v_cmp_ge_i32 s[78:79], v242, 48
  v_cmp_ge_i32 s[80:81], v242, 49
  v_cmp_ge_i32 s[82:83], v242, 50
  v_cmp_ge_i32 s[84:85], v242, 51
  v_cndmask_b32 v24, v241, v24, s[78:79]
  v_cndmask_b32 v25, v241, v25, s[80:81]
  v_cndmask_b32 v26, v241, v26, s[82:83]
  v_cndmask_b32 v27, v241, v27, s[84:85]
  v_cmp_ge_i32 s[78:79], v242, 32
  v_cmp_ge_i32 s[80:81], v242, 33
  v_cmp_ge_i32 s[82:83], v242, 34
  v_cmp_ge_i32 s[84:85], v242, 35
  v_cndmask_b32 v28, v241, v28, s[78:79]
  v_cndmask_b32 v29, v241, v29, s[80:81]
  v_cndmask_b32 v30, v241, v30, s[82:83]
  v_cndmask_b32 v31, v241, v31, s[84:85]
  s_setpc_b64 s[76:77]
L_rare00:
  s_nop 15
  v_max3_f32 v242, v0, v1, v2
  v_max3_f32 v242, v242, v3, v8
  v_max3_f32 v242, v242, v9, v10
  v_max3_f32 v242, v242, v11, v16
  v_max3_f32 v242, v242, v17, v18
  v_max3_f32 v242, v242, v19, v24
  v_max3_f32 v242, v242, v25, v26
  v_max_f32 v242, v242, v27
  v_mov_b32 v243, v242
  s_nop 1
  v_permlane16_swap_b32 v242, v243
  v_max_f32 v242, v242, v243
  v_mov_b32 v243, v242
  s_nop 1
  v_permlane32_swap_b32 v242, v243
  v_max_f32 v242, v242, v243
  v_max_f32 v242, 0, v242
  v_sub_f32 v244, 0, v242
  v_exp_f32 v244, v244
  v_sub_f32 v192, v192, v242
  v_sub_f32 v193, v193, v242
  v_sub_f32 v194, v194, v242
  v_sub_f32 v195, v195, v242
  v_mul_f32 v230, v230, v244
  v_accvgpr_read_b32 v246, a16
  v_accvgpr_read_b32 v247, a17
  v_accvgpr_read_b32 v248, a18
  v_accvgpr_read_b32 v249, a19
  v_mul_f32 v246, v246, v244
  v_mul_f32 v247, v247, v244
  v_mul_f32 v248, v248, v244
  v_mul_f32 v249, v249, v244
  v_accvgpr_write_b32 a16, v246
  v_accvgpr_write_b32 a17, v247
  v_accvgpr_write_b32 a18, v248
  v_accvgpr_write_b32 a19, v249
  v_accvgpr_read_b32 v246, a20
  v_accvgpr_read_b32 v247, a21
  v_accvgpr_read_b32 v248, a22
  v_accvgpr_read_b32 v249, a23
  v_mul_f32 v246, v246, v244
  v_mul_f32 v247, v247, v244
  v_mul_f32 v248, v248, v244
  v_mul_f32 v249, v249, v244
  v_accvgpr_write_b32 a20, v246
  v_accvgpr_write_b32 a21, v247
  v_accvgpr_write_b32 a22, v248
  v_accvgpr_write_b32 a23, v249
  v_accvgpr_read_b32 v246, a24
  v_accvgpr_read_b32 v247, a25
  v_accvgpr_read_b32 v248, a26
  v_accvgpr_read_b32 v249, a27
  v_mul_f32 v246, v246, v244
  v_mul_f32 v247, v247, v244
  v_mul_f32 v248, v248, v244
  v_mul_f32 v249, v249, v244
  v_accvgpr_write_b32 a24, v246
  v_accvgpr_write_b32 a25, v247
  v_accvgpr_write_b32 a26, v248
  v_accvgpr_write_b32 a27, v249
  v_accvgpr_read_b32 v246, a28
  v_accvgpr_read_b32 v247, a29
  v_accvgpr_read_b32 v248, a30
  v_accvgpr_read_b32 v249, a31
  v_mul_f32 v246, v246, v244
  v_mul_f32 v247, v247, v244
  v_mul_f32 v248, v248, v244
  v_mul_f32 v249, v249, v244
  v_accvgpr_write_b32 a28, v246
  v_accvgpr_write_b32 a29, v247
  v_accvgpr_write_b32 a30, v248
  v_accvgpr_write_b32 a31, v249
  v_accvgpr_read_b32 v246, a32
  v_accvgpr_read_b32 v247, a33
  v_accvgpr_read_b32 v248, a34
  v_accvgpr_read_b32 v249, a35
  v_mul_f32 v246, v246, v244
  v_mul_f32 v247, v247, v244
  v_mul_f32 v248, v248, v244
  v_mul_f32 v249, v249, v244
  v_accvgpr_write_b32 a32, v246
  v_accvgpr_write_b32 a33, v247
  v_accvgpr_write_b32 a34, v248
  v_accvgpr_write_b32 a35, v249
  v_accvgpr_read_b32 v246, a36
  v_accvgpr_read_b32 v247, a37
  v_accvgpr_read_b32 v248, a38
  v_accvgpr_read_b32 v249, a39
  v_mul_f32 v246, v246, v244
  v_mul_f32 v247, v247, v244
  v_mul_f32 v248, v248, v244
  v_mul_f32 v249, v249, v244
  v_accvgpr_write_b32 a36, v246
  v_accvgpr_write_b32 a37, v247
  v_accvgpr_write_b32 a38, v248
  v_accvgpr_write_b32 a39, v249
  v_accvgpr_read_b32 v246, a40
  v_accvgpr_read_b32 v247, a41
  v_accvgpr_read_b32 v248, a42
  v_accvgpr_read_b32 v249, a43
  v_mul_f32 v246, v246, v244
  v_mul_f32 v247, v247, v244
  v_mul_f32 v248, v248, v244
  v_mul_f32 v249, v249, v244
  v_accvgpr_write_b32 a40, v246
  v_accvgpr_write_b32 a41, v247
  v_accvgpr_write_b32 a42, v248
  v_accvgpr_write_b32 a43, v249
  v_accvgpr_read_b32 v246, a44
  v_accvgpr_read_b32 v247, a45
  v_accvgpr_read_b32 v248, a46
  v_accvgpr_read_b32 v249, a47
  v_mul_f32 v246, v246, v244
  v_mul_f32 v247, v247, v244
  v_mul_f32 v248, v248, v244
  v_mul_f32 v249, v249, v244
  v_accvgpr_write_b32 a44, v246
  v_accvgpr_write_b32 a45, v247
  v_accvgpr_write_b32 a46, v248
  v_accvgpr_write_b32 a47, v249
  v_sub_f32 v0, v0, v242
  v_sub_f32 v1, v1, v242
  v_sub_f32 v2, v2, v242
  v_sub_f32 v3, v3, v242
  v_sub_f32 v8, v8, v242
  v_sub_f32 v9, v9, v242
  v_sub_f32 v10, v10, v242
  v_sub_f32 v11, v11, v242
  v_sub_f32 v16, v16, v242
  v_sub_f32 v17, v17, v242
  v_sub_f32 v18, v18, v242
  v_sub_f32 v19, v19, v242
  v_sub_f32 v24, v24, v242
  v_sub_f32 v25, v25, v242
  v_sub_f32 v26, v26, v242
  v_sub_f32 v27, v27, v242
  v_sub_f32 v32, v32, v242
  v_sub_f32 v33, v33, v242
  v_sub_f32 v34, v34, v242
  v_sub_f32 v35, v35, v242
  v_sub_f32 v40, v40, v242
  v_sub_f32 v41, v41, v242
  v_sub_f32 v42, v42, v242
  v_sub_f32 v43, v43, v242
  v_sub_f32 v48, v48, v242
  v_sub_f32 v49, v49, v242
  v_sub_f32 v50, v50, v242
  v_sub_f32 v51, v51, v242
  v_sub_f32 v56, v56, v242
  v_sub_f32 v57, v57, v242
  v_sub_f32 v58, v58, v242
  v_sub_f32 v59, v59, v242
  v_exp_f32 v246, v0
  v_exp_f32 v247, v1
  v_exp_f32 v248, v2
  v_exp_f32 v249, v3
  v_cvt_pk_bf16_f32 v128, v246, v247
  v_cvt_pk_bf16_f32 v129, v248, v249
  v_exp_f32 v246, v8
  v_exp_f32 v247, v9
  v_exp_f32 v248, v10
  v_exp_f32 v249, v11
  v_cvt_pk_bf16_f32 v130, v246, v247
  v_cvt_pk_bf16_f32 v131, v248, v249
  v_exp_f32 v246, v16
  v_exp_f32 v247, v17
  v_exp_f32 v248, v18
  v_exp_f32 v249, v19
  v_cvt_pk_bf16_f32 v136, v246, v247
  v_cvt_pk_bf16_f32 v137, v248, v249
  v_exp_f32 v246, v24
  v_exp_f32 v247, v25
  v_exp_f32 v248, v26
  v_exp_f32 v249, v27
  v_cvt_pk_bf16_f32 v138, v246, v247
  v_cvt_pk_bf16_f32 v139, v248, v249
  s_nop 1
  v_mfma_f32_16x16x32_bf16 v[208:211], a[248:251], v[128:131], 0
  v_mfma_f32_16x16x32_bf16 v[208:211], a[248:251], v[136:139], v[208:211]
  v_max3_f32 v242, v4, v5, v6
  v_max3_f32 v242, v242, v7, v12
  v_max3_f32 v242, v242, v13, v14
  v_max3_f32 v242, v242, v15, v20
  v_max3_f32 v242, v242, v21, v22
  v_max3_f32 v242, v242, v23, v28
  v_max3_f32 v242, v242, v29, v30
  v_max_f32 v242, v242, v31
  v_mov_b32 v243, v242
  s_nop 1
  v_permlane16_swap_b32 v242, v243
  v_max_f32 v242, v242, v243
  v_mov_b32 v243, v242
  s_nop 1
  v_permlane32_swap_b32 v242, v243
  v_max_f32 v242, v242, v243
  v_max_f32 v242, 0, v242
  v_sub_f32 v244, 0, v242
  v_exp_f32 v244, v244
  v_sub_f32 v196, v196, v242
  v_sub_f32 v197, v197, v242
  v_sub_f32 v198, v198, v242
  v_sub_f32 v199, v199, v242
  v_mul_f32 v231, v231, v244
  v_accvgpr_read_b32 v246, a80
  v_accvgpr_read_b32 v247, a81
  v_accvgpr_read_b32 v248, a82
  v_accvgpr_read_b32 v249, a83
  v_mul_f32 v246, v246, v244
  v_mul_f32 v247, v247, v244
  v_mul_f32 v248, v248, v244
  v_mul_f32 v249, v249, v244
  v_accvgpr_write_b32 a80, v246
  v_accvgpr_write_b32 a81, v247
  v_accvgpr_write_b32 a82, v248
  v_accvgpr_write_b32 a83, v249
  v_accvgpr_read_b32 v246, a84
  v_accvgpr_read_b32 v247, a85
  v_accvgpr_read_b32 v248, a86
  v_accvgpr_read_b32 v249, a87
  v_mul_f32 v246, v246, v244
  v_mul_f32 v247, v247, v244
  v_mul_f32 v248, v248, v244
  v_mul_f32 v249, v249, v244
  v_accvgpr_write_b32 a84, v246
  v_accvgpr_write_b32 a85, v247
  v_accvgpr_write_b32 a86, v248
  v_accvgpr_write_b32 a87, v249
  v_accvgpr_read_b32 v246, a88
  v_accvgpr_read_b32 v247, a89
  v_accvgpr_read_b32 v248, a90
  v_accvgpr_read_b32 v249, a91
  v_mul_f32 v246, v246, v244
  v_mul_f32 v247, v247, v244
  v_mul_f32 v248, v248, v244
  v_mul_f32 v249, v249, v244
  v_accvgpr_write_b32 a88, v246
  v_accvgpr_write_b32 a89, v247
  v_accvgpr_write_b32 a90, v248
  v_accvgpr_write_b32 a91, v249
  v_accvgpr_read_b32 v246, a92
  v_accvgpr_read_b32 v247, a93
  v_accvgpr_read_b32 v248, a94
  v_accvgpr_read_b32 v249, a95
  v_mul_f32 v246, v246, v244
  v_mul_f32 v247, v247, v244
  v_mul_f32 v248, v248, v244
  v_mul_f32 v249, v249, v244
  v_accvgpr_write_b32 a92, v246
  v_accvgpr_write_b32 a93, v247
  v_accvgpr_write_b32 a94, v248
  v_accvgpr_write_b32 a95, v249
  v_accvgpr_read_b32 v246, a96
  v_accvgpr_read_b32 v247, a97
  v_accvgpr_read_b32 v248, a98
  v_accvgpr_read_b32 v249, a99
  v_mul_f32 v246, v246, v244
  v_mul_f32 v247, v247, v244
  v_mul_f32 v248, v248, v244
  v_mul_f32 v249, v249, v244
  v_accvgpr_write_b32 a96, v246
  v_accvgpr_write_b32 a97, v247
  v_accvgpr_write_b32 a98, v248
  v_accvgpr_write_b32 a99, v249
  v_accvgpr_read_b32 v246, a100
  v_accvgpr_read_b32 v247, a101
  v_accvgpr_read_b32 v248, a102
  v_accvgpr_read_b32 v249, a103
  v_mul_f32 v246, v246, v244
  v_mul_f32 v247, v247, v244
  v_mul_f32 v248, v248, v244
  v_mul_f32 v249, v249, v244
  v_accvgpr_write_b32 a100, v246
  v_accvgpr_write_b32 a101, v247
  v_accvgpr_write_b32 a102, v248
  v_accvgpr_write_b32 a103, v249
  v_accvgpr_read_b32 v246, a104
  v_accvgpr_read_b32 v247, a105
  v_accvgpr_read_b32 v248, a106
  v_accvgpr_read_b32 v249, a107
  v_mul_f32 v246, v246, v244
  v_mul_f32 v247, v247, v244
  v_mul_f32 v248, v248, v244
  v_mul_f32 v249, v249, v244
  v_accvgpr_write_b32 a104, v246
  v_accvgpr_write_b32 a105, v247
  v_accvgpr_write_b32 a106, v248
  v_accvgpr_write_b32 a107, v249
  v_accvgpr_read_b32 v246, a108
  v_accvgpr_read_b32 v247, a109
  v_accvgpr_read_b32 v248, a110
  v_accvgpr_read_b32 v249, a111
  v_mul_f32 v246, v246, v244
  v_mul_f32 v247, v247, v244
  v_mul_f32 v248, v248, v244
  v_mul_f32 v249, v249, v244
  v_accvgpr_write_b32 a108, v246
  v_accvgpr_write_b32 a109, v247
  v_accvgpr_write_b32 a110, v248
  v_accvgpr_write_b32 a111, v249
  v_sub_f32 v4, v4, v242
  v_sub_f32 v5, v5, v242
  v_sub_f32 v6, v6, v242
  v_sub_f32 v7, v7, v242
  v_sub_f32 v12, v12, v242
  v_sub_f32 v13, v13, v242
  v_sub_f32 v14, v14, v242
  v_sub_f32 v15, v15, v242
  v_sub_f32 v20, v20, v242
  v_sub_f32 v21, v21, v242
  v_sub_f32 v22, v22, v242
  v_sub_f32 v23, v23, v242
  v_sub_f32 v28, v28, v242
  v_sub_f32 v29, v29, v242
  v_sub_f32 v30, v30, v242
  v_sub_f32 v31, v31, v242
  v_sub_f32 v36, v36, v242
  v_sub_f32 v37, v37, v242
  v_sub_f32 v38, v38, v242
  v_sub_f32 v39, v39, v242
  v_sub_f32 v44, v44, v242
  v_sub_f32 v45, v45, v242
  v_sub_f32 v46, v46, v242
  v_sub_f32 v47, v47, v242
  v_sub_f32 v52, v52, v242
  v_sub_f32 v53, v53, v242
  v_sub_f32 v54, v54, v242
  v_sub_f32 v55, v55, v242
  v_sub_f32 v60, v60, v242
  v_sub_f32 v61, v61, v242
  v_sub_f32 v62, v62, v242
  v_sub_f32 v63, v63, v242
  v_exp_f32 v246, v4
  v_exp_f32 v247, v5
  v_exp_f32 v248, v6
  v_exp_f32 v249, v7
  v_cvt_pk_bf16_f32 v132, v246, v247
  v_cvt_pk_bf16_f32 v133, v248, v249
  v_exp_f32 v246, v12
  v_exp_f32 v247, v13
  v_exp_f32 v248, v14
  v_exp_f32 v249, v15
  v_cvt_pk_bf16_f32 v134, v246, v247
  v_cvt_pk_bf16_f32 v135, v248, v249
  v_exp_f32 v246, v20
  v_exp_f32 v247, v21
  v_exp_f32 v248, v22
  v_exp_f32 v249, v23
  v_cvt_pk_bf16_f32 v140, v246, v247
  v_cvt_pk_bf16_f32 v141, v248, v249
  v_exp_f32 v246, v28
  v_exp_f32 v247, v29
  v_exp_f32 v248, v30
  v_exp_f32 v249, v31
  v_cvt_pk_bf16_f32 v142, v246, v247
  v_cvt_pk_bf16_f32 v143, v248, v249
  s_nop 1
  v_mfma_f32_16x16x32_bf16 v[212:215], a[248:251], v[132:135], 0
  v_mfma_f32_16x16x32_bf16 v[212:215], a[248:251], v[140:143], v[212:215]
  s_nop 15
  s_nop 1
  s_setpc_b64 s[76:77]
L_mask01:
  s_nop 7
  s_add_u32 s49, s45, 1
  s_lshl_b32 s49, s49, 6
  v_subrev_u32 v242, s49, v236
  v_cmp_ge_i32 s[78:79], v242, 0
  v_cmp_ge_i32 s[80:81], v242, 1
  v_cmp_ge_i32 s[82:83], v242, 2
  v_cmp_ge_i32 s[84:85], v242, 3
  v_cndmask_b32 v32, v241, v32, s[78:79]
  v_cndmask_b32 v33, v241, v33, s[80:81]
  v_cndmask_b32 v34, v241, v34, s[82:83]
  v_cndmask_b32 v35, v241, v35, s[84:85]
  v_cmp_ge_i32 s[78:79], v242, -16
  v_cmp_ge_i32 s[80:81], v242, -15
  v_cmp_ge_i32 s[82:83], v242, -14
  v_cmp_ge_i32 s[84:85], v242, -13
  v_cndmask_b32 v36, v241, v36, s[78:79]
  v_cndmask_b32 v37, v241, v37, s[80:81]
  v_cndmask_b32 v38, v241, v38, s[82:83]
  v_cndmask_b32 v39, v241, v39, s[84:85]
  v_cmp_ge_i32 s[78:79], v242, 16
  v_cmp_ge_i32 s[80:81], v242, 17
  v_cmp_ge_i32 s[82:83], v242, 18
  v_cmp_ge_i32 s[84:85], v242, 19
  v_cndmask_b32 v40, v241, v40, s[78:79]
  v_cndmask_b32 v41, v241, v41, s[80:81]
  v_cndmask_b32 v42, v241, v42, s[82:83]
  v_cndmask_b32 v43, v241, v43, s[84:85]
  v_cmp_ge_i32 s[78:79], v242, 0
  v_cmp_ge_i32 s[80:81], v242, 1
  v_cmp_ge_i32 s[82:83], v242, 2
  v_cmp_ge_i32 s[84:85], v242, 3
  v_cndmask_b32 v44, v241, v44, s[78:79]
  v_cndmask_b32 v45, v241, v45, s[80:81]
  v_cndmask_b32 v46, v241, v46, s[82:83]
  v_cndmask_b32 v47, v241, v47, s[84:85]
  v_cmp_ge_i32 s[78:79], v242, 32
  v_cmp_ge_i32 s[80:81], v242, 33
  v_cmp_ge_i32 s[82:83], v242, 34
  v_cmp_ge_i32 s[84:85], v242, 35
  v_cndmask_b32 v48, v241, v48, s[78:79]
  v_cndmask_b32 v49, v241, v49, s[80:81]
  v_cndmask_b32 v50, v241, v50, s[82:83]
  v_cndmask_b32 v51, v241, v51, s[84:85]
  v_cmp_ge_i32 s[78:79], v242, 16
  v_cmp_ge_i32 s[80:81], v242, 17
  v_cmp_ge_i32 s[82:83], v242, 18
  v_cmp_ge_i32 s[84:85], v242, 19
  v_cndmask_b32 v52, v241, v52, s[78:79]
  v_cndmask_b32 v53, v241, v53, s[80:81]
  v_cndmask_b32 v54, v241, v54, s[82:83]
  v_cndmask_b32 v55, v241, v55, s[84:85]
  v_cmp_ge_i32 s[78:79], v242, 48
  v_cmp_ge_i32 s[80:81], v242, 49
  v_cmp_ge_i32 s[82:83], v242, 50
  v_cmp_ge_i32 s[84:85], v242, 51
  v_cndmask_b32 v56, v241, v56, s[78:79]
  v_cndmask_b32 v57, v241, v57, s[80:81]
  v_cndmask_b32 v58, v241, v58, s[82:83]
  v_cndmask_b32 v59, v241, v59, s[84:85]
  v_cmp_ge_i32 s[78:79], v242, 32
  v_cmp_ge_i32 s[80:81], v242, 33
  v_cmp_ge_i32 s[82:83], v242, 34
  v_cmp_ge_i32 s[84:85], v242, 35
  v_cndmask_b32 v60, v241, v60, s[78:79]
  v_cndmask_b32 v61, v241, v61, s[80:81]
  v_cndmask_b32 v62, v241, v62, s[82:83]
  v_cndmask_b32 v63, v241, v63, s[84:85]
  s_setpc_b64 s[76:77]
L_rare01:
  s_nop 15
  v_max3_f32 v242, v32, v33, v34
  v_max3_f32 v242, v242, v35, v40
  v_max3_f32 v242, v242, v41, v42
  v_max3_f32 v242, v242, v43, v48
  v_max3_f32 v242, v242, v49, v50
  v_max3_f32 v242, v242, v51, v56
  v_max3_f32 v242, v242, v57, v58
  v_max_f32 v242, v242, v59
  v_mov_b32 v243, v242
  s_nop 1
  v_permlane16_swap_b32 v242, v243
  v_max_f32 v242, v242, v243
  v_mov_b32 v243, v242
  s_nop 1
  v_permlane32_swap_b32 v242, v243
  v_max_f32 v242, v242, v243
  v_max_f32 v242, 0, v242
  v_sub_f32 v244, 0, v242
  v_exp_f32 v244, v244
  v_sub_f32 v192, v192, v242
  v_sub_f32 v193, v193, v242
  v_sub_f32 v194, v194, v242
  v_sub_f32 v195, v195, v242
  v_mul_f32 v230, v230, v244
  v_accvgpr_read_b32 v246, a16
  v_accvgpr_read_b32 v247, a17
  v_accvgpr_read_b32 v248, a18
  v_accvgpr_read_b32 v249, a19
  v_mul_f32 v246, v246, v244
  v_mul_f32 v247, v247, v244
  v_mul_f32 v248, v248, v244
  v_mul_f32 v249, v249, v244
  v_accvgpr_write_b32 a16, v246
  v_accvgpr_write_b32 a17, v247
  v_accvgpr_write_b32 a18, v248
  v_accvgpr_write_b32 a19, v249
  v_accvgpr_read_b32 v246, a20
  v_accvgpr_read_b32 v247, a21
  v_accvgpr_read_b32 v248, a22
  v_accvgpr_read_b32 v249, a23
  v_mul_f32 v246, v246, v244
  v_mul_f32 v247, v247, v244
  v_mul_f32 v248, v248, v244
  v_mul_f32 v249, v249, v244
  v_accvgpr_write_b32 a20, v246
  v_accvgpr_write_b32 a21, v247
  v_accvgpr_write_b32 a22, v248
  v_accvgpr_write_b32 a23, v249
  v_accvgpr_read_b32 v246, a24
  v_accvgpr_read_b32 v247, a25
  v_accvgpr_read_b32 v248, a26
  v_accvgpr_read_b32 v249, a27
  v_mul_f32 v246, v246, v244
  v_mul_f32 v247, v247, v244
  v_mul_f32 v248, v248, v244
  v_mul_f32 v249, v249, v244
  v_accvgpr_write_b32 a24, v246
  v_accvgpr_write_b32 a25, v247
  v_accvgpr_write_b32 a26, v248
  v_accvgpr_write_b32 a27, v249
  v_accvgpr_read_b32 v246, a28
  v_accvgpr_read_b32 v247, a29
  v_accvgpr_read_b32 v248, a30
  v_accvgpr_read_b32 v249, a31
  v_mul_f32 v246, v246, v244
  v_mul_f32 v247, v247, v244
  v_mul_f32 v248, v248, v244
  v_mul_f32 v249, v249, v244
  v_accvgpr_write_b32 a28, v246
  v_accvgpr_write_b32 a29, v247
  v_accvgpr_write_b32 a30, v248
  v_accvgpr_write_b32 a31, v249
  v_accvgpr_read_b32 v246, a32
  v_accvgpr_read_b32 v247, a33
  v_accvgpr_read_b32 v248, a34
  v_accvgpr_read_b32 v249, a35
  v_mul_f32 v246, v246, v244
  v_mul_f32 v247, v247, v244
  v_mul_f32 v248, v248, v244
  v_mul_f32 v249, v249, v244
  v_accvgpr_write_b32 a32, v246
  v_accvgpr_write_b32 a33, v247
  v_accvgpr_write_b32 a34, v248
  v_accvgpr_write_b32 a35, v249
  v_accvgpr_read_b32 v246, a36
  v_accvgpr_read_b32 v247, a37
  v_accvgpr_read_b32 v248, a38
  v_accvgpr_read_b32 v249, a39
  v_mul_f32 v246, v246, v244
  v_mul_f32 v247, v247, v244
  v_mul_f32 v248, v248, v244
  v_mul_f32 v249, v249, v244
  v_accvgpr_write_b32 a36, v246
  v_accvgpr_write_b32 a37, v247
  v_accvgpr_write_b32 a38, v248
  v_accvgpr_write_b32 a39, v249
  v_accvgpr_read_b32 v246, a40
  v_accvgpr_read_b32 v247, a41
  v_accvgpr_read_b32 v248, a42
  v_accvgpr_read_b32 v249, a43
  v_mul_f32 v246, v246, v244
  v_mul_f32 v247, v247, v244
  v_mul_f32 v248, v248, v244
  v_mul_f32 v249, v249, v244
  v_accvgpr_write_b32 a40, v246
  v_accvgpr_write_b32 a41, v247
  v_accvgpr_write_b32 a42, v248
  v_accvgpr_write_b32 a43, v249
  v_accvgpr_read_b32 v246, a44
  v_accvgpr_read_b32 v247, a45
  v_accvgpr_read_b32 v248, a46
  v_accvgpr_read_b32 v249, a47
  v_mul_f32 v246, v246, v244
  v_mul_f32 v247, v247, v244
  v_mul_f32 v248, v248, v244
  v_mul_f32 v249, v249, v244
  v_accvgpr_write_b32 a44, v246
  v_accvgpr_write_b32 a45, v247
  v_accvgpr_write_b32 a46, v248
  v_accvgpr_write_b32 a47, v249
  v_sub_f32 v0, v0, v242
  v_sub_f32 v1, v1, v242
  v_sub_f32 v2, v2, v242
  v_sub_f32 v3, v3, v242
  v_sub_f32 v8, v8, v242
  v_sub_f32 v9, v9, v242
  v_sub_f32 v10, v10, v242
  v_sub_f32 v11, v11, v242
  v_sub_f32 v16, v16, v242
  v_sub_f32 v17, v17, v242
  v_sub_f32 v18, v18, v242
  v_sub_f32 v19, v19, v242
  v_sub_f32 v24, v24, v242
  v_sub_f32 v25, v25, v242
  v_sub_f32 v26, v26, v242
  v_sub_f32 v27, v27, v242
  v_sub_f32 v32, v32, v242
  v_sub_f32 v33, v33, v242
  v_sub_f32 v34, v34, v242
  v_sub_f32 v35, v35, v242
  v_sub_f32 v40, v40, v242
  v_sub_f32 v41, v41, v242
  v_sub_f32 v42, v42, v242
  v_sub_f32 v43, v43, v242
  v_sub_f32 v48, v48, v242
  v_sub_f32 v49, v49, v242
  v_sub_f32 v50, v50, v242
  v_sub_f32 v51, v51, v242
  v_sub_f32 v56, v56, v242
  v_sub_f32 v57, v57, v242
  v_sub_f32 v58, v58, v242
  v_sub_f32 v59, v59, v242
  v_exp_f32 v246, v32
  v_exp_f32 v247, v33
  v_exp_f32 v248, v34
  v_exp_f32 v249, v35
  v_cvt_pk_bf16_f32 v144, v246, v247
  v_cvt_pk_bf16_f32 v145, v248, v249
  v_exp_f32 v246, v40
  v_exp_f32 v247, v41
  v_exp_f32 v248, v42
  v_exp_f32 v249, v43
  v_cvt_pk_bf16_f32 v146, v246, v247
  v_cvt_pk_bf16_f32 v147, v248, v249
  v_exp_f32 v246, v48
  v_exp_f32 v247, v49
  v_exp_f32 v248, v50
  v_exp_f32 v249, v51
  v_cvt_pk_bf16_f32 v152, v246, v247
  v_cvt_pk_bf16_f32 v153, v248, v249
  v_exp_f32 v246, v56
  v_exp_f32 v247, v57
  v_exp_f32 v248, v58
  v_exp_f32 v249, v59
  v_cvt_pk_bf16_f32 v154, v246, v247
  v_cvt_pk_bf16_f32 v155, v248, v249
  s_nop 1
  v_mfma_f32_16x16x32_bf16 v[208:211], a[248:251], v[144:147], 0
  v_mfma_f32_16x16x32_bf16 v[208:211], a[248:251], v[152:155], v[208:211]
  v_max3_f32 v242, v36, v37, v38
  v_max3_f32 v242, v242, v39, v44
  v_max3_f32 v242, v242, v45, v46
  v_max3_f32 v242, v242, v47, v52
  v_max3_f32 v242, v242, v53, v54
  v_max3_f32 v242, v242, v55, v60
  v_max3_f32 v242, v242, v61, v62
  v_max_f32 v242, v242, v63
  v_mov_b32 v243, v242
  s_nop 1
  v_permlane16_swap_b32 v242, v243
  v_max_f32 v242, v242, v243
  v_mov_b32 v243, v242
  s_nop 1
  v_permlane32_swap_b32 v242, v243
  v_max_f32 v242, v242, v243
  v_max_f32 v242, 0, v242
  v_sub_f32 v244, 0, v242
  v_exp_f32 v244, v244
  v_sub_f32 v196, v196, v242
  v_sub_f32 v197, v197, v242
  v_sub_f32 v198, v198, v242
  v_sub_f32 v199, v199, v242
  v_mul_f32 v231, v231, v244
  v_accvgpr_read_b32 v246, a80
  v_accvgpr_read_b32 v247, a81
  v_accvgpr_read_b32 v248, a82
  v_accvgpr_read_b32 v249, a83
  v_mul_f32 v246, v246, v244
  v_mul_f32 v247, v247, v244
  v_mul_f32 v248, v248, v244
  v_mul_f32 v249, v249, v244
  v_accvgpr_write_b32 a80, v246
  v_accvgpr_write_b32 a81, v247
  v_accvgpr_write_b32 a82, v248
  v_accvgpr_write_b32 a83, v249
  v_accvgpr_read_b32 v246, a84
  v_accvgpr_read_b32 v247, a85
  v_accvgpr_read_b32 v248, a86
  v_accvgpr_read_b32 v249, a87
  v_mul_f32 v246, v246, v244
  v_mul_f32 v247, v247, v244
  v_mul_f32 v248, v248, v244
  v_mul_f32 v249, v249, v244
  v_accvgpr_write_b32 a84, v246
  v_accvgpr_write_b32 a85, v247
  v_accvgpr_write_b32 a86, v248
  v_accvgpr_write_b32 a87, v249
  v_accvgpr_read_b32 v246, a88
  v_accvgpr_read_b32 v247, a89
  v_accvgpr_read_b32 v248, a90
  v_accvgpr_read_b32 v249, a91
  v_mul_f32 v246, v246, v244
  v_mul_f32 v247, v247, v244
  v_mul_f32 v248, v248, v244
  v_mul_f32 v249, v249, v244
  v_accvgpr_write_b32 a88, v246
  v_accvgpr_write_b32 a89, v247
  v_accvgpr_write_b32 a90, v248
  v_accvgpr_write_b32 a91, v249
  v_accvgpr_read_b32 v246, a92
  v_accvgpr_read_b32 v247, a93
  v_accvgpr_read_b32 v248, a94
  v_accvgpr_read_b32 v249, a95
  v_mul_f32 v246, v246, v244
  v_mul_f32 v247, v247, v244
  v_mul_f32 v248, v248, v244
  v_mul_f32 v249, v249, v244
  v_accvgpr_write_b32 a92, v246
  v_accvgpr_write_b32 a93, v247
  v_accvgpr_write_b32 a94, v248
  v_accvgpr_write_b32 a95, v249
  v_accvgpr_read_b32 v246, a96
  v_accvgpr_read_b32 v247, a97
  v_accvgpr_read_b32 v248, a98
  v_accvgpr_read_b32 v249, a99
  v_mul_f32 v246, v246, v244
  v_mul_f32 v247, v247, v244
  v_mul_f32 v248, v248, v244
  v_mul_f32 v249, v249, v244
  v_accvgpr_write_b32 a96, v246
  v_accvgpr_write_b32 a97, v247
  v_accvgpr_write_b32 a98, v248
  v_accvgpr_write_b32 a99, v249
  v_accvgpr_read_b32 v246, a100
  v_accvgpr_read_b32 v247, a101
  v_accvgpr_read_b32 v248, a102
  v_accvgpr_read_b32 v249, a103
  v_mul_f32 v246, v246, v244
  v_mul_f32 v247, v247, v244
  v_mul_f32 v248, v248, v244
  v_mul_f32 v249, v249, v244
  v_accvgpr_write_b32 a100, v246
  v_accvgpr_write_b32 a101, v247
  v_accvgpr_write_b32 a102, v248
  v_accvgpr_write_b32 a103, v249
  v_accvgpr_read_b32 v246, a104
  v_accvgpr_read_b32 v247, a105
  v_accvgpr_read_b32 v248, a106
  v_accvgpr_read_b32 v249, a107
  v_mul_f32 v246, v246, v244
  v_mul_f32 v247, v247, v244
  v_mul_f32 v248, v248, v244
  v_mul_f32 v249, v249, v244
  v_accvgpr_write_b32 a104, v246
  v_accvgpr_write_b32 a105, v247
  v_accvgpr_write_b32 a106, v248
  v_accvgpr_write_b32 a107, v249
  v_accvgpr_read_b32 v246, a108
  v_accvgpr_read_b32 v247, a109
  v_accvgpr_read_b32 v248, a110
  v_accvgpr_read_b32 v249, a111
  v_mul_f32 v246, v246, v244
  v_mul_f32 v247, v247, v244
  v_mul_f32 v248, v248, v244
  v_mul_f32 v249, v249, v244
  v_accvgpr_write_b32 a108, v246
  v_accvgpr_write_b32 a109, v247
  v_accvgpr_write_b32 a110, v248
  v_accvgpr_write_b32 a111, v249
  v_sub_f32 v4, v4, v242
  v_sub_f32 v5, v5, v242
  v_sub_f32 v6, v6, v242
  v_sub_f32 v7, v7, v242
  v_sub_f32 v12, v12, v242
  v_sub_f32 v13, v13, v242
  v_sub_f32 v14, v14, v242
  v_sub_f32 v15, v15, v242
  v_sub_f32 v20, v20, v242
  v_sub_f32 v21, v21, v242
  v_sub_f32 v22, v22, v242
  v_sub_f32 v23, v23, v242
  v_sub_f32 v28, v28, v242
  v_sub_f32 v29, v29, v242
  v_sub_f32 v30, v30, v242
  v_sub_f32 v31, v31, v242
  v_sub_f32 v36, v36, v242
  v_sub_f32 v37, v37, v242
  v_sub_f32 v38, v38, v242
  v_sub_f32 v39, v39, v242
  v_sub_f32 v44, v44, v242
  v_sub_f32 v45, v45, v242
  v_sub_f32 v46, v46, v242
  v_sub_f32 v47, v47, v242
  v_sub_f32 v52, v52, v242
  v_sub_f32 v53, v53, v242
  v_sub_f32 v54, v54, v242
  v_sub_f32 v55, v55, v242
  v_sub_f32 v60, v60, v242
  v_sub_f32 v61, v61, v242
  v_sub_f32 v62, v62, v242
  v_sub_f32 v63, v63, v242
  v_exp_f32 v246, v36
  v_exp_f32 v247, v37
  v_exp_f32 v248, v38
  v_exp_f32 v249, v39
  v_cvt_pk_bf16_f32 v148, v246, v247
  v_cvt_pk_bf16_f32 v149, v248, v249
  v_exp_f32 v246, v44
  v_exp_f32 v247, v45
  v_exp_f32 v248, v46
  v_exp_f32 v249, v47
  v_cvt_pk_bf16_f32 v150, v246, v247
  v_cvt_pk_bf16_f32 v151, v248, v249
  v_exp_f32 v246, v52
  v_exp_f32 v247, v53
  v_exp_f32 v248, v54
  v_exp_f32 v249, v55
  v_cvt_pk_bf16_f32 v156, v246, v247
  v_cvt_pk_bf16_f32 v157, v248, v249
  v_exp_f32 v246, v60
  v_exp_f32 v247, v61
  v_exp_f32 v248, v62
  v_exp_f32 v249, v63
  v_cvt_pk_bf16_f32 v158, v246, v247
  v_cvt_pk_bf16_f32 v159, v248, v249
  s_nop 1
  v_mfma_f32_16x16x32_bf16 v[212:215], a[248:251], v[148:151], 0
  v_mfma_f32_16x16x32_bf16 v[212:215], a[248:251], v[156:159], v[212:215]
  s_nop 15
  s_nop 1
  s_setpc_b64 s[76:77]
L_mask10:
  s_nop 7
  s_add_u32 s49, s45, 1
  s_lshl_b32 s49, s49, 6
  v_subrev_u32 v242, s49, v237
  v_cmp_ge_i32 s[78:79], v242, 0
  v_cmp_ge_i32 s[80:81], v242, 1
  v_cmp_ge_i32 s[82:83], v242, 2
  v_cmp_ge_i32 s[84:85], v242, 3
  v_cndmask_b32 v64, v241, v64, s[78:79]
  v_cndmask_b32 v65, v241, v65, s[80:81]
  v_cndmask_b32 v66, v241, v66, s[82:83]
  v_cndmask_b32 v67, v241, v67, s[84:85]
  v_cmp_ge_i32 s[78:79], v242, -16
  v_cmp_ge_i32 s[80:81], v242, -15
  v_cmp_ge_i32 s[82:83], v242, -14
  v_cmp_ge_i32 s[84:85], v242, -13
  v_cndmask_b32 v68, v241, v68, s[78:79]
  v_cndmask_b32 v69, v241, v69, s[80:81]
  v_cndmask_b32 v70, v241, v70, s[82:83]
  v_cndmask_b32 v71, v241, v71, s[84:85]
  v_cmp_ge_i32 s[78:79], v242, 16
  v_cmp_ge_i32 s[80:81], v242, 17
  v_cmp_ge_i32 s[82:83], v242, 18
  v_cmp_ge_i32 s[84:85], v242, 19
  v_cndmask_b32 v72, v241, v72, s[78:79]
  v_cndmask_b32 v73, v241, v73, s[80:81]
  v_cndmask_b32 v74, v241, v74, s[82:83]
  v_cndmask_b32 v75, v241, v75, s[84:85]
  v_cmp_ge_i32 s[78:79], v242, 0
  v_cmp_ge_i32 s[80:81], v242, 1
  v_cmp_ge_i32 s[82:83], v242, 2
  v_cmp_ge_i32 s[84:85], v242, 3
  v_cndmask_b32 v76, v241, v76, s[78:79]
  v_cndmask_b32 v77, v241, v77, s[80:81]
  v_cndmask_b32 v78, v241, v78, s[82:83]
  v_cndmask_b32 v79, v241, v79, s[84:85]
  v_cmp_ge_i32 s[78:79], v242, 32
  v_cmp_ge_i32 s[80:81], v242, 33
  v_cmp_ge_i32 s[82:83], v242, 34
  v_cmp_ge_i32 s[84:85], v242, 35
  v_cndmask_b32 v80, v241, v80, s[78:79]
  v_cndmask_b32 v81, v241, v81, s[80:81]
  v_cndmask_b32 v82, v241, v82, s[82:83]
  v_cndmask_b32 v83, v241, v83, s[84:85]
  v_cmp_ge_i32 s[78:79], v242, 16
  v_cmp_ge_i32 s[80:81], v242, 17
  v_cmp_ge_i32 s[82:83], v242, 18
  v_cmp_ge_i32 s[84:85], v242, 19
  v_cndmask_b32 v84, v241, v84, s[78:79]
  v_cndmask_b32 v85, v241, v85, s[80:81]
  v_cndmask_b32 v86, v241, v86, s[82:83]
  v_cndmask_b32 v87, v241, v87, s[84:85]
  v_cmp_ge_i32 s[78:79], v242, 48
  v_cmp_ge_i32 s[80:81], v242, 49
  v_cmp_ge_i32 s[82:83], v242, 50
  v_cmp_ge_i32 s[84:85], v242, 51
  v_cndmask_b32 v88, v241, v88, s[78:79]
  v_cndmask_b32 v89, v241, v89, s[80:81]
  v_cndmask_b32 v90, v241, v90, s[82:83]
  v_cndmask_b32 v91, v241, v91, s[84:85]
  v_cmp_ge_i32 s[78:79], v242, 32
  v_cmp_ge_i32 s[80:81], v242, 33
  v_cmp_ge_i32 s[82:83], v242, 34
  v_cmp_ge_i32 s[84:85], v242, 35
  v_cndmask_b32 v92, v241, v92, s[78:79]
  v_cndmask_b32 v93, v241, v93, s[80:81]
  v_cndmask_b32 v94, v241, v94, s[82:83]
  v_cndmask_b32 v95, v241, v95, s[84:85]
  s_setpc_b64 s[76:77]
L_rare10:
  s_nop 15
  v_max3_f32 v242, v64, v65, v66
  v_max3_f32 v242, v242, v67, v72
  v_max3_f32 v242, v242, v73, v74
  v_max3_f32 v242, v242, v75, v80
  v_max3_f32 v242, v242, v81, v82
  v_max3_f32 v242, v242, v83, v88
  v_max3_f32 v242, v242, v89, v90
  v_max_f32 v242, v242, v91
  v_mov_b32 v243, v242
  s_nop 1
  v_permlane16_swap_b32 v242, v243
  v_max_f32 v242, v242, v243
  v_mov_b32 v243, v242
  s_nop 1
  v_permlane32_swap_b32 v242, v243
  v_max_f32 v242, v242, v243
  v_max_f32 v242, 0, v242
  v_sub_f32 v244, 0, v242
  v_exp_f32 v244, v244
  v_sub_f32 v200, v200, v242
  v_sub_f32 v201, v201, v242
  v_sub_f32 v202, v202, v242
  v_sub_f32 v203, v203, v242
  v_mul_f32 v232, v232, v244
  v_accvgpr_read_b32 v246, a144
  v_accvgpr_read_b32 v247, a145
  v_accvgpr_read_b32 v248, a146
  v_accvgpr_read_b32 v249, a147
  v_mul_f32 v246, v246, v244
  v_mul_f32 v247, v247, v244
  v_mul_f32 v248, v248, v244
  v_mul_f32 v249, v249, v244
  v_accvgpr_write_b32 a144, v246
  v_accvgpr_write_b32 a145, v247
  v_accvgpr_write_b32 a146, v248
  v_accvgpr_write_b32 a147, v249
  v_accvgpr_read_b32 v246, a148
  v_accvgpr_read_b32 v247, a149
  v_accvgpr_read_b32 v248, a150
  v_accvgpr_read_b32 v249, a151
  v_mul_f32 v246, v246, v244
  v_mul_f32 v247, v247, v244
  v_mul_f32 v248, v248, v244
  v_mul_f32 v249, v249, v244
  v_accvgpr_write_b32 a148, v246
  v_accvgpr_write_b32 a149, v247
  v_accvgpr_write_b32 a150, v248
  v_accvgpr_write_b32 a151, v249
  v_accvgpr_read_b32 v246, a152
  v_accvgpr_read_b32 v247, a153
  v_accvgpr_read_b32 v248, a154
  v_accvgpr_read_b32 v249, a155
  v_mul_f32 v246, v246, v244
  v_mul_f32 v247, v247, v244
  v_mul_f32 v248, v248, v244
  v_mul_f32 v249, v249, v244
  v_accvgpr_write_b32 a152, v246
  v_accvgpr_write_b32 a153, v247
  v_accvgpr_write_b32 a154, v248
  v_accvgpr_write_b32 a155, v249
  v_accvgpr_read_b32 v246, a156
  v_accvgpr_read_b32 v247, a157
  v_accvgpr_read_b32 v248, a158
  v_accvgpr_read_b32 v249, a159
  v_mul_f32 v246, v246, v244
  v_mul_f32 v247, v247, v244
  v_mul_f32 v248, v248, v244
  v_mul_f32 v249, v249, v244
  v_accvgpr_write_b32 a156, v246
  v_accvgpr_write_b32 a157, v247
  v_accvgpr_write_b32 a158, v248
  v_accvgpr_write_b32 a159, v249
  v_accvgpr_read_b32 v246, a160
  v_accvgpr_read_b32 v247, a161
  v_accvgpr_read_b32 v248, a162
  v_accvgpr_read_b32 v249, a163
  v_mul_f32 v246, v246, v244
  v_mul_f32 v247, v247, v244
  v_mul_f32 v248, v248, v244
  v_mul_f32 v249, v249, v244
  v_accvgpr_write_b32 a160, v246
  v_accvgpr_write_b32 a161, v247
  v_accvgpr_write_b32 a162, v248
  v_accvgpr_write_b32 a163, v249
  v_accvgpr_read_b32 v246, a164
  v_accvgpr_read_b32 v247, a165
  v_accvgpr_read_b32 v248, a166
  v_accvgpr_read_b32 v249, a167
  v_mul_f32 v246, v246, v244
  v_mul_f32 v247, v247, v244
  v_mul_f32 v248, v248, v244
  v_mul_f32 v249, v249, v244
  v_accvgpr_write_b32 a164, v246
  v_accvgpr_write_b32 a165, v247
  v_accvgpr_write_b32 a166, v248
  v_accvgpr_write_b32 a167, v249
  v_accvgpr_read_b32 v246, a168
  v_accvgpr_read_b32 v247, a169
  v_accvgpr_read_b32 v248, a170
  v_accvgpr_read_b32 v249, a171
  v_mul_f32 v246, v246, v244
  v_mul_f32 v247, v247, v244
  v_mul_f32 v248, v248, v244
  v_mul_f32 v249, v249, v244
  v_accvgpr_write_b32 a168, v246
  v_accvgpr_write_b32 a169, v247
  v_accvgpr_write_b32 a170, v248
  v_accvgpr_write_b32 a171, v249
  v_accvgpr_read_b32 v246, a172
  v_accvgpr_read_b32 v247, a173
  v_accvgpr_read_b32 v248, a174
  v_accvgpr_read_b32 v249, a175
  v_mul_f32 v246, v246, v244
  v_mul_f32 v247, v247, v244
  v_mul_f32 v248, v248, v244
  v_mul_f32 v249, v249, v244
  v_accvgpr_write_b32 a172, v246
  v_accvgpr_write_b32 a173, v247
  v_accvgpr_write_b32 a174, v248
  v_accvgpr_write_b32 a175, v249
  v_sub_f32 v64, v64, v242
  v_sub_f32 v65, v65, v242
  v_sub_f32 v66, v66, v242
  v_sub_f32 v67, v67, v242
  v_sub_f32 v72, v72, v242
  v_sub_f32 v73, v73, v242
  v_sub_f32 v74, v74, v242
  v_sub_f32 v75, v75, v242
  v_sub_f32 v80, v80, v242
  v_sub_f32 v81, v81, v242
  v_sub_f32 v82, v82, v242
  v_sub_f32 v83, v83, v242
  v_sub_f32 v88, v88, v242
  v_sub_f32 v89, v89, v242
  v_sub_f32 v90, v90, v242
  v_sub_f32 v91, v91, v242
  v_sub_f32 v96, v96, v242
  v_sub_f32 v97, v97, v242
  v_sub_f32 v98, v98, v242
  v_sub_f32 v99, v99, v242
  v_sub_f32 v104, v104, v242
  v_sub_f32 v105, v105, v242
  v_sub_f32 v106, v106, v242
  v_sub_f32 v107, v107, v242
  v_sub_f32 v112, v112, v242
  v_sub_f32 v113, v113, v242
  v_sub_f32 v114, v114, v242
  v_sub_f32 v115, v115, v242
  v_sub_f32 v120, v120, v242
  v_sub_f32 v121, v121, v242
  v_sub_f32 v122, v122, v242
  v_sub_f32 v123, v123, v242
  v_exp_f32 v246, v64
  v_exp_f32 v247, v65
  v_exp_f32 v248, v66
  v_exp_f32 v249, v67
  v_cvt_pk_bf16_f32 v160, v246, v247
  v_cvt_pk_bf16_f32 v161, v248, v249
  v_exp_f32 v246, v72
  v_exp_f32 v247, v73
  v_exp_f32 v248, v74
  v_exp_f32 v249, v75
  v_cvt_pk_bf16_f32 v162, v246, v247
  v_cvt_pk_bf16_f32 v163, v248, v249
  v_exp_f32 v246, v80
  v_exp_f32 v247, v81
  v_exp_f32 v248, v82
  v_exp_f32 v249, v83
  v_cvt_pk_bf16_f32 v168, v246, v247
  v_cvt_pk_bf16_f32 v169, v248, v249
  v_exp_f32 v246, v88
  v_exp_f32 v247, v89
  v_exp_f32 v248, v90
  v_exp_f32 v249, v91
  v_cvt_pk_bf16_f32 v170, v246, v247
  v_cvt_pk_bf16_f32 v171, v248, v249
  s_nop 1
  v_mfma_f32_16x16x32_bf16 v[216:219], a[248:251], v[160:163], 0
  v_mfma_f32_16x16x32_bf16 v[216:219], a[248:251], v[168:171], v[216:219]
  v_max3_f32 v242, v68, v69, v70
  v_max3_f32 v242, v242, v71, v76
  v_max3_f32 v242, v242, v77, v78
  v_max3_f32 v242, v242, v79, v84
  v_max3_f32 v242, v242, v85, v86
  v_max3_f32 v242, v242, v87, v92
  v_max3_f32 v242, v242, v93, v94
  v_max_f32 v242, v242, v95
  v_mov_b32 v243, v242
  s_nop 1
  v_permlane16_swap_b32 v242, v243
  v_max_f32 v242, v242, v243
  v_mov_b32 v243, v242
  s_nop 1
  v_permlane32_swap_b32 v242, v243
  v_max_f32 v242, v242, v243
  v_max_f32 v242, 0, v242
  v_sub_f32 v244, 0, v242
  v_exp_f32 v244, v244
  v_sub_f32 v204, v204, v242
  v_sub_f32 v205, v205, v242
  v_sub_f32 v206, v206, v242
  v_sub_f32 v207, v207, v242
  v_mul_f32 v233, v233, v244
  v_accvgpr_read_b32 v246, a208
  v_accvgpr_read_b32 v247, a209
  v_accvgpr_read_b32 v248, a210
  v_accvgpr_read_b32 v249, a211
  v_mul_f32 v246, v246, v244
  v_mul_f32 v247, v247, v244
  v_mul_f32 v248, v248, v244
  v_mul_f32 v249, v249, v244
  v_accvgpr_write_b32 a208, v246
  v_accvgpr_write_b32 a209, v247
  v_accvgpr_write_b32 a210, v248
  v_accvgpr_write_b32 a211, v249
  v_accvgpr_read_b32 v246, a212
  v_accvgpr_read_b32 v247, a213
  v_accvgpr_read_b32 v248, a214
  v_accvgpr_read_b32 v249, a215
  v_mul_f32 v246, v246, v244
  v_mul_f32 v247, v247, v244
  v_mul_f32 v248, v248, v244
  v_mul_f32 v249, v249, v244
  v_accvgpr_write_b32 a212, v246
  v_accvgpr_write_b32 a213, v247
  v_accvgpr_write_b32 a214, v248
  v_accvgpr_write_b32 a215, v249
  v_accvgpr_read_b32 v246, a216
  v_accvgpr_read_b32 v247, a217
  v_accvgpr_read_b32 v248, a218
  v_accvgpr_read_b32 v249, a219
  v_mul_f32 v246, v246, v244
  v_mul_f32 v247, v247, v244
  v_mul_f32 v248, v248, v244
  v_mul_f32 v249, v249, v244
  v_accvgpr_write_b32 a216, v246
  v_accvgpr_write_b32 a217, v247
  v_accvgpr_write_b32 a218, v248
  v_accvgpr_write_b32 a219, v249
  v_accvgpr_read_b32 v246, a220
  v_accvgpr_read_b32 v247, a221
  v_accvgpr_read_b32 v248, a222
  v_accvgpr_read_b32 v249, a223
  v_mul_f32 v246, v246, v244
  v_mul_f32 v247, v247, v244
  v_mul_f32 v248, v248, v244
  v_mul_f32 v249, v249, v244
  v_accvgpr_write_b32 a220, v246
  v_accvgpr_write_b32 a221, v247
  v_accvgpr_write_b32 a222, v248
  v_accvgpr_write_b32 a223, v249
  v_accvgpr_read_b32 v246, a224
  v_accvgpr_read_b32 v247, a225
  v_accvgpr_read_b32 v248, a226
  v_accvgpr_read_b32 v249, a227
  v_mul_f32 v246, v246, v244
  v_mul_f32 v247, v247, v244
  v_mul_f32 v248, v248, v244
  v_mul_f32 v249, v249, v244
  v_accvgpr_write_b32 a224, v246
  v_accvgpr_write_b32 a225, v247
  v_accvgpr_write_b32 a226, v248
  v_accvgpr_write_b32 a227, v249
  v_accvgpr_read_b32 v246, a228
  v_accvgpr_read_b32 v247, a229
  v_accvgpr_read_b32 v248, a230
  v_accvgpr_read_b32 v249, a231
  v_mul_f32 v246, v246, v244
  v_mul_f32 v247, v247, v244
  v_mul_f32 v248, v248, v244
  v_mul_f32 v249, v249, v244
  v_accvgpr_write_b32 a228, v246
  v_accvgpr_write_b32 a229, v247
  v_accvgpr_write_b32 a230, v248
  v_accvgpr_write_b32 a231, v249
  v_accvgpr_read_b32 v246, a232
  v_accvgpr_read_b32 v247, a233
  v_accvgpr_read_b32 v248, a234
  v_accvgpr_read_b32 v249, a235
  v_mul_f32 v246, v246, v244
  v_mul_f32 v247, v247, v244
  v_mul_f32 v248, v248, v244
  v_mul_f32 v249, v249, v244
  v_accvgpr_write_b32 a232, v246
  v_accvgpr_write_b32 a233, v247
  v_accvgpr_write_b32 a234, v248
  v_accvgpr_write_b32 a235, v249
  v_accvgpr_read_b32 v246, a236
  v_accvgpr_read_b32 v247, a237
  v_accvgpr_read_b32 v248, a238
  v_accvgpr_read_b32 v249, a239
  v_mul_f32 v246, v246, v244
  v_mul_f32 v247, v247, v244
  v_mul_f32 v248, v248, v244
  v_mul_f32 v249, v249, v244
  v_accvgpr_write_b32 a236, v246
  v_accvgpr_write_b32 a237, v247
  v_accvgpr_write_b32 a238, v248
  v_accvgpr_write_b32 a239, v249
  v_sub_f32 v68, v68, v242
  v_sub_f32 v69, v69, v242
  v_sub_f32 v70, v70, v242
  v_sub_f32 v71, v71, v242
  v_sub_f32 v76, v76, v242
  v_sub_f32 v77, v77, v242
  v_sub_f32 v78, v78, v242
  v_sub_f32 v79, v79, v242
  v_sub_f32 v84, v84, v242
  v_sub_f32 v85, v85, v242
  v_sub_f32 v86, v86, v242
  v_sub_f32 v87, v87, v242
  v_sub_f32 v92, v92, v242
  v_sub_f32 v93, v93, v242
  v_sub_f32 v94, v94, v242
  v_sub_f32 v95, v95, v242
  v_sub_f32 v100, v100, v242
  v_sub_f32 v101, v101, v242
  v_sub_f32 v102, v102, v242
  v_sub_f32 v103, v103, v242
  v_sub_f32 v108, v108, v242
  v_sub_f32 v109, v109, v242
  v_sub_f32 v110, v110, v242
  v_sub_f32 v111, v111, v242
  v_sub_f32 v116, v116, v242
  v_sub_f32 v117, v117, v242
  v_sub_f32 v118, v118, v242
  v_sub_f32 v119, v119, v242
  v_sub_f32 v124, v124, v242
  v_sub_f32 v125, v125, v242
  v_sub_f32 v126, v126, v242
  v_sub_f32 v127, v127, v242
  v_exp_f32 v246, v68
  v_exp_f32 v247, v69
  v_exp_f32 v248, v70
  v_exp_f32 v249, v71
  v_cvt_pk_bf16_f32 v164, v246, v247
  v_cvt_pk_bf16_f32 v165, v248, v249
  v_exp_f32 v246, v76
  v_exp_f32 v247, v77
  v_exp_f32 v248, v78
  v_exp_f32 v249, v79
  v_cvt_pk_bf16_f32 v166, v246, v247
  v_cvt_pk_bf16_f32 v167, v248, v249
  v_exp_f32 v246, v84
  v_exp_f32 v247, v85
  v_exp_f32 v248, v86
  v_exp_f32 v249, v87
  v_cvt_pk_bf16_f32 v172, v246, v247
  v_cvt_pk_bf16_f32 v173, v248, v249
  v_exp_f32 v246, v92
  v_exp_f32 v247, v93
  v_exp_f32 v248, v94
  v_exp_f32 v249, v95
  v_cvt_pk_bf16_f32 v174, v246, v247
  v_cvt_pk_bf16_f32 v175, v248, v249
  s_nop 1
  v_mfma_f32_16x16x32_bf16 v[220:223], a[248:251], v[164:167], 0
  v_mfma_f32_16x16x32_bf16 v[220:223], a[248:251], v[172:175], v[220:223]
  s_nop 15
  s_nop 1
  s_setpc_b64 s[76:77]
L_mask11:
  s_nop 7
  s_add_u32 s49, s45, 1
  s_lshl_b32 s49, s49, 6
  v_subrev_u32 v242, s49, v237
  v_cmp_ge_i32 s[78:79], v242, 0
  v_cmp_ge_i32 s[80:81], v242, 1
  v_cmp_ge_i32 s[82:83], v242, 2
  v_cmp_ge_i32 s[84:85], v242, 3
  v_cndmask_b32 v96, v241, v96, s[78:79]
  v_cndmask_b32 v97, v241, v97, s[80:81]
  v_cndmask_b32 v98, v241, v98, s[82:83]
  v_cndmask_b32 v99, v241, v99, s[84:85]
  v_cmp_ge_i32 s[78:79], v242, -16
  v_cmp_ge_i32 s[80:81], v242, -15
  v_cmp_ge_i32 s[82:83], v242, -14
  v_cmp_ge_i32 s[84:85], v242, -13
  v_cndmask_b32 v100, v241, v100, s[78:79]
  v_cndmask_b32 v101, v241, v101, s[80:81]
  v_cndmask_b32 v102, v241, v102, s[82:83]
  v_cndmask_b32 v103, v241, v103, s[84:85]
  v_cmp_ge_i32 s[78:79], v242, 16
  v_cmp_ge_i32 s[80:81], v242, 17
  v_cmp_ge_i32 s[82:83], v242, 18
  v_cmp_ge_i32 s[84:85], v242, 19
  v_cndmask_b32 v104, v241, v104, s[78:79]
  v_cndmask_b32 v105, v241, v105, s[80:81]
  v_cndmask_b32 v106, v241, v106, s[82:83]
  v_cndmask_b32 v107, v241, v107, s[84:85]
  v_cmp_ge_i32 s[78:79], v242, 0
  v_cmp_ge_i32 s[80:81], v242, 1
  v_cmp_ge_i32 s[82:83], v242, 2
  v_cmp_ge_i32 s[84:85], v242, 3
  v_cndmask_b32 v108, v241, v108, s[78:79]
  v_cndmask_b32 v109, v241, v109, s[80:81]
  v_cndmask_b32 v110, v241, v110, s[82:83]
  v_cndmask_b32 v111, v241, v111, s[84:85]
  v_cmp_ge_i32 s[78:79], v242, 32
  v_cmp_ge_i32 s[80:81], v242, 33
  v_cmp_ge_i32 s[82:83], v242, 34
  v_cmp_ge_i32 s[84:85], v242, 35
  v_cndmask_b32 v112, v241, v112, s[78:79]
  v_cndmask_b32 v113, v241, v113, s[80:81]
  v_cndmask_b32 v114, v241, v114, s[82:83]
  v_cndmask_b32 v115, v241, v115, s[84:85]
  v_cmp_ge_i32 s[78:79], v242, 16
  v_cmp_ge_i32 s[80:81], v242, 17
  v_cmp_ge_i32 s[82:83], v242, 18
  v_cmp_ge_i32 s[84:85], v242, 19
  v_cndmask_b32 v116, v241, v116, s[78:79]
  v_cndmask_b32 v117, v241, v117, s[80:81]
  v_cndmask_b32 v118, v241, v118, s[82:83]
  v_cndmask_b32 v119, v241, v119, s[84:85]
  v_cmp_ge_i32 s[78:79], v242, 48
  v_cmp_ge_i32 s[80:81], v242, 49
  v_cmp_ge_i32 s[82:83], v242, 50
  v_cmp_ge_i32 s[84:85], v242, 51
  v_cndmask_b32 v120, v241, v120, s[78:79]
  v_cndmask_b32 v121, v241, v121, s[80:81]
  v_cndmask_b32 v122, v241, v122, s[82:83]
  v_cndmask_b32 v123, v241, v123, s[84:85]
  v_cmp_ge_i32 s[78:79], v242, 32
  v_cmp_ge_i32 s[80:81], v242, 33
  v_cmp_ge_i32 s[82:83], v242, 34
  v_cmp_ge_i32 s[84:85], v242, 35
  v_cndmask_b32 v124, v241, v124, s[78:79]
  v_cndmask_b32 v125, v241, v125, s[80:81]
  v_cndmask_b32 v126, v241, v126, s[82:83]
  v_cndmask_b32 v127, v241, v127, s[84:85]
  s_setpc_b64 s[76:77]
L_rare11:
  s_nop 15
  v_max3_f32 v242, v96, v97, v98
  v_max3_f32 v242, v242, v99, v104
  v_max3_f32 v242, v242, v105, v106
  v_max3_f32 v242, v242, v107, v112
  v_max3_f32 v242, v242, v113, v114
  v_max3_f32 v242, v242, v115, v120
  v_max3_f32 v242, v242, v121, v122
  v_max_f32 v242, v242, v123
  v_mov_b32 v243, v242
  s_nop 1
  v_permlane16_swap_b32 v242, v243
  v_max_f32 v242, v242, v243
  v_mov_b32 v243, v242
  s_nop 1
  v_permlane32_swap_b32 v242, v243
  v_max_f32 v242, v242, v243
  v_max_f32 v242, 0, v242
  v_sub_f32 v244, 0, v242
  v_exp_f32 v244, v244
  v_sub_f32 v200, v200, v242
  v_sub_f32 v201, v201, v242
  v_sub_f32 v202, v202, v242
  v_sub_f32 v203, v203, v242
  v_mul_f32 v232, v232, v244
  v_accvgpr_read_b32 v246, a144
  v_accvgpr_read_b32 v247, a145
  v_accvgpr_read_b32 v248, a146
  v_accvgpr_read_b32 v249, a147
  v_mul_f32 v246, v246, v244
  v_mul_f32 v247, v247, v244
  v_mul_f32 v248, v248, v244
  v_mul_f32 v249, v249, v244
  v_accvgpr_write_b32 a144, v246
  v_accvgpr_write_b32 a145, v247
  v_accvgpr_write_b32 a146, v248
  v_accvgpr_write_b32 a147, v249
  v_accvgpr_read_b32 v246, a148
  v_accvgpr_read_b32 v247, a149
  v_accvgpr_read_b32 v248, a150
  v_accvgpr_read_b32 v249, a151
  v_mul_f32 v246, v246, v244
  v_mul_f32 v247, v247, v244
  v_mul_f32 v248, v248, v244
  v_mul_f32 v249, v249, v244
  v_accvgpr_write_b32 a148, v246
  v_accvgpr_write_b32 a149, v247
  v_accvgpr_write_b32 a150, v248
  v_accvgpr_write_b32 a151, v249
  v_accvgpr_read_b32 v246, a152
  v_accvgpr_read_b32 v247, a153
  v_accvgpr_read_b32 v248, a154
  v_accvgpr_read_b32 v249, a155
  v_mul_f32 v246, v246, v244
  v_mul_f32 v247, v247, v244
  v_mul_f32 v248, v248, v244
  v_mul_f32 v249, v249, v244
  v_accvgpr_write_b32 a152, v246
  v_accvgpr_write_b32 a153, v247
  v_accvgpr_write_b32 a154, v248
  v_accvgpr_write_b32 a155, v249
  v_accvgpr_read_b32 v246, a156
  v_accvgpr_read_b32 v247, a157
  v_accvgpr_read_b32 v248, a158
  v_accvgpr_read_b32 v249, a159
  v_mul_f32 v246, v246, v244
  v_mul_f32 v247, v247, v244
  v_mul_f32 v248, v248, v244
  v_mul_f32 v249, v249, v244
  v_accvgpr_write_b32 a156, v246
  v_accvgpr_write_b32 a157, v247
  v_accvgpr_write_b32 a158, v248
  v_accvgpr_write_b32 a159, v249
  v_accvgpr_read_b32 v246, a160
  v_accvgpr_read_b32 v247, a161
  v_accvgpr_read_b32 v248, a162
  v_accvgpr_read_b32 v249, a163
  v_mul_f32 v246, v246, v244
  v_mul_f32 v247, v247, v244
  v_mul_f32 v248, v248, v244
  v_mul_f32 v249, v249, v244
  v_accvgpr_write_b32 a160, v246
  v_accvgpr_write_b32 a161, v247
  v_accvgpr_write_b32 a162, v248
  v_accvgpr_write_b32 a163, v249
  v_accvgpr_read_b32 v246, a164
  v_accvgpr_read_b32 v247, a165
  v_accvgpr_read_b32 v248, a166
  v_accvgpr_read_b32 v249, a167
  v_mul_f32 v246, v246, v244
  v_mul_f32 v247, v247, v244
  v_mul_f32 v248, v248, v244
  v_mul_f32 v249, v249, v244
  v_accvgpr_write_b32 a164, v246
  v_accvgpr_write_b32 a165, v247
  v_accvgpr_write_b32 a166, v248
  v_accvgpr_write_b32 a167, v249
  v_accvgpr_read_b32 v246, a168
  v_accvgpr_read_b32 v247, a169
  v_accvgpr_read_b32 v248, a170
  v_accvgpr_read_b32 v249, a171
  v_mul_f32 v246, v246, v244
  v_mul_f32 v247, v247, v244
  v_mul_f32 v248, v248, v244
  v_mul_f32 v249, v249, v244
  v_accvgpr_write_b32 a168, v246
  v_accvgpr_write_b32 a169, v247
  v_accvgpr_write_b32 a170, v248
  v_accvgpr_write_b32 a171, v249
  v_accvgpr_read_b32 v246, a172
  v_accvgpr_read_b32 v247, a173
  v_accvgpr_read_b32 v248, a174
  v_accvgpr_read_b32 v249, a175
  v_mul_f32 v246, v246, v244
  v_mul_f32 v247, v247, v244
  v_mul_f32 v248, v248, v244
  v_mul_f32 v249, v249, v244
  v_accvgpr_write_b32 a172, v246
  v_accvgpr_write_b32 a173, v247
  v_accvgpr_write_b32 a174, v248
  v_accvgpr_write_b32 a175, v249
  v_sub_f32 v64, v64, v242
  v_sub_f32 v65, v65, v242
  v_sub_f32 v66, v66, v242
  v_sub_f32 v67, v67, v242
  v_sub_f32 v72, v72, v242
  v_sub_f32 v73, v73, v242
  v_sub_f32 v74, v74, v242
  v_sub_f32 v75, v75, v242
  v_sub_f32 v80, v80, v242
  v_sub_f32 v81, v81, v242
  v_sub_f32 v82, v82, v242
  v_sub_f32 v83, v83, v242
  v_sub_f32 v88, v88, v242
  v_sub_f32 v89, v89, v242
  v_sub_f32 v90, v90, v242
  v_sub_f32 v91, v91, v242
  v_sub_f32 v96, v96, v242
  v_sub_f32 v97, v97, v242
  v_sub_f32 v98, v98, v242
  v_sub_f32 v99, v99, v242
  v_sub_f32 v104, v104, v242
  v_sub_f32 v105, v105, v242
  v_sub_f32 v106, v106, v242
  v_sub_f32 v107, v107, v242
  v_sub_f32 v112, v112, v242
  v_sub_f32 v113, v113, v242
  v_sub_f32 v114, v114, v242
  v_sub_f32 v115, v115, v242
  v_sub_f32 v120, v120, v242
  v_sub_f32 v121, v121, v242
  v_sub_f32 v122, v122, v242
  v_sub_f32 v123, v123, v242
  v_exp_f32 v246, v96
  v_exp_f32 v247, v97
  v_exp_f32 v248, v98
  v_exp_f32 v249, v99
  v_cvt_pk_bf16_f32 v176, v246, v247
  v_cvt_pk_bf16_f32 v177, v248, v249
  v_exp_f32 v246, v104
  v_exp_f32 v247, v105
  v_exp_f32 v248, v106
  v_exp_f32 v249, v107
  v_cvt_pk_bf16_f32 v178, v246, v247
  v_cvt_pk_bf16_f32 v179, v248, v249
  v_exp_f32 v246, v112
  v_exp_f32 v247, v113
  v_exp_f32 v248, v114
  v_exp_f32 v249, v115
  v_cvt_pk_bf16_f32 v184, v246, v247
  v_cvt_pk_bf16_f32 v185, v248, v249
  v_exp_f32 v246, v120
  v_exp_f32 v247, v121
  v_exp_f32 v248, v122
  v_exp_f32 v249, v123
  v_cvt_pk_bf16_f32 v186, v246, v247
  v_cvt_pk_bf16_f32 v187, v248, v249
  s_nop 1
  v_mfma_f32_16x16x32_bf16 v[216:219], a[248:251], v[176:179], 0
  v_mfma_f32_16x16x32_bf16 v[216:219], a[248:251], v[184:187], v[216:219]
  v_max3_f32 v242, v100, v101, v102
  v_max3_f32 v242, v242, v103, v108
  v_max3_f32 v242, v242, v109, v110
  v_max3_f32 v242, v242, v111, v116
  v_max3_f32 v242, v242, v117, v118
  v_max3_f32 v242, v242, v119, v124
  v_max3_f32 v242, v242, v125, v126
  v_max_f32 v242, v242, v127
  v_mov_b32 v243, v242
  s_nop 1
  v_permlane16_swap_b32 v242, v243
  v_max_f32 v242, v242, v243
  v_mov_b32 v243, v242
  s_nop 1
  v_permlane32_swap_b32 v242, v243
  v_max_f32 v242, v242, v243
  v_max_f32 v242, 0, v242
  v_sub_f32 v244, 0, v242
  v_exp_f32 v244, v244
  v_sub_f32 v204, v204, v242
  v_sub_f32 v205, v205, v242
  v_sub_f32 v206, v206, v242
  v_sub_f32 v207, v207, v242
  v_mul_f32 v233, v233, v244
  v_accvgpr_read_b32 v246, a208
  v_accvgpr_read_b32 v247, a209
  v_accvgpr_read_b32 v248, a210
  v_accvgpr_read_b32 v249, a211
  v_mul_f32 v246, v246, v244
  v_mul_f32 v247, v247, v244
  v_mul_f32 v248, v248, v244
  v_mul_f32 v249, v249, v244
  v_accvgpr_write_b32 a208, v246
  v_accvgpr_write_b32 a209, v247
  v_accvgpr_write_b32 a210, v248
  v_accvgpr_write_b32 a211, v249
  v_accvgpr_read_b32 v246, a212
  v_accvgpr_read_b32 v247, a213
  v_accvgpr_read_b32 v248, a214
  v_accvgpr_read_b32 v249, a215
  v_mul_f32 v246, v246, v244
  v_mul_f32 v247, v247, v244
  v_mul_f32 v248, v248, v244
  v_mul_f32 v249, v249, v244
  v_accvgpr_write_b32 a212, v246
  v_accvgpr_write_b32 a213, v247
  v_accvgpr_write_b32 a214, v248
  v_accvgpr_write_b32 a215, v249
  v_accvgpr_read_b32 v246, a216
  v_accvgpr_read_b32 v247, a217
  v_accvgpr_read_b32 v248, a218
  v_accvgpr_read_b32 v249, a219
  v_mul_f32 v246, v246, v244
  v_mul_f32 v247, v247, v244
  v_mul_f32 v248, v248, v244
  v_mul_f32 v249, v249, v244
  v_accvgpr_write_b32 a216, v246
  v_accvgpr_write_b32 a217, v247
  v_accvgpr_write_b32 a218, v248
  v_accvgpr_write_b32 a219, v249
  v_accvgpr_read_b32 v246, a220
  v_accvgpr_read_b32 v247, a221
  v_accvgpr_read_b32 v248, a222
  v_accvgpr_read_b32 v249, a223
  v_mul_f32 v246, v246, v244
  v_mul_f32 v247, v247, v244
  v_mul_f32 v248, v248, v244
  v_mul_f32 v249, v249, v244
  v_accvgpr_write_b32 a220, v246
  v_accvgpr_write_b32 a221, v247
  v_accvgpr_write_b32 a222, v248
  v_accvgpr_write_b32 a223, v249
  v_accvgpr_read_b32 v246, a224
  v_accvgpr_read_b32 v247, a225
  v_accvgpr_read_b32 v248, a226
  v_accvgpr_read_b32 v249, a227
  v_mul_f32 v246, v246, v244
  v_mul_f32 v247, v247, v244
  v_mul_f32 v248, v248, v244
  v_mul_f32 v249, v249, v244
  v_accvgpr_write_b32 a224, v246
  v_accvgpr_write_b32 a225, v247
  v_accvgpr_write_b32 a226, v248
  v_accvgpr_write_b32 a227, v249
  v_accvgpr_read_b32 v246, a228
  v_accvgpr_read_b32 v247, a229
  v_accvgpr_read_b32 v248, a230
  v_accvgpr_read_b32 v249, a231
  v_mul_f32 v246, v246, v244
  v_mul_f32 v247, v247, v244
  v_mul_f32 v248, v248, v244
  v_mul_f32 v249, v249, v244
  v_accvgpr_write_b32 a228, v246
  v_accvgpr_write_b32 a229, v247
  v_accvgpr_write_b32 a230, v248
  v_accvgpr_write_b32 a231, v249
  v_accvgpr_read_b32 v246, a232
  v_accvgpr_read_b32 v247, a233
  v_accvgpr_read_b32 v248, a234
  v_accvgpr_read_b32 v249, a235
  v_mul_f32 v246, v246, v244
  v_mul_f32 v247, v247, v244
  v_mul_f32 v248, v248, v244
  v_mul_f32 v249, v249, v244
  v_accvgpr_write_b32 a232, v246
  v_accvgpr_write_b32 a233, v247
  v_accvgpr_write_b32 a234, v248
  v_accvgpr_write_b32 a235, v249
  v_accvgpr_read_b32 v246, a236
  v_accvgpr_read_b32 v247, a237
  v_accvgpr_read_b32 v248, a238
  v_accvgpr_read_b32 v249, a239
  v_mul_f32 v246, v246, v244
  v_mul_f32 v247, v247, v244
  v_mul_f32 v248, v248, v244
  v_mul_f32 v249, v249, v244
  v_accvgpr_write_b32 a236, v246
  v_accvgpr_write_b32 a237, v247
  v_accvgpr_write_b32 a238, v248
  v_accvgpr_write_b32 a239, v249
  v_sub_f32 v68, v68, v242
  v_sub_f32 v69, v69, v242
  v_sub_f32 v70, v70, v242
  v_sub_f32 v71, v71, v242
  v_sub_f32 v76, v76, v242
  v_sub_f32 v77, v77, v242
  v_sub_f32 v78, v78, v242
  v_sub_f32 v79, v79, v242
  v_sub_f32 v84, v84, v242
  v_sub_f32 v85, v85, v242
  v_sub_f32 v86, v86, v242
  v_sub_f32 v87, v87, v242
  v_sub_f32 v92, v92, v242
  v_sub_f32 v93, v93, v242
  v_sub_f32 v94, v94, v242
  v_sub_f32 v95, v95, v242
  v_sub_f32 v100, v100, v242
  v_sub_f32 v101, v101, v242
  v_sub_f32 v102, v102, v242
  v_sub_f32 v103, v103, v242
  v_sub_f32 v108, v108, v242
  v_sub_f32 v109, v109, v242
  v_sub_f32 v110, v110, v242
  v_sub_f32 v111, v111, v242
  v_sub_f32 v116, v116, v242
  v_sub_f32 v117, v117, v242
  v_sub_f32 v118, v118, v242
  v_sub_f32 v119, v119, v242
  v_sub_f32 v124, v124, v242
  v_sub_f32 v125, v125, v242
  v_sub_f32 v126, v126, v242
  v_sub_f32 v127, v127, v242
  v_exp_f32 v246, v100
  v_exp_f32 v247, v101
  v_exp_f32 v248, v102
  v_exp_f32 v249, v103
  v_cvt_pk_bf16_f32 v180, v246, v247
  v_cvt_pk_bf16_f32 v181, v248, v249
  v_exp_f32 v246, v108
  v_exp_f32 v247, v109
  v_exp_f32 v248, v110
  v_exp_f32 v249, v111
  v_cvt_pk_bf16_f32 v182, v246, v247
  v_cvt_pk_bf16_f32 v183, v248, v249
  v_exp_f32 v246, v116
  v_exp_f32 v247, v117
  v_exp_f32 v248, v118
  v_exp_f32 v249, v119
  v_cvt_pk_bf16_f32 v188, v246, v247
  v_cvt_pk_bf16_f32 v189, v248, v249
  v_exp_f32 v246, v124
  v_exp_f32 v247, v125
  v_exp_f32 v248, v126
  v_exp_f32 v249, v127
  v_cvt_pk_bf16_f32 v190, v246, v247
  v_cvt_pk_bf16_f32 v191, v248, v249
  s_nop 1
  v_mfma_f32_16x16x32_bf16 v[220:223], a[248:251], v[180:183], 0
  v_mfma_f32_16x16x32_bf16 v[220:223], a[248:251], v[188:191], v[220:223]
  s_nop 15
  s_nop 1
  s_setpc_b64 s[76:77]
L_spin_ln:
  s_mov_b32 s63, 0x8000
L_spin_ln_loop:
  global_load_dword v254, v253, s[100:101] sc1
  s_waitcnt vmcnt(0)
  v_cmp_gt_u32 vcc, 8, v254
  s_nop 4
  s_cbranch_vccz L_back_ln
  s_sub_u32 s63, s63, 1
  s_cmp_lg_u32 s63, 0
  s_cbranch_scc1 L_spin_ln_loop
  s_branch L_back_ln
L_spin_kv:
  s_mov_b32 s85, 0x8000
L_spin_kv_loop:
  global_load_dword v226, v227, s[100:101] sc1
  s_waitcnt vmcnt(0)
  v_cmp_gt_u32 vcc, 8, v226
  s_nop 4
  s_cbranch_vccz L_back_kv
  s_sub_u32 s85, s85, 1
  s_cmp_lg_u32 s85, 0
  s_cbranch_scc1 L_spin_kv_loop
  s_branch L_back_kv
L_k3_entry:
  s_mov_b32 s35, s42
  v_mov_b32 v64, v252
  s_load_dwordx2 s[4:5], s[0:1], 96
  s_load_dwordx2 s[6:7], s[0:1], 40
  s_load_dwordx2 s[8:9], s[0:1], 72
  s_load_dwordx2 s[10:11], s[0:1], 0
  s_load_dwordx2 s[92:93], s[0:1], 80
  v_lshrrev_b32 v88, 4, v64
  s_and_b32 s44, s2, 7
  s_lshr_b32 s32, s44, 1
  s_and_b32 s44, s44, 1
  s_lshl_b32 s44, s44, 3
  s_lshr_b32 s45, s2, 3
  s_and_b32 s34, s45, 3
  s_lshr_b32 s45, s45, 2
  s_add_u32 s33, s44, s45
  s_mul_i32 s44, s32, 44
  s_cmp_eq_u32 s32, 3
  s_cselect_b32 s44, 128, s44
  s_cmp_eq_u32 s32, 2
  s_cselect_b32 s36, 20, 22
  s_lshl_b32 s45, s33, 3
  s_lshl_b32 s46, s35, 1
  s_add_u32 s45, s45, s46
  s_mul_i32 s45, s45, 176128
  s_lshl_b32 s46, s44, 10
  s_add_u32 s38, s45, s46
  s_lshl_b32 s45, s44, 15
  s_cmp_eq_u32 s32, 3
  s_cselect_b32 s45, 0, s45
  s_lshl_b32 s46, s34, 8
  s_add_u32 s56, s45, s46
  s_lshl_b32 s46, s35, 6
  s_add_u32 s39, s56, s46
  s_lshl_b32 s55, s44, 10
  s_mov_b32 s57, 131072
  v_add_u32 v66, 174080, v64
  v_lshrrev_b32 v81, 4, v88
  v_and_b32 v81, 1, v81
  v_lshlrev_b32 v81, 1, v81
  v_and_b32 v80, 3, v88
  v_xor_b32 v80, v80, v81
  v_lshlrev_b32 v80, 4, v80
  v_lshrrev_b32 v81, 2, v88
  v_lshlrev_b32 v81, 10, v81
  v_add_u32 v67, v80, v81
  v_add_u32 v68, 15360, v67
  v_add_u32 v69, 30720, v67
  v_add_u32 v70, 46080, v67
  s_lshl_b32 s52, s35, 12
  s_lshl_b32 s53, s35, 12
  s_add_u32 s53, s53, 16384
  s_mov_b32 s37, 0
  s_mov_b32 s40, 0
  s_waitcnt lgkmcnt(0)
  s_add_u32 s12, s4, 0x2200000
  s_addc_u32 s13, s5, 0
  s_mov_b32 s14, 0x1580000
  s_mov_b32 s15, 0x20000
  s_mov_b32 s18, 4194304
  s_cmp_eq_u32 s32, 3
  s_cselect_b32 s16, s8, s6
  s_cselect_b32 s17, s9, s7
  s_cselect_b32 s18, 1409024, s18
  s_mov_b32 s19, 0x20000
  s_add_u32 s62, s4, 0x4002000
  s_addc_u32 s63, s5, 0
  s_lshl_b32 s44, s33, 7
  v_mov_b32 v90, s44
  global_load_dword v91, v90, s[62:63] sc1
  s_add_u32 s47, s39, 0
  s_add_u32 m0, s53, 0
  s_nop 0
  buffer_load_dwordx4 v67, s[16:19], s47 offen offset:0 lds
  buffer_load_dwordx4 v68, s[16:19], s47 offen offset:1024 lds
  buffer_load_dwordx4 v69, s[16:19], s47 offen offset:2048 lds
  buffer_load_dwordx4 v70, s[16:19], s47 offen offset:3072 lds
  s_add_u32 s47, s39, 65536
  s_add_u32 m0, s53, 32768
  s_nop 0
  buffer_load_dwordx4 v67, s[16:19], s47 offen offset:0 lds
  buffer_load_dwordx4 v68, s[16:19], s47 offen offset:1024 lds
  buffer_load_dwordx4 v69, s[16:19], s47 offen offset:2048 lds
  buffer_load_dwordx4 v70, s[16:19], s47 offen offset:3072 lds
  s_add_u32 s47, s39, 131072
  s_add_u32 m0, s53, 65536
  s_nop 0
  buffer_load_dwordx4 v67, s[16:19], s47 offen offset:0 lds
  buffer_load_dwordx4 v68, s[16:19], s47 offen offset:1024 lds
  buffer_load_dwordx4 v69, s[16:19], s47 offen offset:2048 lds
  buffer_load_dwordx4 v70, s[16:19], s47 offen offset:3072 lds
  s_lshr_b32 s44, s35, 1
  s_lshl_b32 s44, s44, 13
  v_add_u32 v74, s44, v64
  v_lshrrev_b32 v82, 4, v88
  v_and_b32 v80, 15, v88
  v_lshrrev_b32 v80, 2, v80
  v_lshlrev_b32 v81, 2, v82
  v_add_u32 v80, v80, v81
  v_lshlrev_b32 v80, 6, v80
  v_and_b32 v81, 1, v82
  v_lshlrev_b32 v81, 5, v81
  v_add_u32 v80, v80, v81
  v_and_b32 v81, 3, v88
  v_lshlrev_b32 v81, 3, v81
  v_add_u32 v80, v80, v81
  s_and_b32 s44, s35, 1
  s_lshl_b32 s44, s44, 13
  s_add_u32 s44, s44, 16384
  v_add_u32 v75, s44, v80
  v_xor_b32 v76, 32, v75
  s_lshl_b32 s48, s33, 2
  s_add_u32 s48, s48, s34
  s_mov_b32 s41, 0
  s_add_u32 s20, s4, 0x3800000
  s_addc_u32 s21, s5, 0
  s_mov_b32 s22, 0x800000
  s_mov_b32 s23, 0x20000
  s_mov_b32 s24, s10
  s_mov_b32 s25, s11
  s_mov_b32 s26, 0x200000
  s_mov_b32 s27, 0x20000
  s_mov_b32 s28, s92
  s_mov_b32 s29, s93
  s_mov_b32 s30, 0x200000
  s_mov_b32 s31, 0x20000
  s_add_u32 s88, s4, 0x4000000
  s_addc_u32 s89, s5, 0
  s_mov_b32 s90, 0x2000
  s_mov_b32 s91, 0x20000
  s_waitcnt vmcnt(12)
  s_barrier
  s_cmp_lg_u32 s35, 0
  s_cbranch_scc1 L_sig_cb
  s_lshr_b32 s64, s2, 5
  s_sub_u32 s64, 15, s64
  s_lshl_b32 s64, s64, 7
  v_mov_b32 v82, s64
  v_mov_b32 v83, 1
  s_mov_b64 exec, 1
  global_atomic_add v82, v83, s[62:63] sc1
  s_mov_b64 exec, -1
L_sig_cb:
  v_readfirstlane_b32 s44, v91
  s_nop 1
  s_cmp_ge_u32 s44, 32
  s_cbranch_scc1 L_poll_ctx_done
  s_mov_b32 s45, 0x8000
L_poll_ctx:
  s_sleep 8
  global_load_dword v91, v90, s[62:63] sc1
  s_waitcnt vmcnt(0)
  v_readfirstlane_b32 s44, v91
  s_nop 1
  s_cmp_ge_u32 s44, 32
  s_cbranch_scc1 L_poll_ctx_done
  s_sub_u32 s45, s45, 1
  s_cmp_lg_u32 s45, 0
  s_cbranch_scc1 L_poll_ctx
L_poll_ctx_done:
  s_add_u32 s46, s38, 0
  s_add_u32 m0, s52, 0
  s_nop 0
  buffer_load_dwordx4 v64, s[12:15], s46 offen offset:0 sc1 lds
  buffer_load_dwordx4 v64, s[12:15], s46 offen offset:1024 sc1 lds
  buffer_load_dwordx4 v66, s[12:15], s46 offen offset:2048 sc1 lds
  buffer_load_dwordx4 v66, s[12:15], s46 offen offset:3072 sc1 lds
  s_add_u32 s46, s38, 2048
  s_add_u32 m0, s52, 32768
  s_nop 0
  buffer_load_dwordx4 v64, s[12:15], s46 offen offset:0 sc1 lds
  buffer_load_dwordx4 v64, s[12:15], s46 offen offset:1024 sc1 lds
  buffer_load_dwordx4 v66, s[12:15], s46 offen offset:2048 sc1 lds
  buffer_load_dwordx4 v66, s[12:15], s46 offen offset:3072 sc1 lds
  s_add_u32 s46, s38, 4096
  s_add_u32 m0, s52, 65536
  s_nop 0
  buffer_load_dwordx4 v64, s[12:15], s46 offen offset:0 sc1 lds
  buffer_load_dwordx4 v64, s[12:15], s46 offen offset:1024 sc1 lds
  buffer_load_dwordx4 v66, s[12:15], s46 offen offset:2048 sc1 lds
  buffer_load_dwordx4 v66, s[12:15], s46 offen offset:3072 sc1 lds
  s_mov_b32 s37, 3
  s_add_u32 s38, s38, 6144
  s_add_u32 s39, s39, 196608
  s_mov_b32 s40, 98304
L_main_out_kernel:
  s_waitcnt vmcnt(8)
  s_barrier
  v_add_u32 v71, s41, v74
  v_add_u32 v72, s41, v75
  v_add_u32 v73, s41, v76
  s_add_u32 s41, s41, 32768
  s_cmp_ge_u32 s41, 163840
  s_cselect_b32 s41, 0, s41
  ds_read_b64_tr_b16 a[32:33], v72 offset:0
  ds_read_b64_tr_b16 a[34:35], v72 offset:1024
  ds_read_b64_tr_b16 a[36:37], v73 offset:0
  ds_read_b64_tr_b16 a[38:39], v73 offset:1024
  ds_read_b64_tr_b16 a[40:41], v72 offset:4096
  ds_read_b64_tr_b16 a[42:43], v72 offset:5120
  ds_read_b64_tr_b16 a[44:45], v73 offset:4096
  ds_read_b64_tr_b16 a[46:47], v73 offset:5120
  ds_read_b128 a[0:3], v71 offset:0
  ds_read_b128 a[4:7], v71 offset:2048
  ds_read_b128 a[8:11], v71 offset:4096
  ds_read_b128 a[12:15], v71 offset:6144
  ds_read_b64_tr_b16 a[48:49], v72 offset:2048
  ds_read_b64_tr_b16 a[50:51], v72 offset:3072
  ds_read_b64_tr_b16 a[52:53], v73 offset:2048
  ds_read_b64_tr_b16 a[54:55], v73 offset:3072
  ds_read_b64_tr_b16 a[56:57], v72 offset:6144
  ds_read_b64_tr_b16 a[58:59], v72 offset:7168
  ds_read_b64_tr_b16 a[60:61], v73 offset:6144
  ds_read_b64_tr_b16 a[62:63], v73 offset:7168
  ds_read_b128 a[16:19], v71 offset:1024
  ds_read_b128 a[20:23], v71 offset:3072
  ds_read_b128 a[24:27], v71 offset:5120
  ds_read_b128 a[28:31], v71 offset:7168
  s_waitcnt lgkmcnt(15)
  v_mfma_f32_16x16x32_bf16 v[0:3], a[32:35], a[0:3], 0
  s_waitcnt vmcnt(4)
  s_barrier
  s_cmp_lt_u32 s37, s36
  s_cselect_b32 s46, s38, 0x40000000
  s_cselect_b32 s47, s39, 0x40000000
  s_add_u32 m0, s40, s52
  s_nop 0
  buffer_load_dwordx4 v64, s[12:15], s46 offen offset:0 sc1 lds
  s_waitcnt lgkmcnt(2)
  v_mfma_f32_16x16x32_bf16 v[0:3], a[48:51], a[16:19], v[0:3]
  v_add_u32 v71, s41, v74
  v_add_u32 v72, s41, v75
  v_mfma_f32_16x16x32_bf16 v[4:7], a[32:35], a[4:7], 0
  v_add_u32 v73, s41, v76
  s_add_u32 s41, s41, 32768
  buffer_load_dwordx4 v64, s[12:15], s46 offen offset:1024 sc1 lds
  v_mfma_f32_16x16x32_bf16 v[4:7], a[48:51], a[20:23], v[4:7]
  s_cmp_ge_u32 s41, 163840
  s_cselect_b32 s41, 0, s41
  ds_read_b64_tr_b16 a[96:97], v72 offset:0
  v_mfma_f32_16x16x32_bf16 v[8:11], a[32:35], a[8:11], 0
  s_waitcnt lgkmcnt(1)
  ds_read_b64_tr_b16 a[98:99], v72 offset:1024
  v_mfma_f32_16x16x32_bf16 v[8:11], a[48:51], a[24:27], v[8:11]
  ds_read_b64_tr_b16 a[100:101], v73 offset:0
  buffer_load_dwordx4 v66, s[12:15], s46 offen offset:2048 sc1 lds
  v_mfma_f32_16x16x32_bf16 v[12:15], a[32:35], a[12:15], 0
  ds_read_b64_tr_b16 a[102:103], v73 offset:1024
  v_mfma_f32_16x16x32_bf16 v[12:15], a[48:51], a[28:31], v[12:15]
  ds_read_b64_tr_b16 a[104:105], v72 offset:4096
  buffer_load_dwordx4 v66, s[12:15], s46 offen offset:3072 sc1 lds
  v_mfma_f32_16x16x32_bf16 v[16:19], a[36:39], a[0:3], 0
  ds_read_b64_tr_b16 a[106:107], v72 offset:5120
  v_mfma_f32_16x16x32_bf16 v[16:19], a[52:55], a[16:19], v[16:19]
  s_add_u32 m0, s40, s53
  ds_read_b64_tr_b16 a[108:109], v73 offset:4096
  v_mfma_f32_16x16x32_bf16 v[20:23], a[36:39], a[4:7], 0
  ds_read_b64_tr_b16 a[110:111], v73 offset:5120
  buffer_load_dwordx4 v67, s[16:19], s47 offen offset:0  lds
  v_mfma_f32_16x16x32_bf16 v[20:23], a[52:55], a[20:23], v[20:23]
  ds_read_b128 a[64:67], v71 offset:0
  v_mfma_f32_16x16x32_bf16 v[24:27], a[36:39], a[8:11], 0
  ds_read_b128 a[68:71], v71 offset:2048
  buffer_load_dwordx4 v68, s[16:19], s47 offen offset:1024  lds
  v_mfma_f32_16x16x32_bf16 v[24:27], a[52:55], a[24:27], v[24:27]
  ds_read_b128 a[72:75], v71 offset:4096
  v_mfma_f32_16x16x32_bf16 v[28:31], a[36:39], a[12:15], 0
  ds_read_b128 a[76:79], v71 offset:6144
  v_mfma_f32_16x16x32_bf16 v[28:31], a[52:55], a[28:31], v[28:31]
  ds_read_b64_tr_b16 a[112:113], v72 offset:2048
  buffer_load_dwordx4 v69, s[16:19], s47 offen offset:2048  lds
  v_mfma_f32_16x16x32_bf16 v[32:35], a[40:43], a[0:3], 0
  ds_read_b64_tr_b16 a[114:115], v72 offset:3072
  v_mfma_f32_16x16x32_bf16 v[32:35], a[56:59], a[16:19], v[32:35]
  ds_read_b64_tr_b16 a[116:117], v73 offset:2048
  v_mfma_f32_16x16x32_bf16 v[36:39], a[40:43], a[4:7], 0
  s_add_u32 s37, s37, 1
  ds_read_b64_tr_b16 a[118:119], v73 offset:3072
  buffer_load_dwordx4 v70, s[16:19], s47 offen offset:3072  lds
  s_add_u32 s38, s38, 2048
  s_add_u32 s39, s39, 65536
  s_add_u32 s40, s40, 32768
  s_cmp_ge_u32 s40, 163840
  s_cselect_b32 s40, 0, s40
  s_cmp_lt_u32 s37, s36
  s_cselect_b32 s46, s38, 0x40000000
  s_cselect_b32 s47, s39, 0x40000000
  v_mfma_f32_16x16x32_bf16 v[36:39], a[56:59], a[20:23], v[36:39]
  s_add_u32 m0, s40, s52
  ds_read_b64_tr_b16 a[120:121], v72 offset:6144
  v_mfma_f32_16x16x32_bf16 v[40:43], a[40:43], a[8:11], 0
  ds_read_b64_tr_b16 a[122:123], v72 offset:7168
  buffer_load_dwordx4 v64, s[12:15], s46 offen offset:0 sc1 lds
  v_mfma_f32_16x16x32_bf16 v[40:43], a[56:59], a[24:27], v[40:43]
  ds_read_b64_tr_b16 a[124:125], v73 offset:6144
  v_mfma_f32_16x16x32_bf16 v[44:47], a[40:43], a[12:15], 0
  ds_read_b64_tr_b16 a[126:127], v73 offset:7168
  v_mfma_f32_16x16x32_bf16 v[44:47], a[56:59], a[28:31], v[44:47]
  ds_read_b128 a[80:83], v71 offset:1024
  buffer_load_dwordx4 v64, s[12:15], s46 offen offset:1024 sc1 lds
  v_mfma_f32_16x16x32_bf16 v[48:51], a[44:47], a[0:3], 0
  ds_read_b128 a[84:87], v71 offset:3072
  v_mfma_f32_16x16x32_bf16 v[48:51], a[60:63], a[16:19], v[48:51]
  ds_read_b128 a[88:91], v71 offset:5120
  buffer_load_dwordx4 v66, s[12:15], s46 offen offset:2048 sc1 lds
  v_mfma_f32_16x16x32_bf16 v[52:55], a[44:47], a[4:7], 0
  ds_read_b128 a[92:95], v71 offset:7168
  v_mfma_f32_16x16x32_bf16 v[52:55], a[60:63], a[20:23], v[52:55]
  v_mfma_f32_16x16x32_bf16 v[56:59], a[44:47], a[8:11], 0
  buffer_load_dwordx4 v66, s[12:15], s46 offen offset:3072 sc1 lds
  v_mfma_f32_16x16x32_bf16 v[56:59], a[60:63], a[24:27], v[56:59]
  v_mfma_f32_16x16x32_bf16 v[60:63], a[44:47], a[12:15], 0
  s_add_u32 m0, s40, s53
  v_mfma_f32_16x16x32_bf16 v[60:63], a[60:63], a[28:31], v[60:63]
  s_waitcnt lgkmcnt(15)
  buffer_load_dwordx4 v67, s[16:19], s47 offen offset:0  lds
  v_mfma_f32_16x16x32_bf16 v[0:3], a[96:99], a[64:67], v[0:3]
  s_waitcnt vmcnt(13)
  s_barrier
  s_waitcnt lgkmcnt(2)
  v_mfma_f32_16x16x32_bf16 v[0:3], a[112:115], a[80:83], v[0:3]
  v_add_u32 v71, s41, v74
  v_add_u32 v72, s41, v75
  buffer_load_dwordx4 v68, s[16:19], s47 offen offset:1024  lds
  v_mfma_f32_16x16x32_bf16 v[4:7], a[96:99], a[68:71], v[4:7]
  v_add_u32 v73, s41, v76
  s_add_u32 s41, s41, 32768
  v_mfma_f32_16x16x32_bf16 v[4:7], a[112:115], a[84:87], v[4:7]
  s_cmp_ge_u32 s41, 163840
  s_cselect_b32 s41, 0, s41
  ds_read_b64_tr_b16 a[32:33], v72 offset:0
  v_mfma_f32_16x16x32_bf16 v[8:11], a[96:99], a[72:75], v[8:11]
  s_waitcnt lgkmcnt(1)
  ds_read_b64_tr_b16 a[34:35], v72 offset:1024
  buffer_load_dwordx4 v69, s[16:19], s47 offen offset:2048  lds
  v_mfma_f32_16x16x32_bf16 v[8:11], a[112:115], a[88:91], v[8:11]
  ds_read_b64_tr_b16 a[36:37], v73 offset:0
  v_mfma_f32_16x16x32_bf16 v[12:15], a[96:99], a[76:79], v[12:15]
  s_add_u32 s37, s37, 1
  ds_read_b64_tr_b16 a[38:39], v73 offset:1024
  buffer_load_dwordx4 v70, s[16:19], s47 offen offset:3072  lds
  s_add_u32 s38, s38, 2048
  s_add_u32 s39, s39, 65536
  s_add_u32 s40, s40, 32768
  s_cmp_ge_u32 s40, 163840
  s_cselect_b32 s40, 0, s40
  v_mfma_f32_16x16x32_bf16 v[12:15], a[112:115], a[92:95], v[12:15]
  s_cmp_lt_u32 s37, s36
  s_cselect_b32 s46, s38, 0x40000000
  s_cselect_b32 s47, s39, 0x40000000
  ds_read_b64_tr_b16 a[40:41], v72 offset:4096
  v_mfma_f32_16x16x32_bf16 v[16:19], a[100:103], a[64:67], v[16:19]
  s_add_u32 m0, s40, s52
  ds_read_b64_tr_b16 a[42:43], v72 offset:5120
  v_mfma_f32_16x16x32_bf16 v[16:19], a[116:119], a[80:83], v[16:19]
  ds_read_b64_tr_b16 a[44:45], v73 offset:4096
  buffer_load_dwordx4 v64, s[12:15], s46 offen offset:0 sc1 lds
  v_mfma_f32_16x16x32_bf16 v[20:23], a[100:103], a[68:71], v[20:23]
  ds_read_b64_tr_b16 a[46:47], v73 offset:5120
  v_mfma_f32_16x16x32_bf16 v[20:23], a[116:119], a[84:87], v[20:23]
  ds_read_b128 a[0:3], v71 offset:0
  buffer_load_dwordx4 v64, s[12:15], s46 offen offset:1024 sc1 lds
  v_mfma_f32_16x16x32_bf16 v[24:27], a[100:103], a[72:75], v[24:27]
  ds_read_b128 a[4:7], v71 offset:2048
  v_mfma_f32_16x16x32_bf16 v[24:27], a[116:119], a[88:91], v[24:27]
  ds_read_b128 a[8:11], v71 offset:4096
  v_mfma_f32_16x16x32_bf16 v[28:31], a[100:103], a[76:79], v[28:31]
  ds_read_b128 a[12:15], v71 offset:6144
  buffer_load_dwordx4 v66, s[12:15], s46 offen offset:2048 sc1 lds
  v_mfma_f32_16x16x32_bf16 v[28:31], a[116:119], a[92:95], v[28:31]
  ds_read_b64_tr_b16 a[48:49], v72 offset:2048
  v_mfma_f32_16x16x32_bf16 v[32:35], a[104:107], a[64:67], v[32:35]
  ds_read_b64_tr_b16 a[50:51], v72 offset:3072
  v_mfma_f32_16x16x32_bf16 v[32:35], a[120:123], a[80:83], v[32:35]
  ds_read_b64_tr_b16 a[52:53], v73 offset:2048
  buffer_load_dwordx4 v66, s[12:15], s46 offen offset:3072 sc1 lds
  v_mfma_f32_16x16x32_bf16 v[36:39], a[104:107], a[68:71], v[36:39]
  s_add_u32 m0, s40, s53
  ds_read_b64_tr_b16 a[54:55], v73 offset:3072
  v_mfma_f32_16x16x32_bf16 v[36:39], a[120:123], a[84:87], v[36:39]
  ds_read_b64_tr_b16 a[56:57], v72 offset:6144
  buffer_load_dwordx4 v67, s[16:19], s47 offen offset:0  lds
  v_mfma_f32_16x16x32_bf16 v[40:43], a[104:107], a[72:75], v[40:43]
  ds_read_b64_tr_b16 a[58:59], v72 offset:7168
  v_mfma_f32_16x16x32_bf16 v[40:43], a[120:123], a[88:91], v[40:43]
  ds_read_b64_tr_b16 a[60:61], v73 offset:6144
  v_mfma_f32_16x16x32_bf16 v[44:47], a[104:107], a[76:79], v[44:47]
  ds_read_b64_tr_b16 a[62:63], v73 offset:7168
  buffer_load_dwordx4 v68, s[16:19], s47 offen offset:1024  lds
  v_mfma_f32_16x16x32_bf16 v[44:47], a[120:123], a[92:95], v[44:47]
  ds_read_b128 a[16:19], v71 offset:1024
  v_mfma_f32_16x16x32_bf16 v[48:51], a[108:111], a[64:67], v[48:51]
  ds_read_b128 a[20:23], v71 offset:3072
  buffer_load_dwordx4 v69, s[16:19], s47 offen offset:2048  lds
  v_mfma_f32_16x16x32_bf16 v[48:51], a[124:127], a[80:83], v[48:51]
  ds_read_b128 a[24:27], v71 offset:5120
  v_mfma_f32_16x16x32_bf16 v[52:55], a[108:111], a[68:71], v[52:55]
  ds_read_b128 a[28:31], v71 offset:7168
  v_mfma_f32_16x16x32_bf16 v[52:55], a[124:127], a[84:87], v[52:55]
  s_add_u32 s37, s37, 1
  buffer_load_dwordx4 v70, s[16:19], s47 offen offset:3072  lds
  s_add_u32 s38, s38, 2048
  s_add_u32 s39, s39, 65536
  s_add_u32 s40, s40, 32768
  s_cmp_ge_u32 s40, 163840
  s_cselect_b32 s40, 0, s40
  v_mfma_f32_16x16x32_bf16 v[56:59], a[108:111], a[72:75], v[56:59]
  v_mfma_f32_16x16x32_bf16 v[56:59], a[124:127], a[88:91], v[56:59]
  v_mfma_f32_16x16x32_bf16 v[60:63], a[108:111], a[76:79], v[60:63]
  v_mfma_f32_16x16x32_bf16 v[60:63], a[124:127], a[92:95], v[60:63]
  s_waitcnt lgkmcnt(0)
  s_waitcnt vmcnt(8)
  s_barrier
  s_lshr_b32 s42, s36, 1
  s_sub_u32 s42, s42, 1
L_loop3:
  v_mfma_f32_16x16x32_bf16 v[0:3], a[32:35], a[0:3], v[0:3]
  s_cmp_lt_u32 s37, s36
  s_cselect_b32 s46, s38, 0x40000000
  s_cselect_b32 s47, s39, 0x40000000
  v_add_u32 v71, s41, v74
  v_add_u32 v72, s41, v75
  s_add_u32 m0, s40, s52
  s_nop 0
  buffer_load_dwordx4 v64, s[12:15], s46 offen offset:0 sc1 lds
  v_mfma_f32_16x16x32_bf16 v[0:3], a[48:51], a[16:19], v[0:3]
  v_add_u32 v73, s41, v76
  s_add_u32 s41, s41, 32768
  v_mfma_f32_16x16x32_bf16 v[4:7], a[32:35], a[4:7], v[4:7]
  s_cmp_ge_u32 s41, 163840
  s_cselect_b32 s41, 0, s41
  v_mfma_f32_16x16x32_bf16 v[4:7], a[48:51], a[20:23], v[4:7]
  ds_read_b64_tr_b16 a[96:97], v72 offset:0
  buffer_load_dwordx4 v64, s[12:15], s46 offen offset:1024 sc1 lds
  v_mfma_f32_16x16x32_bf16 v[8:11], a[32:35], a[8:11], v[8:11]
  ds_read_b64_tr_b16 a[98:99], v72 offset:1024
  v_mfma_f32_16x16x32_bf16 v[8:11], a[48:51], a[24:27], v[8:11]
  ds_read_b64_tr_b16 a[100:101], v73 offset:0
  v_mfma_f32_16x16x32_bf16 v[12:15], a[32:35], a[12:15], v[12:15]
  ds_read_b64_tr_b16 a[102:103], v73 offset:1024
  v_mfma_f32_16x16x32_bf16 v[12:15], a[48:51], a[28:31], v[12:15]
  ds_read_b64_tr_b16 a[104:105], v72 offset:4096
  buffer_load_dwordx4 v66, s[12:15], s46 offen offset:2048 sc1 lds
  v_mfma_f32_16x16x32_bf16 v[16:19], a[36:39], a[0:3], v[16:19]
  ds_read_b64_tr_b16 a[106:107], v72 offset:5120
  v_mfma_f32_16x16x32_bf16 v[16:19], a[52:55], a[16:19], v[16:19]
  ds_read_b64_tr_b16 a[108:109], v73 offset:4096
  v_mfma_f32_16x16x32_bf16 v[20:23], a[36:39], a[4:7], v[20:23]
  ds_read_b64_tr_b16 a[110:111], v73 offset:5120
  v_mfma_f32_16x16x32_bf16 v[20:23], a[52:55], a[20:23], v[20:23]
  ds_read_b128 a[64:67], v71 offset:0
  buffer_load_dwordx4 v66, s[12:15], s46 offen offset:3072 sc1 lds
  v_mfma_f32_16x16x32_bf16 v[24:27], a[36:39], a[8:11], v[24:27]
  ds_read_b128 a[68:71], v71 offset:2048
  v_mfma_f32_16x16x32_bf16 v[24:27], a[52:55], a[24:27], v[24:27]
  ds_read_b128 a[72:75], v71 offset:4096
  v_mfma_f32_16x16x32_bf16 v[28:31], a[36:39], a[12:15], v[28:31]
  s_add_u32 m0, s40, s53
  ds_read_b128 a[76:79], v71 offset:6144
  v_mfma_f32_16x16x32_bf16 v[28:31], a[52:55], a[28:31], v[28:31]
  ds_read_b64_tr_b16 a[112:113], v72 offset:2048
  buffer_load_dwordx4 v67, s[16:19], s47 offen offset:0  lds
  v_mfma_f32_16x16x32_bf16 v[32:35], a[40:43], a[0:3], v[32:35]
  ds_read_b64_tr_b16 a[114:115], v72 offset:3072
  v_mfma_f32_16x16x32_bf16 v[32:35], a[56:59], a[16:19], v[32:35]
  ds_read_b64_tr_b16 a[116:117], v73 offset:2048
  v_mfma_f32_16x16x32_bf16 v[36:39], a[40:43], a[4:7], v[36:39]
  ds_read_b64_tr_b16 a[118:119], v73 offset:3072
  v_mfma_f32_16x16x32_bf16 v[36:39], a[56:59], a[20:23], v[36:39]
  ds_read_b64_tr_b16 a[120:121], v72 offset:6144
  buffer_load_dwordx4 v68, s[16:19], s47 offen offset:1024  lds
  v_mfma_f32_16x16x32_bf16 v[40:43], a[40:43], a[8:11], v[40:43]
  ds_read_b64_tr_b16 a[122:123], v72 offset:7168
  v_mfma_f32_16x16x32_bf16 v[40:43], a[56:59], a[24:27], v[40:43]
  ds_read_b64_tr_b16 a[124:125], v73 offset:6144
  v_mfma_f32_16x16x32_bf16 v[44:47], a[40:43], a[12:15], v[44:47]
  ds_read_b64_tr_b16 a[126:127], v73 offset:7168
  v_mfma_f32_16x16x32_bf16 v[44:47], a[56:59], a[28:31], v[44:47]
  ds_read_b128 a[80:83], v71 offset:1024
  buffer_load_dwordx4 v69, s[16:19], s47 offen offset:2048  lds
  v_mfma_f32_16x16x32_bf16 v[48:51], a[44:47], a[0:3], v[48:51]
  ds_read_b128 a[84:87], v71 offset:3072
  v_mfma_f32_16x16x32_bf16 v[48:51], a[60:63], a[16:19], v[48:51]
  ds_read_b128 a[88:91], v71 offset:5120
  v_mfma_f32_16x16x32_bf16 v[52:55], a[44:47], a[4:7], v[52:55]
  ds_read_b128 a[92:95], v71 offset:7168
  v_mfma_f32_16x16x32_bf16 v[52:55], a[60:63], a[20:23], v[52:55]
  s_add_u32 s37, s37, 1
  buffer_load_dwordx4 v70, s[16:19], s47 offen offset:3072  lds
  s_add_u32 s38, s38, 2048
  s_add_u32 s39, s39, 65536
  s_add_u32 s40, s40, 32768
  v_mfma_f32_16x16x32_bf16 v[56:59], a[44:47], a[8:11], v[56:59]
  s_cmp_ge_u32 s40, 163840
  s_cselect_b32 s40, 0, s40
  v_mfma_f32_16x16x32_bf16 v[56:59], a[60:63], a[24:27], v[56:59]
  s_cmp_lt_u32 s37, s36
  s_cselect_b32 s46, s38, 0x40000000
  s_cselect_b32 s47, s39, 0x40000000
  v_mfma_f32_16x16x32_bf16 v[60:63], a[44:47], a[12:15], v[60:63]
  s_add_u32 m0, s40, s52
  v_mfma_f32_16x16x32_bf16 v[60:63], a[60:63], a[28:31], v[60:63]
  s_waitcnt lgkmcnt(2)
  buffer_load_dwordx4 v64, s[12:15], s46 offen offset:0 sc1 lds
  v_mfma_f32_16x16x32_bf16 v[0:3], a[96:99], a[64:67], v[0:3]
  v_add_u32 v71, s41, v74
  v_add_u32 v72, s41, v75
  v_mfma_f32_16x16x32_bf16 v[0:3], a[112:115], a[80:83], v[0:3]
  v_add_u32 v73, s41, v76
  s_add_u32 s41, s41, 32768
  v_mfma_f32_16x16x32_bf16 v[4:7], a[96:99], a[68:71], v[4:7]
  s_cmp_ge_u32 s41, 163840
  s_cselect_b32 s41, 0, s41
  buffer_load_dwordx4 v64, s[12:15], s46 offen offset:1024 sc1 lds
  v_mfma_f32_16x16x32_bf16 v[4:7], a[112:115], a[84:87], v[4:7]
  ds_read_b64_tr_b16 a[32:33], v72 offset:0
  v_mfma_f32_16x16x32_bf16 v[8:11], a[96:99], a[72:75], v[8:11]
  s_waitcnt lgkmcnt(1)
  ds_read_b64_tr_b16 a[34:35], v72 offset:1024
  v_mfma_f32_16x16x32_bf16 v[8:11], a[112:115], a[88:91], v[8:11]
  ds_read_b64_tr_b16 a[36:37], v73 offset:0
  v_mfma_f32_16x16x32_bf16 v[12:15], a[96:99], a[76:79], v[12:15]
  ds_read_b64_tr_b16 a[38:39], v73 offset:1024
  buffer_load_dwordx4 v66, s[12:15], s46 offen offset:2048 sc1 lds
  v_mfma_f32_16x16x32_bf16 v[12:15], a[112:115], a[92:95], v[12:15]
  ds_read_b64_tr_b16 a[40:41], v72 offset:4096
  v_mfma_f32_16x16x32_bf16 v[16:19], a[100:103], a[64:67], v[16:19]
  ds_read_b64_tr_b16 a[42:43], v72 offset:5120
  v_mfma_f32_16x16x32_bf16 v[16:19], a[116:119], a[80:83], v[16:19]
  ds_read_b64_tr_b16 a[44:45], v73 offset:4096
  v_mfma_f32_16x16x32_bf16 v[20:23], a[100:103], a[68:71], v[20:23]
  ds_read_b64_tr_b16 a[46:47], v73 offset:5120
  buffer_load_dwordx4 v66, s[12:15], s46 offen offset:3072 sc1 lds
  v_mfma_f32_16x16x32_bf16 v[20:23], a[116:119], a[84:87], v[20:23]
  ds_read_b128 a[0:3], v71 offset:0
  v_mfma_f32_16x16x32_bf16 v[24:27], a[100:103], a[72:75], v[24:27]
  ds_read_b128 a[4:7], v71 offset:2048
  v_mfma_f32_16x16x32_bf16 v[24:27], a[116:119], a[88:91], v[24:27]
  s_add_u32 m0, s40, s53
  ds_read_b128 a[8:11], v71 offset:4096
  v_mfma_f32_16x16x32_bf16 v[28:31], a[100:103], a[76:79], v[28:31]
  ds_read_b128 a[12:15], v71 offset:6144
  buffer_load_dwordx4 v67, s[16:19], s47 offen offset:0  lds
  v_mfma_f32_16x16x32_bf16 v[28:31], a[116:119], a[92:95], v[28:31]
  ds_read_b64_tr_b16 a[48:49], v72 offset:2048
  v_mfma_f32_16x16x32_bf16 v[32:35], a[104:107], a[64:67], v[32:35]
  ds_read_b64_tr_b16 a[50:51], v72 offset:3072
  v_mfma_f32_16x16x32_bf16 v[32:35], a[120:123], a[80:83], v[32:35]
  ds_read_b64_tr_b16 a[52:53], v73 offset:2048
  v_mfma_f32_16x16x32_bf16 v[36:39], a[104:107], a[68:71], v[36:39]
  ds_read_b64_tr_b16 a[54:55], v73 offset:3072
  buffer_load_dwordx4 v68, s[16:19], s47 offen offset:1024  lds
  v_mfma_f32_16x16x32_bf16 v[36:39], a[120:123], a[84:87], v[36:39]
  ds_read_b64_tr_b16 a[56:57], v72 offset:6144
  v_mfma_f32_16x16x32_bf16 v[40:43], a[104:107], a[72:75], v[40:43]
  ds_read_b64_tr_b16 a[58:59], v72 offset:7168
  v_mfma_f32_16x16x32_bf16 v[40:43], a[120:123], a[88:91], v[40:43]
  ds_read_b64_tr_b16 a[60:61], v73 offset:6144
  v_mfma_f32_16x16x32_bf16 v[44:47], a[104:107], a[76:79], v[44:47]
  ds_read_b64_tr_b16 a[62:63], v73 offset:7168
  buffer_load_dwordx4 v69, s[16:19], s47 offen offset:2048  lds
  v_mfma_f32_16x16x32_bf16 v[44:47], a[120:123], a[92:95], v[44:47]
  ds_read_b128 a[16:19], v71 offset:1024
  v_mfma_f32_16x16x32_bf16 v[48:51], a[108:111], a[64:67], v[48:51]
  ds_read_b128 a[20:23], v71 offset:3072
  v_mfma_f32_16x16x32_bf16 v[48:51], a[124:127], a[80:83], v[48:51]
  ds_read_b128 a[24:27], v71 offset:5120
  v_mfma_f32_16x16x32_bf16 v[52:55], a[108:111], a[68:71], v[52:55]
  s_add_u32 s37, s37, 1
  ds_read_b128 a[28:31], v71 offset:7168
  buffer_load_dwordx4 v70, s[16:19], s47 offen offset:3072  lds
  s_add_u32 s38, s38, 2048
  s_add_u32 s39, s39, 65536
  s_add_u32 s40, s40, 32768
  s_cmp_ge_u32 s40, 163840
  s_cselect_b32 s40, 0, s40
  v_mfma_f32_16x16x32_bf16 v[52:55], a[124:127], a[84:87], v[52:55]
  v_mfma_f32_16x16x32_bf16 v[56:59], a[108:111], a[72:75], v[56:59]
  v_mfma_f32_16x16x32_bf16 v[56:59], a[124:127], a[88:91], v[56:59]
  v_mfma_f32_16x16x32_bf16 v[60:63], a[108:111], a[76:79], v[60:63]
  v_mfma_f32_16x16x32_bf16 v[60:63], a[124:127], a[92:95], v[60:63]
  s_waitcnt lgkmcnt(0)
  s_waitcnt vmcnt(8)
  s_barrier
  s_sub_u32 s42, s42, 1
  s_cmp_lg_u32 s42, 0
  s_cbranch_scc1 L_loop3
  s_waitcnt vmcnt(0)
  s_barrier
  v_lshrrev_b32 v81, 4, v64
  v_and_b32 v82, 15, v81
  v_lshlrev_b32 v82, 10, v82
  v_lshrrev_b32 v81, 4, v81
  v_lshlrev_b32 v81, 3, v81
  v_add_u32 v81, v81, v82
  s_lshl_b32 s54, s33, 7
  s_lshl_b32 s46, s32, 5
  s_add_u32 s54, s54, s46
  s_lshl_b32 s54, s54, 10
  s_lshl_b32 s46, s34, 8
  s_add_u32 s54, s54, s46
  s_lshl_b32 s46, s35, 6
  s_add_u32 s54, s54, s46
  s_add_u32 s46, s54, 0
  buffer_load_dwordx2 v[90:91], v81, s[24:27], s46 offen offset:0
  s_add_u32 s46, s54, 0
  buffer_load_dwordx2 v[92:93], v81, s[24:27], s46 offen offset:32
  s_add_u32 s46, s54, 16384
  buffer_load_dwordx2 v[94:95], v81, s[24:27], s46 offen offset:0
  s_add_u32 s46, s54, 16384
  buffer_load_dwordx2 v[96:97], v81, s[24:27], s46 offen offset:32
  s_lshl_b32 s44, s48, 17
  s_lshl_b32 s45, s32, 13
  s_add_u32 s44, s44, s45
  s_and_b32 s45, s35, 1
  s_lshl_b32 s45, s45, 11
  s_add_u32 s44, s44, s45
  s_lshr_b32 s46, s35, 1
  s_lshl_b32 s46, s46, 1
  s_nop 4
  s_and_b32 s45, s35, 1
  s_lshl_b32 s45, s45, 12
  v_add_u32 v80, s45, v64
  s_add_u32 s47, s46, 0
  s_cmp_eq_u32 s47, s32
  s_cbranch_scc1 L_own0
  s_lshl_b32 s47, s47, 15
  s_add_u32 s47, s47, s44
  s_add_u32 s42, s47, 0
  v_cvt_pk_bf16_f32 v104, v0, v1
  v_cvt_pk_bf16_f32 v105, v2, v3
  v_cvt_pk_bf16_f32 v106, v16, v17
  v_cvt_pk_bf16_f32 v107, v18, v19
  buffer_store_dwordx4 v[104:107], v64, s[20:23], s42 offen offset:0 sc1
  v_cvt_pk_bf16_f32 v108, v32, v33
  v_cvt_pk_bf16_f32 v109, v34, v35
  v_cvt_pk_bf16_f32 v110, v48, v49
  v_cvt_pk_bf16_f32 v111, v50, v51
  buffer_store_dwordx4 v[108:111], v64, s[20:23], s42 offen offset:1024 sc1
  s_add_u32 s42, s47, 4096
  v_cvt_pk_bf16_f32 v112, v4, v5
  v_cvt_pk_bf16_f32 v113, v6, v7
  v_cvt_pk_bf16_f32 v114, v20, v21
  v_cvt_pk_bf16_f32 v115, v22, v23
  buffer_store_dwordx4 v[112:115], v64, s[20:23], s42 offen offset:0 sc1
  v_cvt_pk_bf16_f32 v116, v36, v37
  v_cvt_pk_bf16_f32 v117, v38, v39
  v_cvt_pk_bf16_f32 v118, v52, v53
  v_cvt_pk_bf16_f32 v119, v54, v55
  buffer_store_dwordx4 v[116:119], v64, s[20:23], s42 offen offset:1024 sc1
  s_branch L_done0
L_own0:
  ds_write_b128 v80, v[0:3] offset:0
  ds_write_b128 v80, v[16:19] offset:1024
  ds_write_b128 v80, v[32:35] offset:2048
  ds_write_b128 v80, v[48:51] offset:3072
  ds_write_b128 v80, v[4:7] offset:8192
  ds_write_b128 v80, v[20:23] offset:9216
  ds_write_b128 v80, v[36:39] offset:10240
  ds_write_b128 v80, v[52:55] offset:11264
L_done0:
  s_add_u32 s47, s46, 1
  s_cmp_eq_u32 s47, s32
  s_cbranch_scc1 L_own1
  s_lshl_b32 s47, s47, 15
  s_add_u32 s47, s47, s44
  s_add_u32 s42, s47, 0
  v_cvt_pk_bf16_f32 v104, v8, v9
  v_cvt_pk_bf16_f32 v105, v10, v11
  v_cvt_pk_bf16_f32 v106, v24, v25
  v_cvt_pk_bf16_f32 v107, v26, v27
  buffer_store_dwordx4 v[104:107], v64, s[20:23], s42 offen offset:0 sc1
  v_cvt_pk_bf16_f32 v108, v40, v41
  v_cvt_pk_bf16_f32 v109, v42, v43
  v_cvt_pk_bf16_f32 v110, v56, v57
  v_cvt_pk_bf16_f32 v111, v58, v59
  buffer_store_dwordx4 v[108:111], v64, s[20:23], s42 offen offset:1024 sc1
  s_add_u32 s42, s47, 4096
  v_cvt_pk_bf16_f32 v112, v12, v13
  v_cvt_pk_bf16_f32 v113, v14, v15
  v_cvt_pk_bf16_f32 v114, v28, v29
  v_cvt_pk_bf16_f32 v115, v30, v31
  buffer_store_dwordx4 v[112:115], v64, s[20:23], s42 offen offset:0 sc1
  v_cvt_pk_bf16_f32 v116, v44, v45
  v_cvt_pk_bf16_f32 v117, v46, v47
  v_cvt_pk_bf16_f32 v118, v60, v61
  v_cvt_pk_bf16_f32 v119, v62, v63
  buffer_store_dwordx4 v[116:119], v64, s[20:23], s42 offen offset:1024 sc1
  s_branch L_done1
L_own1:
  ds_write_b128 v80, v[8:11] offset:0
  ds_write_b128 v80, v[24:27] offset:1024
  ds_write_b128 v80, v[40:43] offset:2048
  ds_write_b128 v80, v[56:59] offset:3072
  ds_write_b128 v80, v[12:15] offset:8192
  ds_write_b128 v80, v[28:31] offset:9216
  ds_write_b128 v80, v[44:47] offset:10240
  ds_write_b128 v80, v[60:63] offset:11264
L_done1:
  s_waitcnt vmcnt(0) lgkmcnt(0)
  s_barrier
  s_cmp_lg_u32 s35, 0
  s_cbranch_scc1 L_wait_done
  s_lshl_b32 s44, s48, 7
  s_lshl_b32 s45, s32, 2
  s_add_u32 s45, s45, s44
  v_mov_b32 v82, s44
  v_mov_b32 v83, s45
  v_mov_b32 v84, 1
  s_mov_b64 s[62:63], exec
  s_mov_b64 exec, 1
  buffer_store_dword v84, v83, s[88:91], 0 offen sc1
L_poll:
  buffer_load_dwordx4 v[104:107], v82, s[88:91], 0 offen sc1
  s_waitcnt vmcnt(0)
  v_and_b32 v104, v104, v105
  v_and_b32 v106, v106, v107
  v_and_b32 v104, v104, v106
  s_nop 0
  v_readfirstlane_b32 s45, v104
  s_nop 1
  s_cmp_eq_u32 s45, 1
  s_cbranch_scc1 L_poll_done
  s_branch L_poll
L_poll_done:
  s_mov_b64 exec, s[62:63]
L_wait_done:
  s_barrier
  s_lshl_b32 s44, s48, 17
  s_lshl_b32 s45, s32, 15
  s_add_u32 s44, s44, s45
  s_lshl_b32 s45, s35, 10
  s_add_u32 s44, s44, s45
  s_add_u32 s46, s32, 1
  s_and_b32 s46, s46, 3
  s_lshl_b32 s46, s46, 13
  s_add_u32 s46, s46, s44
  buffer_load_dwordx4 v[16:19], v64, s[20:23], s46 offen sc1
  s_add_u32 s46, s46, 4096
  buffer_load_dwordx4 v[20:23], v64, s[20:23], s46 offen sc1
  s_add_u32 s46, s32, 2
  s_and_b32 s46, s46, 3
  s_lshl_b32 s46, s46, 13
  s_add_u32 s46, s46, s44
  buffer_load_dwordx4 v[24:27], v64, s[20:23], s46 offen sc1
  s_add_u32 s46, s46, 4096
  buffer_load_dwordx4 v[28:31], v64, s[20:23], s46 offen sc1
  s_add_u32 s46, s32, 3
  s_and_b32 s46, s46, 3
  s_lshl_b32 s46, s46, 13
  s_add_u32 s46, s46, s44
  buffer_load_dwordx4 v[32:35], v64, s[20:23], s46 offen sc1
  s_add_u32 s46, s46, 4096
  buffer_load_dwordx4 v[36:39], v64, s[20:23], s46 offen sc1
  s_lshl_b32 s45, s35, 11
  v_add_u32 v80, s45, v64
  ds_read_b128 v[0:3], v80 offset:0
  ds_read_b128 v[4:7], v80 offset:1024
  ds_read_b128 v[8:11], v80 offset:8192
  ds_read_b128 v[12:15], v80 offset:9216
  v_lshlrev_b32 v84, 16, v90
  v_and_b32 v85, 0xffff0000, v90
  v_lshlrev_b32 v86, 16, v91
  v_and_b32 v87, 0xffff0000, v91
  s_waitcnt lgkmcnt(3)
  v_add_f32 v0, v0, v84
  v_add_f32 v1, v1, v85
  v_add_f32 v2, v2, v86
  v_add_f32 v3, v3, v87
  v_lshlrev_b32 v84, 16, v92
  v_and_b32 v85, 0xffff0000, v92
  v_lshlrev_b32 v86, 16, v93
  v_and_b32 v87, 0xffff0000, v93
  s_waitcnt lgkmcnt(2)
  v_add_f32 v4, v4, v84
  v_add_f32 v5, v5, v85
  v_add_f32 v6, v6, v86
  v_add_f32 v7, v7, v87
  v_lshlrev_b32 v84, 16, v94
  v_and_b32 v85, 0xffff0000, v94
  v_lshlrev_b32 v86, 16, v95
  v_and_b32 v87, 0xffff0000, v95
  s_waitcnt lgkmcnt(1)
  v_add_f32 v8, v8, v84
  v_add_f32 v9, v9, v85
  v_add_f32 v10, v10, v86
  v_add_f32 v11, v11, v87
  v_lshlrev_b32 v84, 16, v96
  v_and_b32 v85, 0xffff0000, v96
  v_lshlrev_b32 v86, 16, v97
  v_and_b32 v87, 0xffff0000, v97
  s_waitcnt lgkmcnt(0)
  v_add_f32 v12, v12, v84
  v_add_f32 v13, v13, v85
  v_add_f32 v14, v14, v86
  v_add_f32 v15, v15, v87
  s_waitcnt vmcnt(5)
  v_lshlrev_b32 v84, 16, v16
  v_and_b32 v85, 0xffff0000, v16
  v_lshlrev_b32 v86, 16, v17
  v_and_b32 v87, 0xffff0000, v17
  v_add_f32 v0, v0, v84
  v_add_f32 v1, v1, v85
  v_add_f32 v2, v2, v86
  v_add_f32 v3, v3, v87
  s_waitcnt vmcnt(3)
  v_lshlrev_b32 v84, 16, v24
  v_and_b32 v85, 0xffff0000, v24
  v_lshlrev_b32 v86, 16, v25
  v_and_b32 v87, 0xffff0000, v25
  v_add_f32 v0, v0, v84
  v_add_f32 v1, v1, v85
  v_add_f32 v2, v2, v86
  v_add_f32 v3, v3, v87
  s_waitcnt vmcnt(1)
  v_lshlrev_b32 v84, 16, v32
  v_and_b32 v85, 0xffff0000, v32
  v_lshlrev_b32 v86, 16, v33
  v_and_b32 v87, 0xffff0000, v33
  v_add_f32 v0, v0, v84
  v_add_f32 v1, v1, v85
  v_add_f32 v2, v2, v86
  v_add_f32 v3, v3, v87
  v_cvt_pk_bf16_f32 v90, v0, v1
  v_cvt_pk_bf16_f32 v91, v2, v3
  s_add_u32 s46, s54, 0
  buffer_store_dwordx2 v[90:91], v81, s[28:31], s46 offen offset:0
  v_lshlrev_b32 v84, 16, v18
  v_and_b32 v85, 0xffff0000, v18
  v_lshlrev_b32 v86, 16, v19
  v_and_b32 v87, 0xffff0000, v19
  v_add_f32 v4, v4, v84
  v_add_f32 v5, v5, v85
  v_add_f32 v6, v6, v86
  v_add_f32 v7, v7, v87
  v_lshlrev_b32 v84, 16, v26
  v_and_b32 v85, 0xffff0000, v26
  v_lshlrev_b32 v86, 16, v27
  v_and_b32 v87, 0xffff0000, v27
  v_add_f32 v4, v4, v84
  v_add_f32 v5, v5, v85
  v_add_f32 v6, v6, v86
  v_add_f32 v7, v7, v87
  v_lshlrev_b32 v84, 16, v34
  v_and_b32 v85, 0xffff0000, v34
  v_lshlrev_b32 v86, 16, v35
  v_and_b32 v87, 0xffff0000, v35
  v_add_f32 v4, v4, v84
  v_add_f32 v5, v5, v85
  v_add_f32 v6, v6, v86
  v_add_f32 v7, v7, v87
  v_cvt_pk_bf16_f32 v92, v4, v5
  v_cvt_pk_bf16_f32 v93, v6, v7
  s_add_u32 s46, s54, 0
  buffer_store_dwordx2 v[92:93], v81, s[28:31], s46 offen offset:32
  v_lshlrev_b32 v84, 16, v20
  v_and_b32 v85, 0xffff0000, v20
  v_lshlrev_b32 v86, 16, v21
  v_and_b32 v87, 0xffff0000, v21
  v_add_f32 v8, v8, v84
  v_add_f32 v9, v9, v85
  v_add_f32 v10, v10, v86
  v_add_f32 v11, v11, v87
  v_lshlrev_b32 v84, 16, v28
  v_and_b32 v85, 0xffff0000, v28
  v_lshlrev_b32 v86, 16, v29
  v_and_b32 v87, 0xffff0000, v29
  v_add_f32 v8, v8, v84
  v_add_f32 v9, v9, v85
  v_add_f32 v10, v10, v86
  v_add_f32 v11, v11, v87
  s_waitcnt vmcnt(2)
  v_lshlrev_b32 v84, 16, v36
  v_and_b32 v85, 0xffff0000, v36
  v_lshlrev_b32 v86, 16, v37
  v_and_b32 v87, 0xffff0000, v37
  v_add_f32 v8, v8, v84
  v_add_f32 v9, v9, v85
  v_add_f32 v10, v10, v86
  v_add_f32 v11, v11, v87
  v_cvt_pk_bf16_f32 v94, v8, v9
  v_cvt_pk_bf16_f32 v95, v10, v11
  s_add_u32 s46, s54, 16384
  buffer_store_dwordx2 v[94:95], v81, s[28:31], s46 offen offset:0
  v_lshlrev_b32 v84, 16, v22
  v_and_b32 v85, 0xffff0000, v22
  v_lshlrev_b32 v86, 16, v23
  v_and_b32 v87, 0xffff0000, v23
  v_add_f32 v12, v12, v84
  v_add_f32 v13, v13, v85
  v_add_f32 v14, v14, v86
  v_add_f32 v15, v15, v87
  v_lshlrev_b32 v84, 16, v30
  v_and_b32 v85, 0xffff0000, v30
  v_lshlrev_b32 v86, 16, v31
  v_and_b32 v87, 0xffff0000, v31
  v_add_f32 v12, v12, v84
  v_add_f32 v13, v13, v85
  v_add_f32 v14, v14, v86
  v_add_f32 v15, v15, v87
  v_lshlrev_b32 v84, 16, v38
  v_and_b32 v85, 0xffff0000, v38
  v_lshlrev_b32 v86, 16, v39
  v_and_b32 v87, 0xffff0000, v39
  v_add_f32 v12, v12, v84
  v_add_f32 v13, v13, v85
  v_add_f32 v14, v14, v86
  v_add_f32 v15, v15, v87
  v_cvt_pk_bf16_f32 v96, v12, v13
  v_cvt_pk_bf16_f32 v97, v14, v15
  s_add_u32 s46, s54, 16384
  buffer_store_dwordx2 v[96:97], v81, s[28:31], s46 offen offset:32
L_end_out_kernel:
L_end_kv_kernel:
L_end_attn_kernel:
  s_endpgm
.p2align 8
.fill 16384, 4, 0xBF810000
.section .rodata,"a"
.p2align 6
.amdhsa_kernel parallel_sum__compressed_kv_cla__glu_gated_swiglu__prompt_kernel
  .amdhsa_next_free_vgpr 512
  .amdhsa_next_free_sgpr 102
  .amdhsa_accum_offset 256
  .amdhsa_group_segment_fixed_size 0
  .amdhsa_kernarg_size 104
  .amdhsa_user_sgpr_count 2
  .amdhsa_user_sgpr_kernarg_segment_ptr 1
  .amdhsa_system_sgpr_workgroup_id_x 1
  .amdhsa_float_denorm_mode_32 3
.end_amdhsa_kernel
```
